```python
import torch

def _softmax(x, axis=-1):
    return torch.softmax(x, dim=axis)

def _gelu(x):
    return torch.nn.functional.gelu(x, approximate='tanh')

def _silu(x):
    return torch.nn.functional.silu(x)

def _sigmoid(x):
    return torch.sigmoid(x)

def _layernorm(x, axis=-1, eps=1e-05):
    m = x.mean(dim=axis, keepdim=True)
    v = x.var(dim=axis, keepdim=True, unbiased=False)
    return (x - m) / torch.sqrt(v + eps)

def _scatter_add(tgt, idx, src, axis=0):
    return tgt.clone().index_add_(axis, idx, src)

def _segment_sum(src, seg, n):
    out = torch.zeros((n,) + src.shape[1:], dtype=src.dtype)
    return out.index_add_(0, seg, src)

def _pad(x, pw):
    flat = tuple((v for pair in reversed(pw) for v in pair))
    return torch.nn.functional.pad(x, flat)
kernel_name = 'adaLN_cond__memory_aug_recurrent_mem_tr__mixer_token_mlp__prompt'

def setup_inputs():

    _w = lambda a: (lambda t: t.to(torch.bfloat16) if t.is_floating_point() else t)(torch.as_tensor(a))

    def _A_setup():
        B, S, Dm = (1, 2048, 640)
        H, Dh = (32, 128)
        M, seg = (8, 32)
        seg = min(seg, S)
        S = S // seg * seg
        return {'x': _w((lambda *s: torch.randn(*s, dtype=torch.bfloat16) * 0.05)(B, S, Dm)), 'mem0': _w((lambda *s: torch.randn(*s, dtype=torch.bfloat16) * 0.8)(B, M, Dm)), 'Wq': _w((lambda *s: torch.randn(*s, dtype=torch.bfloat16) * 1.6)(Dm, H, Dh) * Dm ** (-0.5)), 'Wk': _w((lambda *s: torch.randn(*s, dtype=torch.bfloat16) * 1.6)(Dm, H, Dh) * Dm ** (-0.5)), 'Wv': _w((lambda *s: torch.randn(*s, dtype=torch.bfloat16) * 0.8)(Dm, H, Dh) * Dm ** (-0.5)), 'Wo': _w((lambda *s: torch.randn(*s, dtype=torch.bfloat16) * 0.8)(H, Dh, Dm) * (H * Dh) ** (-0.5)), 'seg_len': seg}
    _A_in = _A_setup()

    def _B_setup():
        B, S, D, F = (1, 2048, 640, 1728)
        return {'x': _w((lambda *s: torch.randn(*s, dtype=torch.bfloat16) * 0.05)(B, S, D)), 'w1': _w((lambda *s: torch.randn(*s, dtype=torch.bfloat16) * 1.6)(S, F) * S ** (-0.5)), 'b1': _w((lambda *s: torch.randn(*s, dtype=torch.bfloat16) * 1.6)(F) * 0.02), 'w2': _w((lambda *s: torch.randn(*s, dtype=torch.bfloat16) * 0.2)(F, S) * F ** (-0.5)), 'b2': _w((lambda *s: torch.randn(*s, dtype=torch.bfloat16) * 0.2)(S) * 0.02)}
    _B_in = _B_setup()
    return {'A_x': _A_in['x'], 'A_mem0': _A_in['mem0'], 'A_Wq': _A_in['Wq'], 'A_Wk': _A_in['Wk'], 'A_Wv': _A_in['Wv'], 'A_Wo': _A_in['Wo'], 'A_seg_len': _A_in['seg_len'], 'B_x': _B_in['x'], 'B_w1': _B_in['w1'], 'B_b1': _B_in['b1'], 'B_w2': _B_in['w2'], 'B_b2': _B_in['b2'], 'c': _w((lambda *s: torch.randn(*s, dtype=torch.bfloat16) * 0.05)(1, 640) * 8.0), 'w_mod': _w((lambda *s: torch.randn(*s, dtype=torch.bfloat16) * 0.05)(640, 6 * 640) * 640 ** (-0.5) * 8.0)}

def reference(A_x, A_mem0, A_Wq, A_Wk, A_Wv, A_Wo, A_seg_len, B_x, B_w1, B_b1, B_w2, B_b2, c, w_mod):

    def _A_ref(x, mem0, Wq, Wk, Wv, Wo, seg_len):
        B, S, Dm = x.shape
        H, Dh = (Wq.shape[1], Wq.shape[2])
        M = mem0.shape[1]
        scale = Dh ** (-0.5)
        n_seg = S // seg_len
        L = M + seg_len
        idx = torch.arange(L)
        mask = (idx[:, None] < M) | (idx[:, None] >= idx[None, :])
        mem = mem0
        outs = []
        for s in range(n_seg):
            xs = x[:, s * seg_len:(s + 1) * seg_len, :].clone()
            h = torch.concatenate([mem, xs], axis=1)
            q = torch.einsum('btd,dhe->bhte', h, Wq)
            k = torch.einsum('btd,dhe->bhte', h, Wk)
            v = torch.einsum('btd,dhe->bhte', h, Wv)
            scores = torch.einsum('bhqe,bhke->bhqk', q, k) * scale
            scores = torch.where(mask[None, None], scores, -1000000000.0)
            p = _softmax(scores, axis=-1)
            o = torch.einsum('bhqk,bhke->bhqe', p, v)
            o = torch.einsum('bhte,hed->btd', o, Wo)
            mem = o[:, :M, :].clone()
            outs.append(o[:, M:, :])
        return torch.concatenate(outs, axis=1)

    def _B_ref(x, w1, b1, w2, b2):
        B, S, D = x.shape
        h = _layernorm(x, axis=-1)
        u = torch.einsum('bsd,sf->bdf', h, w1) + b1
        u = _gelu(u)
        y = torch.einsum('bdf,fs->bds', u, w2) + b2
        return (lambda x, *d: x.permute(*d))(y, 0, 2, 1)
    x = A_x
    mod = (_silu(c) @ w_mod).reshape(c.shape[0], 6, 1, -1)
    sa, ca, ga, sb, cb, gb = (mod[:, 0].clone(), mod[:, 1].clone(), mod[:, 2].clone(), mod[:, 3].clone(), mod[:, 4].clone(), mod[:, 5].clone())
    h = _layernorm(x, axis=-1) * (1 + ca) + sa
    x = x + ga * _A_ref(h, A_mem0, A_Wq, A_Wk, A_Wv, A_Wo, A_seg_len)
    h = _layernorm(x, axis=-1) * (1 + cb) + sb
    x = x + gb * _B_ref(h, B_w1, B_b1, B_w2, B_b2)
    return x
```

```asm
; @launch kernel=main_kernel grid=(256,1,1) block=(256,1,1) lds=163840
.amdgcn_target "amdgcn-amd-amdhsa--gfx950"
.text
.globl main_kernel
.p2align 8
.type main_kernel,@function
main_kernel:
    s_cmp_ge_u32 s2, 256
    s_cbranch_scc1 main_kernel_xtra
    s_and_b32 s20, s2, 7
    s_cmp_lt_u32 s20, 2
    s_cbranch_scc1 L_early_1
    s_lshr_b32 s21, s2, 3
    s_mul_i32 s21, s21, 6
    s_add_u32 s20, s20, s21
    s_sub_u32 s20, s20, 2
    s_cmp_ge_u32 s20, 21
    s_cbranch_scc1 L_early_1
    s_load_dwordx2 s[30:31], s[0:1], 120
    s_mov_b32 s22, 128
    s_cmp_eq_u32 s20, 20
    s_cbranch_scc1 L_early_zero_2
    s_load_dwordx2 s[4:5], s[0:1], 128
    s_load_dwordx2 s[8:9], s[0:1], 96
    s_load_dwordx2 s[12:13], s[0:1], 104
    v_and_b32 v1, 63, v0
    v_lshrrev_b32 v2, 6, v0
    v_lshrrev_b32 v3, 3, v1
    v_lshl_add_u32 v3, v2, 3, v3
    v_and_b32 v4, 7, v1
    s_waitcnt lgkmcnt(0)
    s_and_b32 s5, s5, 0xffff
    s_mov_b32 s6, 268435456
    s_mov_b32 s7, 0x20000
    s_and_b32 s9, s9, 0xffff
    s_mov_b32 s10, 1280
    s_mov_b32 s11, 0x20000
    s_and_b32 s13, s13, 0xffff
    s_mov_b32 s14, 4915200
    s_mov_b32 s15, 0x20000
    s_movk_i32 s16, 7680
    v_mul_lo_u32 v5, v3, s16
    v_lshl_add_u32 v5, v4, 4, v5
    s_lshl_b32 s17, s20, 7
    v_lshlrev_b32 v6, 1, v3
    buffer_load_ushort v100, v6, s[8:11], 0 offen offset:0
    buffer_load_ushort v101, v6, s[8:11], 0 offen offset:64
    buffer_load_ushort v102, v6, s[8:11], 0 offen offset:128
    buffer_load_ushort v103, v6, s[8:11], 0 offen offset:192
    buffer_load_ushort v104, v6, s[8:11], 0 offen offset:256
    buffer_load_ushort v105, v6, s[8:11], 0 offen offset:320
    buffer_load_ushort v106, v6, s[8:11], 0 offen offset:384
    buffer_load_ushort v107, v6, s[8:11], 0 offen offset:448
    buffer_load_ushort v108, v6, s[8:11], 0 offen offset:512
    buffer_load_ushort v109, v6, s[8:11], 0 offen offset:576
    buffer_load_ushort v110, v6, s[8:11], 0 offen offset:640
    buffer_load_ushort v111, v6, s[8:11], 0 offen offset:704
    buffer_load_ushort v112, v6, s[8:11], 0 offen offset:768
    buffer_load_ushort v113, v6, s[8:11], 0 offen offset:832
    buffer_load_ushort v114, v6, s[8:11], 0 offen offset:896
    buffer_load_ushort v115, v6, s[8:11], 0 offen offset:960
    buffer_load_ushort v116, v6, s[8:11], 0 offen offset:1024
    buffer_load_ushort v117, v6, s[8:11], 0 offen offset:1088
    buffer_load_ushort v118, v6, s[8:11], 0 offen offset:1152
    buffer_load_ushort v119, v6, s[8:11], 0 offen offset:1216
    buffer_load_dwordx4 v[20:23], v5, s[12:15], s17 offen
    s_add_u32 s17, s17, 245760
    buffer_load_dwordx4 v[24:27], v5, s[12:15], s17 offen
    s_add_u32 s17, s17, 245760
    buffer_load_dwordx4 v[28:31], v5, s[12:15], s17 offen
    s_add_u32 s17, s17, 245760
    buffer_load_dwordx4 v[32:35], v5, s[12:15], s17 offen
    s_add_u32 s17, s17, 245760
    buffer_load_dwordx4 v[36:39], v5, s[12:15], s17 offen
    s_add_u32 s17, s17, 245760
    buffer_load_dwordx4 v[40:43], v5, s[12:15], s17 offen
    s_add_u32 s17, s17, 245760
    buffer_load_dwordx4 v[44:47], v5, s[12:15], s17 offen
    s_add_u32 s17, s17, 245760
    buffer_load_dwordx4 v[48:51], v5, s[12:15], s17 offen
    s_add_u32 s17, s17, 245760
    buffer_load_dwordx4 v[52:55], v5, s[12:15], s17 offen
    s_add_u32 s17, s17, 245760
    buffer_load_dwordx4 v[56:59], v5, s[12:15], s17 offen
    s_add_u32 s17, s17, 245760
    buffer_load_dwordx4 v[60:63], v5, s[12:15], s17 offen
    s_add_u32 s17, s17, 245760
    buffer_load_dwordx4 v[64:67], v5, s[12:15], s17 offen
    s_add_u32 s17, s17, 245760
    buffer_load_dwordx4 v[68:71], v5, s[12:15], s17 offen
    s_add_u32 s17, s17, 245760
    buffer_load_dwordx4 v[72:75], v5, s[12:15], s17 offen
    s_add_u32 s17, s17, 245760
    buffer_load_dwordx4 v[76:79], v5, s[12:15], s17 offen
    s_add_u32 s17, s17, 245760
    buffer_load_dwordx4 v[80:83], v5, s[12:15], s17 offen
    s_add_u32 s17, s17, 245760
    buffer_load_dwordx4 v[84:87], v5, s[12:15], s17 offen
    s_add_u32 s17, s17, 245760
    buffer_load_dwordx4 v[88:91], v5, s[12:15], s17 offen
    s_add_u32 s17, s17, 245760
    buffer_load_dwordx4 v[92:95], v5, s[12:15], s17 offen
    s_add_u32 s17, s17, 245760
    buffer_load_dwordx4 v[96:99], v5, s[12:15], s17 offen
    s_add_u32 s17, s17, 245760
    v_mov_b32 v10, 0
    v_mov_b32 v11, 0
    v_mov_b32 v12, 0
    v_mov_b32 v13, 0
    v_mov_b32 v14, 0
    v_mov_b32 v15, 0
    v_mov_b32 v16, 0
    v_mov_b32 v17, 0
    s_waitcnt vmcnt(20)
    v_lshlrev_b32 v100, 16, v100
    v_mul_f32 v7, 0xbfb8aa3b, v100
    v_exp_f32 v7, v7
    s_nop 0
    v_add_f32 v7, 1.0, v7
    v_rcp_f32 v7, v7
    s_nop 0
    v_mul_f32 v100, v100, v7
    v_cvt_pk_bf16_f32 v100, v100, v100
    v_and_b32 v100, 0xffff0000, v100
    v_lshlrev_b32 v101, 16, v101
    v_mul_f32 v7, 0xbfb8aa3b, v101
    v_exp_f32 v7, v7
    s_nop 0
    v_add_f32 v7, 1.0, v7
    v_rcp_f32 v7, v7
    s_nop 0
    v_mul_f32 v101, v101, v7
    v_cvt_pk_bf16_f32 v101, v101, v101
    v_and_b32 v101, 0xffff0000, v101
    v_lshlrev_b32 v102, 16, v102
    v_mul_f32 v7, 0xbfb8aa3b, v102
    v_exp_f32 v7, v7
    s_nop 0
    v_add_f32 v7, 1.0, v7
    v_rcp_f32 v7, v7
    s_nop 0
    v_mul_f32 v102, v102, v7
    v_cvt_pk_bf16_f32 v102, v102, v102
    v_and_b32 v102, 0xffff0000, v102
    v_lshlrev_b32 v103, 16, v103
    v_mul_f32 v7, 0xbfb8aa3b, v103
    v_exp_f32 v7, v7
    s_nop 0
    v_add_f32 v7, 1.0, v7
    v_rcp_f32 v7, v7
    s_nop 0
    v_mul_f32 v103, v103, v7
    v_cvt_pk_bf16_f32 v103, v103, v103
    v_and_b32 v103, 0xffff0000, v103
    v_lshlrev_b32 v104, 16, v104
    v_mul_f32 v7, 0xbfb8aa3b, v104
    v_exp_f32 v7, v7
    s_nop 0
    v_add_f32 v7, 1.0, v7
    v_rcp_f32 v7, v7
    s_nop 0
    v_mul_f32 v104, v104, v7
    v_cvt_pk_bf16_f32 v104, v104, v104
    v_and_b32 v104, 0xffff0000, v104
    v_lshlrev_b32 v105, 16, v105
    v_mul_f32 v7, 0xbfb8aa3b, v105
    v_exp_f32 v7, v7
    s_nop 0
    v_add_f32 v7, 1.0, v7
    v_rcp_f32 v7, v7
    s_nop 0
    v_mul_f32 v105, v105, v7
    v_cvt_pk_bf16_f32 v105, v105, v105
    v_and_b32 v105, 0xffff0000, v105
    v_lshlrev_b32 v106, 16, v106
    v_mul_f32 v7, 0xbfb8aa3b, v106
    v_exp_f32 v7, v7
    s_nop 0
    v_add_f32 v7, 1.0, v7
    v_rcp_f32 v7, v7
    s_nop 0
    v_mul_f32 v106, v106, v7
    v_cvt_pk_bf16_f32 v106, v106, v106
    v_and_b32 v106, 0xffff0000, v106
    v_lshlrev_b32 v107, 16, v107
    v_mul_f32 v7, 0xbfb8aa3b, v107
    v_exp_f32 v7, v7
    s_nop 0
    v_add_f32 v7, 1.0, v7
    v_rcp_f32 v7, v7
    s_nop 0
    v_mul_f32 v107, v107, v7
    v_cvt_pk_bf16_f32 v107, v107, v107
    v_and_b32 v107, 0xffff0000, v107
    v_lshlrev_b32 v108, 16, v108
    v_mul_f32 v7, 0xbfb8aa3b, v108
    v_exp_f32 v7, v7
    s_nop 0
    v_add_f32 v7, 1.0, v7
    v_rcp_f32 v7, v7
    s_nop 0
    v_mul_f32 v108, v108, v7
    v_cvt_pk_bf16_f32 v108, v108, v108
    v_and_b32 v108, 0xffff0000, v108
    v_lshlrev_b32 v109, 16, v109
    v_mul_f32 v7, 0xbfb8aa3b, v109
    v_exp_f32 v7, v7
    s_nop 0
    v_add_f32 v7, 1.0, v7
    v_rcp_f32 v7, v7
    s_nop 0
    v_mul_f32 v109, v109, v7
    v_cvt_pk_bf16_f32 v109, v109, v109
    v_and_b32 v109, 0xffff0000, v109
    v_lshlrev_b32 v110, 16, v110
    v_mul_f32 v7, 0xbfb8aa3b, v110
    v_exp_f32 v7, v7
    s_nop 0
    v_add_f32 v7, 1.0, v7
    v_rcp_f32 v7, v7
    s_nop 0
    v_mul_f32 v110, v110, v7
    v_cvt_pk_bf16_f32 v110, v110, v110
    v_and_b32 v110, 0xffff0000, v110
    v_lshlrev_b32 v111, 16, v111
    v_mul_f32 v7, 0xbfb8aa3b, v111
    v_exp_f32 v7, v7
    s_nop 0
    v_add_f32 v7, 1.0, v7
    v_rcp_f32 v7, v7
    s_nop 0
    v_mul_f32 v111, v111, v7
    v_cvt_pk_bf16_f32 v111, v111, v111
    v_and_b32 v111, 0xffff0000, v111
    v_lshlrev_b32 v112, 16, v112
    v_mul_f32 v7, 0xbfb8aa3b, v112
    v_exp_f32 v7, v7
    s_nop 0
    v_add_f32 v7, 1.0, v7
    v_rcp_f32 v7, v7
    s_nop 0
    v_mul_f32 v112, v112, v7
    v_cvt_pk_bf16_f32 v112, v112, v112
    v_and_b32 v112, 0xffff0000, v112
    v_lshlrev_b32 v113, 16, v113
    v_mul_f32 v7, 0xbfb8aa3b, v113
    v_exp_f32 v7, v7
    s_nop 0
    v_add_f32 v7, 1.0, v7
    v_rcp_f32 v7, v7
    s_nop 0
    v_mul_f32 v113, v113, v7
    v_cvt_pk_bf16_f32 v113, v113, v113
    v_and_b32 v113, 0xffff0000, v113
    v_lshlrev_b32 v114, 16, v114
    v_mul_f32 v7, 0xbfb8aa3b, v114
    v_exp_f32 v7, v7
    s_nop 0
    v_add_f32 v7, 1.0, v7
    v_rcp_f32 v7, v7
    s_nop 0
    v_mul_f32 v114, v114, v7
    v_cvt_pk_bf16_f32 v114, v114, v114
    v_and_b32 v114, 0xffff0000, v114
    v_lshlrev_b32 v115, 16, v115
    v_mul_f32 v7, 0xbfb8aa3b, v115
    v_exp_f32 v7, v7
    s_nop 0
    v_add_f32 v7, 1.0, v7
    v_rcp_f32 v7, v7
    s_nop 0
    v_mul_f32 v115, v115, v7
    v_cvt_pk_bf16_f32 v115, v115, v115
    v_and_b32 v115, 0xffff0000, v115
    v_lshlrev_b32 v116, 16, v116
    v_mul_f32 v7, 0xbfb8aa3b, v116
    v_exp_f32 v7, v7
    s_nop 0
    v_add_f32 v7, 1.0, v7
    v_rcp_f32 v7, v7
    s_nop 0
    v_mul_f32 v116, v116, v7
    v_cvt_pk_bf16_f32 v116, v116, v116
    v_and_b32 v116, 0xffff0000, v116
    v_lshlrev_b32 v117, 16, v117
    v_mul_f32 v7, 0xbfb8aa3b, v117
    v_exp_f32 v7, v7
    s_nop 0
    v_add_f32 v7, 1.0, v7
    v_rcp_f32 v7, v7
    s_nop 0
    v_mul_f32 v117, v117, v7
    v_cvt_pk_bf16_f32 v117, v117, v117
    v_and_b32 v117, 0xffff0000, v117
    v_lshlrev_b32 v118, 16, v118
    v_mul_f32 v7, 0xbfb8aa3b, v118
    v_exp_f32 v7, v7
    s_nop 0
    v_add_f32 v7, 1.0, v7
    v_rcp_f32 v7, v7
    s_nop 0
    v_mul_f32 v118, v118, v7
    v_cvt_pk_bf16_f32 v118, v118, v118
    v_and_b32 v118, 0xffff0000, v118
    v_lshlrev_b32 v119, 16, v119
    v_mul_f32 v7, 0xbfb8aa3b, v119
    v_exp_f32 v7, v7
    s_nop 0
    v_add_f32 v7, 1.0, v7
    v_rcp_f32 v7, v7
    s_nop 0
    v_mul_f32 v119, v119, v7
    v_cvt_pk_bf16_f32 v119, v119, v119
    v_and_b32 v119, 0xffff0000, v119
    s_waitcnt vmcnt(19)
    v_lshlrev_b32 v8, 16, v20
    v_and_b32 v9, 0xffff0000, v20
    v_fmac_f32 v10, v8, v100
    v_fmac_f32 v11, v9, v100
    v_lshlrev_b32 v8, 16, v21
    v_and_b32 v9, 0xffff0000, v21
    v_fmac_f32 v12, v8, v100
    v_fmac_f32 v13, v9, v100
    v_lshlrev_b32 v8, 16, v22
    v_and_b32 v9, 0xffff0000, v22
    v_fmac_f32 v14, v8, v100
    v_fmac_f32 v15, v9, v100
    v_lshlrev_b32 v8, 16, v23
    v_and_b32 v9, 0xffff0000, v23
    v_fmac_f32 v16, v8, v100
    v_fmac_f32 v17, v9, v100
    s_waitcnt vmcnt(18)
    v_lshlrev_b32 v8, 16, v24
    v_and_b32 v9, 0xffff0000, v24
    v_fmac_f32 v10, v8, v101
    v_fmac_f32 v11, v9, v101
    v_lshlrev_b32 v8, 16, v25
    v_and_b32 v9, 0xffff0000, v25
    v_fmac_f32 v12, v8, v101
    v_fmac_f32 v13, v9, v101
    v_lshlrev_b32 v8, 16, v26
    v_and_b32 v9, 0xffff0000, v26
    v_fmac_f32 v14, v8, v101
    v_fmac_f32 v15, v9, v101
    v_lshlrev_b32 v8, 16, v27
    v_and_b32 v9, 0xffff0000, v27
    v_fmac_f32 v16, v8, v101
    v_fmac_f32 v17, v9, v101
    s_waitcnt vmcnt(17)
    v_lshlrev_b32 v8, 16, v28
    v_and_b32 v9, 0xffff0000, v28
    v_fmac_f32 v10, v8, v102
    v_fmac_f32 v11, v9, v102
    v_lshlrev_b32 v8, 16, v29
    v_and_b32 v9, 0xffff0000, v29
    v_fmac_f32 v12, v8, v102
    v_fmac_f32 v13, v9, v102
    v_lshlrev_b32 v8, 16, v30
    v_and_b32 v9, 0xffff0000, v30
    v_fmac_f32 v14, v8, v102
    v_fmac_f32 v15, v9, v102
    v_lshlrev_b32 v8, 16, v31
    v_and_b32 v9, 0xffff0000, v31
    v_fmac_f32 v16, v8, v102
    v_fmac_f32 v17, v9, v102
    s_waitcnt vmcnt(16)
    v_lshlrev_b32 v8, 16, v32
    v_and_b32 v9, 0xffff0000, v32
    v_fmac_f32 v10, v8, v103
    v_fmac_f32 v11, v9, v103
    v_lshlrev_b32 v8, 16, v33
    v_and_b32 v9, 0xffff0000, v33
    v_fmac_f32 v12, v8, v103
    v_fmac_f32 v13, v9, v103
    v_lshlrev_b32 v8, 16, v34
    v_and_b32 v9, 0xffff0000, v34
    v_fmac_f32 v14, v8, v103
    v_fmac_f32 v15, v9, v103
    v_lshlrev_b32 v8, 16, v35
    v_and_b32 v9, 0xffff0000, v35
    v_fmac_f32 v16, v8, v103
    v_fmac_f32 v17, v9, v103
    s_waitcnt vmcnt(15)
    v_lshlrev_b32 v8, 16, v36
    v_and_b32 v9, 0xffff0000, v36
    v_fmac_f32 v10, v8, v104
    v_fmac_f32 v11, v9, v104
    v_lshlrev_b32 v8, 16, v37
    v_and_b32 v9, 0xffff0000, v37
    v_fmac_f32 v12, v8, v104
    v_fmac_f32 v13, v9, v104
    v_lshlrev_b32 v8, 16, v38
    v_and_b32 v9, 0xffff0000, v38
    v_fmac_f32 v14, v8, v104
    v_fmac_f32 v15, v9, v104
    v_lshlrev_b32 v8, 16, v39
    v_and_b32 v9, 0xffff0000, v39
    v_fmac_f32 v16, v8, v104
    v_fmac_f32 v17, v9, v104
    s_waitcnt vmcnt(14)
    v_lshlrev_b32 v8, 16, v40
    v_and_b32 v9, 0xffff0000, v40
    v_fmac_f32 v10, v8, v105
    v_fmac_f32 v11, v9, v105
    v_lshlrev_b32 v8, 16, v41
    v_and_b32 v9, 0xffff0000, v41
    v_fmac_f32 v12, v8, v105
    v_fmac_f32 v13, v9, v105
    v_lshlrev_b32 v8, 16, v42
    v_and_b32 v9, 0xffff0000, v42
    v_fmac_f32 v14, v8, v105
    v_fmac_f32 v15, v9, v105
    v_lshlrev_b32 v8, 16, v43
    v_and_b32 v9, 0xffff0000, v43
    v_fmac_f32 v16, v8, v105
    v_fmac_f32 v17, v9, v105
    s_waitcnt vmcnt(13)
    v_lshlrev_b32 v8, 16, v44
    v_and_b32 v9, 0xffff0000, v44
    v_fmac_f32 v10, v8, v106
    v_fmac_f32 v11, v9, v106
    v_lshlrev_b32 v8, 16, v45
    v_and_b32 v9, 0xffff0000, v45
    v_fmac_f32 v12, v8, v106
    v_fmac_f32 v13, v9, v106
    v_lshlrev_b32 v8, 16, v46
    v_and_b32 v9, 0xffff0000, v46
    v_fmac_f32 v14, v8, v106
    v_fmac_f32 v15, v9, v106
    v_lshlrev_b32 v8, 16, v47
    v_and_b32 v9, 0xffff0000, v47
    v_fmac_f32 v16, v8, v106
    v_fmac_f32 v17, v9, v106
    s_waitcnt vmcnt(12)
    v_lshlrev_b32 v8, 16, v48
    v_and_b32 v9, 0xffff0000, v48
    v_fmac_f32 v10, v8, v107
    v_fmac_f32 v11, v9, v107
    v_lshlrev_b32 v8, 16, v49
    v_and_b32 v9, 0xffff0000, v49
    v_fmac_f32 v12, v8, v107
    v_fmac_f32 v13, v9, v107
    v_lshlrev_b32 v8, 16, v50
    v_and_b32 v9, 0xffff0000, v50
    v_fmac_f32 v14, v8, v107
    v_fmac_f32 v15, v9, v107
    v_lshlrev_b32 v8, 16, v51
    v_and_b32 v9, 0xffff0000, v51
    v_fmac_f32 v16, v8, v107
    v_fmac_f32 v17, v9, v107
    s_waitcnt vmcnt(11)
    v_lshlrev_b32 v8, 16, v52
    v_and_b32 v9, 0xffff0000, v52
    v_fmac_f32 v10, v8, v108
    v_fmac_f32 v11, v9, v108
    v_lshlrev_b32 v8, 16, v53
    v_and_b32 v9, 0xffff0000, v53
    v_fmac_f32 v12, v8, v108
    v_fmac_f32 v13, v9, v108
    v_lshlrev_b32 v8, 16, v54
    v_and_b32 v9, 0xffff0000, v54
    v_fmac_f32 v14, v8, v108
    v_fmac_f32 v15, v9, v108
    v_lshlrev_b32 v8, 16, v55
    v_and_b32 v9, 0xffff0000, v55
    v_fmac_f32 v16, v8, v108
    v_fmac_f32 v17, v9, v108
    s_waitcnt vmcnt(10)
    v_lshlrev_b32 v8, 16, v56
    v_and_b32 v9, 0xffff0000, v56
    v_fmac_f32 v10, v8, v109
    v_fmac_f32 v11, v9, v109
    v_lshlrev_b32 v8, 16, v57
    v_and_b32 v9, 0xffff0000, v57
    v_fmac_f32 v12, v8, v109
    v_fmac_f32 v13, v9, v109
    v_lshlrev_b32 v8, 16, v58
    v_and_b32 v9, 0xffff0000, v58
    v_fmac_f32 v14, v8, v109
    v_fmac_f32 v15, v9, v109
    v_lshlrev_b32 v8, 16, v59
    v_and_b32 v9, 0xffff0000, v59
    v_fmac_f32 v16, v8, v109
    v_fmac_f32 v17, v9, v109
    s_waitcnt vmcnt(9)
    v_lshlrev_b32 v8, 16, v60
    v_and_b32 v9, 0xffff0000, v60
    v_fmac_f32 v10, v8, v110
    v_fmac_f32 v11, v9, v110
    v_lshlrev_b32 v8, 16, v61
    v_and_b32 v9, 0xffff0000, v61
    v_fmac_f32 v12, v8, v110
    v_fmac_f32 v13, v9, v110
    v_lshlrev_b32 v8, 16, v62
    v_and_b32 v9, 0xffff0000, v62
    v_fmac_f32 v14, v8, v110
    v_fmac_f32 v15, v9, v110
    v_lshlrev_b32 v8, 16, v63
    v_and_b32 v9, 0xffff0000, v63
    v_fmac_f32 v16, v8, v110
    v_fmac_f32 v17, v9, v110
    s_waitcnt vmcnt(8)
    v_lshlrev_b32 v8, 16, v64
    v_and_b32 v9, 0xffff0000, v64
    v_fmac_f32 v10, v8, v111
    v_fmac_f32 v11, v9, v111
    v_lshlrev_b32 v8, 16, v65
    v_and_b32 v9, 0xffff0000, v65
    v_fmac_f32 v12, v8, v111
    v_fmac_f32 v13, v9, v111
    v_lshlrev_b32 v8, 16, v66
    v_and_b32 v9, 0xffff0000, v66
    v_fmac_f32 v14, v8, v111
    v_fmac_f32 v15, v9, v111
    v_lshlrev_b32 v8, 16, v67
    v_and_b32 v9, 0xffff0000, v67
    v_fmac_f32 v16, v8, v111
    v_fmac_f32 v17, v9, v111
    s_waitcnt vmcnt(7)
    v_lshlrev_b32 v8, 16, v68
    v_and_b32 v9, 0xffff0000, v68
    v_fmac_f32 v10, v8, v112
    v_fmac_f32 v11, v9, v112
    v_lshlrev_b32 v8, 16, v69
    v_and_b32 v9, 0xffff0000, v69
    v_fmac_f32 v12, v8, v112
    v_fmac_f32 v13, v9, v112
    v_lshlrev_b32 v8, 16, v70
    v_and_b32 v9, 0xffff0000, v70
    v_fmac_f32 v14, v8, v112
    v_fmac_f32 v15, v9, v112
    v_lshlrev_b32 v8, 16, v71
    v_and_b32 v9, 0xffff0000, v71
    v_fmac_f32 v16, v8, v112
    v_fmac_f32 v17, v9, v112
    s_waitcnt vmcnt(6)
    v_lshlrev_b32 v8, 16, v72
    v_and_b32 v9, 0xffff0000, v72
    v_fmac_f32 v10, v8, v113
    v_fmac_f32 v11, v9, v113
    v_lshlrev_b32 v8, 16, v73
    v_and_b32 v9, 0xffff0000, v73
    v_fmac_f32 v12, v8, v113
    v_fmac_f32 v13, v9, v113
    v_lshlrev_b32 v8, 16, v74
    v_and_b32 v9, 0xffff0000, v74
    v_fmac_f32 v14, v8, v113
    v_fmac_f32 v15, v9, v113
    v_lshlrev_b32 v8, 16, v75
    v_and_b32 v9, 0xffff0000, v75
    v_fmac_f32 v16, v8, v113
    v_fmac_f32 v17, v9, v113
    s_waitcnt vmcnt(5)
    v_lshlrev_b32 v8, 16, v76
    v_and_b32 v9, 0xffff0000, v76
    v_fmac_f32 v10, v8, v114
    v_fmac_f32 v11, v9, v114
    v_lshlrev_b32 v8, 16, v77
    v_and_b32 v9, 0xffff0000, v77
    v_fmac_f32 v12, v8, v114
    v_fmac_f32 v13, v9, v114
    v_lshlrev_b32 v8, 16, v78
    v_and_b32 v9, 0xffff0000, v78
    v_fmac_f32 v14, v8, v114
    v_fmac_f32 v15, v9, v114
    v_lshlrev_b32 v8, 16, v79
    v_and_b32 v9, 0xffff0000, v79
    v_fmac_f32 v16, v8, v114
    v_fmac_f32 v17, v9, v114
    s_waitcnt vmcnt(4)
    v_lshlrev_b32 v8, 16, v80
    v_and_b32 v9, 0xffff0000, v80
    v_fmac_f32 v10, v8, v115
    v_fmac_f32 v11, v9, v115
    v_lshlrev_b32 v8, 16, v81
    v_and_b32 v9, 0xffff0000, v81
    v_fmac_f32 v12, v8, v115
    v_fmac_f32 v13, v9, v115
    v_lshlrev_b32 v8, 16, v82
    v_and_b32 v9, 0xffff0000, v82
    v_fmac_f32 v14, v8, v115
    v_fmac_f32 v15, v9, v115
    v_lshlrev_b32 v8, 16, v83
    v_and_b32 v9, 0xffff0000, v83
    v_fmac_f32 v16, v8, v115
    v_fmac_f32 v17, v9, v115
    s_waitcnt vmcnt(3)
    v_lshlrev_b32 v8, 16, v84
    v_and_b32 v9, 0xffff0000, v84
    v_fmac_f32 v10, v8, v116
    v_fmac_f32 v11, v9, v116
    v_lshlrev_b32 v8, 16, v85
    v_and_b32 v9, 0xffff0000, v85
    v_fmac_f32 v12, v8, v116
    v_fmac_f32 v13, v9, v116
    v_lshlrev_b32 v8, 16, v86
    v_and_b32 v9, 0xffff0000, v86
    v_fmac_f32 v14, v8, v116
    v_fmac_f32 v15, v9, v116
    v_lshlrev_b32 v8, 16, v87
    v_and_b32 v9, 0xffff0000, v87
    v_fmac_f32 v16, v8, v116
    v_fmac_f32 v17, v9, v116
    s_waitcnt vmcnt(2)
    v_lshlrev_b32 v8, 16, v88
    v_and_b32 v9, 0xffff0000, v88
    v_fmac_f32 v10, v8, v117
    v_fmac_f32 v11, v9, v117
    v_lshlrev_b32 v8, 16, v89
    v_and_b32 v9, 0xffff0000, v89
    v_fmac_f32 v12, v8, v117
    v_fmac_f32 v13, v9, v117
    v_lshlrev_b32 v8, 16, v90
    v_and_b32 v9, 0xffff0000, v90
    v_fmac_f32 v14, v8, v117
    v_fmac_f32 v15, v9, v117
    v_lshlrev_b32 v8, 16, v91
    v_and_b32 v9, 0xffff0000, v91
    v_fmac_f32 v16, v8, v117
    v_fmac_f32 v17, v9, v117
    s_waitcnt vmcnt(1)
    v_lshlrev_b32 v8, 16, v92
    v_and_b32 v9, 0xffff0000, v92
    v_fmac_f32 v10, v8, v118
    v_fmac_f32 v11, v9, v118
    v_lshlrev_b32 v8, 16, v93
    v_and_b32 v9, 0xffff0000, v93
    v_fmac_f32 v12, v8, v118
    v_fmac_f32 v13, v9, v118
    v_lshlrev_b32 v8, 16, v94
    v_and_b32 v9, 0xffff0000, v94
    v_fmac_f32 v14, v8, v118
    v_fmac_f32 v15, v9, v118
    v_lshlrev_b32 v8, 16, v95
    v_and_b32 v9, 0xffff0000, v95
    v_fmac_f32 v16, v8, v118
    v_fmac_f32 v17, v9, v118
    s_waitcnt vmcnt(0)
    v_lshlrev_b32 v8, 16, v96
    v_and_b32 v9, 0xffff0000, v96
    v_fmac_f32 v10, v8, v119
    v_fmac_f32 v11, v9, v119
    v_lshlrev_b32 v8, 16, v97
    v_and_b32 v9, 0xffff0000, v97
    v_fmac_f32 v12, v8, v119
    v_fmac_f32 v13, v9, v119
    v_lshlrev_b32 v8, 16, v98
    v_and_b32 v9, 0xffff0000, v98
    v_fmac_f32 v14, v8, v119
    v_fmac_f32 v15, v9, v119
    v_lshlrev_b32 v8, 16, v99
    v_and_b32 v9, 0xffff0000, v99
    v_fmac_f32 v16, v8, v119
    v_fmac_f32 v17, v9, v119
    v_add_f32_dpp v10, v10, v10 row_ror:8 row_mask:0xf bank_mask:0xf
    v_add_f32_dpp v11, v11, v11 row_ror:8 row_mask:0xf bank_mask:0xf
    v_add_f32_dpp v12, v12, v12 row_ror:8 row_mask:0xf bank_mask:0xf
    v_add_f32_dpp v13, v13, v13 row_ror:8 row_mask:0xf bank_mask:0xf
    v_add_f32_dpp v14, v14, v14 row_ror:8 row_mask:0xf bank_mask:0xf
    v_add_f32_dpp v15, v15, v15 row_ror:8 row_mask:0xf bank_mask:0xf
    v_add_f32_dpp v16, v16, v16 row_ror:8 row_mask:0xf bank_mask:0xf
    v_add_f32_dpp v17, v17, v17 row_ror:8 row_mask:0xf bank_mask:0xf
    v_mov_b32 v20, v10
    v_mov_b32 v21, v11
    v_mov_b32 v22, v12
    v_mov_b32 v23, v13
    v_mov_b32 v24, v14
    v_mov_b32 v25, v15
    v_mov_b32 v26, v16
    v_mov_b32 v27, v17
    v_permlane16_swap_b32 v10, v20
    v_permlane16_swap_b32 v11, v21
    v_permlane16_swap_b32 v12, v22
    v_permlane16_swap_b32 v13, v23
    v_permlane16_swap_b32 v14, v24
    v_permlane16_swap_b32 v15, v25
    v_permlane16_swap_b32 v16, v26
    v_permlane16_swap_b32 v17, v27
    v_add_f32 v10, v10, v20
    v_add_f32 v11, v11, v21
    v_add_f32 v12, v12, v22
    v_add_f32 v13, v13, v23
    v_add_f32 v14, v14, v24
    v_add_f32 v15, v15, v25
    v_add_f32 v16, v16, v26
    v_add_f32 v17, v17, v27
    v_mov_b32 v20, v10
    v_mov_b32 v21, v11
    v_mov_b32 v22, v12
    v_mov_b32 v23, v13
    v_mov_b32 v24, v14
    v_mov_b32 v25, v15
    v_mov_b32 v26, v16
    v_mov_b32 v27, v17
    v_permlane32_swap_b32 v10, v20
    v_permlane32_swap_b32 v11, v21
    v_permlane32_swap_b32 v12, v22
    v_permlane32_swap_b32 v13, v23
    v_permlane32_swap_b32 v14, v24
    v_permlane32_swap_b32 v15, v25
    v_permlane32_swap_b32 v16, v26
    v_permlane32_swap_b32 v17, v27
    v_add_f32 v10, v10, v20
    v_add_f32 v11, v11, v21
    v_add_f32 v12, v12, v22
    v_add_f32 v13, v13, v23
    v_add_f32 v14, v14, v24
    v_add_f32 v15, v15, v25
    v_add_f32 v16, v16, v26
    v_add_f32 v17, v17, v27
    v_lshlrev_b32 v8, 5, v4
    v_lshl_add_u32 v8, v2, 8, v8
    s_mov_b64 exec, 0xff
    ds_write_b128 v8, v[10:13]
    ds_write_b128 v8, v[14:17] offset:16
    s_mov_b64 exec, -1
    s_waitcnt lgkmcnt(0)
    s_barrier
    v_readfirstlane_b32 s18, v2
    s_nop 0
    s_cmp_lg_u32 s18, 0
    s_cbranch_scc1 L_modw_4
    v_lshlrev_b32 v8, 2, v1
    ds_read_b32 v10, v8 offset:0
    ds_read_b32 v11, v8 offset:256
    ds_read_b32 v12, v8 offset:512
    ds_read_b32 v13, v8 offset:768
    s_waitcnt lgkmcnt(0)
    v_add_f32 v10, v10, v11
    v_add_f32 v12, v12, v13
    v_add_f32 v10, v10, v12
    v_cvt_pk_bf16_f32 v10, v10, v10
    v_and_b32 v10, 0xffff0000, v10
    s_cmp_ge_u32 s20, 10
    s_cselect_b32 s18, 1, 0
    s_cmp_lt_u32 s20, 20
    s_cselect_b32 s18, s18, 0
    s_cmp_ge_u32 s20, 40
    s_cselect_b32 s19, 1, 0
    s_cmp_lt_u32 s20, 50
    s_cselect_b32 s19, s19, 0
    s_or_b32 s18, s18, s19
    s_cmp_eq_u32 s18, 0
    s_cbranch_scc1 L_mod1_5
    v_add_f32 v10, 1.0, v10
    v_cvt_pk_bf16_f32 v10, v10, v10
    v_and_b32 v10, 0xffff0000, v10
L_mod1_5:
    s_lshl_b32 s17, s20, 8
    s_add_u32 s17, s17, 0
    buffer_store_dword v10, v8, s[4:7], s17 offen sc1
    s_waitcnt vmcnt(0)
L_modw_4:
    s_branch L_early_join_3
L_early_zero_2:
    s_load_dwordx2 s[4:5], s[0:1], 128
    s_waitcnt lgkmcnt(0)
    s_and_b32 s5, s5, 0xffff
    s_mov_b32 s6, 268435456
    s_mov_b32 s7, 0x20000
    v_and_b32 v1, 255, v0
    v_lshlrev_b32 v1, 4, v1
    v_mov_b32 v4, 0
    v_mov_b32 v5, 0
    v_mov_b32 v6, 0
    v_mov_b32 v7, 0
    s_mov_b32 s21, 786432
    buffer_store_dwordx4 v[4:7], v1, s[4:7], s21 offen sc1
    s_add_u32 s21, s21, 4096
    buffer_store_dwordx4 v[4:7], v1, s[4:7], s21 offen sc1
    s_add_u32 s21, s21, 4096
    buffer_store_dwordx4 v[4:7], v1, s[4:7], s21 offen sc1
    s_add_u32 s21, s21, 4096
    buffer_store_dwordx4 v[4:7], v1, s[4:7], s21 offen sc1
    s_add_u32 s21, s21, 4096
    buffer_store_dwordx4 v[4:7], v1, s[4:7], s21 offen sc1
    s_add_u32 s21, s21, 4096
    buffer_store_dwordx4 v[4:7], v1, s[4:7], s21 offen sc1
    s_add_u32 s21, s21, 4096
    buffer_store_dwordx4 v[4:7], v1, s[4:7], s21 offen sc1
    s_add_u32 s21, s21, 4096
    buffer_store_dwordx4 v[4:7], v1, s[4:7], s21 offen sc1
    s_add_u32 s21, s21, 4096
    buffer_store_dwordx4 v[4:7], v1, s[4:7], s21 offen sc1
    s_add_u32 s21, s21, 4096
    s_mov_b32 s22, 132
L_early_join_3:
    s_waitcnt vmcnt(0) lgkmcnt(0)
    s_barrier
    v_lshrrev_b32 v1, 6, v0
    s_nop 0
    v_readfirstlane_b32 s21, v1
    s_nop 0
    s_cmp_lg_u32 s21, 0
    s_cbranch_scc1 L_early_sig_6
    v_mov_b32 v1, s22
    v_mov_b32 v2, 1
    s_mov_b64 exec, 1
    global_atomic_add v1, v2, s[30:31]
    s_mov_b64 exec, -1
L_early_sig_6:
L_early_1:
    s_load_dwordx2 s[24:25], s[0:1], 120
    s_load_dwordx2 s[4:5], s[0:1], 128
    s_getreg_b32 s27, hwreg(HW_REG_XCC_ID, 0, 4)
    v_lshrrev_b32 v1, 6, v0
    s_nop 0
    v_readfirstlane_b32 s26, v1
    s_and_b32 s27, s27, 7
    s_waitcnt lgkmcnt(0)
    s_and_b32 s5, s5, 0xffff
    s_mov_b32 s6, 268435456
    s_mov_b32 s7, 0x20000
    s_cmp_lg_u32 s26, 0
    s_cbranch_scc1 L_role_wait_7
    s_lshl_b32 s41, s27, 2
    v_mov_b32 v1, s41
    v_mov_b32 v12, 1
    s_mov_b64 exec, 1
    global_atomic_add v3, v1, v12, s[24:25] sc0
    s_waitcnt vmcnt(0)
    v_readfirstlane_b32 s41, v3
    s_nop 0
    s_cmp_ge_u32 s41, 32
    s_cbranch_scc1 L_role_over_9
    s_lshl_b32 s42, s27, 5
    s_add_u32 s41, s41, s42
    s_branch L_role_pub_8
L_role_over_9:
    v_mov_b32 v1, 32
    global_atomic_add v3, v1, v12, s[24:25] sc0
    s_waitcnt vmcnt(0)
    v_readfirstlane_b32 s44, v3
    s_mov_b32 s45, 0x100000
    v_mov_b32 v11, 0
L_tick_10:
    global_load_dwordx4 v[2:5], v11, s[24:25] sc1
    global_load_dwordx4 v[6:9], v11, s[24:25] offset:16 sc1
    s_waitcnt vmcnt(0)
    v_add3_u32 v10, v2, v3, v4
    v_add3_u32 v10, v10, v5, v6
    v_add3_u32 v10, v10, v7, v8
    v_add_u32 v10, v10, v9
    s_nop 0
    v_readfirstlane_b32 s42, v10
    s_nop 0
    s_cmp_ge_u32 s42, 256
    s_cbranch_scc1 L_tickd_11
    s_sleep 4
    s_sub_u32 s45, s45, 1
    s_cbranch_scc0 L_tick_10
L_tickd_11:
    v_readfirstlane_b32 s42, v2
    v_readfirstlane_b32 s43, v3
    v_readfirstlane_b32 s42, v2
    s_nop 0
    s_min_u32 s42, s42, 32
    s_sub_u32 s43, 32, s42
    s_add_u32 s41, s42, s44
    s_add_u32 s41, s41, 0
    s_cmp_lt_u32 s44, s43
    s_cbranch_scc1 L_role_found_12
    s_sub_u32 s44, s44, s43
    v_readfirstlane_b32 s42, v3
    s_nop 0
    s_min_u32 s42, s42, 32
    s_sub_u32 s43, 32, s42
    s_add_u32 s41, s42, s44
    s_add_u32 s41, s41, 32
    s_cmp_lt_u32 s44, s43
    s_cbranch_scc1 L_role_found_12
    s_sub_u32 s44, s44, s43
    v_readfirstlane_b32 s42, v4
    s_nop 0
    s_min_u32 s42, s42, 32
    s_sub_u32 s43, 32, s42
    s_add_u32 s41, s42, s44
    s_add_u32 s41, s41, 64
    s_cmp_lt_u32 s44, s43
    s_cbranch_scc1 L_role_found_12
    s_sub_u32 s44, s44, s43
    v_readfirstlane_b32 s42, v5
    s_nop 0
    s_min_u32 s42, s42, 32
    s_sub_u32 s43, 32, s42
    s_add_u32 s41, s42, s44
    s_add_u32 s41, s41, 96
    s_cmp_lt_u32 s44, s43
    s_cbranch_scc1 L_role_found_12
    s_sub_u32 s44, s44, s43
    v_readfirstlane_b32 s42, v6
    s_nop 0
    s_min_u32 s42, s42, 32
    s_sub_u32 s43, 32, s42
    s_add_u32 s41, s42, s44
    s_add_u32 s41, s41, 128
    s_cmp_lt_u32 s44, s43
    s_cbranch_scc1 L_role_found_12
    s_sub_u32 s44, s44, s43
    v_readfirstlane_b32 s42, v7
    s_nop 0
    s_min_u32 s42, s42, 32
    s_sub_u32 s43, 32, s42
    s_add_u32 s41, s42, s44
    s_add_u32 s41, s41, 160
    s_cmp_lt_u32 s44, s43
    s_cbranch_scc1 L_role_found_12
    s_sub_u32 s44, s44, s43
    v_readfirstlane_b32 s42, v8
    s_nop 0
    s_min_u32 s42, s42, 32
    s_sub_u32 s43, 32, s42
    s_add_u32 s41, s42, s44
    s_add_u32 s41, s41, 192
    s_cmp_lt_u32 s44, s43
    s_cbranch_scc1 L_role_found_12
    s_sub_u32 s44, s44, s43
    v_readfirstlane_b32 s42, v9
    s_nop 0
    s_min_u32 s42, s42, 32
    s_sub_u32 s43, 32, s42
    s_add_u32 s41, s42, s44
    s_add_u32 s41, s41, 224
    s_cmp_lt_u32 s44, s43
    s_cbranch_scc1 L_role_found_12
    s_sub_u32 s44, s44, s43
L_role_found_12:
L_role_pub_8:
    s_mov_b64 exec, -1
    v_mov_b32 v1, 163836
    v_mov_b32 v2, s41
    ds_write_b32 v1, v2
    s_waitcnt lgkmcnt(0)
L_role_wait_7:
    s_barrier
    v_mov_b32 v1, 163836
    ds_read_b32 v2, v1
    s_waitcnt lgkmcnt(0)
    v_readfirstlane_b32 s41, v2
    s_barrier
    s_sub_u32 s28, s41, 64
    s_cmp_ge_u32 s41, 64
    s_cbranch_scc1 main_kernel_worker
    s_lshr_b32 s27, s41, 5
    s_and_b32 s28, s41, 31
    v_mov_b32 v110, v0
    s_lshr_b32 s29, s28, 1
    s_lshl_b32 s41, s27, 4
    s_add_u32 s29, s29, s41
    s_and_b32 s30, s28, 1
    s_load_dwordx2 s[8:9], s[0:1], 16
    s_load_dwordx2 s[12:13], s[0:1], 24
    s_load_dwordx2 s[16:17], s[0:1], 32
    s_load_dwordx2 s[20:21], s[0:1], 40
    v_and_b32 v34, 63, v110
    v_and_b32 v35, 15, v34
    v_lshrrev_b32 v36, 4, v34
    v_mov_b32 v74, -1
    v_mov_b32 v75, -1
    v_mov_b32 v76, -1
    v_mov_b32 v77, -1
    s_lshl_b32 s44, s27, 5
    s_add_u32 s44, s44, s28
    v_lshlrev_b32 v37, 4, v34
    s_mul_i32 s41, s28, 20480
    s_mul_i32 s42, s26, 5120
    s_add_u32 s41, s41, s42
    s_lshl_b32 s42, s27, 20
    s_add_u32 s41, s41, s42
    s_add_u32 s41, s41, 96468992
    buffer_store_dwordx4 v[74:77], v37, s[4:7], s41 offen sc1
    s_add_u32 s41, s41, 1024
    buffer_store_dwordx4 v[74:77], v37, s[4:7], s41 offen sc1
    s_add_u32 s41, s41, 1024
    buffer_store_dwordx4 v[74:77], v37, s[4:7], s41 offen sc1
    s_add_u32 s41, s41, 1024
    buffer_store_dwordx4 v[74:77], v37, s[4:7], s41 offen sc1
    s_add_u32 s41, s41, 1024
    buffer_store_dwordx4 v[74:77], v37, s[4:7], s41 offen sc1
    s_add_u32 s41, s41, 1024
    v_lshrrev_b32 v38, 1, v34
    v_lshlrev_b32 v38, 14, v38
    v_and_b32 v39, 1, v34
    v_lshl_add_u32 v38, v39, 13, v38
    v_mov_b32 v39, 0x40000000
    v_cmp_gt_u32 vcc, 6, v34
    s_nop 1
    v_cndmask_b32 v38, v39, v38, vcc
    s_lshl_b32 s41, s44, 7
    s_add_u32 s41, s41, 92536832
    buffer_store_dword v74, v38, s[4:7], s41 offen sc1
    s_load_dwordx2 s[80:81], s[0:1], 128
    s_mov_b32 s62, 0x7fffffff
    s_mov_b32 s63, 0x7fffffff
    s_mov_b32 s64, s41
    s_waitcnt lgkmcnt(0)
    s_and_b32 s9, s9, 0xffff
    s_mov_b32 s10, 5242880
    s_mov_b32 s11, 0x20000
    s_and_b32 s13, s13, 0xffff
    s_mov_b32 s14, 5242880
    s_mov_b32 s15, 0x20000
    s_and_b32 s17, s17, 0xffff
    s_mov_b32 s18, 5242880
    s_mov_b32 s19, 0x20000
    s_and_b32 s21, s21, 0xffff
    s_mov_b32 s22, 5242880
    s_mov_b32 s23, 0x20000
    v_lshlrev_b32 v38, 1, v36
    v_xor_b32 v39, v35, v38
    v_lshlrev_b32 v39, 4, v39
    v_lshl_add_u32 v42, v36, 13, v39
    v_xor_b32 v43, 128, v42
    s_lshl_b32 s41, s29, 8
    s_lshl_b32 s42, s26, 17
    s_add_u32 s41, s41, s42
    v_add_u32 v42, s41, v42
    v_add_u32 v43, s41, v43
    v_and_b32 v38, 7, v34
    v_and_b32 v39, 1, v36
    v_lshlrev_b32 v39, 1, v39
    v_xor_b32 v38, v38, v39
    v_lshlrev_b32 v38, 4, v38
    v_lshrrev_b32 v39, 3, v34
    v_lshl_add_u32 v44, v39, 13, v38
    v_xor_b32 v45, 64, v44
    s_lshl_b32 s42, s30, 7
    s_add_u32 s41, s41, s42
    v_add_u32 v44, s41, v44
    v_add_u32 v45, s41, v45
    v_lshrrev_b32 v49, 2, v35
    v_and_b32 v50, 3, v35
    v_and_b32 v38, 1, v36
    v_lshl_add_u32 v38, v38, 2, v49
    v_lshlrev_b32 v38, 1, v38
    v_lshrrev_b32 v39, 1, v50
    v_xor_b32 v38, v38, v39
    v_lshlrev_b32 v38, 4, v38
    v_and_b32 v39, 1, v50
    v_lshl_add_u32 v38, v39, 3, v38
    v_lshl_add_u32 v39, v36, 3, v49
    v_lshl_add_u32 v38, v39, 8, v38
    s_lshl_b32 s41, s26, 6
    v_xor_b32 v46, s41, v38
    v_xor_b32 v47, 32, v46
    v_and_b32 v38, 1, v36
    v_lshlrev_b32 v38, 1, v38
    v_lshrrev_b32 v40, 1, v49
    v_add_u32 v38, v38, v40
    v_lshlrev_b32 v38, 1, v38
    v_lshrrev_b32 v40, 1, v50
    v_xor_b32 v38, v38, v40
    v_lshlrev_b32 v38, 4, v38
    v_and_b32 v40, 1, v50
    v_lshl_add_u32 v38, v40, 3, v38
    v_lshl_add_u32 v38, v39, 7, v38
    s_lshl_b32 s41, s26, 5
    v_xor_b32 v48, s41, v38
    v_add_u32 v48, 32768, v48
    s_lshl_b32 s42, s26, 12
    s_add_u32 m0, s42, 0
    s_mov_b32 s41, 0
    buffer_load_dwordx4 v42, s[8:11], s41 offen lds
    s_add_u32 m0, s42, 1024
    s_mov_b32 s41, 32768
    buffer_load_dwordx4 v42, s[8:11], s41 offen lds
    s_add_u32 m0, s42, 2048
    s_mov_b32 s41, 65536
    buffer_load_dwordx4 v43, s[8:11], s41 offen lds
    s_add_u32 m0, s42, 3072
    s_mov_b32 s41, 98304
    buffer_load_dwordx4 v43, s[8:11], s41 offen lds
    s_add_u32 m0, s42, 16384
    s_mov_b32 s41, 0
    buffer_load_dwordx4 v42, s[12:15], s41 offen lds
    s_add_u32 m0, s42, 17408
    s_mov_b32 s41, 32768
    buffer_load_dwordx4 v42, s[12:15], s41 offen lds
    s_add_u32 m0, s42, 18432
    s_mov_b32 s41, 65536
    buffer_load_dwordx4 v43, s[12:15], s41 offen lds
    s_add_u32 m0, s42, 19456
    s_mov_b32 s41, 98304
    buffer_load_dwordx4 v43, s[12:15], s41 offen lds
    s_lshl_b32 s42, s26, 11
    s_add_u32 m0, s42, 32768
    s_mov_b32 s41, 0
    buffer_load_dwordx4 v44, s[16:19], s41 offen lds
    s_add_u32 m0, s42, 33792
    s_mov_b32 s41, 65536
    buffer_load_dwordx4 v45, s[16:19], s41 offen lds
    s_lshl_b32 s42, s26, 12
    s_add_u32 m0, s42, 40960
    s_mov_b32 s41, 524288
    buffer_load_dwordx4 v42, s[8:11], s41 offen lds
    s_add_u32 m0, s42, 41984
    s_mov_b32 s41, 557056
    buffer_load_dwordx4 v42, s[8:11], s41 offen lds
    s_add_u32 m0, s42, 43008
    s_mov_b32 s41, 589824
    buffer_load_dwordx4 v43, s[8:11], s41 offen lds
    s_add_u32 m0, s42, 44032
    s_mov_b32 s41, 622592
    buffer_load_dwordx4 v43, s[8:11], s41 offen lds
    s_add_u32 m0, s42, 57344
    s_mov_b32 s41, 524288
    buffer_load_dwordx4 v42, s[12:15], s41 offen lds
    s_add_u32 m0, s42, 58368
    s_mov_b32 s41, 557056
    buffer_load_dwordx4 v42, s[12:15], s41 offen lds
    s_add_u32 m0, s42, 59392
    s_mov_b32 s41, 589824
    buffer_load_dwordx4 v43, s[12:15], s41 offen lds
    s_add_u32 m0, s42, 60416
    s_mov_b32 s41, 622592
    buffer_load_dwordx4 v43, s[12:15], s41 offen lds
    s_lshl_b32 s42, s26, 11
    s_add_u32 m0, s42, 73728
    s_mov_b32 s41, 524288
    buffer_load_dwordx4 v44, s[16:19], s41 offen lds
    s_add_u32 m0, s42, 74752
    s_mov_b32 s41, 589824
    buffer_load_dwordx4 v45, s[16:19], s41 offen lds
    s_lshl_b32 s42, s26, 12
    s_add_u32 m0, s42, 81920
    s_mov_b32 s41, 1048576
    buffer_load_dwordx4 v42, s[8:11], s41 offen lds
    s_add_u32 m0, s42, 82944
    s_mov_b32 s41, 1081344
    buffer_load_dwordx4 v42, s[8:11], s41 offen lds
    s_add_u32 m0, s42, 83968
    s_mov_b32 s41, 1114112
    buffer_load_dwordx4 v43, s[8:11], s41 offen lds
    s_add_u32 m0, s42, 84992
    s_mov_b32 s41, 1146880
    buffer_load_dwordx4 v43, s[8:11], s41 offen lds
    s_add_u32 m0, s42, 98304
    s_mov_b32 s41, 1048576
    buffer_load_dwordx4 v42, s[12:15], s41 offen lds
    s_add_u32 m0, s42, 99328
    s_mov_b32 s41, 1081344
    buffer_load_dwordx4 v42, s[12:15], s41 offen lds
    s_add_u32 m0, s42, 100352
    s_mov_b32 s41, 1114112
    buffer_load_dwordx4 v43, s[12:15], s41 offen lds
    s_add_u32 m0, s42, 101376
    s_mov_b32 s41, 1146880
    buffer_load_dwordx4 v43, s[12:15], s41 offen lds
    s_lshl_b32 s42, s26, 11
    s_add_u32 m0, s42, 114688
    s_mov_b32 s41, 1048576
    buffer_load_dwordx4 v44, s[16:19], s41 offen lds
    s_add_u32 m0, s42, 115712
    s_mov_b32 s41, 1114112
    buffer_load_dwordx4 v45, s[16:19], s41 offen lds
    s_lshl_b32 s42, s26, 12
    s_add_u32 m0, s42, 122880
    s_mov_b32 s41, 1572864
    buffer_load_dwordx4 v42, s[8:11], s41 offen lds
    s_add_u32 m0, s42, 123904
    s_mov_b32 s41, 1605632
    buffer_load_dwordx4 v42, s[8:11], s41 offen lds
    s_add_u32 m0, s42, 124928
    s_mov_b32 s41, 1638400
    buffer_load_dwordx4 v43, s[8:11], s41 offen lds
    s_add_u32 m0, s42, 125952
    s_mov_b32 s41, 1671168
    buffer_load_dwordx4 v43, s[8:11], s41 offen lds
    s_add_u32 m0, s42, 139264
    s_mov_b32 s41, 1572864
    buffer_load_dwordx4 v42, s[12:15], s41 offen lds
    s_add_u32 m0, s42, 140288
    s_mov_b32 s41, 1605632
    buffer_load_dwordx4 v42, s[12:15], s41 offen lds
    s_add_u32 m0, s42, 141312
    s_mov_b32 s41, 1638400
    buffer_load_dwordx4 v43, s[12:15], s41 offen lds
    s_add_u32 m0, s42, 142336
    s_mov_b32 s41, 1671168
    buffer_load_dwordx4 v43, s[12:15], s41 offen lds
    s_lshl_b32 s42, s26, 11
    s_add_u32 m0, s42, 155648
    s_mov_b32 s41, 1572864
    buffer_load_dwordx4 v44, s[16:19], s41 offen lds
    s_add_u32 m0, s42, 156672
    s_mov_b32 s41, 1638400
    buffer_load_dwordx4 v45, s[16:19], s41 offen lds
    v_and_b32 v54, 1, v36
    v_lshrrev_b32 v55, 1, v36
    s_mul_i32 s41, s26, 160
    v_lshl_add_u32 v38, v36, 4, v35
    v_add_u32 v38, s41, v38
    v_lshrrev_b32 v39, 3, v38
    v_lshlrev_b32 v39, 12, v39
    v_and_b32 v40, 7, v38
    v_lshl_add_u32 v39, v40, 4, v39
    s_lshl_b32 s42, s28, 7
    v_add_u32 v39, s42, v39
    v_mov_b32 v56, 0x40000000
    v_cmp_gt_u32 vcc, 2, v36
    s_nop 1
    v_cndmask_b32 v10, v56, v39, vcc
    v_add_u32 v38, s41, v34
    v_lshlrev_b32 v0, 4, v38
    v_mov_b32 v56, 0x40000000
    v_cmp_gt_u32 vcc, 32, v34
    s_nop 1
    v_cndmask_b32 v20, v56, v0, vcc
    s_mul_i32 s41, s26, 3840
    s_add_u32 s41, s41, 81920
    s_movk_i32 s42, 384
    v_mul_lo_u32 v40, v36, s42
    v_lshl_add_u32 v40, v35, 4, v40
    v_add_u32 v1, s41, v40
    v_lshlrev_b32 v40, 4, v34
    v_add_u32 v40, 136192, v40
    v_cndmask_b32 v21, v40, v1, vcc
    v_mul_lo_u32 v40, v36, s42
    v_lshrrev_b32 v39, 1, v49
    v_lshl_add_u32 v40, v39, 6, v40
    v_lshrrev_b32 v39, 1, v50
    v_lshl_add_u32 v40, v39, 5, v40
    v_and_b32 v39, 1, v49
    v_lshl_add_u32 v40, v39, 4, v40
    v_and_b32 v39, 1, v50
    v_lshl_add_u32 v40, v39, 3, v40
    v_add_u32 v2, 81920, v40
    v_mov_b32 v39, 0x4444
    v_mov_b32 v40, 0xeeee
    v_cmp_gt_u32 vcc, 8, v35
    s_nop 1
    v_cndmask_b32 v3, v40, v39, vcc
    s_lshl_b32 s41, s26, 9
    s_add_u32 s41, s41, 97280
    v_lshl_add_u32 v39, v55, 4, v35
    v_lshlrev_b32 v39, 4, v39
    v_lshl_add_u32 v39, v54, 3, v39
    v_add_u32 v4, s41, v39
    v_lshl_add_u32 v39, v36, 3, v49
    v_lshlrev_b32 v39, 4, v39
    v_and_b32 v40, 1, v50
    v_lshl_add_u32 v39, v40, 3, v39
    v_add_u32 v5, 97280, v39
    v_xor_b32 v39, v36, v35
    v_lshlrev_b32 v39, 4, v39
    v_lshl_add_u32 v39, v35, 8, v39
    v_add_u32 v6, 114688, v39
    v_lshl_add_u32 v39, v36, 2, v49
    v_and_b32 v40, 6, v39
    v_lshrrev_b32 v38, 1, v50
    v_xor_b32 v40, v40, v38
    v_lshlrev_b32 v40, 4, v40
    v_lshl_add_u32 v40, v39, 7, v40
    v_and_b32 v38, 1, v50
    v_lshl_add_u32 v40, v38, 3, v40
    v_add_u32 v7, 131072, v40
    v_lshlrev_b32 v39, 3, v34
    v_add_u32 v19, 101376, v39
    s_lshl_b32 s41, s26, 9
    v_add_u32 v8, s41, v19
    s_lshl_b32 s41, s26, 5
    s_add_u32 s57, s41, s28
    s_cmp_lt_u32 s57, 80
    s_cselect_b32 s56, 1, 0
    s_min_u32 s57, s57, 79
    v_lshrrev_b32 v38, 3, v35
    v_lshl_add_u32 v38, v38, 2, v36
    v_lshlrev_b32 v38, 7, v38
    v_and_b32 v39, 7, v35
    v_lshl_add_u32 v38, v39, 4, v38
    s_lshl_b32 s41, s57, 12
    v_add_u32 v11, s41, v38
    s_lshr_b32 s41, s57, 5
    s_lshl_b32 s41, s41, 14
    s_and_b32 s42, s57, 31
    s_lshl_b32 s42, s42, 8
    s_add_u32 s41, s41, s42
    v_lshlrev_b32 v38, 7, v36
    v_lshl_add_u32 v38, v35, 4, v38
    v_add_u32 v38, s41, v38
    v_cmp_gt_u32 vcc, 8, v35
    s_nop 1
    v_cndmask_b32 v38, v56, v38, vcc
    v_cmp_gt_u32 vcc, 2, v36
    s_nop 1
    v_cndmask_b32 v13, v56, v38, vcc
    s_lshl_b32 s41, s57, 7
    v_lshlrev_b32 v38, 4, v34
    v_add_u32 v38, s41, v38
    v_cmp_gt_u32 vcc, 8, v34
    s_nop 1
    v_cndmask_b32 v22, v56, v38, vcc
    s_lshl_b32 s41, s26, 3
    v_add_u32 v38, s41, v36
    v_and_b32 v39, 15, v38
    v_xor_b32 v39, v39, v35
    v_lshlrev_b32 v39, 4, v39
    v_lshl_add_u32 v14, v38, 13, v39
    v_add_u32 v38, s41, v36
    v_add_u32 v38, 4, v38
    v_and_b32 v39, 15, v38
    v_xor_b32 v39, v39, v35
    v_lshlrev_b32 v39, 4, v39
    v_lshl_add_u32 v15, v38, 13, v39
    s_lshl_b32 s42, s29, 8
    v_add_u32 v14, s42, v14
    v_add_u32 v15, s42, v15
    v_lshrrev_b32 v38, 3, v34
    v_add_u32 v38, s41, v38
    v_and_b32 v39, 6, v38
    v_and_b32 v40, 7, v34
    v_xor_b32 v39, v39, v40
    v_lshlrev_b32 v39, 4, v39
    v_lshl_add_u32 v16, v38, 13, v39
    s_lshl_b32 s43, s30, 7
    s_add_u32 s42, s42, s43
    v_add_u32 v16, s42, v16
    s_lshl_b32 s78, s27, 5
    s_add_u32 s78, s78, s28
    s_lshl_b32 s78, s78, 7
    s_add_u32 s78, s78, 794624
    s_lshl_b32 s76, s26, 11
    s_add_u32 s76, s76, 114688
    s_lshl_b32 s77, s26, 10
    s_add_u32 s77, s77, 131072
    v_lshrrev_b32 v38, 1, v34
    v_lshlrev_b32 v38, 13, v38
    v_and_b32 v39, 1, v34
    v_lshl_add_u32 v38, v39, 7, v38
    s_lshl_b32 s42, s29, 8
    v_add_u32 v23, s42, v38
    s_lshl_b32 s43, s30, 7
    s_add_u32 s42, s42, s43
    v_lshlrev_b32 v38, 13, v34
    v_add_u32 v38, s42, v38
    v_mov_b32 v39, 0x40000000
    v_cmp_gt_u32 vcc, 32, v34
    s_nop 1
    v_cndmask_b32 v12, v39, v38, vcc
    s_mul_i32 s41, s26, 160
    v_lshl_add_u32 v38, v55, 4, v35
    v_add_u32 v38, s41, v38
    v_lshlrev_b32 v38, 4, v38
    v_lshl_add_u32 v0, v54, 15, v38
    s_mul_i32 s41, s26, 3840
    s_add_u32 s41, s41, 81920
    s_movk_i32 s42, 384
    v_mul_lo_u32 v40, v55, s42
    v_lshl_add_u32 v40, v35, 4, v40
    v_lshl_add_u32 v40, v54, 3, v40
    v_add_u32 v1, s41, v40
    s_lshr_b32 s41, s57, 6
    s_lshl_b32 s41, s41, 14
    s_and_b32 s42, s57, 63
    s_lshl_b32 s42, s42, 7
    s_add_u32 s41, s41, s42
    v_lshlrev_b32 v38, 4, v34
    v_add_u32 v38, s41, v38
    v_mov_b32 v39, 0x40000000
    v_cmp_gt_u32 vcc, 8, v34
    s_nop 1
    v_cndmask_b32 v12, v39, v38, vcc
    s_cmp_eq_u32 s26, 3
    s_cselect_b32 s83, 8192, 0
    s_lshl_b32 s41, s29, 11
    s_lshl_b32 s42, s30, 10
    s_add_u32 s41, s41, s42
    v_lshlrev_b32 v38, 4, v34
    v_add_u32 v17, s41, v38
    v_lshlrev_b32 v38, 9, v36
    v_lshl_add_u32 v38, v35, 3, v38
    v_add_u32 v18, 101376, v38
    v_and_b32 v38, 7, v35
    v_lshrrev_b32 v39, 1, v38
    v_and_b32 v40, 1, v38
    v_lshlrev_b32 v40, 4, v40
    v_mov_b32 v57, 0x3f80
    v_lshlrev_b32 v40, v40, v57
    v_lshrrev_b32 v38, 3, v35
    v_cmp_eq_u32 vcc, 0, v39
    s_nop 1
    v_cndmask_b32 v58, 0, v40, vcc
    v_cmp_eq_u32 vcc, 0, v38
    s_nop 1
    v_cndmask_b32 v24, 0, v58, vcc
    v_cmp_eq_u32 vcc, v38, v55
    s_nop 1
    v_cndmask_b32 v20, 0, v58, vcc
    v_cmp_eq_u32 vcc, 1, v39
    s_nop 1
    v_cndmask_b32 v58, 0, v40, vcc
    v_cmp_eq_u32 vcc, 0, v38
    s_nop 1
    v_cndmask_b32 v25, 0, v58, vcc
    v_cmp_eq_u32 vcc, v38, v55
    s_nop 1
    v_cndmask_b32 v21, 0, v58, vcc
    v_cmp_eq_u32 vcc, 2, v39
    s_nop 1
    v_cndmask_b32 v58, 0, v40, vcc
    v_cmp_eq_u32 vcc, 0, v38
    s_nop 1
    v_cndmask_b32 v26, 0, v58, vcc
    v_cmp_eq_u32 vcc, v38, v55
    s_nop 1
    v_cndmask_b32 v22, 0, v58, vcc
    v_cmp_eq_u32 vcc, 3, v39
    s_nop 1
    v_cndmask_b32 v58, 0, v40, vcc
    v_cmp_eq_u32 vcc, 0, v38
    s_nop 1
    v_cndmask_b32 v27, 0, v58, vcc
    v_cmp_eq_u32 vcc, v38, v55
    s_nop 1
    v_cndmask_b32 v23, 0, v58, vcc
    v_mov_b32 v28, 0x3f803f80
    v_mov_b32 v29, 0x3f803f80
    v_mov_b32 v30, 0x3f803f80
    v_mov_b32 v31, 0x3f803f80
    v_mov_b32 v32, 0x3f003f00
    v_mov_b32 v33, 0x3f003f00
    s_load_dwordx2 s[84:85], s[0:1], 8
    s_waitcnt lgkmcnt(0)
    s_and_b32 s85, s85, 0xffff
    s_mov_b32 s86, 10240
    s_mov_b32 s87, 0x20000
    v_lshrrev_b32 v94, 5, v110
    v_and_b32 v95, 31, v110
    v_mul_u32_u24 v95, 20, v95
    v_mul_u32_u24 v40, 1280, v94
    v_lshl_add_u32 v40, v95, 1, v40
    buffer_load_dword v96, v40, s[84:87], 0 offen offset:0
    buffer_load_dword v97, v40, s[84:87], 0 offen offset:4
    buffer_load_dword v98, v40, s[84:87], 0 offen offset:8
    buffer_load_dword v99, v40, s[84:87], 0 offen offset:12
    buffer_load_dword v100, v40, s[84:87], 0 offen offset:16
    buffer_load_dword v101, v40, s[84:87], 0 offen offset:20
    buffer_load_dword v102, v40, s[84:87], 0 offen offset:24
    buffer_load_dword v103, v40, s[84:87], 0 offen offset:28
    buffer_load_dword v104, v40, s[84:87], 0 offen offset:32
    buffer_load_dword v105, v40, s[84:87], 0 offen offset:36
    s_waitcnt vmcnt(40)
    s_barrier
    v_add_u32 v51, 0, v46
    v_add_u32 v52, 0, v47
    v_add_u32 v53, 0, v48
    ds_read_b64_tr_b16 a[0:1], v51 offset:0
    ds_read_b64_tr_b16 a[2:3], v51 offset:1024
    ds_read_b64_tr_b16 a[4:5], v51 offset:8192
    ds_read_b64_tr_b16 a[6:7], v51 offset:9216
    ds_read_b64_tr_b16 a[80:81], v52 offset:0
    ds_read_b64_tr_b16 a[82:83], v52 offset:1024
    ds_read_b64_tr_b16 a[84:85], v52 offset:8192
    ds_read_b64_tr_b16 a[86:87], v52 offset:9216
    ds_read_b64_tr_b16 a[160:161], v51 offset:16384
    ds_read_b64_tr_b16 a[162:163], v51 offset:17408
    ds_read_b64_tr_b16 a[164:165], v51 offset:24576
    ds_read_b64_tr_b16 a[166:167], v51 offset:25600
    ds_read_b64_tr_b16 a[240:241], v52 offset:16384
    ds_read_b64_tr_b16 a[242:243], v52 offset:17408
    ds_read_b64_tr_b16 a[244:245], v52 offset:24576
    ds_read_b64_tr_b16 a[246:247], v52 offset:25600
    ds_read_b64_tr_b16 v[176:177], v53 offset:0
    ds_read_b64_tr_b16 v[178:179], v53 offset:512
    ds_read_b64_tr_b16 v[180:181], v53 offset:4096
    ds_read_b64_tr_b16 v[182:183], v53 offset:4608
    s_waitcnt lgkmcnt(0)
    s_barrier
    s_lshl_b32 s42, s26, 12
    s_add_u32 m0, s42, 0
    s_mov_b32 s41, 2097152
    buffer_load_dwordx4 v42, s[8:11], s41 offen lds
    s_add_u32 m0, s42, 1024
    s_mov_b32 s41, 2129920
    buffer_load_dwordx4 v42, s[8:11], s41 offen lds
    s_add_u32 m0, s42, 2048
    s_mov_b32 s41, 2162688
    buffer_load_dwordx4 v43, s[8:11], s41 offen lds
    s_add_u32 m0, s42, 3072
    s_mov_b32 s41, 2195456
    buffer_load_dwordx4 v43, s[8:11], s41 offen lds
    s_add_u32 m0, s42, 16384
    s_mov_b32 s41, 2097152
    buffer_load_dwordx4 v42, s[12:15], s41 offen lds
    s_add_u32 m0, s42, 17408
    s_mov_b32 s41, 2129920
    buffer_load_dwordx4 v42, s[12:15], s41 offen lds
    s_add_u32 m0, s42, 18432
    s_mov_b32 s41, 2162688
    buffer_load_dwordx4 v43, s[12:15], s41 offen lds
    s_add_u32 m0, s42, 19456
    s_mov_b32 s41, 2195456
    buffer_load_dwordx4 v43, s[12:15], s41 offen lds
    s_lshl_b32 s42, s26, 11
    s_add_u32 m0, s42, 32768
    s_mov_b32 s41, 2097152
    buffer_load_dwordx4 v44, s[16:19], s41 offen lds
    s_add_u32 m0, s42, 33792
    s_mov_b32 s41, 2162688
    buffer_load_dwordx4 v45, s[16:19], s41 offen lds
    s_waitcnt vmcnt(40)
    s_barrier
    v_add_u32 v51, 40960, v46
    v_add_u32 v52, 40960, v47
    v_add_u32 v53, 40960, v48
    ds_read_b64_tr_b16 a[8:9], v51 offset:0
    ds_read_b64_tr_b16 a[10:11], v51 offset:1024
    ds_read_b64_tr_b16 a[12:13], v51 offset:8192
    ds_read_b64_tr_b16 a[14:15], v51 offset:9216
    ds_read_b64_tr_b16 a[88:89], v52 offset:0
    ds_read_b64_tr_b16 a[90:91], v52 offset:1024
    ds_read_b64_tr_b16 a[92:93], v52 offset:8192
    ds_read_b64_tr_b16 a[94:95], v52 offset:9216
    ds_read_b64_tr_b16 a[168:169], v51 offset:16384
    ds_read_b64_tr_b16 a[170:171], v51 offset:17408
    ds_read_b64_tr_b16 a[172:173], v51 offset:24576
    ds_read_b64_tr_b16 a[174:175], v51 offset:25600
    ds_read_b64_tr_b16 a[248:249], v52 offset:16384
    ds_read_b64_tr_b16 a[250:251], v52 offset:17408
    ds_read_b64_tr_b16 a[252:253], v52 offset:24576
    ds_read_b64_tr_b16 a[254:255], v52 offset:25600
    ds_read_b64_tr_b16 v[184:185], v53 offset:0
    ds_read_b64_tr_b16 v[186:187], v53 offset:512
    ds_read_b64_tr_b16 v[188:189], v53 offset:4096
    ds_read_b64_tr_b16 v[190:191], v53 offset:4608
    s_waitcnt lgkmcnt(0)
    s_barrier
    s_lshl_b32 s42, s26, 12
    s_add_u32 m0, s42, 40960
    s_mov_b32 s41, 2621440
    buffer_load_dwordx4 v42, s[8:11], s41 offen lds
    s_add_u32 m0, s42, 41984
    s_mov_b32 s41, 2654208
    buffer_load_dwordx4 v42, s[8:11], s41 offen lds
    s_add_u32 m0, s42, 43008
    s_mov_b32 s41, 2686976
    buffer_load_dwordx4 v43, s[8:11], s41 offen lds
    s_add_u32 m0, s42, 44032
    s_mov_b32 s41, 2719744
    buffer_load_dwordx4 v43, s[8:11], s41 offen lds
    s_add_u32 m0, s42, 57344
    s_mov_b32 s41, 2621440
    buffer_load_dwordx4 v42, s[12:15], s41 offen lds
    s_add_u32 m0, s42, 58368
    s_mov_b32 s41, 2654208
    buffer_load_dwordx4 v42, s[12:15], s41 offen lds
    s_add_u32 m0, s42, 59392
    s_mov_b32 s41, 2686976
    buffer_load_dwordx4 v43, s[12:15], s41 offen lds
    s_add_u32 m0, s42, 60416
    s_mov_b32 s41, 2719744
    buffer_load_dwordx4 v43, s[12:15], s41 offen lds
    s_lshl_b32 s42, s26, 11
    s_add_u32 m0, s42, 73728
    s_mov_b32 s41, 2621440
    buffer_load_dwordx4 v44, s[16:19], s41 offen lds
    s_add_u32 m0, s42, 74752
    s_mov_b32 s41, 2686976
    buffer_load_dwordx4 v45, s[16:19], s41 offen lds
    s_waitcnt vmcnt(40)
    s_barrier
    s_cmp_lg_u32 s26, 0
    s_cbranch_scc1 L_probe_13
    s_add_u32 s41, s64, 0
    s_memtime s[46:47]
    s_waitcnt lgkmcnt(0)
    s_load_dword s42, s[80:81], s41
    s_waitcnt lgkmcnt(0)
    s_memtime s[60:61]
    s_waitcnt lgkmcnt(0)
    s_sub_u32 s42, s60, s46
    s_min_u32 s62, s62, s42
L_probe_13:
    v_add_u32 v51, 81920, v46
    v_add_u32 v52, 81920, v47
    v_add_u32 v53, 81920, v48
    ds_read_b64_tr_b16 a[16:17], v51 offset:0
    ds_read_b64_tr_b16 a[18:19], v51 offset:1024
    ds_read_b64_tr_b16 a[20:21], v51 offset:8192
    ds_read_b64_tr_b16 a[22:23], v51 offset:9216
    ds_read_b64_tr_b16 a[96:97], v52 offset:0
    ds_read_b64_tr_b16 a[98:99], v52 offset:1024
    ds_read_b64_tr_b16 a[100:101], v52 offset:8192
    ds_read_b64_tr_b16 a[102:103], v52 offset:9216
    ds_read_b64_tr_b16 a[176:177], v51 offset:16384
    ds_read_b64_tr_b16 a[178:179], v51 offset:17408
    ds_read_b64_tr_b16 a[180:181], v51 offset:24576
    ds_read_b64_tr_b16 a[182:183], v51 offset:25600
    ds_read_b64_tr_b16 v[112:113], v52 offset:16384
    ds_read_b64_tr_b16 v[114:115], v52 offset:17408
    ds_read_b64_tr_b16 v[116:117], v52 offset:24576
    ds_read_b64_tr_b16 v[118:119], v52 offset:25600
    ds_read_b64_tr_b16 v[192:193], v53 offset:0
    ds_read_b64_tr_b16 v[194:195], v53 offset:512
    ds_read_b64_tr_b16 v[196:197], v53 offset:4096
    ds_read_b64_tr_b16 v[198:199], v53 offset:4608
    s_waitcnt lgkmcnt(0)
    s_barrier
    s_lshl_b32 s42, s26, 12
    s_add_u32 m0, s42, 81920
    s_mov_b32 s41, 3145728
    buffer_load_dwordx4 v42, s[8:11], s41 offen lds
    s_add_u32 m0, s42, 82944
    s_mov_b32 s41, 3178496
    buffer_load_dwordx4 v42, s[8:11], s41 offen lds
    s_add_u32 m0, s42, 83968
    s_mov_b32 s41, 3211264
    buffer_load_dwordx4 v43, s[8:11], s41 offen lds
    s_add_u32 m0, s42, 84992
    s_mov_b32 s41, 3244032
    buffer_load_dwordx4 v43, s[8:11], s41 offen lds
    s_add_u32 m0, s42, 98304
    s_mov_b32 s41, 3145728
    buffer_load_dwordx4 v42, s[12:15], s41 offen lds
    s_add_u32 m0, s42, 99328
    s_mov_b32 s41, 3178496
    buffer_load_dwordx4 v42, s[12:15], s41 offen lds
    s_add_u32 m0, s42, 100352
    s_mov_b32 s41, 3211264
    buffer_load_dwordx4 v43, s[12:15], s41 offen lds
    s_add_u32 m0, s42, 101376
    s_mov_b32 s41, 3244032
    buffer_load_dwordx4 v43, s[12:15], s41 offen lds
    s_lshl_b32 s42, s26, 11
    s_add_u32 m0, s42, 114688
    s_mov_b32 s41, 3145728
    buffer_load_dwordx4 v44, s[16:19], s41 offen lds
    s_add_u32 m0, s42, 115712
    s_mov_b32 s41, 3211264
    buffer_load_dwordx4 v45, s[16:19], s41 offen lds
    s_waitcnt vmcnt(40)
    s_barrier
    s_cmp_lg_u32 s26, 0
    s_cbranch_scc1 L_probe_14
    s_add_u32 s41, s64, 8192
    s_memtime s[46:47]
    s_waitcnt lgkmcnt(0)
    s_load_dword s42, s[80:81], s41
    s_waitcnt lgkmcnt(0)
    s_memtime s[60:61]
    s_waitcnt lgkmcnt(0)
    s_sub_u32 s42, s60, s46
    s_min_u32 s63, s63, s42
L_probe_14:
    v_add_u32 v51, 122880, v46
    v_add_u32 v52, 122880, v47
    v_add_u32 v53, 122880, v48
    ds_read_b64_tr_b16 a[24:25], v51 offset:0
    ds_read_b64_tr_b16 a[26:27], v51 offset:1024
    ds_read_b64_tr_b16 a[28:29], v51 offset:8192
    ds_read_b64_tr_b16 a[30:31], v51 offset:9216
    ds_read_b64_tr_b16 a[104:105], v52 offset:0
    ds_read_b64_tr_b16 a[106:107], v52 offset:1024
    ds_read_b64_tr_b16 a[108:109], v52 offset:8192
    ds_read_b64_tr_b16 a[110:111], v52 offset:9216
    ds_read_b64_tr_b16 a[184:185], v51 offset:16384
    ds_read_b64_tr_b16 a[186:187], v51 offset:17408
    ds_read_b64_tr_b16 a[188:189], v51 offset:24576
    ds_read_b64_tr_b16 a[190:191], v51 offset:25600
    ds_read_b64_tr_b16 v[120:121], v52 offset:16384
    ds_read_b64_tr_b16 v[122:123], v52 offset:17408
    ds_read_b64_tr_b16 v[124:125], v52 offset:24576
    ds_read_b64_tr_b16 v[126:127], v52 offset:25600
    ds_read_b64_tr_b16 v[200:201], v53 offset:0
    ds_read_b64_tr_b16 v[202:203], v53 offset:512
    ds_read_b64_tr_b16 v[204:205], v53 offset:4096
    ds_read_b64_tr_b16 v[206:207], v53 offset:4608
    s_waitcnt lgkmcnt(0)
    s_barrier
    s_lshl_b32 s42, s26, 12
    s_add_u32 m0, s42, 122880
    s_mov_b32 s41, 3670016
    buffer_load_dwordx4 v42, s[8:11], s41 offen lds
    s_add_u32 m0, s42, 123904
    s_mov_b32 s41, 3702784
    buffer_load_dwordx4 v42, s[8:11], s41 offen lds
    s_add_u32 m0, s42, 124928
    s_mov_b32 s41, 3735552
    buffer_load_dwordx4 v43, s[8:11], s41 offen lds
    s_add_u32 m0, s42, 125952
    s_mov_b32 s41, 3768320
    buffer_load_dwordx4 v43, s[8:11], s41 offen lds
    s_add_u32 m0, s42, 139264
    s_mov_b32 s41, 3670016
    buffer_load_dwordx4 v42, s[12:15], s41 offen lds
    s_add_u32 m0, s42, 140288
    s_mov_b32 s41, 3702784
    buffer_load_dwordx4 v42, s[12:15], s41 offen lds
    s_add_u32 m0, s42, 141312
    s_mov_b32 s41, 3735552
    buffer_load_dwordx4 v43, s[12:15], s41 offen lds
    s_add_u32 m0, s42, 142336
    s_mov_b32 s41, 3768320
    buffer_load_dwordx4 v43, s[12:15], s41 offen lds
    s_lshl_b32 s42, s26, 11
    s_add_u32 m0, s42, 155648
    s_mov_b32 s41, 3670016
    buffer_load_dwordx4 v44, s[16:19], s41 offen lds
    s_add_u32 m0, s42, 156672
    s_mov_b32 s41, 3735552
    buffer_load_dwordx4 v45, s[16:19], s41 offen lds
    s_waitcnt vmcnt(30)
    s_barrier
    s_cmp_lg_u32 s26, 0
    s_cbranch_scc1 L_probe_15
    s_add_u32 s41, s64, 16384
    s_memtime s[46:47]
    s_waitcnt lgkmcnt(0)
    s_load_dword s42, s[80:81], s41
    s_waitcnt lgkmcnt(0)
    s_memtime s[60:61]
    s_waitcnt lgkmcnt(0)
    s_sub_u32 s42, s60, s46
    s_min_u32 s62, s62, s42
L_probe_15:
    v_add_u32 v51, 0, v46
    v_add_u32 v52, 0, v47
    v_add_u32 v53, 0, v48
    ds_read_b64_tr_b16 a[32:33], v51 offset:0
    ds_read_b64_tr_b16 a[34:35], v51 offset:1024
    ds_read_b64_tr_b16 a[36:37], v51 offset:8192
    ds_read_b64_tr_b16 a[38:39], v51 offset:9216
    ds_read_b64_tr_b16 a[112:113], v52 offset:0
    ds_read_b64_tr_b16 a[114:115], v52 offset:1024
    ds_read_b64_tr_b16 a[116:117], v52 offset:8192
    ds_read_b64_tr_b16 a[118:119], v52 offset:9216
    ds_read_b64_tr_b16 a[192:193], v51 offset:16384
    ds_read_b64_tr_b16 a[194:195], v51 offset:17408
    ds_read_b64_tr_b16 a[196:197], v51 offset:24576
    ds_read_b64_tr_b16 a[198:199], v51 offset:25600
    ds_read_b64_tr_b16 v[128:129], v52 offset:16384
    ds_read_b64_tr_b16 v[130:131], v52 offset:17408
    ds_read_b64_tr_b16 v[132:133], v52 offset:24576
    ds_read_b64_tr_b16 v[134:135], v52 offset:25600
    ds_read_b64_tr_b16 v[208:209], v53 offset:0
    ds_read_b64_tr_b16 v[210:211], v53 offset:512
    ds_read_b64_tr_b16 v[212:213], v53 offset:4096
    ds_read_b64_tr_b16 v[214:215], v53 offset:4608
    s_waitcnt lgkmcnt(0)
    s_barrier
    s_lshl_b32 s41, s44, 16
    s_lshl_b32 s42, s26, 14
    s_add_u32 s41, s41, s42
    s_add_u32 s41, s41, 159383552
    v_mov_b32 v74, -1
    v_mov_b32 v75, -1
    v_mov_b32 v76, -1
    v_mov_b32 v77, -1
    v_lshlrev_b32 v37, 4, v34
    buffer_store_dwordx4 v[74:77], v37, s[4:7], s41 offen sc1
    s_add_u32 s41, s41, 1024
    buffer_store_dwordx4 v[74:77], v37, s[4:7], s41 offen sc1
    s_add_u32 s41, s41, 1024
    buffer_store_dwordx4 v[74:77], v37, s[4:7], s41 offen sc1
    s_add_u32 s41, s41, 1024
    buffer_store_dwordx4 v[74:77], v37, s[4:7], s41 offen sc1
    s_add_u32 s41, s41, 1024
    buffer_store_dwordx4 v[74:77], v37, s[4:7], s41 offen sc1
    s_add_u32 s41, s41, 1024
    buffer_store_dwordx4 v[74:77], v37, s[4:7], s41 offen sc1
    s_add_u32 s41, s41, 1024
    buffer_store_dwordx4 v[74:77], v37, s[4:7], s41 offen sc1
    s_add_u32 s41, s41, 1024
    buffer_store_dwordx4 v[74:77], v37, s[4:7], s41 offen sc1
    s_add_u32 s41, s41, 1024
    buffer_store_dwordx4 v[74:77], v37, s[4:7], s41 offen sc1
    s_add_u32 s41, s41, 1024
    buffer_store_dwordx4 v[74:77], v37, s[4:7], s41 offen sc1
    s_add_u32 s41, s41, 1024
    buffer_store_dwordx4 v[74:77], v37, s[4:7], s41 offen sc1
    s_add_u32 s41, s41, 1024
    buffer_store_dwordx4 v[74:77], v37, s[4:7], s41 offen sc1
    s_add_u32 s41, s41, 1024
    buffer_store_dwordx4 v[74:77], v37, s[4:7], s41 offen sc1
    s_add_u32 s41, s41, 1024
    buffer_store_dwordx4 v[74:77], v37, s[4:7], s41 offen sc1
    s_add_u32 s41, s41, 1024
    buffer_store_dwordx4 v[74:77], v37, s[4:7], s41 offen sc1
    s_add_u32 s41, s41, 1024
    buffer_store_dwordx4 v[74:77], v37, s[4:7], s41 offen sc1
    s_add_u32 s41, s41, 1024
    s_lshl_b32 s42, s26, 12
    s_add_u32 m0, s42, 0
    s_mov_b32 s41, 4194304
    buffer_load_dwordx4 v42, s[8:11], s41 offen lds
    s_add_u32 m0, s42, 1024
    s_mov_b32 s41, 4227072
    buffer_load_dwordx4 v42, s[8:11], s41 offen lds
    s_add_u32 m0, s42, 2048
    s_mov_b32 s41, 4259840
    buffer_load_dwordx4 v43, s[8:11], s41 offen lds
    s_add_u32 m0, s42, 3072
    s_mov_b32 s41, 4292608
    buffer_load_dwordx4 v43, s[8:11], s41 offen lds
    s_add_u32 m0, s42, 16384
    s_mov_b32 s41, 4194304
    buffer_load_dwordx4 v42, s[12:15], s41 offen lds
    s_add_u32 m0, s42, 17408
    s_mov_b32 s41, 4227072
    buffer_load_dwordx4 v42, s[12:15], s41 offen lds
    s_add_u32 m0, s42, 18432
    s_mov_b32 s41, 4259840
    buffer_load_dwordx4 v43, s[12:15], s41 offen lds
    s_add_u32 m0, s42, 19456
    s_mov_b32 s41, 4292608
    buffer_load_dwordx4 v43, s[12:15], s41 offen lds
    s_lshl_b32 s42, s26, 11
    s_add_u32 m0, s42, 32768
    s_mov_b32 s41, 4194304
    buffer_load_dwordx4 v44, s[16:19], s41 offen lds
    s_add_u32 m0, s42, 33792
    s_mov_b32 s41, 4259840
    buffer_load_dwordx4 v45, s[16:19], s41 offen lds
    s_waitcnt vmcnt(46)
    s_barrier
    s_cmp_lg_u32 s26, 0
    s_cbranch_scc1 L_probe_16
    s_add_u32 s41, s64, 24576
    s_memtime s[46:47]
    s_waitcnt lgkmcnt(0)
    s_load_dword s42, s[80:81], s41
    s_waitcnt lgkmcnt(0)
    s_memtime s[60:61]
    s_waitcnt lgkmcnt(0)
    s_sub_u32 s42, s60, s46
    s_min_u32 s63, s63, s42
L_probe_16:
    v_add_u32 v51, 40960, v46
    v_add_u32 v52, 40960, v47
    v_add_u32 v53, 40960, v48
    ds_read_b64_tr_b16 a[40:41], v51 offset:0
    ds_read_b64_tr_b16 a[42:43], v51 offset:1024
    ds_read_b64_tr_b16 a[44:45], v51 offset:8192
    ds_read_b64_tr_b16 a[46:47], v51 offset:9216
    ds_read_b64_tr_b16 a[120:121], v52 offset:0
    ds_read_b64_tr_b16 a[122:123], v52 offset:1024
    ds_read_b64_tr_b16 a[124:125], v52 offset:8192
    ds_read_b64_tr_b16 a[126:127], v52 offset:9216
    ds_read_b64_tr_b16 a[200:201], v51 offset:16384
    ds_read_b64_tr_b16 a[202:203], v51 offset:17408
    ds_read_b64_tr_b16 a[204:205], v51 offset:24576
    ds_read_b64_tr_b16 a[206:207], v51 offset:25600
    ds_read_b64_tr_b16 v[136:137], v52 offset:16384
    ds_read_b64_tr_b16 v[138:139], v52 offset:17408
    ds_read_b64_tr_b16 v[140:141], v52 offset:24576
    ds_read_b64_tr_b16 v[142:143], v52 offset:25600
    ds_read_b64_tr_b16 v[216:217], v53 offset:0
    ds_read_b64_tr_b16 v[218:219], v53 offset:512
    ds_read_b64_tr_b16 v[220:221], v53 offset:4096
    ds_read_b64_tr_b16 v[222:223], v53 offset:4608
    s_waitcnt lgkmcnt(0)
    s_barrier
    s_lshl_b32 s42, s26, 12
    s_add_u32 m0, s42, 40960
    s_mov_b32 s41, 4718592
    buffer_load_dwordx4 v42, s[8:11], s41 offen lds
    s_add_u32 m0, s42, 41984
    s_mov_b32 s41, 4751360
    buffer_load_dwordx4 v42, s[8:11], s41 offen lds
    s_add_u32 m0, s42, 43008
    s_mov_b32 s41, 4784128
    buffer_load_dwordx4 v43, s[8:11], s41 offen lds
    s_add_u32 m0, s42, 44032
    s_mov_b32 s41, 4816896
    buffer_load_dwordx4 v43, s[8:11], s41 offen lds
    s_add_u32 m0, s42, 57344
    s_mov_b32 s41, 4718592
    buffer_load_dwordx4 v42, s[12:15], s41 offen lds
    s_add_u32 m0, s42, 58368
    s_mov_b32 s41, 4751360
    buffer_load_dwordx4 v42, s[12:15], s41 offen lds
    s_add_u32 m0, s42, 59392
    s_mov_b32 s41, 4784128
    buffer_load_dwordx4 v43, s[12:15], s41 offen lds
    s_add_u32 m0, s42, 60416
    s_mov_b32 s41, 4816896
    buffer_load_dwordx4 v43, s[12:15], s41 offen lds
    s_lshl_b32 s42, s26, 11
    s_add_u32 m0, s42, 73728
    s_mov_b32 s41, 4718592
    buffer_load_dwordx4 v44, s[16:19], s41 offen lds
    s_add_u32 m0, s42, 74752
    s_mov_b32 s41, 4784128
    buffer_load_dwordx4 v45, s[16:19], s41 offen lds
    s_waitcnt vmcnt(46)
    s_barrier
    s_cmp_lg_u32 s26, 0
    s_cbranch_scc1 L_probe_17
    s_add_u32 s41, s64, 32768
    s_memtime s[46:47]
    s_waitcnt lgkmcnt(0)
    s_load_dword s42, s[80:81], s41
    s_waitcnt lgkmcnt(0)
    s_memtime s[60:61]
    s_waitcnt lgkmcnt(0)
    s_sub_u32 s42, s60, s46
    s_min_u32 s62, s62, s42
L_probe_17:
    v_add_u32 v51, 81920, v46
    v_add_u32 v52, 81920, v47
    v_add_u32 v53, 81920, v48
    ds_read_b64_tr_b16 a[48:49], v51 offset:0
    ds_read_b64_tr_b16 a[50:51], v51 offset:1024
    ds_read_b64_tr_b16 a[52:53], v51 offset:8192
    ds_read_b64_tr_b16 a[54:55], v51 offset:9216
    ds_read_b64_tr_b16 a[128:129], v52 offset:0
    ds_read_b64_tr_b16 a[130:131], v52 offset:1024
    ds_read_b64_tr_b16 a[132:133], v52 offset:8192
    ds_read_b64_tr_b16 a[134:135], v52 offset:9216
    ds_read_b64_tr_b16 a[208:209], v51 offset:16384
    ds_read_b64_tr_b16 a[210:211], v51 offset:17408
    ds_read_b64_tr_b16 a[212:213], v51 offset:24576
    ds_read_b64_tr_b16 a[214:215], v51 offset:25600
    ds_read_b64_tr_b16 v[144:145], v52 offset:16384
    ds_read_b64_tr_b16 v[146:147], v52 offset:17408
    ds_read_b64_tr_b16 v[148:149], v52 offset:24576
    ds_read_b64_tr_b16 v[150:151], v52 offset:25600
    ds_read_b64_tr_b16 v[224:225], v53 offset:0
    ds_read_b64_tr_b16 v[226:227], v53 offset:512
    ds_read_b64_tr_b16 v[228:229], v53 offset:4096
    ds_read_b64_tr_b16 v[230:231], v53 offset:4608
    s_waitcnt lgkmcnt(0)
    s_waitcnt vmcnt(36)
    s_barrier
    s_cmp_lg_u32 s26, 0
    s_cbranch_scc1 L_probe_18
    s_add_u32 s41, s64, 40960
    s_memtime s[46:47]
    s_waitcnt lgkmcnt(0)
    s_load_dword s42, s[80:81], s41
    s_waitcnt lgkmcnt(0)
    s_memtime s[60:61]
    s_waitcnt lgkmcnt(0)
    s_sub_u32 s42, s60, s46
    s_min_u32 s63, s63, s42
L_probe_18:
    v_add_u32 v51, 122880, v46
    v_add_u32 v52, 122880, v47
    v_add_u32 v53, 122880, v48
    ds_read_b64_tr_b16 a[56:57], v51 offset:0
    ds_read_b64_tr_b16 a[58:59], v51 offset:1024
    ds_read_b64_tr_b16 a[60:61], v51 offset:8192
    ds_read_b64_tr_b16 a[62:63], v51 offset:9216
    ds_read_b64_tr_b16 a[136:137], v52 offset:0
    ds_read_b64_tr_b16 a[138:139], v52 offset:1024
    ds_read_b64_tr_b16 a[140:141], v52 offset:8192
    ds_read_b64_tr_b16 a[142:143], v52 offset:9216
    ds_read_b64_tr_b16 a[216:217], v51 offset:16384
    ds_read_b64_tr_b16 a[218:219], v51 offset:17408
    ds_read_b64_tr_b16 a[220:221], v51 offset:24576
    ds_read_b64_tr_b16 a[222:223], v51 offset:25600
    ds_read_b64_tr_b16 v[152:153], v52 offset:16384
    ds_read_b64_tr_b16 v[154:155], v52 offset:17408
    ds_read_b64_tr_b16 v[156:157], v52 offset:24576
    ds_read_b64_tr_b16 v[158:159], v52 offset:25600
    ds_read_b64_tr_b16 v[232:233], v53 offset:0
    ds_read_b64_tr_b16 v[234:235], v53 offset:512
    ds_read_b64_tr_b16 v[236:237], v53 offset:4096
    ds_read_b64_tr_b16 v[238:239], v53 offset:4608
    s_waitcnt lgkmcnt(0)
    s_barrier
    s_lshl_b32 s41, s29, 1
    s_add_u32 s41, s41, s30
    s_mul_i32 s41, s41, 81920
    s_mul_i32 s42, s26, 20480
    s_add_u32 s41, s41, s42
    s_add_u32 s42, s42, 81920
    v_lshlrev_b32 v37, 4, v34
    s_mov_b32 m0, s42
    s_add_u32 s42, s42, 1024
    buffer_load_dwordx4 v37, s[20:23], s41 offen lds
    s_add_u32 s41, s41, 1024
    s_mov_b32 m0, s42
    s_add_u32 s42, s42, 1024
    buffer_load_dwordx4 v37, s[20:23], s41 offen lds
    s_add_u32 s41, s41, 1024
    s_mov_b32 m0, s42
    s_add_u32 s42, s42, 1024
    buffer_load_dwordx4 v37, s[20:23], s41 offen lds
    s_add_u32 s41, s41, 1024
    s_mov_b32 m0, s42
    s_add_u32 s42, s42, 1024
    buffer_load_dwordx4 v37, s[20:23], s41 offen lds
    s_add_u32 s41, s41, 1024
    s_mov_b32 m0, s42
    s_add_u32 s42, s42, 1024
    buffer_load_dwordx4 v37, s[20:23], s41 offen lds
    s_add_u32 s41, s41, 1024
    s_mov_b32 m0, s42
    s_add_u32 s42, s42, 1024
    buffer_load_dwordx4 v37, s[20:23], s41 offen lds
    s_add_u32 s41, s41, 1024
    s_mov_b32 m0, s42
    s_add_u32 s42, s42, 1024
    buffer_load_dwordx4 v37, s[20:23], s41 offen lds
    s_add_u32 s41, s41, 1024
    s_mov_b32 m0, s42
    s_add_u32 s42, s42, 1024
    buffer_load_dwordx4 v37, s[20:23], s41 offen lds
    s_add_u32 s41, s41, 1024
    s_mov_b32 m0, s42
    s_add_u32 s42, s42, 1024
    buffer_load_dwordx4 v37, s[20:23], s41 offen lds
    s_add_u32 s41, s41, 1024
    s_mov_b32 m0, s42
    s_add_u32 s42, s42, 1024
    buffer_load_dwordx4 v37, s[20:23], s41 offen lds
    s_add_u32 s41, s41, 1024
    s_mov_b32 m0, s42
    s_add_u32 s42, s42, 1024
    buffer_load_dwordx4 v37, s[20:23], s41 offen lds
    s_add_u32 s41, s41, 1024
    s_mov_b32 m0, s42
    s_add_u32 s42, s42, 1024
    buffer_load_dwordx4 v37, s[20:23], s41 offen lds
    s_add_u32 s41, s41, 1024
    s_mov_b32 m0, s42
    s_add_u32 s42, s42, 1024
    buffer_load_dwordx4 v37, s[20:23], s41 offen lds
    s_add_u32 s41, s41, 1024
    s_mov_b32 m0, s42
    s_add_u32 s42, s42, 1024
    buffer_load_dwordx4 v37, s[20:23], s41 offen lds
    s_add_u32 s41, s41, 1024
    s_mov_b32 m0, s42
    s_add_u32 s42, s42, 1024
    buffer_load_dwordx4 v37, s[20:23], s41 offen lds
    s_add_u32 s41, s41, 1024
    s_mov_b32 m0, s42
    s_add_u32 s42, s42, 1024
    buffer_load_dwordx4 v37, s[20:23], s41 offen lds
    s_add_u32 s41, s41, 1024
    s_mov_b32 m0, s42
    s_add_u32 s42, s42, 1024
    buffer_load_dwordx4 v37, s[20:23], s41 offen lds
    s_add_u32 s41, s41, 1024
    s_mov_b32 m0, s42
    s_add_u32 s42, s42, 1024
    buffer_load_dwordx4 v37, s[20:23], s41 offen lds
    s_add_u32 s41, s41, 1024
    s_mov_b32 m0, s42
    s_add_u32 s42, s42, 1024
    buffer_load_dwordx4 v37, s[20:23], s41 offen lds
    s_add_u32 s41, s41, 1024
    s_mov_b32 m0, s42
    s_add_u32 s42, s42, 1024
    buffer_load_dwordx4 v37, s[20:23], s41 offen lds
    s_add_u32 s41, s41, 1024
    s_waitcnt vmcnt(30)
    s_barrier
    s_cmp_lg_u32 s26, 0
    s_cbranch_scc1 L_arr_19
    s_cmp_lt_u32 s63, s62
    s_cselect_b32 s41, 0x10001, 1
    v_mov_b32 v38, 36
    v_mov_b32 v39, s41
    s_mov_b64 exec, 1
    global_atomic_add v38, v39, s[24:25]
    s_mov_b64 exec, -1
L_arr_19:
    v_add_u32 v51, 0, v46
    v_add_u32 v52, 0, v47
    v_add_u32 v53, 0, v48
    ds_read_b64_tr_b16 a[64:65], v51 offset:0
    ds_read_b64_tr_b16 a[66:67], v51 offset:1024
    ds_read_b64_tr_b16 a[68:69], v51 offset:8192
    ds_read_b64_tr_b16 a[70:71], v51 offset:9216
    ds_read_b64_tr_b16 a[144:145], v52 offset:0
    ds_read_b64_tr_b16 a[146:147], v52 offset:1024
    ds_read_b64_tr_b16 a[148:149], v52 offset:8192
    ds_read_b64_tr_b16 a[150:151], v52 offset:9216
    ds_read_b64_tr_b16 a[224:225], v51 offset:16384
    ds_read_b64_tr_b16 a[226:227], v51 offset:17408
    ds_read_b64_tr_b16 a[228:229], v51 offset:24576
    ds_read_b64_tr_b16 a[230:231], v51 offset:25600
    ds_read_b64_tr_b16 v[160:161], v52 offset:16384
    ds_read_b64_tr_b16 v[162:163], v52 offset:17408
    ds_read_b64_tr_b16 v[164:165], v52 offset:24576
    ds_read_b64_tr_b16 v[166:167], v52 offset:25600
    ds_read_b64_tr_b16 v[240:241], v53 offset:0
    ds_read_b64_tr_b16 v[242:243], v53 offset:512
    ds_read_b64_tr_b16 v[244:245], v53 offset:4096
    ds_read_b64_tr_b16 v[246:247], v53 offset:4608
    s_waitcnt lgkmcnt(0)
    s_waitcnt vmcnt(20)
    s_barrier
    v_add_u32 v51, 40960, v46
    v_add_u32 v52, 40960, v47
    v_add_u32 v53, 40960, v48
    ds_read_b64_tr_b16 a[72:73], v51 offset:0
    ds_read_b64_tr_b16 a[74:75], v51 offset:1024
    ds_read_b64_tr_b16 a[76:77], v51 offset:8192
    ds_read_b64_tr_b16 a[78:79], v51 offset:9216
    ds_read_b64_tr_b16 a[152:153], v52 offset:0
    ds_read_b64_tr_b16 a[154:155], v52 offset:1024
    ds_read_b64_tr_b16 a[156:157], v52 offset:8192
    ds_read_b64_tr_b16 a[158:159], v52 offset:9216
    ds_read_b64_tr_b16 a[232:233], v51 offset:16384
    ds_read_b64_tr_b16 a[234:235], v51 offset:17408
    ds_read_b64_tr_b16 a[236:237], v51 offset:24576
    ds_read_b64_tr_b16 a[238:239], v51 offset:25600
    ds_read_b64_tr_b16 v[168:169], v52 offset:16384
    ds_read_b64_tr_b16 v[170:171], v52 offset:17408
    ds_read_b64_tr_b16 v[172:173], v52 offset:24576
    ds_read_b64_tr_b16 v[174:175], v52 offset:25600
    ds_read_b64_tr_b16 v[248:249], v53 offset:0
    ds_read_b64_tr_b16 v[250:251], v53 offset:512
    ds_read_b64_tr_b16 v[252:253], v53 offset:4096
    ds_read_b64_tr_b16 v[254:255], v53 offset:4608
    s_waitcnt lgkmcnt(0)
    s_waitcnt vmcnt(0)
    s_barrier
    v_lshl_add_u32 v38, v36, 2, v49
    s_movk_i32 s41, 1280
    v_mul_lo_u32 v38, v38, s41
    v_lshl_add_u32 v38, v50, 3, v38
    s_mul_i32 s41, s26, 320
    s_add_u32 s41, s41, 81920
    v_add_u32 v38, s41, v38
    s_mul_i32 s41, s26, 20480
    v_lshlrev_b32 v9, 4, v34
    v_add_u32 v9, s41, v9
    v_add_u32 v39, 40960, v38
    ds_read_b64_tr_b16 v[54:55], v38 offset:0
    ds_read_b64_tr_b16 v[56:57], v38 offset:20480
    ds_read_b64_tr_b16 v[58:59], v39 offset:0
    ds_read_b64_tr_b16 v[60:61], v39 offset:20480
    ds_read_b64_tr_b16 v[62:63], v38 offset:32
    ds_read_b64_tr_b16 v[64:65], v38 offset:20512
    ds_read_b64_tr_b16 v[66:67], v39 offset:32
    ds_read_b64_tr_b16 v[68:69], v39 offset:20512
    ds_read_b64_tr_b16 v[70:71], v38 offset:64
    ds_read_b64_tr_b16 v[72:73], v38 offset:20544
    ds_read_b64_tr_b16 v[74:75], v39 offset:64
    ds_read_b64_tr_b16 v[76:77], v39 offset:20544
    ds_read_b64_tr_b16 v[78:79], v38 offset:96
    ds_read_b64_tr_b16 v[80:81], v38 offset:20576
    ds_read_b64_tr_b16 v[82:83], v39 offset:96
    ds_read_b64_tr_b16 v[84:85], v39 offset:20576
    ds_read_b64_tr_b16 v[86:87], v38 offset:128
    ds_read_b64_tr_b16 v[88:89], v38 offset:20608
    ds_read_b64_tr_b16 v[90:91], v39 offset:128
    ds_read_b64_tr_b16 v[92:93], v39 offset:20608
    s_waitcnt lgkmcnt(0)
    ds_write_b128 v9, v[54:57] offset:0
    ds_write_b128 v9, v[58:61] offset:1024
    ds_write_b128 v9, v[62:65] offset:2048
    ds_write_b128 v9, v[66:69] offset:3072
    ds_write_b128 v9, v[70:73] offset:4096
    ds_write_b128 v9, v[74:77] offset:5120
    ds_write_b128 v9, v[78:81] offset:6144
    ds_write_b128 v9, v[82:85] offset:7168
    ds_write_b128 v9, v[86:89] offset:8192
    ds_write_b128 v9, v[90:93] offset:9216
    ds_read_b64_tr_b16 v[54:55], v38 offset:160
    ds_read_b64_tr_b16 v[56:57], v38 offset:20640
    ds_read_b64_tr_b16 v[58:59], v39 offset:160
    ds_read_b64_tr_b16 v[60:61], v39 offset:20640
    ds_read_b64_tr_b16 v[62:63], v38 offset:192
    ds_read_b64_tr_b16 v[64:65], v38 offset:20672
    ds_read_b64_tr_b16 v[66:67], v39 offset:192
    ds_read_b64_tr_b16 v[68:69], v39 offset:20672
    ds_read_b64_tr_b16 v[70:71], v38 offset:224
    ds_read_b64_tr_b16 v[72:73], v38 offset:20704
    ds_read_b64_tr_b16 v[74:75], v39 offset:224
    ds_read_b64_tr_b16 v[76:77], v39 offset:20704
    ds_read_b64_tr_b16 v[78:79], v38 offset:256
    ds_read_b64_tr_b16 v[80:81], v38 offset:20736
    ds_read_b64_tr_b16 v[82:83], v39 offset:256
    ds_read_b64_tr_b16 v[84:85], v39 offset:20736
    ds_read_b64_tr_b16 v[86:87], v38 offset:288
    ds_read_b64_tr_b16 v[88:89], v38 offset:20768
    ds_read_b64_tr_b16 v[90:91], v39 offset:288
    ds_read_b64_tr_b16 v[92:93], v39 offset:20768
    s_waitcnt lgkmcnt(0)
    ds_write_b128 v9, v[54:57] offset:10240
    ds_write_b128 v9, v[58:61] offset:11264
    ds_write_b128 v9, v[62:65] offset:12288
    ds_write_b128 v9, v[66:69] offset:13312
    ds_write_b128 v9, v[70:73] offset:14336
    ds_write_b128 v9, v[74:77] offset:15360
    ds_write_b128 v9, v[78:81] offset:16384
    ds_write_b128 v9, v[82:85] offset:17408
    ds_write_b128 v9, v[86:89] offset:18432
    ds_write_b128 v9, v[90:93] offset:19456
    s_waitcnt lgkmcnt(0)
    s_barrier
    v_add_u32 v56, 0, v95
    v_lshrrev_b32 v57, 4, v56
    v_lshlrev_b32 v57, 7, v57
    v_lshl_add_u32 v57, v56, 4, v57
    v_lshl_add_u32 v57, v94, 1, v57
    v_add_u32 v57, 81920, v57
    ds_write_b16 v57, v96
    v_add_u32 v56, 1, v95
    v_lshrrev_b32 v57, 4, v56
    v_lshlrev_b32 v57, 7, v57
    v_lshl_add_u32 v57, v56, 4, v57
    v_lshl_add_u32 v57, v94, 1, v57
    v_add_u32 v57, 81920, v57
    ds_write_b16_d16_hi v57, v96
    v_add_u32 v56, 2, v95
    v_lshrrev_b32 v57, 4, v56
    v_lshlrev_b32 v57, 7, v57
    v_lshl_add_u32 v57, v56, 4, v57
    v_lshl_add_u32 v57, v94, 1, v57
    v_add_u32 v57, 81920, v57
    ds_write_b16 v57, v97
    v_add_u32 v56, 3, v95
    v_lshrrev_b32 v57, 4, v56
    v_lshlrev_b32 v57, 7, v57
    v_lshl_add_u32 v57, v56, 4, v57
    v_lshl_add_u32 v57, v94, 1, v57
    v_add_u32 v57, 81920, v57
    ds_write_b16_d16_hi v57, v97
    v_add_u32 v56, 4, v95
    v_lshrrev_b32 v57, 4, v56
    v_lshlrev_b32 v57, 7, v57
    v_lshl_add_u32 v57, v56, 4, v57
    v_lshl_add_u32 v57, v94, 1, v57
    v_add_u32 v57, 81920, v57
    ds_write_b16 v57, v98
    v_add_u32 v56, 5, v95
    v_lshrrev_b32 v57, 4, v56
    v_lshlrev_b32 v57, 7, v57
    v_lshl_add_u32 v57, v56, 4, v57
    v_lshl_add_u32 v57, v94, 1, v57
    v_add_u32 v57, 81920, v57
    ds_write_b16_d16_hi v57, v98
    v_add_u32 v56, 6, v95
    v_lshrrev_b32 v57, 4, v56
    v_lshlrev_b32 v57, 7, v57
    v_lshl_add_u32 v57, v56, 4, v57
    v_lshl_add_u32 v57, v94, 1, v57
    v_add_u32 v57, 81920, v57
    ds_write_b16 v57, v99
    v_add_u32 v56, 7, v95
    v_lshrrev_b32 v57, 4, v56
    v_lshlrev_b32 v57, 7, v57
    v_lshl_add_u32 v57, v56, 4, v57
    v_lshl_add_u32 v57, v94, 1, v57
    v_add_u32 v57, 81920, v57
    ds_write_b16_d16_hi v57, v99
    v_add_u32 v56, 8, v95
    v_lshrrev_b32 v57, 4, v56
    v_lshlrev_b32 v57, 7, v57
    v_lshl_add_u32 v57, v56, 4, v57
    v_lshl_add_u32 v57, v94, 1, v57
    v_add_u32 v57, 81920, v57
    ds_write_b16 v57, v100
    v_add_u32 v56, 9, v95
    v_lshrrev_b32 v57, 4, v56
    v_lshlrev_b32 v57, 7, v57
    v_lshl_add_u32 v57, v56, 4, v57
    v_lshl_add_u32 v57, v94, 1, v57
    v_add_u32 v57, 81920, v57
    ds_write_b16_d16_hi v57, v100
    v_add_u32 v56, 10, v95
    v_lshrrev_b32 v57, 4, v56
    v_lshlrev_b32 v57, 7, v57
    v_lshl_add_u32 v57, v56, 4, v57
    v_lshl_add_u32 v57, v94, 1, v57
    v_add_u32 v57, 81920, v57
    ds_write_b16 v57, v101
    v_add_u32 v56, 11, v95
    v_lshrrev_b32 v57, 4, v56
    v_lshlrev_b32 v57, 7, v57
    v_lshl_add_u32 v57, v56, 4, v57
    v_lshl_add_u32 v57, v94, 1, v57
    v_add_u32 v57, 81920, v57
    ds_write_b16_d16_hi v57, v101
    v_add_u32 v56, 12, v95
    v_lshrrev_b32 v57, 4, v56
    v_lshlrev_b32 v57, 7, v57
    v_lshl_add_u32 v57, v56, 4, v57
    v_lshl_add_u32 v57, v94, 1, v57
    v_add_u32 v57, 81920, v57
    ds_write_b16 v57, v102
    v_add_u32 v56, 13, v95
    v_lshrrev_b32 v57, 4, v56
    v_lshlrev_b32 v57, 7, v57
    v_lshl_add_u32 v57, v56, 4, v57
    v_lshl_add_u32 v57, v94, 1, v57
    v_add_u32 v57, 81920, v57
    ds_write_b16_d16_hi v57, v102
    v_add_u32 v56, 14, v95
    v_lshrrev_b32 v57, 4, v56
    v_lshlrev_b32 v57, 7, v57
    v_lshl_add_u32 v57, v56, 4, v57
    v_lshl_add_u32 v57, v94, 1, v57
    v_add_u32 v57, 81920, v57
    ds_write_b16 v57, v103
    v_add_u32 v56, 15, v95
    v_lshrrev_b32 v57, 4, v56
    v_lshlrev_b32 v57, 7, v57
    v_lshl_add_u32 v57, v56, 4, v57
    v_lshl_add_u32 v57, v94, 1, v57
    v_add_u32 v57, 81920, v57
    ds_write_b16_d16_hi v57, v103
    v_add_u32 v56, 16, v95
    v_lshrrev_b32 v57, 4, v56
    v_lshlrev_b32 v57, 7, v57
    v_lshl_add_u32 v57, v56, 4, v57
    v_lshl_add_u32 v57, v94, 1, v57
    v_add_u32 v57, 81920, v57
    ds_write_b16 v57, v104
    v_add_u32 v56, 17, v95
    v_lshrrev_b32 v57, 4, v56
    v_lshlrev_b32 v57, 7, v57
    v_lshl_add_u32 v57, v56, 4, v57
    v_lshl_add_u32 v57, v94, 1, v57
    v_add_u32 v57, 81920, v57
    ds_write_b16_d16_hi v57, v104
    v_add_u32 v56, 18, v95
    v_lshrrev_b32 v57, 4, v56
    v_lshlrev_b32 v57, 7, v57
    v_lshl_add_u32 v57, v56, 4, v57
    v_lshl_add_u32 v57, v94, 1, v57
    v_add_u32 v57, 81920, v57
    ds_write_b16 v57, v105
    v_add_u32 v56, 19, v95
    v_lshrrev_b32 v57, 4, v56
    v_lshlrev_b32 v57, 7, v57
    v_lshl_add_u32 v57, v56, 4, v57
    v_lshl_add_u32 v57, v94, 1, v57
    v_add_u32 v57, 81920, v57
    ds_write_b16_d16_hi v57, v105
    s_mov_b32 s31, 0
    s_mov_b32 s49, 0
    s_mov_b32 s38, 33554432
    s_mov_b32 s39, 50331648
    s_mov_b32 s42, 786432
    s_mov_b32 s45, 0x200000
    v_mov_b32 v74, 132
L_zw_20:
    global_load_dword v75, v74, s[24:25] sc1
    s_waitcnt vmcnt(0)
    v_readfirstlane_b32 s41, v75
    s_nop 0
    s_cmp_ge_u32 s41, 1
    s_cbranch_scc1 L_zd_21
    s_sleep 2
    s_sub_u32 s45, s45, 1
    s_cbranch_scc0 L_zw_20
L_zd_21:
    s_mov_b32 s45, 0x200000
    v_mov_b32 v74, 0
L_cw_22:
    buffer_load_dword v75, v74, s[4:7], s42 offen sc1
    s_waitcnt vmcnt(0)
    v_readfirstlane_b32 s41, v75
    s_nop 0
    s_cmp_ge_u32 s41, 64
    s_cbranch_scc1 L_cd_23
    s_sleep 2
    s_sub_u32 s45, s45, 1
    s_cbranch_scc0 L_cw_22
L_cd_23:
    s_mov_b32 m0, s76
    s_nop 0
    buffer_load_dwordx4 v14, s[4:7], s38 offen sc1 lds
    s_add_u32 m0, s76, 1024
    s_nop 0
    buffer_load_dwordx4 v15, s[4:7], s38 offen sc1 lds
    s_mov_b32 m0, s77
    s_nop 0
    buffer_load_dwordx4 v16, s[4:7], s39 offen sc1 lds
    s_add_u32 s38, s38, 262144
    s_add_u32 s39, s39, 262144
    s_xor_b32 s76, s76, 8192
    s_xor_b32 s77, s77, 4096
    s_mul_i32 s41, s27, 327680
    s_add_u32 s35, s41, 96468992
    s_mul_i32 s41, s27, 49152
    s_add_u32 s37, s41, 92274688
    s_sub_u32 s41, 49152, s41
    s_add_u32 s33, s41, 92274688
    s_mul_i32 s41, s27, 10240
    s_add_u32 s55, s41, 98566144
    s_xor_b32 s54, s55, 32768
    s_mov_b32 s45, 0x100000
    v_mov_b32 v83, 0
L_tick_24:
    global_load_dwordx4 v[74:77], v83, s[24:25] sc1
    global_load_dwordx4 v[78:81], v83, s[24:25] offset:16 sc1
    s_waitcnt vmcnt(0)
    v_add3_u32 v82, v74, v75, v76
    v_add3_u32 v82, v82, v77, v78
    v_add3_u32 v82, v82, v79, v80
    v_add_u32 v82, v82, v81
    s_nop 0
    v_readfirstlane_b32 s42, v82
    s_nop 0
    s_cmp_ge_u32 s42, 256
    s_cbranch_scc1 L_tickd_25
    s_sleep 4
    s_sub_u32 s45, s45, 1
    s_cbranch_scc0 L_tick_24
L_tickd_25:
    v_readfirstlane_b32 s42, v74
    v_readfirstlane_b32 s43, v75
    s_cmp_eq_u32 s27, 0
    s_cselect_b32 s41, s42, s43
    s_cmp_ge_u32 s41, 32
    s_cselect_b32 s32, 1, 0
    s_mov_b32 s45, 0x100000
    v_mov_b32 v38, 36
L_initw_26:
    global_load_dword v39, v38, s[24:25] sc1
    s_waitcnt vmcnt(0)
    v_readfirstlane_b32 s41, v39
    s_nop 0
    s_and_b32 s42, s41, 0xffff
    s_cmp_ge_u32 s42, 64
    s_cbranch_scc1 L_initd_27
    s_sleep 2
    s_sub_u32 s45, s45, 1
    s_cbranch_scc0 L_initw_26
L_initd_27:
    s_lshr_b32 s42, s41, 16
    s_cmp_ge_u32 s42, 32
    s_cselect_b32 s42, 8192, 0
    s_add_u32 s33, s33, s42
    s_add_u32 s37, s37, s42
    s_add_u32 s89, s42, 159383552
    s_lshl_b32 s41, s27, 15
    s_add_u32 s88, s89, s41
    s_waitcnt vmcnt(0) lgkmcnt(0)
    s_barrier
    s_mov_b32 s52, 0x3e0293ee
    s_mov_b32 s53, 0x3e0293ee
    s_mov_b32 s50, 0xbe0293ee
    s_mov_b32 s40, 0x40000000
    v_mov_b32 v74, 0
    v_mov_b32 v75, 0
    v_mov_b32 v76, 0
    v_mov_b32 v77, 0
    v_mov_b32 v78, 0
    v_mov_b32 v79, 0
    v_mov_b32 v80, 0
    v_mov_b32 v81, 0
    v_mov_b32 v82, 0
    v_mov_b32 v83, 0
    v_mov_b32 v84, 0
    v_mov_b32 v85, 0
    v_mov_b32 v86, 0
    v_mov_b32 v87, 0
    v_mov_b32 v88, 0
    v_mov_b32 v89, 0
    v_mov_b32 v90, 0
    v_mov_b32 v91, 0
    v_mov_b32 v92, 0
    v_mov_b32 v93, 0
    s_cmp_eq_u32 s32, 0
    s_cbranch_scc1 L_slow_28
L_step_29:
    s_cmp_eq_u32 s31, 63
    s_cbranch_scc1 L_last_short_31
    ds_read_b64_tr_b16 v[34:35], v2 offset:0
    ds_read_b64_tr_b16 v[36:37], v2 offset:128
    ds_read_b64_tr_b16 v[38:39], v2 offset:1536
    ds_read_b64_tr_b16 v[40:41], v2 offset:1664
    ds_read_b64_tr_b16 v[42:43], v2 offset:3072
    ds_read_b64_tr_b16 v[44:45], v2 offset:3200
    ds_read_b64_tr_b16 v[46:47], v2 offset:4608
    ds_read_b64_tr_b16 v[48:49], v2 offset:4736
    ds_read_b64_tr_b16 v[50:51], v2 offset:6144
    ds_read_b64_tr_b16 v[52:53], v2 offset:6272
    ds_read_b64_tr_b16 v[54:55], v2 offset:7680
    ds_read_b64_tr_b16 v[56:57], v2 offset:7808
    s_lshr_b32 s58, s31, 1
    s_and_b32 s58, s58, 1
    s_cmp_lg_u32 s26, 3
    s_cbranch_scc1 L_w3st_32
    buffer_store_dwordx4 v[94:97], v17, s[4:7], s40 offen sc1
    s_add_u32 s41, s40, 4194304
    buffer_store_dwordx4 v[98:101], v17, s[4:7], s41 offen sc1
    s_cmp_lt_u32 s31, 2
    s_cbranch_scc1 L_noprog_33
    s_sub_u32 s43, s31, 1
    v_mov_b32 v110, s43
    buffer_store_dword v110, off, s[4:7], s78 sc1
L_noprog_33:
L_w3st_32:
    s_mov_b32 m0, s76
    s_nop 0
    buffer_load_dwordx4 v14, s[4:7], s38 offen sc1 lds
    s_add_u32 m0, s76, 1024
    s_nop 0
    buffer_load_dwordx4 v15, s[4:7], s38 offen sc1 lds
    s_waitcnt lgkmcnt(10)
    v_smfmac_f32_16x16x64_bf16 v[74:77], v[34:37], a[0:7], v3
    ds_read_b64_tr_b16 v[58:59], v2 offset:9216
    v_smfmac_f32_16x16x64_bf16 v[78:81], v[34:37], a[80:87], v3
    ds_read_b64_tr_b16 v[60:61], v2 offset:9344
    s_waitcnt lgkmcnt(10)
    v_smfmac_f32_16x16x64_bf16 v[74:77], v[38:41], a[8:15], v3
    ds_read_b64_tr_b16 v[62:63], v2 offset:10752
    v_smfmac_f32_16x16x64_bf16 v[78:81], v[38:41], a[88:95], v3
    ds_read_b64_tr_b16 v[64:65], v2 offset:10880
    s_waitcnt lgkmcnt(10)
    v_smfmac_f32_16x16x64_bf16 v[74:77], v[42:45], a[16:23], v3
    ds_read_b64_tr_b16 v[66:67], v2 offset:12288
    v_smfmac_f32_16x16x64_bf16 v[78:81], v[42:45], a[96:103], v3
    ds_read_b64_tr_b16 v[68:69], v2 offset:12416
    s_waitcnt lgkmcnt(10)
    v_smfmac_f32_16x16x64_bf16 v[74:77], v[46:49], a[24:31], v3
    ds_read_b64_tr_b16 v[70:71], v2 offset:13824
    v_smfmac_f32_16x16x64_bf16 v[78:81], v[46:49], a[104:111], v3
    ds_read_b64_tr_b16 v[72:73], v2 offset:13952
    s_waitcnt lgkmcnt(10)
    v_smfmac_f32_16x16x64_bf16 v[74:77], v[50:53], a[32:39], v3
    v_smfmac_f32_16x16x64_bf16 v[78:81], v[50:53], a[112:119], v3
    s_waitcnt lgkmcnt(8)
    v_smfmac_f32_16x16x64_bf16 v[74:77], v[54:57], a[40:47], v3
    v_smfmac_f32_16x16x64_bf16 v[78:81], v[54:57], a[120:127], v3
    s_mov_b32 m0, s77
    s_nop 0
    buffer_load_dwordx4 v16, s[4:7], s39 offen sc1 lds
    s_add_u32 s38, s38, 262144
    s_add_u32 s39, s39, 262144
    s_xor_b32 s76, s76, 8192
    s_xor_b32 s77, s77, 4096
    s_waitcnt lgkmcnt(6)
    v_smfmac_f32_16x16x64_bf16 v[74:77], v[58:61], a[48:55], v3
    v_smfmac_f32_16x16x64_bf16 v[78:81], v[58:61], a[128:135], v3
    s_waitcnt lgkmcnt(4)
    v_smfmac_f32_16x16x64_bf16 v[74:77], v[62:65], a[56:63], v3
    v_smfmac_f32_16x16x64_bf16 v[78:81], v[62:65], a[136:143], v3
    s_waitcnt lgkmcnt(2)
    v_smfmac_f32_16x16x64_bf16 v[74:77], v[66:69], a[64:71], v3
    v_smfmac_f32_16x16x64_bf16 v[78:81], v[66:69], a[144:151], v3
    s_waitcnt lgkmcnt(0)
    v_smfmac_f32_16x16x64_bf16 v[74:77], v[70:73], a[72:79], v3
    v_smfmac_f32_16x16x64_bf16 v[78:81], v[70:73], a[152:159], v3
    v_smfmac_f32_16x16x64_bf16 v[82:85], v[34:37], a[160:167], v3
    v_add_u32 v110, s49, v6
    v_smfmac_f32_16x16x64_bf16 v[86:89], v[34:37], a[240:247], v3
    ds_read_b128 v[94:97], v110 offset:0
    v_smfmac_f32_16x16x64_bf16 v[82:85], v[38:41], a[168:175], v3
    v_xor_b32 v110, 64, v110
    v_smfmac_f32_16x16x64_bf16 v[86:89], v[38:41], a[248:255], v3
    ds_read_b128 v[98:101], v110 offset:0
    v_smfmac_f32_16x16x64_bf16 v[82:85], v[42:45], a[176:183], v3
    v_xor_b32 v110, 192, v110
    v_smfmac_f32_16x16x64_bf16 v[86:89], v[42:45], v[112:119], v3
    ds_read_b128 v[102:105], v110 offset:0
    v_smfmac_f32_16x16x64_bf16 v[82:85], v[46:49], a[184:191], v3
    v_xor_b32 v110, 64, v110
    v_smfmac_f32_16x16x64_bf16 v[86:89], v[46:49], v[120:127], v3
    ds_read_b128 v[106:109], v110 offset:0
    v_smfmac_f32_16x16x64_bf16 v[82:85], v[50:53], a[192:199], v3
    v_permlane32_swap_b32 v74, v78
    v_smfmac_f32_16x16x64_bf16 v[86:89], v[50:53], v[128:135], v3
    v_permlane32_swap_b32 v75, v79
    v_smfmac_f32_16x16x64_bf16 v[82:85], v[54:57], a[200:207], v3
    v_permlane32_swap_b32 v76, v80
    v_smfmac_f32_16x16x64_bf16 v[86:89], v[54:57], v[136:143], v3
    v_permlane32_swap_b32 v77, v81
    v_smfmac_f32_16x16x64_bf16 v[82:85], v[58:61], a[208:215], v3
    v_add_f32 v74, v74, v78
    v_smfmac_f32_16x16x64_bf16 v[86:89], v[58:61], v[144:151], v3
    v_add_f32 v75, v75, v79
    v_smfmac_f32_16x16x64_bf16 v[82:85], v[62:65], a[216:223], v3
    v_add_f32 v76, v76, v80
    v_smfmac_f32_16x16x64_bf16 v[86:89], v[62:65], v[152:159], v3
    v_add_f32 v77, v77, v81
    v_smfmac_f32_16x16x64_bf16 v[82:85], v[66:69], a[224:231], v3
    v_cvt_pk_bf16_f32 v74, v74, v75
    v_smfmac_f32_16x16x64_bf16 v[86:89], v[66:69], v[160:167], v3
    v_cvt_pk_bf16_f32 v75, v76, v77
    v_smfmac_f32_16x16x64_bf16 v[82:85], v[70:73], a[232:239], v3
    ds_write_b64 v4, v[74:75] offset:0
    v_smfmac_f32_16x16x64_bf16 v[86:89], v[70:73], v[168:175], v3
    v_smfmac_f32_16x16x64_bf16 v[90:93], v[34:37], v[176:183], v3
    v_smfmac_f32_16x16x64_bf16 v[90:93], v[38:41], v[184:191], v3
    v_smfmac_f32_16x16x64_bf16 v[90:93], v[42:45], v[192:199], v3
    v_smfmac_f32_16x16x64_bf16 v[90:93], v[46:49], v[200:207], v3
    v_smfmac_f32_16x16x64_bf16 v[90:93], v[50:53], v[208:215], v3
    s_nop 2
    v_permlane32_swap_b32 v82, v86
    v_permlane32_swap_b32 v83, v87
    v_smfmac_f32_16x16x64_bf16 v[90:93], v[54:57], v[216:223], v3
    v_permlane32_swap_b32 v84, v88
    v_permlane32_swap_b32 v85, v89
    v_smfmac_f32_16x16x64_bf16 v[90:93], v[58:61], v[224:231], v3
    v_add_f32 v82, v82, v86
    v_add_f32 v83, v83, v87
    v_smfmac_f32_16x16x64_bf16 v[90:93], v[62:65], v[232:239], v3
    v_add_f32 v84, v84, v88
    v_add_f32 v85, v85, v89
    v_smfmac_f32_16x16x64_bf16 v[90:93], v[66:69], v[240:247], v3
    v_cvt_pk_bf16_f32 v82, v82, v83
    v_cvt_pk_bf16_f32 v83, v84, v85
    v_smfmac_f32_16x16x64_bf16 v[90:93], v[70:73], v[248:255], v3
    ds_write_b64 v4, v[82:83] offset:2048
    v_add_u32 v110, s49, v6
    ds_read_b128 v[74:77], v110 offset:4096
    v_xor_b32 v110, 64, v110
    ds_read_b128 v[78:81], v110 offset:4096
    v_xor_b32 v110, 192, v110
    ds_read_b128 v[82:85], v110 offset:4096
    v_xor_b32 v110, 64, v110
    ds_read_b128 v[86:89], v110 offset:4096
    s_waitcnt lgkmcnt(4)
    s_barrier
    ds_read_b64_tr_b16 v[34:35], v5 offset:0
    ds_read_b64_tr_b16 v[36:37], v5 offset:64
    ds_read_b64_tr_b16 v[38:39], v5 offset:512
    ds_read_b64_tr_b16 v[40:41], v5 offset:576
    ds_read_b64_tr_b16 v[42:43], v5 offset:1024
    ds_read_b64_tr_b16 v[44:45], v5 offset:1088
    ds_read_b64_tr_b16 v[46:47], v5 offset:1536
    ds_read_b64_tr_b16 v[48:49], v5 offset:1600
    v_cvt_pk_bf16_f32 v110, v90, v91
    v_cvt_pk_bf16_f32 v111, v92, v93
    ds_write_b64 v8, v[110:111]
    ds_read_b64_tr_b16 v[50:51], v5 offset:2048
    ds_read_b64_tr_b16 v[52:53], v5 offset:2112
    s_waitcnt lgkmcnt(9)
    v_mfma_f32_16x16x32_bf16 v[70:73], v[94:97], v[34:37], 0
    v_mfma_f32_16x16x32_bf16 v[90:93], v[74:77], v[34:37], 0
    ds_read_b64_tr_b16 v[54:55], v5 offset:2560
    ds_read_b64_tr_b16 v[56:57], v5 offset:2624
    s_waitcnt lgkmcnt(9)
    v_mfma_f32_16x16x32_bf16 v[70:73], v[98:101], v[38:41], v[70:73]
    v_mfma_f32_16x16x32_bf16 v[90:93], v[78:81], v[38:41], v[90:93]
    ds_read_b64_tr_b16 v[58:59], v5 offset:3072
    ds_read_b64_tr_b16 v[60:61], v5 offset:3136
    s_waitcnt lgkmcnt(9)
    v_mfma_f32_16x16x32_bf16 v[70:73], v[102:105], v[42:45], v[70:73]
    v_mfma_f32_16x16x32_bf16 v[90:93], v[82:85], v[42:45], v[90:93]
    ds_read_b64_tr_b16 v[62:63], v5 offset:3584
    ds_read_b64_tr_b16 v[64:65], v5 offset:3648
    s_waitcnt lgkmcnt(9)
    v_mfma_f32_16x16x32_bf16 v[70:73], v[106:109], v[46:49], v[70:73]
    v_mfma_f32_16x16x32_bf16 v[90:93], v[86:89], v[46:49], v[90:93]
    s_waitcnt lgkmcnt(6)
    v_mfma_f32_16x16x32_bf16 v[66:69], v[50:53], v[34:37], 0
    s_waitcnt lgkmcnt(4)
    v_mfma_f32_16x16x32_bf16 v[66:69], v[54:57], v[38:41], v[66:69]
    s_waitcnt lgkmcnt(2)
    v_mfma_f32_16x16x32_bf16 v[66:69], v[58:61], v[42:45], v[66:69]
    s_waitcnt lgkmcnt(0)
    v_mfma_f32_16x16x32_bf16 v[66:69], v[62:65], v[46:49], v[66:69]
    s_barrier
    s_lshr_b32 s41, s49, 1
    v_add_u32 v110, s41, v7
    v_max3_f32 v111, v70, v71, v72
    ds_read_b64_tr_b16 v[34:35], v110
    ds_read_b64_tr_b16 v[36:37], v110 offset:2048
    v_xor_b32 v110, 32, v110
    ds_read_b64_tr_b16 v[38:39], v110
    ds_read_b64_tr_b16 v[40:41], v110 offset:2048
    v_xor_b32 v110, 96, v110
    ds_read_b64_tr_b16 v[42:43], v110
    ds_read_b64_tr_b16 v[44:45], v110 offset:2048
    v_xor_b32 v110, 32, v110
    ds_read_b64_tr_b16 v[46:47], v110
    ds_read_b64_tr_b16 v[48:49], v110 offset:2048
    v_max3_f32 v111, v111, v73, v90
    v_max3_f32 v111, v111, v91, v92
    v_max3_f32 v111, v111, v93, v66
    v_max3_f32 v111, v111, v67, v68
    v_max_f32 v111, v111, v69
    ds_read_b64 v[50:51], v19 offset:0
    ds_read_b64 v[52:53], v19 offset:512
    ds_read_b64 v[54:55], v19 offset:1024
    ds_read_b64 v[56:57], v19 offset:1536
    v_mov_b32 v110, v111
    ds_read_b128 v[94:97], v9 offset:0
    ds_read_b128 v[98:101], v9 offset:1024
    v_permlane32_swap_b32 v111, v110
    v_max_f32 v111, v111, v110
    v_mov_b32 v110, v111
    ds_read_b128 v[102:105], v9 offset:2048
    ds_read_b128 v[106:109], v9 offset:3072
    v_permlane16_swap_b32 v111, v110
    v_max_f32 v111, v111, v110
    v_mul_f32 v111, s50, v111
    v_pk_fma_f32 v[70:71], v[70:71], s[52:53], v[110:111] op_sel:[0,0,1] op_sel_hi:[1,1,1]
    v_pk_fma_f32 v[72:73], v[72:73], s[52:53], v[110:111] op_sel:[0,0,1] op_sel_hi:[1,1,1]
    v_exp_f32 v70, v70
    v_exp_f32 v71, v71
    v_exp_f32 v72, v72
    v_exp_f32 v73, v73
    v_cvt_pk_bf16_f32 v74, v70, v71
    v_cvt_pk_bf16_f32 v75, v72, v73
    v_pk_fma_f32 v[90:91], v[90:91], s[52:53], v[110:111] op_sel:[0,0,1] op_sel_hi:[1,1,1]
    v_pk_fma_f32 v[92:93], v[92:93], s[52:53], v[110:111] op_sel:[0,0,1] op_sel_hi:[1,1,1]
    v_exp_f32 v90, v90
    v_exp_f32 v91, v91
    v_exp_f32 v92, v92
    v_exp_f32 v93, v93
    v_cvt_pk_bf16_f32 v76, v90, v91
    v_cvt_pk_bf16_f32 v77, v92, v93
    v_pk_fma_f32 v[66:67], v[66:67], s[52:53], v[110:111] op_sel:[0,0,1] op_sel_hi:[1,1,1]
    v_pk_fma_f32 v[68:69], v[68:69], s[52:53], v[110:111] op_sel:[0,0,1] op_sel_hi:[1,1,1]
    s_waitcnt lgkmcnt(12)
    v_mfma_f32_16x16x32_bf16 v[70:73], v[38:41], v[74:77], 0
    v_exp_f32 v66, v66
    s_waitcnt lgkmcnt(10)
    v_mfma_f32_16x16x32_bf16 v[90:93], v[42:45], v[74:77], 0
    v_exp_f32 v67, v67
    s_waitcnt lgkmcnt(8)
    v_mfma_f32_16x16x32_bf16 v[80:83], v[46:49], v[74:77], 0
    v_exp_f32 v68, v68
    v_mfma_f32_16x16x32_bf16 v[84:87], v[28:31], v[74:77], 0
    v_exp_f32 v69, v69
    v_cvt_pk_bf16_f32 v78, v66, v67
    v_cvt_pk_bf16_f32 v79, v68, v69
    v_mfma_f32_16x16x32_bf16 v[66:69], v[34:37], v[74:77], 0
    s_waitcnt lgkmcnt(4)
    s_nop 0
    v_mfma_f32_16x16x16_bf16 v[84:87], v[32:33], v[78:79], v[84:87]
    v_mfma_f32_16x16x16_bf16 v[70:73], v[52:53], v[78:79], v[70:73]
    v_mfma_f32_16x16x16_bf16 v[90:93], v[54:55], v[78:79], v[90:93]
    v_mfma_f32_16x16x16_bf16 v[80:83], v[56:57], v[78:79], v[80:83]
    v_mfma_f32_16x16x16_bf16 v[66:69], v[50:51], v[78:79], v[66:69]
    ds_read_b128 v[58:61], v9 offset:4096
    ds_read_b128 v[62:65], v9 offset:5120
    ds_read_b128 v[38:41], v9 offset:6144
    ds_read_b128 v[42:45], v9 offset:7168
    v_rcp_f32 v110, v84
    s_nop 0
    v_pk_mul_f32 v[70:71], v[70:71], v[110:111] op_sel_hi:[1,0]
    v_pk_mul_f32 v[72:73], v[72:73], v[110:111] op_sel_hi:[1,0]
    v_pk_mul_f32 v[90:91], v[90:91], v[110:111] op_sel_hi:[1,0]
    v_pk_mul_f32 v[92:93], v[92:93], v[110:111] op_sel_hi:[1,0]
    v_pk_mul_f32 v[80:81], v[80:81], v[110:111] op_sel_hi:[1,0]
    v_pk_mul_f32 v[82:83], v[82:83], v[110:111] op_sel_hi:[1,0]
    v_pk_mul_f32 v[66:67], v[66:67], v[110:111] op_sel_hi:[1,0]
    v_pk_mul_f32 v[68:69], v[68:69], v[110:111] op_sel_hi:[1,0]
    v_cvt_pk_bf16_f32 v74, v66, v67
    v_cvt_pk_bf16_f32 v75, v68, v69
    v_cvt_pk_bf16_f32 v76, v70, v71
    v_cvt_pk_bf16_f32 v77, v72, v73
    v_cvt_pk_bf16_f32 v34, v90, v91
    v_cvt_pk_bf16_f32 v35, v92, v93
    v_cvt_pk_bf16_f32 v36, v80, v81
    v_cvt_pk_bf16_f32 v37, v82, v83
    ds_read_b128 v[46:49], v9 offset:8192
    ds_read_b128 v[50:53], v9 offset:9216
    s_waitcnt lgkmcnt(8)
    v_mfma_f32_16x16x32_bf16 v[66:69], v[74:77], v[94:97], 0
    v_mfma_f32_16x16x32_bf16 v[66:69], v[34:37], v[98:101], v[66:69]
    ds_read_b128 v[94:97], v9 offset:10240
    ds_read_b128 v[98:101], v9 offset:11264
    s_waitcnt lgkmcnt(8)
    v_mfma_f32_16x16x32_bf16 v[70:73], v[74:77], v[102:105], 0
    v_mfma_f32_16x16x32_bf16 v[70:73], v[34:37], v[106:109], v[70:73]
    ds_read_b128 v[102:105], v9 offset:12288
    ds_read_b128 v[106:109], v9 offset:13312
    s_waitcnt lgkmcnt(8)
    v_mfma_f32_16x16x32_bf16 v[90:93], v[74:77], v[58:61], 0
    v_mfma_f32_16x16x32_bf16 v[90:93], v[34:37], v[62:65], v[90:93]
    ds_read_b128 v[58:61], v9 offset:14336
    ds_read_b128 v[62:65], v9 offset:15360
    s_waitcnt lgkmcnt(8)
    v_mfma_f32_16x16x32_bf16 v[80:83], v[74:77], v[38:41], 0
    v_cvt_pk_bf16_f32 v66, v66, v67
    v_cvt_pk_bf16_f32 v67, v68, v69
    v_mfma_f32_16x16x32_bf16 v[80:83], v[34:37], v[42:45], v[80:83]
    ds_read_b128 v[38:41], v9 offset:16384
    ds_read_b128 v[42:45], v9 offset:17408
    v_cvt_pk_bf16_f32 v68, v70, v71
    v_cvt_pk_bf16_f32 v69, v72, v73
    s_waitcnt lgkmcnt(8)
    v_mfma_f32_16x16x32_bf16 v[84:87], v[74:77], v[46:49], 0
    s_add_u32 s41, s35, 0
    v_permlane16_swap_b32 v66, v68
    v_mfma_f32_16x16x32_bf16 v[84:87], v[34:37], v[50:53], v[84:87]
    ds_read_b128 v[46:49], v9 offset:18432
    ds_read_b128 v[50:53], v9 offset:19456
    v_permlane16_swap_b32 v67, v69
    v_and_or_b32 v66, v66, -2, s58
    s_waitcnt lgkmcnt(8)
    v_mfma_f32_16x16x32_bf16 v[54:57], v[74:77], v[94:97], 0
    buffer_store_dwordx4 v[66:69], v10, s[4:7], s41 offen
    v_cvt_pk_bf16_f32 v90, v90, v91
    v_mfma_f32_16x16x32_bf16 v[54:57], v[34:37], v[98:101], v[54:57]
    v_cvt_pk_bf16_f32 v91, v92, v93
    v_cvt_pk_bf16_f32 v92, v80, v81
    s_waitcnt lgkmcnt(6)
    v_mfma_f32_16x16x32_bf16 v[66:69], v[74:77], v[102:105], 0
    v_cvt_pk_bf16_f32 v93, v82, v83
    s_add_u32 s41, s35, 16384
    v_mfma_f32_16x16x32_bf16 v[66:69], v[34:37], v[106:109], v[66:69]
    v_permlane16_swap_b32 v90, v92
    v_permlane16_swap_b32 v91, v93
    s_waitcnt lgkmcnt(4)
    v_mfma_f32_16x16x32_bf16 v[70:73], v[74:77], v[58:61], 0
    v_and_or_b32 v90, v90, -2, s58
    buffer_store_dwordx4 v[90:93], v10, s[4:7], s41 offen
    v_mfma_f32_16x16x32_bf16 v[70:73], v[34:37], v[62:65], v[70:73]
    v_cvt_pk_bf16_f32 v84, v84, v85
    v_cvt_pk_bf16_f32 v85, v86, v87
    s_waitcnt lgkmcnt(2)
    v_mfma_f32_16x16x32_bf16 v[90:93], v[74:77], v[38:41], 0
    v_cvt_pk_bf16_f32 v86, v54, v55
    v_cvt_pk_bf16_f32 v87, v56, v57
    v_mfma_f32_16x16x32_bf16 v[90:93], v[34:37], v[42:45], v[90:93]
    s_add_u32 s41, s35, 32768
    v_permlane16_swap_b32 v84, v86
    s_waitcnt lgkmcnt(0)
    v_mfma_f32_16x16x32_bf16 v[80:83], v[74:77], v[46:49], 0
    v_permlane16_swap_b32 v85, v87
    v_and_or_b32 v84, v84, -2, s58
    v_mfma_f32_16x16x32_bf16 v[80:83], v[34:37], v[50:53], v[80:83]
    buffer_store_dwordx4 v[84:87], v10, s[4:7], s41 offen
    v_cvt_pk_bf16_f32 v66, v66, v67
    v_cvt_pk_bf16_f32 v67, v68, v69
    v_cvt_pk_bf16_f32 v68, v70, v71
    v_cvt_pk_bf16_f32 v69, v72, v73
    s_add_u32 s41, s35, 49152
    v_permlane16_swap_b32 v66, v68
    v_permlane16_swap_b32 v67, v69
    v_and_or_b32 v66, v66, -2, s58
    buffer_store_dwordx4 v[66:69], v10, s[4:7], s41 offen
    v_cvt_pk_bf16_f32 v90, v90, v91
    v_cvt_pk_bf16_f32 v91, v92, v93
    v_cvt_pk_bf16_f32 v92, v80, v81
    v_cvt_pk_bf16_f32 v93, v82, v83
    s_add_u32 s41, s35, 65536
    v_permlane16_swap_b32 v90, v92
    v_permlane16_swap_b32 v91, v93
    v_and_or_b32 v90, v90, -2, s58
    buffer_store_dwordx4 v[90:93], v10, s[4:7], s41 offen
    s_cmp_eq_u32 s56, 0
    s_cbranch_scc1 L_nored_34
    s_nop 15
    s_nop 15
    s_nop 15
    buffer_load_dwordx4 v[34:37], v11, s[4:7], s35 offen offset:0 sc1
    buffer_load_dwordx4 v[38:41], v11, s[4:7], s35 offen offset:1024 sc1
    buffer_load_dwordx4 v[42:45], v11, s[4:7], s35 offen offset:2048 sc1
    buffer_load_dwordx4 v[46:49], v11, s[4:7], s35 offen offset:3072 sc1
    s_mov_b32 s45, 0x80000
    s_lshr_b32 s58, s31, 1
    s_and_b32 s58, s58, 1
    s_nop 7
    s_nop 7
    s_nop 7
    buffer_load_dwordx4 v[50:53], v11, s[4:7], s35 offen offset:0 sc1
    buffer_load_dwordx4 v[54:57], v11, s[4:7], s35 offen offset:1024 sc1
    buffer_load_dwordx4 v[58:61], v11, s[4:7], s35 offen offset:2048 sc1
    buffer_load_dwordx4 v[62:65], v11, s[4:7], s35 offen offset:3072 sc1
L_pt_39:
    s_waitcnt vmcnt(4)
    v_bitop3_b32 v111, v34, v38, s58 bitop3:0x7e
    v_bitop3_b32 v110, v42, v46, s58 bitop3:0x7e
    v_or_b32 v111, v111, v110
    v_and_b32 v111, 1, v111
    v_cmp_eq_u32 vcc, 1, v111
    s_cbranch_vccz L_pd_36
    buffer_load_dwordx4 v[34:37], v11, s[4:7], s35 offen offset:0 sc1
    buffer_load_dwordx4 v[38:41], v11, s[4:7], s35 offen offset:1024 sc1
    buffer_load_dwordx4 v[42:45], v11, s[4:7], s35 offen offset:2048 sc1
    buffer_load_dwordx4 v[46:49], v11, s[4:7], s35 offen offset:3072 sc1
    s_waitcnt vmcnt(4)
    v_bitop3_b32 v111, v50, v54, s58 bitop3:0x7e
    v_bitop3_b32 v110, v58, v62, s58 bitop3:0x7e
    v_or_b32 v111, v111, v110
    v_and_b32 v111, 1, v111
    v_cmp_eq_u32 vcc, 1, v111
    s_cbranch_vccz L_pd_37
    buffer_load_dwordx4 v[50:53], v11, s[4:7], s35 offen offset:0 sc1
    buffer_load_dwordx4 v[54:57], v11, s[4:7], s35 offen offset:1024 sc1
    buffer_load_dwordx4 v[58:61], v11, s[4:7], s35 offen offset:2048 sc1
    buffer_load_dwordx4 v[62:65], v11, s[4:7], s35 offen offset:3072 sc1
    s_sub_u32 s45, s45, 1
    s_cbranch_scc0 L_pt_39
    s_waitcnt vmcnt(0)
L_pd_36:
    v_mfma_f32_16x16x32_bf16 v[66:69], v[24:27], v[34:37], 0
    v_mfma_f32_16x16x32_bf16 v[66:69], v[24:27], v[38:41], v[66:69]
    v_mfma_f32_16x16x32_bf16 v[66:69], v[24:27], v[42:45], v[66:69]
    v_mfma_f32_16x16x32_bf16 v[66:69], v[24:27], v[46:49], v[66:69]
    s_branch L_pe_38
L_pd_37:
    s_nop 6
    v_mfma_f32_16x16x32_bf16 v[66:69], v[24:27], v[50:53], 0
    v_mfma_f32_16x16x32_bf16 v[66:69], v[24:27], v[54:57], v[66:69]
    v_mfma_f32_16x16x32_bf16 v[66:69], v[24:27], v[58:61], v[66:69]
    v_mfma_f32_16x16x32_bf16 v[66:69], v[24:27], v[62:65], v[66:69]
L_pe_38:
    s_nop 7
    v_add_f32_dpp v70, v66, v66 row_ror:8 row_mask:0xf bank_mask:0xf
    v_add_f32_dpp v71, v67, v67 row_ror:8 row_mask:0xf bank_mask:0xf
    v_add_f32_dpp v72, v68, v68 row_ror:8 row_mask:0xf bank_mask:0xf
    v_add_f32_dpp v73, v69, v69 row_ror:8 row_mask:0xf bank_mask:0xf
    v_cvt_pk_bf16_f32 v70, v70, v71
    v_cvt_pk_bf16_f32 v71, v72, v73
    v_mov_b32 v72, v70
    v_mov_b32 v73, v71
    s_nop 0
    v_permlane16_swap_b32 v70, v72
    v_permlane16_swap_b32 v71, v73
    v_and_b32 v70, -2, v70
    buffer_store_dwordx4 v[70:73], v12, s[4:7], s88 offen sc1
    s_branch L_join_35
L_nored_34:
    s_cmp_lg_u32 s26, 3
    s_cbranch_scc1 L_join_35
    v_and_b32 v34, 0x7f0, v17
    v_add_u32 v34, 99328, v34
    ds_read_b128 v[94:97], v34
    ds_read_b64 v[42:43], v18 offset:0
    ds_read_b64 v[44:45], v18 offset:128
    ds_read_b64 v[46:47], v18 offset:256
    ds_read_b64 v[48:49], v18 offset:384
    s_lshl_b32 s40, s31, 16
    s_add_u32 s40, s40, 83886080
    s_waitcnt lgkmcnt(0)
    v_lshlrev_b32 v50, 16, v42
    v_and_b32 v51, 0xffff0000, v42
    v_lshlrev_b32 v52, 16, v46
    v_and_b32 v53, 0xffff0000, v46
    v_add_f32 v50, v50, v52
    v_add_f32 v51, v51, v53
    v_cvt_pk_bf16_f32 v98, v50, v51
    v_lshlrev_b32 v50, 16, v43
    v_and_b32 v51, 0xffff0000, v43
    v_lshlrev_b32 v52, 16, v47
    v_and_b32 v53, 0xffff0000, v47
    v_add_f32 v50, v50, v52
    v_add_f32 v51, v51, v53
    v_cvt_pk_bf16_f32 v99, v50, v51
    v_lshlrev_b32 v50, 16, v44
    v_and_b32 v51, 0xffff0000, v44
    v_lshlrev_b32 v52, 16, v48
    v_and_b32 v53, 0xffff0000, v48
    v_add_f32 v50, v50, v52
    v_add_f32 v51, v51, v53
    v_cvt_pk_bf16_f32 v100, v50, v51
    v_lshlrev_b32 v50, 16, v45
    v_and_b32 v51, 0xffff0000, v45
    v_lshlrev_b32 v52, 16, v49
    v_and_b32 v53, 0xffff0000, v49
    v_add_f32 v50, v50, v52
    v_add_f32 v51, v51, v53
    v_cvt_pk_bf16_f32 v101, v50, v51
    s_add_u32 s43, s31, 3
    s_and_b32 s42, s43, 3
    s_cmp_lg_u32 s42, 0
    s_cbranch_scc1 L_nokv_40
    s_cmp_ge_u32 s43, 64
    s_cbranch_scc1 L_nokv_40
    s_lshr_b32 s42, s43, 2
    s_lshl_b32 s42, s42, 7
    s_add_u32 s42, s42, 786432
    s_mov_b32 s45, 0x200000
    v_mov_b32 v78, 0
L_cw_41:
    buffer_load_dword v79, v78, s[4:7], s42 offen sc1
    s_waitcnt vmcnt(0)
    v_readfirstlane_b32 s41, v79
    s_nop 0
    s_cmp_ge_u32 s41, 64
    s_cbranch_scc1 L_cd_42
    s_sleep 1
    s_sub_u32 s45, s45, 1
    s_cbranch_scc0 L_cw_41
L_cd_42:
L_nokv_40:
L_join_35:
    s_barrier
    s_mov_b32 s58, 0
    s_add_u32 s43, s89, s83
    s_nop 15
    s_nop 15
    s_nop 15
    s_nop 15
    s_nop 15
    s_nop 15
    buffer_load_dwordx4 v[34:37], v0, s[4:7], s89 offen offset:0 sc1
    buffer_load_dwordx4 v[38:41], v0, s[4:7], s43 offen offset:512 sc1
    buffer_load_dwordx4 v[42:45], v0, s[4:7], s43 offen offset:1024 sc1
    buffer_load_dwordx4 v[46:49], v0, s[4:7], s43 offen offset:1536 sc1
    buffer_load_dwordx4 v[50:53], v0, s[4:7], s43 offen offset:2048 sc1
    s_mov_b32 s45, 0x80000
    v_mov_b32 v74, 0
    v_mov_b32 v75, 0
    v_mov_b32 v76, 0
    v_mov_b32 v77, 0
    v_mov_b32 v78, 0
    v_mov_b32 v79, 0
    v_mov_b32 v80, 0
    v_mov_b32 v81, 0
    v_mov_b32 v82, 0
    v_mov_b32 v83, 0
    v_mov_b32 v84, 0
    v_mov_b32 v85, 0
    v_mov_b32 v86, 0
    v_mov_b32 v87, 0
    v_mov_b32 v88, 0
    v_mov_b32 v89, 0
    v_mov_b32 v90, 0
    v_mov_b32 v91, 0
    v_mov_b32 v92, 0
    v_mov_b32 v93, 0
    s_add_u32 s31, s31, 1
    s_xor_b32 s49, s49, 8192
    s_xor_b32 s35, s35, 1048576
L_pt_45:
    s_waitcnt vmcnt(0)
    v_bitop3_b32 v111, v34, v38, s58 bitop3:0x7e
    v_bitop3_b32 v110, v42, v46, s58 bitop3:0x7e
    v_or_b32 v111, v111, v110
    v_xor_b32 v110, s58, v50
    v_or_b32 v111, v111, v110
    v_and_b32 v111, 1, v111
    v_cmp_eq_u32 vcc, 1, v111
    s_cbranch_vccz L_pd_43
    buffer_load_dwordx4 v[34:37], v0, s[4:7], s89 offen offset:0 sc1
    buffer_load_dwordx4 v[38:41], v0, s[4:7], s43 offen offset:512 sc1
    buffer_load_dwordx4 v[42:45], v0, s[4:7], s43 offen offset:1024 sc1
    buffer_load_dwordx4 v[46:49], v0, s[4:7], s43 offen offset:1536 sc1
    buffer_load_dwordx4 v[50:53], v0, s[4:7], s43 offen offset:2048 sc1
    s_sub_u32 s45, s45, 1
    s_cbranch_scc0 L_pt_45
    s_waitcnt vmcnt(0)
L_pd_43:
    v_mfma_f32_16x16x32_bf16 v[54:57], v[20:23], v[34:37], 0
    v_mfma_f32_16x16x32_bf16 v[58:61], v[20:23], v[38:41], 0
    v_mfma_f32_16x16x32_bf16 v[62:65], v[20:23], v[42:45], 0
    v_mfma_f32_16x16x32_bf16 v[66:69], v[20:23], v[46:49], 0
    v_mfma_f32_16x16x32_bf16 v[70:73], v[20:23], v[50:53], 0
L_pe_44:
    s_add_u32 s89, s89, 65536
    s_add_u32 s88, s88, 65536
    s_cmp_eq_u32 s31, 32
    s_cselect_b32 s43, 8192, 0
    s_xor_b32 s89, s89, s43
    s_xor_b32 s88, s88, s43
    v_cvt_pk_bf16_f32 v54, v54, v55
    v_cvt_pk_bf16_f32 v55, v56, v57
    ds_write_b64 v1, v[54:55] offset:0
    v_cvt_pk_bf16_f32 v58, v58, v59
    v_cvt_pk_bf16_f32 v59, v60, v61
    ds_write_b64 v1, v[58:59] offset:768
    v_cvt_pk_bf16_f32 v62, v62, v63
    v_cvt_pk_bf16_f32 v63, v64, v65
    ds_write_b64 v1, v[62:63] offset:1536
    v_cvt_pk_bf16_f32 v66, v66, v67
    v_cvt_pk_bf16_f32 v67, v68, v69
    ds_write_b64 v1, v[66:67] offset:2304
    v_cvt_pk_bf16_f32 v70, v70, v71
    v_cvt_pk_bf16_f32 v71, v72, v73
    ds_write_b64 v1, v[70:71] offset:3072
    s_waitcnt lgkmcnt(0)
    s_barrier
    s_branch L_step_29
L_last_short_31:
    ds_read_b64_tr_b16 v[34:35], v2 offset:0
    ds_read_b64_tr_b16 v[36:37], v2 offset:128
    ds_read_b64_tr_b16 v[38:39], v2 offset:1536
    ds_read_b64_tr_b16 v[40:41], v2 offset:1664
    ds_read_b64_tr_b16 v[42:43], v2 offset:3072
    ds_read_b64_tr_b16 v[44:45], v2 offset:3200
    ds_read_b64_tr_b16 v[46:47], v2 offset:4608
    ds_read_b64_tr_b16 v[48:49], v2 offset:4736
    ds_read_b64_tr_b16 v[50:51], v2 offset:6144
    ds_read_b64_tr_b16 v[52:53], v2 offset:6272
    ds_read_b64_tr_b16 v[54:55], v2 offset:7680
    ds_read_b64_tr_b16 v[56:57], v2 offset:7808
    ds_read_b64_tr_b16 v[58:59], v2 offset:9216
    ds_read_b64_tr_b16 v[60:61], v2 offset:9344
    ds_read_b64_tr_b16 v[62:63], v2 offset:10752
    ds_read_b64_tr_b16 v[64:65], v2 offset:10880
    ds_read_b64_tr_b16 v[66:67], v2 offset:12288
    ds_read_b64_tr_b16 v[68:69], v2 offset:12416
    ds_read_b64_tr_b16 v[70:71], v2 offset:13824
    ds_read_b64_tr_b16 v[72:73], v2 offset:13952
    s_cmp_lg_u32 s26, 3
    s_cbranch_scc1 L_w3last_46
    buffer_store_dwordx4 v[94:97], v17, s[4:7], s40 offen sc1
    s_add_u32 s41, s40, 4194304
    buffer_store_dwordx4 v[98:101], v17, s[4:7], s41 offen sc1
    s_sub_u32 s43, s31, 1
    v_mov_b32 v110, s43
    buffer_store_dword v110, off, s[4:7], s78 sc1
L_w3last_46:
    s_waitcnt lgkmcnt(0)
    v_smfmac_f32_16x16x64_bf16 v[82:85], v[34:37], a[160:167], v3
    v_smfmac_f32_16x16x64_bf16 v[86:89], v[34:37], a[240:247], v3
    v_smfmac_f32_16x16x64_bf16 v[82:85], v[38:41], a[168:175], v3
    v_smfmac_f32_16x16x64_bf16 v[86:89], v[38:41], a[248:255], v3
    v_smfmac_f32_16x16x64_bf16 v[82:85], v[42:45], a[176:183], v3
    v_smfmac_f32_16x16x64_bf16 v[86:89], v[42:45], v[112:119], v3
    v_smfmac_f32_16x16x64_bf16 v[82:85], v[46:49], a[184:191], v3
    v_smfmac_f32_16x16x64_bf16 v[86:89], v[46:49], v[120:127], v3
    v_smfmac_f32_16x16x64_bf16 v[82:85], v[50:53], a[192:199], v3
    v_smfmac_f32_16x16x64_bf16 v[86:89], v[50:53], v[128:135], v3
    v_smfmac_f32_16x16x64_bf16 v[82:85], v[54:57], a[200:207], v3
    v_smfmac_f32_16x16x64_bf16 v[86:89], v[54:57], v[136:143], v3
    v_smfmac_f32_16x16x64_bf16 v[82:85], v[58:61], a[208:215], v3
    v_smfmac_f32_16x16x64_bf16 v[86:89], v[58:61], v[144:151], v3
    v_smfmac_f32_16x16x64_bf16 v[82:85], v[62:65], a[216:223], v3
    v_smfmac_f32_16x16x64_bf16 v[86:89], v[62:65], v[152:159], v3
    v_smfmac_f32_16x16x64_bf16 v[82:85], v[66:69], a[224:231], v3
    v_smfmac_f32_16x16x64_bf16 v[86:89], v[66:69], v[160:167], v3
    v_smfmac_f32_16x16x64_bf16 v[82:85], v[70:73], a[232:239], v3
    v_smfmac_f32_16x16x64_bf16 v[86:89], v[70:73], v[168:175], v3
    v_smfmac_f32_16x16x64_bf16 v[90:93], v[34:37], v[176:183], v3
    v_smfmac_f32_16x16x64_bf16 v[90:93], v[38:41], v[184:191], v3
    v_smfmac_f32_16x16x64_bf16 v[90:93], v[42:45], v[192:199], v3
    v_smfmac_f32_16x16x64_bf16 v[90:93], v[46:49], v[200:207], v3
    v_smfmac_f32_16x16x64_bf16 v[90:93], v[50:53], v[208:215], v3
    v_smfmac_f32_16x16x64_bf16 v[90:93], v[54:57], v[216:223], v3
    v_smfmac_f32_16x16x64_bf16 v[90:93], v[58:61], v[224:231], v3
    v_smfmac_f32_16x16x64_bf16 v[90:93], v[62:65], v[232:239], v3
    v_smfmac_f32_16x16x64_bf16 v[90:93], v[66:69], v[240:247], v3
    v_smfmac_f32_16x16x64_bf16 v[90:93], v[70:73], v[248:255], v3
    v_permlane32_swap_b32 v82, v86
    v_permlane32_swap_b32 v83, v87
    v_permlane32_swap_b32 v84, v88
    v_permlane32_swap_b32 v85, v89
    v_add_f32 v82, v82, v86
    v_add_f32 v83, v83, v87
    v_add_f32 v84, v84, v88
    v_add_f32 v85, v85, v89
    v_cvt_pk_bf16_f32 v82, v82, v83
    v_cvt_pk_bf16_f32 v83, v84, v85
    ds_write_b64 v4, v[82:83] offset:2048
    v_cvt_pk_bf16_f32 v110, v90, v91
    v_cvt_pk_bf16_f32 v111, v92, v93
    ds_write_b64 v8, v[110:111]
    s_waitcnt lgkmcnt(0)
    s_barrier
L_last_30:
    s_cmp_lg_u32 s26, 3
    s_cbranch_scc1 L_endw_47
    v_and_b32 v34, 0x7f0, v17
    v_add_u32 v34, 99328, v34
    ds_read_b128 v[94:97], v34
    ds_read_b64 v[42:43], v18 offset:0
    ds_read_b64 v[44:45], v18 offset:128
    ds_read_b64 v[46:47], v18 offset:256
    ds_read_b64 v[48:49], v18 offset:384
    s_lshl_b32 s40, s31, 16
    s_add_u32 s40, s40, 83886080
    s_waitcnt lgkmcnt(0)
    v_lshlrev_b32 v50, 16, v42
    v_and_b32 v51, 0xffff0000, v42
    v_lshlrev_b32 v52, 16, v46
    v_and_b32 v53, 0xffff0000, v46
    v_add_f32 v50, v50, v52
    v_add_f32 v51, v51, v53
    v_cvt_pk_bf16_f32 v98, v50, v51
    v_lshlrev_b32 v50, 16, v43
    v_and_b32 v51, 0xffff0000, v43
    v_lshlrev_b32 v52, 16, v47
    v_and_b32 v53, 0xffff0000, v47
    v_add_f32 v50, v50, v52
    v_add_f32 v51, v51, v53
    v_cvt_pk_bf16_f32 v99, v50, v51
    v_lshlrev_b32 v50, 16, v44
    v_and_b32 v51, 0xffff0000, v44
    v_lshlrev_b32 v52, 16, v48
    v_and_b32 v53, 0xffff0000, v48
    v_add_f32 v50, v50, v52
    v_add_f32 v51, v51, v53
    v_cvt_pk_bf16_f32 v100, v50, v51
    v_lshlrev_b32 v50, 16, v45
    v_and_b32 v51, 0xffff0000, v45
    v_lshlrev_b32 v52, 16, v49
    v_and_b32 v53, 0xffff0000, v49
    v_add_f32 v50, v50, v52
    v_add_f32 v51, v51, v53
    v_cvt_pk_bf16_f32 v101, v50, v51
    buffer_store_dwordx4 v[94:97], v17, s[4:7], s40 offen sc1
    s_add_u32 s41, s40, 4194304
    buffer_store_dwordx4 v[98:101], v17, s[4:7], s41 offen sc1
    s_waitcnt vmcnt(0)
    s_mov_b32 s43, 64
    v_mov_b32 v78, s43
    buffer_store_dword v78, off, s[4:7], s78 sc1
    s_waitcnt vmcnt(0)
L_endw_47:
    s_branch main_kernel_chain_done
L_slow_28:
L_step_48:
    s_cmp_eq_u32 s31, 63
    s_cbranch_scc1 L_last_short_50
    ds_read_b64_tr_b16 v[34:35], v2 offset:0
    ds_read_b64_tr_b16 v[36:37], v2 offset:128
    ds_read_b64_tr_b16 v[38:39], v2 offset:1536
    ds_read_b64_tr_b16 v[40:41], v2 offset:1664
    ds_read_b64_tr_b16 v[42:43], v2 offset:3072
    ds_read_b64_tr_b16 v[44:45], v2 offset:3200
    ds_read_b64_tr_b16 v[46:47], v2 offset:4608
    ds_read_b64_tr_b16 v[48:49], v2 offset:4736
    ds_read_b64_tr_b16 v[50:51], v2 offset:6144
    ds_read_b64_tr_b16 v[52:53], v2 offset:6272
    ds_read_b64_tr_b16 v[54:55], v2 offset:7680
    ds_read_b64_tr_b16 v[56:57], v2 offset:7808
    s_lshr_b32 s58, s31, 1
    s_and_b32 s58, s58, 1
    s_cmp_lg_u32 s26, 3
    s_cbranch_scc1 L_w3st_51
    buffer_store_dwordx4 v[94:97], v17, s[4:7], s40 offen sc1
    s_add_u32 s41, s40, 4194304
    buffer_store_dwordx4 v[98:101], v17, s[4:7], s41 offen sc1
    s_cmp_lt_u32 s31, 2
    s_cbranch_scc1 L_noprog_52
    s_sub_u32 s43, s31, 1
    v_mov_b32 v110, s43
    buffer_store_dword v110, off, s[4:7], s78 sc1
L_noprog_52:
L_w3st_51:
    s_mov_b32 m0, s76
    s_nop 0
    buffer_load_dwordx4 v14, s[4:7], s38 offen sc1 lds
    s_add_u32 m0, s76, 1024
    s_nop 0
    buffer_load_dwordx4 v15, s[4:7], s38 offen sc1 lds
    s_waitcnt lgkmcnt(10)
    v_smfmac_f32_16x16x64_bf16 v[74:77], v[34:37], a[0:7], v3
    ds_read_b64_tr_b16 v[58:59], v2 offset:9216
    v_smfmac_f32_16x16x64_bf16 v[78:81], v[34:37], a[80:87], v3
    ds_read_b64_tr_b16 v[60:61], v2 offset:9344
    s_waitcnt lgkmcnt(10)
    v_smfmac_f32_16x16x64_bf16 v[74:77], v[38:41], a[8:15], v3
    ds_read_b64_tr_b16 v[62:63], v2 offset:10752
    v_smfmac_f32_16x16x64_bf16 v[78:81], v[38:41], a[88:95], v3
    ds_read_b64_tr_b16 v[64:65], v2 offset:10880
    s_waitcnt lgkmcnt(10)
    v_smfmac_f32_16x16x64_bf16 v[74:77], v[42:45], a[16:23], v3
    ds_read_b64_tr_b16 v[66:67], v2 offset:12288
    v_smfmac_f32_16x16x64_bf16 v[78:81], v[42:45], a[96:103], v3
    ds_read_b64_tr_b16 v[68:69], v2 offset:12416
    s_waitcnt lgkmcnt(10)
    v_smfmac_f32_16x16x64_bf16 v[74:77], v[46:49], a[24:31], v3
    ds_read_b64_tr_b16 v[70:71], v2 offset:13824
    v_smfmac_f32_16x16x64_bf16 v[78:81], v[46:49], a[104:111], v3
    ds_read_b64_tr_b16 v[72:73], v2 offset:13952
    s_waitcnt lgkmcnt(10)
    v_smfmac_f32_16x16x64_bf16 v[74:77], v[50:53], a[32:39], v3
    v_smfmac_f32_16x16x64_bf16 v[78:81], v[50:53], a[112:119], v3
    s_waitcnt lgkmcnt(8)
    v_smfmac_f32_16x16x64_bf16 v[74:77], v[54:57], a[40:47], v3
    v_smfmac_f32_16x16x64_bf16 v[78:81], v[54:57], a[120:127], v3
    s_mov_b32 m0, s77
    s_nop 0
    buffer_load_dwordx4 v16, s[4:7], s39 offen sc1 lds
    s_add_u32 s38, s38, 262144
    s_add_u32 s39, s39, 262144
    s_xor_b32 s76, s76, 8192
    s_xor_b32 s77, s77, 4096
    s_waitcnt lgkmcnt(6)
    v_smfmac_f32_16x16x64_bf16 v[74:77], v[58:61], a[48:55], v3
    v_smfmac_f32_16x16x64_bf16 v[78:81], v[58:61], a[128:135], v3
    s_waitcnt lgkmcnt(4)
    v_smfmac_f32_16x16x64_bf16 v[74:77], v[62:65], a[56:63], v3
    v_smfmac_f32_16x16x64_bf16 v[78:81], v[62:65], a[136:143], v3
    s_waitcnt lgkmcnt(2)
    v_smfmac_f32_16x16x64_bf16 v[74:77], v[66:69], a[64:71], v3
    v_smfmac_f32_16x16x64_bf16 v[78:81], v[66:69], a[144:151], v3
    s_waitcnt lgkmcnt(0)
    v_smfmac_f32_16x16x64_bf16 v[74:77], v[70:73], a[72:79], v3
    v_smfmac_f32_16x16x64_bf16 v[78:81], v[70:73], a[152:159], v3
    v_smfmac_f32_16x16x64_bf16 v[82:85], v[34:37], a[160:167], v3
    v_add_u32 v110, s49, v6
    v_smfmac_f32_16x16x64_bf16 v[86:89], v[34:37], a[240:247], v3
    ds_read_b128 v[94:97], v110 offset:0
    v_smfmac_f32_16x16x64_bf16 v[82:85], v[38:41], a[168:175], v3
    v_xor_b32 v110, 64, v110
    v_smfmac_f32_16x16x64_bf16 v[86:89], v[38:41], a[248:255], v3
    ds_read_b128 v[98:101], v110 offset:0
    v_smfmac_f32_16x16x64_bf16 v[82:85], v[42:45], a[176:183], v3
    v_xor_b32 v110, 192, v110
    v_smfmac_f32_16x16x64_bf16 v[86:89], v[42:45], v[112:119], v3
    ds_read_b128 v[102:105], v110 offset:0
    v_smfmac_f32_16x16x64_bf16 v[82:85], v[46:49], a[184:191], v3
    v_xor_b32 v110, 64, v110
    v_smfmac_f32_16x16x64_bf16 v[86:89], v[46:49], v[120:127], v3
    ds_read_b128 v[106:109], v110 offset:0
    v_smfmac_f32_16x16x64_bf16 v[82:85], v[50:53], a[192:199], v3
    v_permlane32_swap_b32 v74, v78
    v_smfmac_f32_16x16x64_bf16 v[86:89], v[50:53], v[128:135], v3
    v_permlane32_swap_b32 v75, v79
    v_smfmac_f32_16x16x64_bf16 v[82:85], v[54:57], a[200:207], v3
    v_permlane32_swap_b32 v76, v80
    v_smfmac_f32_16x16x64_bf16 v[86:89], v[54:57], v[136:143], v3
    v_permlane32_swap_b32 v77, v81
    v_smfmac_f32_16x16x64_bf16 v[82:85], v[58:61], a[208:215], v3
    v_add_f32 v74, v74, v78
    v_smfmac_f32_16x16x64_bf16 v[86:89], v[58:61], v[144:151], v3
    v_add_f32 v75, v75, v79
    v_smfmac_f32_16x16x64_bf16 v[82:85], v[62:65], a[216:223], v3
    v_add_f32 v76, v76, v80
    v_smfmac_f32_16x16x64_bf16 v[86:89], v[62:65], v[152:159], v3
    v_add_f32 v77, v77, v81
    v_smfmac_f32_16x16x64_bf16 v[82:85], v[66:69], a[224:231], v3
    v_cvt_pk_bf16_f32 v74, v74, v75
    v_smfmac_f32_16x16x64_bf16 v[86:89], v[66:69], v[160:167], v3
    v_cvt_pk_bf16_f32 v75, v76, v77
    v_smfmac_f32_16x16x64_bf16 v[82:85], v[70:73], a[232:239], v3
    ds_write_b64 v4, v[74:75] offset:0
    v_smfmac_f32_16x16x64_bf16 v[86:89], v[70:73], v[168:175], v3
    v_smfmac_f32_16x16x64_bf16 v[90:93], v[34:37], v[176:183], v3
    v_smfmac_f32_16x16x64_bf16 v[90:93], v[38:41], v[184:191], v3
    v_smfmac_f32_16x16x64_bf16 v[90:93], v[42:45], v[192:199], v3
    v_smfmac_f32_16x16x64_bf16 v[90:93], v[46:49], v[200:207], v3
    v_smfmac_f32_16x16x64_bf16 v[90:93], v[50:53], v[208:215], v3
    s_nop 2
    v_permlane32_swap_b32 v82, v86
    v_permlane32_swap_b32 v83, v87
    v_smfmac_f32_16x16x64_bf16 v[90:93], v[54:57], v[216:223], v3
    v_permlane32_swap_b32 v84, v88
    v_permlane32_swap_b32 v85, v89
    v_smfmac_f32_16x16x64_bf16 v[90:93], v[58:61], v[224:231], v3
    v_add_f32 v82, v82, v86
    v_add_f32 v83, v83, v87
    v_smfmac_f32_16x16x64_bf16 v[90:93], v[62:65], v[232:239], v3
    v_add_f32 v84, v84, v88
    v_add_f32 v85, v85, v89
    v_smfmac_f32_16x16x64_bf16 v[90:93], v[66:69], v[240:247], v3
    v_cvt_pk_bf16_f32 v82, v82, v83
    v_cvt_pk_bf16_f32 v83, v84, v85
    v_smfmac_f32_16x16x64_bf16 v[90:93], v[70:73], v[248:255], v3
    ds_write_b64 v4, v[82:83] offset:2048
    v_add_u32 v110, s49, v6
    ds_read_b128 v[74:77], v110 offset:4096
    v_xor_b32 v110, 64, v110
    ds_read_b128 v[78:81], v110 offset:4096
    v_xor_b32 v110, 192, v110
    ds_read_b128 v[82:85], v110 offset:4096
    v_xor_b32 v110, 64, v110
    ds_read_b128 v[86:89], v110 offset:4096
    s_waitcnt lgkmcnt(4)
    s_barrier
    ds_read_b64_tr_b16 v[34:35], v5 offset:0
    ds_read_b64_tr_b16 v[36:37], v5 offset:64
    ds_read_b64_tr_b16 v[38:39], v5 offset:512
    ds_read_b64_tr_b16 v[40:41], v5 offset:576
    ds_read_b64_tr_b16 v[42:43], v5 offset:1024
    ds_read_b64_tr_b16 v[44:45], v5 offset:1088
    ds_read_b64_tr_b16 v[46:47], v5 offset:1536
    ds_read_b64_tr_b16 v[48:49], v5 offset:1600
    v_cvt_pk_bf16_f32 v110, v90, v91
    v_cvt_pk_bf16_f32 v111, v92, v93
    ds_write_b64 v8, v[110:111]
    ds_read_b64_tr_b16 v[50:51], v5 offset:2048
    ds_read_b64_tr_b16 v[52:53], v5 offset:2112
    s_waitcnt lgkmcnt(9)
    v_mfma_f32_16x16x32_bf16 v[70:73], v[94:97], v[34:37], 0
    v_mfma_f32_16x16x32_bf16 v[90:93], v[74:77], v[34:37], 0
    ds_read_b64_tr_b16 v[54:55], v5 offset:2560
    ds_read_b64_tr_b16 v[56:57], v5 offset:2624
    s_waitcnt lgkmcnt(9)
    v_mfma_f32_16x16x32_bf16 v[70:73], v[98:101], v[38:41], v[70:73]
    v_mfma_f32_16x16x32_bf16 v[90:93], v[78:81], v[38:41], v[90:93]
    ds_read_b64_tr_b16 v[58:59], v5 offset:3072
    ds_read_b64_tr_b16 v[60:61], v5 offset:3136
    s_waitcnt lgkmcnt(9)
    v_mfma_f32_16x16x32_bf16 v[70:73], v[102:105], v[42:45], v[70:73]
    v_mfma_f32_16x16x32_bf16 v[90:93], v[82:85], v[42:45], v[90:93]
    ds_read_b64_tr_b16 v[62:63], v5 offset:3584
    ds_read_b64_tr_b16 v[64:65], v5 offset:3648
    s_waitcnt lgkmcnt(9)
    v_mfma_f32_16x16x32_bf16 v[70:73], v[106:109], v[46:49], v[70:73]
    v_mfma_f32_16x16x32_bf16 v[90:93], v[86:89], v[46:49], v[90:93]
    s_waitcnt lgkmcnt(6)
    v_mfma_f32_16x16x32_bf16 v[66:69], v[50:53], v[34:37], 0
    s_waitcnt lgkmcnt(4)
    v_mfma_f32_16x16x32_bf16 v[66:69], v[54:57], v[38:41], v[66:69]
    s_waitcnt lgkmcnt(2)
    v_mfma_f32_16x16x32_bf16 v[66:69], v[58:61], v[42:45], v[66:69]
    s_waitcnt lgkmcnt(0)
    v_mfma_f32_16x16x32_bf16 v[66:69], v[62:65], v[46:49], v[66:69]
    s_barrier
    s_lshr_b32 s41, s49, 1
    v_add_u32 v110, s41, v7
    v_max3_f32 v111, v70, v71, v72
    ds_read_b64_tr_b16 v[34:35], v110
    ds_read_b64_tr_b16 v[36:37], v110 offset:2048
    v_xor_b32 v110, 32, v110
    ds_read_b64_tr_b16 v[38:39], v110
    ds_read_b64_tr_b16 v[40:41], v110 offset:2048
    v_xor_b32 v110, 96, v110
    ds_read_b64_tr_b16 v[42:43], v110
    ds_read_b64_tr_b16 v[44:45], v110 offset:2048
    v_xor_b32 v110, 32, v110
    ds_read_b64_tr_b16 v[46:47], v110
    ds_read_b64_tr_b16 v[48:49], v110 offset:2048
    v_max3_f32 v111, v111, v73, v90
    v_max3_f32 v111, v111, v91, v92
    v_max3_f32 v111, v111, v93, v66
    v_max3_f32 v111, v111, v67, v68
    v_max_f32 v111, v111, v69
    ds_read_b64 v[50:51], v19 offset:0
    ds_read_b64 v[52:53], v19 offset:512
    ds_read_b64 v[54:55], v19 offset:1024
    ds_read_b64 v[56:57], v19 offset:1536
    v_mov_b32 v110, v111
    ds_read_b128 v[94:97], v9 offset:0
    ds_read_b128 v[98:101], v9 offset:1024
    v_permlane32_swap_b32 v111, v110
    v_max_f32 v111, v111, v110
    v_mov_b32 v110, v111
    ds_read_b128 v[102:105], v9 offset:2048
    ds_read_b128 v[106:109], v9 offset:3072
    v_permlane16_swap_b32 v111, v110
    v_max_f32 v111, v111, v110
    v_mul_f32 v111, s50, v111
    v_pk_fma_f32 v[70:71], v[70:71], s[52:53], v[110:111] op_sel:[0,0,1] op_sel_hi:[1,1,1]
    v_pk_fma_f32 v[72:73], v[72:73], s[52:53], v[110:111] op_sel:[0,0,1] op_sel_hi:[1,1,1]
    v_exp_f32 v70, v70
    v_exp_f32 v71, v71
    v_exp_f32 v72, v72
    v_exp_f32 v73, v73
    v_cvt_pk_bf16_f32 v74, v70, v71
    v_cvt_pk_bf16_f32 v75, v72, v73
    v_pk_fma_f32 v[90:91], v[90:91], s[52:53], v[110:111] op_sel:[0,0,1] op_sel_hi:[1,1,1]
    v_pk_fma_f32 v[92:93], v[92:93], s[52:53], v[110:111] op_sel:[0,0,1] op_sel_hi:[1,1,1]
    v_exp_f32 v90, v90
    v_exp_f32 v91, v91
    v_exp_f32 v92, v92
    v_exp_f32 v93, v93
    v_cvt_pk_bf16_f32 v76, v90, v91
    v_cvt_pk_bf16_f32 v77, v92, v93
    v_pk_fma_f32 v[66:67], v[66:67], s[52:53], v[110:111] op_sel:[0,0,1] op_sel_hi:[1,1,1]
    v_pk_fma_f32 v[68:69], v[68:69], s[52:53], v[110:111] op_sel:[0,0,1] op_sel_hi:[1,1,1]
    s_waitcnt lgkmcnt(12)
    v_mfma_f32_16x16x32_bf16 v[70:73], v[38:41], v[74:77], 0
    v_exp_f32 v66, v66
    s_waitcnt lgkmcnt(10)
    v_mfma_f32_16x16x32_bf16 v[90:93], v[42:45], v[74:77], 0
    v_exp_f32 v67, v67
    s_waitcnt lgkmcnt(8)
    v_mfma_f32_16x16x32_bf16 v[80:83], v[46:49], v[74:77], 0
    v_exp_f32 v68, v68
    v_mfma_f32_16x16x32_bf16 v[84:87], v[28:31], v[74:77], 0
    v_exp_f32 v69, v69
    v_cvt_pk_bf16_f32 v78, v66, v67
    v_cvt_pk_bf16_f32 v79, v68, v69
    v_mfma_f32_16x16x32_bf16 v[66:69], v[34:37], v[74:77], 0
    s_waitcnt lgkmcnt(4)
    s_nop 0
    v_mfma_f32_16x16x16_bf16 v[84:87], v[32:33], v[78:79], v[84:87]
    v_mfma_f32_16x16x16_bf16 v[70:73], v[52:53], v[78:79], v[70:73]
    v_mfma_f32_16x16x16_bf16 v[90:93], v[54:55], v[78:79], v[90:93]
    v_mfma_f32_16x16x16_bf16 v[80:83], v[56:57], v[78:79], v[80:83]
    v_mfma_f32_16x16x16_bf16 v[66:69], v[50:51], v[78:79], v[66:69]
    ds_read_b128 v[58:61], v9 offset:4096
    ds_read_b128 v[62:65], v9 offset:5120
    ds_read_b128 v[38:41], v9 offset:6144
    ds_read_b128 v[42:45], v9 offset:7168
    v_rcp_f32 v110, v84
    s_nop 0
    v_pk_mul_f32 v[70:71], v[70:71], v[110:111] op_sel_hi:[1,0]
    v_pk_mul_f32 v[72:73], v[72:73], v[110:111] op_sel_hi:[1,0]
    v_pk_mul_f32 v[90:91], v[90:91], v[110:111] op_sel_hi:[1,0]
    v_pk_mul_f32 v[92:93], v[92:93], v[110:111] op_sel_hi:[1,0]
    v_pk_mul_f32 v[80:81], v[80:81], v[110:111] op_sel_hi:[1,0]
    v_pk_mul_f32 v[82:83], v[82:83], v[110:111] op_sel_hi:[1,0]
    v_pk_mul_f32 v[66:67], v[66:67], v[110:111] op_sel_hi:[1,0]
    v_pk_mul_f32 v[68:69], v[68:69], v[110:111] op_sel_hi:[1,0]
    v_cvt_pk_bf16_f32 v74, v66, v67
    v_cvt_pk_bf16_f32 v75, v68, v69
    v_cvt_pk_bf16_f32 v76, v70, v71
    v_cvt_pk_bf16_f32 v77, v72, v73
    v_cvt_pk_bf16_f32 v34, v90, v91
    v_cvt_pk_bf16_f32 v35, v92, v93
    v_cvt_pk_bf16_f32 v36, v80, v81
    v_cvt_pk_bf16_f32 v37, v82, v83
    ds_read_b128 v[46:49], v9 offset:8192
    ds_read_b128 v[50:53], v9 offset:9216
    s_waitcnt lgkmcnt(8)
    v_mfma_f32_16x16x32_bf16 v[66:69], v[74:77], v[94:97], 0
    v_mfma_f32_16x16x32_bf16 v[66:69], v[34:37], v[98:101], v[66:69]
    ds_read_b128 v[94:97], v9 offset:10240
    ds_read_b128 v[98:101], v9 offset:11264
    s_waitcnt lgkmcnt(8)
    v_mfma_f32_16x16x32_bf16 v[70:73], v[74:77], v[102:105], 0
    v_mfma_f32_16x16x32_bf16 v[70:73], v[34:37], v[106:109], v[70:73]
    ds_read_b128 v[102:105], v9 offset:12288
    ds_read_b128 v[106:109], v9 offset:13312
    s_waitcnt lgkmcnt(8)
    v_mfma_f32_16x16x32_bf16 v[90:93], v[74:77], v[58:61], 0
    v_mfma_f32_16x16x32_bf16 v[90:93], v[34:37], v[62:65], v[90:93]
    ds_read_b128 v[58:61], v9 offset:14336
    ds_read_b128 v[62:65], v9 offset:15360
    s_waitcnt lgkmcnt(8)
    v_mfma_f32_16x16x32_bf16 v[80:83], v[74:77], v[38:41], 0
    v_cvt_pk_bf16_f32 v66, v66, v67
    v_cvt_pk_bf16_f32 v67, v68, v69
    v_mfma_f32_16x16x32_bf16 v[80:83], v[34:37], v[42:45], v[80:83]
    ds_read_b128 v[38:41], v9 offset:16384
    ds_read_b128 v[42:45], v9 offset:17408
    v_cvt_pk_bf16_f32 v68, v70, v71
    v_cvt_pk_bf16_f32 v69, v72, v73
    s_waitcnt lgkmcnt(8)
    v_mfma_f32_16x16x32_bf16 v[84:87], v[74:77], v[46:49], 0
    s_add_u32 s41, s35, 0
    v_permlane16_swap_b32 v66, v68
    v_mfma_f32_16x16x32_bf16 v[84:87], v[34:37], v[50:53], v[84:87]
    ds_read_b128 v[46:49], v9 offset:18432
    ds_read_b128 v[50:53], v9 offset:19456
    v_permlane16_swap_b32 v67, v69
    v_and_or_b32 v66, v66, -2, s58
    s_waitcnt lgkmcnt(8)
    v_mfma_f32_16x16x32_bf16 v[54:57], v[74:77], v[94:97], 0
    buffer_store_dwordx4 v[66:69], v10, s[4:7], s41 offen sc1
    v_cvt_pk_bf16_f32 v90, v90, v91
    v_mfma_f32_16x16x32_bf16 v[54:57], v[34:37], v[98:101], v[54:57]
    v_cvt_pk_bf16_f32 v91, v92, v93
    v_cvt_pk_bf16_f32 v92, v80, v81
    s_waitcnt lgkmcnt(6)
    v_mfma_f32_16x16x32_bf16 v[66:69], v[74:77], v[102:105], 0
    v_cvt_pk_bf16_f32 v93, v82, v83
    s_add_u32 s41, s35, 16384
    v_mfma_f32_16x16x32_bf16 v[66:69], v[34:37], v[106:109], v[66:69]
    v_permlane16_swap_b32 v90, v92
    v_permlane16_swap_b32 v91, v93
    s_waitcnt lgkmcnt(4)
    v_mfma_f32_16x16x32_bf16 v[70:73], v[74:77], v[58:61], 0
    v_and_or_b32 v90, v90, -2, s58
    buffer_store_dwordx4 v[90:93], v10, s[4:7], s41 offen sc1
    v_mfma_f32_16x16x32_bf16 v[70:73], v[34:37], v[62:65], v[70:73]
    v_cvt_pk_bf16_f32 v84, v84, v85
    v_cvt_pk_bf16_f32 v85, v86, v87
    s_waitcnt lgkmcnt(2)
    v_mfma_f32_16x16x32_bf16 v[90:93], v[74:77], v[38:41], 0
    v_cvt_pk_bf16_f32 v86, v54, v55
    v_cvt_pk_bf16_f32 v87, v56, v57
    v_mfma_f32_16x16x32_bf16 v[90:93], v[34:37], v[42:45], v[90:93]
    s_add_u32 s41, s35, 32768
    v_permlane16_swap_b32 v84, v86
    s_waitcnt lgkmcnt(0)
    v_mfma_f32_16x16x32_bf16 v[80:83], v[74:77], v[46:49], 0
    v_permlane16_swap_b32 v85, v87
    v_and_or_b32 v84, v84, -2, s58
    v_mfma_f32_16x16x32_bf16 v[80:83], v[34:37], v[50:53], v[80:83]
    buffer_store_dwordx4 v[84:87], v10, s[4:7], s41 offen sc1
    v_cvt_pk_bf16_f32 v66, v66, v67
    v_cvt_pk_bf16_f32 v67, v68, v69
    v_cvt_pk_bf16_f32 v68, v70, v71
    v_cvt_pk_bf16_f32 v69, v72, v73
    s_add_u32 s41, s35, 49152
    v_permlane16_swap_b32 v66, v68
    v_permlane16_swap_b32 v67, v69
    v_and_or_b32 v66, v66, -2, s58
    buffer_store_dwordx4 v[66:69], v10, s[4:7], s41 offen sc1
    v_cvt_pk_bf16_f32 v90, v90, v91
    v_cvt_pk_bf16_f32 v91, v92, v93
    v_cvt_pk_bf16_f32 v92, v80, v81
    v_cvt_pk_bf16_f32 v93, v82, v83
    s_add_u32 s41, s35, 65536
    v_permlane16_swap_b32 v90, v92
    v_permlane16_swap_b32 v91, v93
    v_and_or_b32 v90, v90, -2, s58
    buffer_store_dwordx4 v[90:93], v10, s[4:7], s41 offen sc1
    s_cmp_eq_u32 s56, 0
    s_cbranch_scc1 L_nored_53
    s_nop 15
    s_nop 15
    s_nop 15
    buffer_load_dwordx4 v[34:37], v11, s[4:7], s35 offen offset:0 sc1
    buffer_load_dwordx4 v[38:41], v11, s[4:7], s35 offen offset:1024 sc1
    buffer_load_dwordx4 v[42:45], v11, s[4:7], s35 offen offset:2048 sc1
    buffer_load_dwordx4 v[46:49], v11, s[4:7], s35 offen offset:3072 sc1
    s_mov_b32 s45, 0x80000
    s_lshr_b32 s58, s31, 1
    s_and_b32 s58, s58, 1
    s_nop 7
    s_nop 7
    s_nop 7
    buffer_load_dwordx4 v[50:53], v11, s[4:7], s35 offen offset:0 sc1
    buffer_load_dwordx4 v[54:57], v11, s[4:7], s35 offen offset:1024 sc1
    buffer_load_dwordx4 v[58:61], v11, s[4:7], s35 offen offset:2048 sc1
    buffer_load_dwordx4 v[62:65], v11, s[4:7], s35 offen offset:3072 sc1
L_pt_58:
    s_waitcnt vmcnt(4)
    v_bitop3_b32 v111, v34, v38, s58 bitop3:0x7e
    v_bitop3_b32 v110, v42, v46, s58 bitop3:0x7e
    v_or_b32 v111, v111, v110
    v_and_b32 v111, 1, v111
    v_cmp_eq_u32 vcc, 1, v111
    s_cbranch_vccz L_pd_55
    buffer_load_dwordx4 v[34:37], v11, s[4:7], s35 offen offset:0 sc1
    buffer_load_dwordx4 v[38:41], v11, s[4:7], s35 offen offset:1024 sc1
    buffer_load_dwordx4 v[42:45], v11, s[4:7], s35 offen offset:2048 sc1
    buffer_load_dwordx4 v[46:49], v11, s[4:7], s35 offen offset:3072 sc1
    s_waitcnt vmcnt(4)
    v_bitop3_b32 v111, v50, v54, s58 bitop3:0x7e
    v_bitop3_b32 v110, v58, v62, s58 bitop3:0x7e
    v_or_b32 v111, v111, v110
    v_and_b32 v111, 1, v111
    v_cmp_eq_u32 vcc, 1, v111
    s_cbranch_vccz L_pd_56
    buffer_load_dwordx4 v[50:53], v11, s[4:7], s35 offen offset:0 sc1
    buffer_load_dwordx4 v[54:57], v11, s[4:7], s35 offen offset:1024 sc1
    buffer_load_dwordx4 v[58:61], v11, s[4:7], s35 offen offset:2048 sc1
    buffer_load_dwordx4 v[62:65], v11, s[4:7], s35 offen offset:3072 sc1
    s_sub_u32 s45, s45, 1
    s_cbranch_scc0 L_pt_58
    s_waitcnt vmcnt(0)
L_pd_55:
    v_mfma_f32_16x16x32_bf16 v[66:69], v[24:27], v[34:37], 0
    v_mfma_f32_16x16x32_bf16 v[66:69], v[24:27], v[38:41], v[66:69]
    v_mfma_f32_16x16x32_bf16 v[66:69], v[24:27], v[42:45], v[66:69]
    v_mfma_f32_16x16x32_bf16 v[66:69], v[24:27], v[46:49], v[66:69]
    s_branch L_pe_57
L_pd_56:
    s_nop 6
    v_mfma_f32_16x16x32_bf16 v[66:69], v[24:27], v[50:53], 0
    v_mfma_f32_16x16x32_bf16 v[66:69], v[24:27], v[54:57], v[66:69]
    v_mfma_f32_16x16x32_bf16 v[66:69], v[24:27], v[58:61], v[66:69]
    v_mfma_f32_16x16x32_bf16 v[66:69], v[24:27], v[62:65], v[66:69]
L_pe_57:
    s_nop 7
    v_add_f32_dpp v70, v66, v66 row_ror:8 row_mask:0xf bank_mask:0xf
    v_add_f32_dpp v71, v67, v67 row_ror:8 row_mask:0xf bank_mask:0xf
    v_add_f32_dpp v72, v68, v68 row_ror:8 row_mask:0xf bank_mask:0xf
    v_add_f32_dpp v73, v69, v69 row_ror:8 row_mask:0xf bank_mask:0xf
    v_cvt_pk_bf16_f32 v70, v70, v71
    v_cvt_pk_bf16_f32 v71, v72, v73
    v_mov_b32 v72, v70
    v_mov_b32 v73, v71
    s_nop 0
    v_permlane16_swap_b32 v70, v72
    v_permlane16_swap_b32 v71, v73
    v_and_b32 v70, -2, v70
    buffer_store_dwordx4 v[70:73], v12, s[4:7], s88 offen sc1
    s_branch L_join_54
L_nored_53:
    s_cmp_lg_u32 s26, 3
    s_cbranch_scc1 L_join_54
    v_and_b32 v34, 0x7f0, v17
    v_add_u32 v34, 99328, v34
    ds_read_b128 v[94:97], v34
    ds_read_b64 v[42:43], v18 offset:0
    ds_read_b64 v[44:45], v18 offset:128
    ds_read_b64 v[46:47], v18 offset:256
    ds_read_b64 v[48:49], v18 offset:384
    s_lshl_b32 s40, s31, 16
    s_add_u32 s40, s40, 83886080
    s_waitcnt lgkmcnt(0)
    v_lshlrev_b32 v50, 16, v42
    v_and_b32 v51, 0xffff0000, v42
    v_lshlrev_b32 v52, 16, v46
    v_and_b32 v53, 0xffff0000, v46
    v_add_f32 v50, v50, v52
    v_add_f32 v51, v51, v53
    v_cvt_pk_bf16_f32 v98, v50, v51
    v_lshlrev_b32 v50, 16, v43
    v_and_b32 v51, 0xffff0000, v43
    v_lshlrev_b32 v52, 16, v47
    v_and_b32 v53, 0xffff0000, v47
    v_add_f32 v50, v50, v52
    v_add_f32 v51, v51, v53
    v_cvt_pk_bf16_f32 v99, v50, v51
    v_lshlrev_b32 v50, 16, v44
    v_and_b32 v51, 0xffff0000, v44
    v_lshlrev_b32 v52, 16, v48
    v_and_b32 v53, 0xffff0000, v48
    v_add_f32 v50, v50, v52
    v_add_f32 v51, v51, v53
    v_cvt_pk_bf16_f32 v100, v50, v51
    v_lshlrev_b32 v50, 16, v45
    v_and_b32 v51, 0xffff0000, v45
    v_lshlrev_b32 v52, 16, v49
    v_and_b32 v53, 0xffff0000, v49
    v_add_f32 v50, v50, v52
    v_add_f32 v51, v51, v53
    v_cvt_pk_bf16_f32 v101, v50, v51
    s_add_u32 s43, s31, 3
    s_and_b32 s42, s43, 3
    s_cmp_lg_u32 s42, 0
    s_cbranch_scc1 L_nokv_59
    s_cmp_ge_u32 s43, 64
    s_cbranch_scc1 L_nokv_59
    s_lshr_b32 s42, s43, 2
    s_lshl_b32 s42, s42, 7
    s_add_u32 s42, s42, 786432
    s_mov_b32 s45, 0x200000
    v_mov_b32 v78, 0
L_cw_60:
    buffer_load_dword v79, v78, s[4:7], s42 offen sc1
    s_waitcnt vmcnt(0)
    v_readfirstlane_b32 s41, v79
    s_nop 0
    s_cmp_ge_u32 s41, 64
    s_cbranch_scc1 L_cd_61
    s_sleep 1
    s_sub_u32 s45, s45, 1
    s_cbranch_scc0 L_cw_60
L_cd_61:
L_nokv_59:
L_join_54:
    s_barrier
    s_mov_b32 s58, 0
    s_add_u32 s43, s89, s83
    s_nop 15
    s_nop 15
    s_nop 15
    s_nop 15
    s_nop 15
    s_nop 15
    buffer_load_dwordx4 v[34:37], v0, s[4:7], s89 offen offset:0 sc1
    buffer_load_dwordx4 v[38:41], v0, s[4:7], s43 offen offset:512 sc1
    buffer_load_dwordx4 v[42:45], v0, s[4:7], s43 offen offset:1024 sc1
    buffer_load_dwordx4 v[46:49], v0, s[4:7], s43 offen offset:1536 sc1
    buffer_load_dwordx4 v[50:53], v0, s[4:7], s43 offen offset:2048 sc1
    s_mov_b32 s45, 0x80000
    v_mov_b32 v74, 0
    v_mov_b32 v75, 0
    v_mov_b32 v76, 0
    v_mov_b32 v77, 0
    v_mov_b32 v78, 0
    v_mov_b32 v79, 0
    v_mov_b32 v80, 0
    v_mov_b32 v81, 0
    v_mov_b32 v82, 0
    v_mov_b32 v83, 0
    v_mov_b32 v84, 0
    v_mov_b32 v85, 0
    v_mov_b32 v86, 0
    v_mov_b32 v87, 0
    v_mov_b32 v88, 0
    v_mov_b32 v89, 0
    v_mov_b32 v90, 0
    v_mov_b32 v91, 0
    v_mov_b32 v92, 0
    v_mov_b32 v93, 0
    s_add_u32 s31, s31, 1
    s_xor_b32 s49, s49, 8192
    s_xor_b32 s35, s35, 1048576
L_pt_64:
    s_waitcnt vmcnt(0)
    v_bitop3_b32 v111, v34, v38, s58 bitop3:0x7e
    v_bitop3_b32 v110, v42, v46, s58 bitop3:0x7e
    v_or_b32 v111, v111, v110
    v_xor_b32 v110, s58, v50
    v_or_b32 v111, v111, v110
    v_and_b32 v111, 1, v111
    v_cmp_eq_u32 vcc, 1, v111
    s_cbranch_vccz L_pd_62
    buffer_load_dwordx4 v[34:37], v0, s[4:7], s89 offen offset:0 sc1
    buffer_load_dwordx4 v[38:41], v0, s[4:7], s43 offen offset:512 sc1
    buffer_load_dwordx4 v[42:45], v0, s[4:7], s43 offen offset:1024 sc1
    buffer_load_dwordx4 v[46:49], v0, s[4:7], s43 offen offset:1536 sc1
    buffer_load_dwordx4 v[50:53], v0, s[4:7], s43 offen offset:2048 sc1
    s_sub_u32 s45, s45, 1
    s_cbranch_scc0 L_pt_64
    s_waitcnt vmcnt(0)
L_pd_62:
    v_mfma_f32_16x16x32_bf16 v[54:57], v[20:23], v[34:37], 0
    v_mfma_f32_16x16x32_bf16 v[58:61], v[20:23], v[38:41], 0
    v_mfma_f32_16x16x32_bf16 v[62:65], v[20:23], v[42:45], 0
    v_mfma_f32_16x16x32_bf16 v[66:69], v[20:23], v[46:49], 0
    v_mfma_f32_16x16x32_bf16 v[70:73], v[20:23], v[50:53], 0
L_pe_63:
    s_add_u32 s89, s89, 65536
    s_add_u32 s88, s88, 65536
    s_cmp_eq_u32 s31, 32
    s_cselect_b32 s43, 8192, 0
    s_xor_b32 s89, s89, s43
    s_xor_b32 s88, s88, s43
    v_cvt_pk_bf16_f32 v54, v54, v55
    v_cvt_pk_bf16_f32 v55, v56, v57
    ds_write_b64 v1, v[54:55] offset:0
    v_cvt_pk_bf16_f32 v58, v58, v59
    v_cvt_pk_bf16_f32 v59, v60, v61
    ds_write_b64 v1, v[58:59] offset:768
    v_cvt_pk_bf16_f32 v62, v62, v63
    v_cvt_pk_bf16_f32 v63, v64, v65
    ds_write_b64 v1, v[62:63] offset:1536
    v_cvt_pk_bf16_f32 v66, v66, v67
    v_cvt_pk_bf16_f32 v67, v68, v69
    ds_write_b64 v1, v[66:67] offset:2304
    v_cvt_pk_bf16_f32 v70, v70, v71
    v_cvt_pk_bf16_f32 v71, v72, v73
    ds_write_b64 v1, v[70:71] offset:3072
    s_waitcnt lgkmcnt(0)
    s_barrier
    s_branch L_step_48
L_last_short_50:
    ds_read_b64_tr_b16 v[34:35], v2 offset:0
    ds_read_b64_tr_b16 v[36:37], v2 offset:128
    ds_read_b64_tr_b16 v[38:39], v2 offset:1536
    ds_read_b64_tr_b16 v[40:41], v2 offset:1664
    ds_read_b64_tr_b16 v[42:43], v2 offset:3072
    ds_read_b64_tr_b16 v[44:45], v2 offset:3200
    ds_read_b64_tr_b16 v[46:47], v2 offset:4608
    ds_read_b64_tr_b16 v[48:49], v2 offset:4736
    ds_read_b64_tr_b16 v[50:51], v2 offset:6144
    ds_read_b64_tr_b16 v[52:53], v2 offset:6272
    ds_read_b64_tr_b16 v[54:55], v2 offset:7680
    ds_read_b64_tr_b16 v[56:57], v2 offset:7808
    ds_read_b64_tr_b16 v[58:59], v2 offset:9216
    ds_read_b64_tr_b16 v[60:61], v2 offset:9344
    ds_read_b64_tr_b16 v[62:63], v2 offset:10752
    ds_read_b64_tr_b16 v[64:65], v2 offset:10880
    ds_read_b64_tr_b16 v[66:67], v2 offset:12288
    ds_read_b64_tr_b16 v[68:69], v2 offset:12416
    ds_read_b64_tr_b16 v[70:71], v2 offset:13824
    ds_read_b64_tr_b16 v[72:73], v2 offset:13952
    s_cmp_lg_u32 s26, 3
    s_cbranch_scc1 L_w3last_65
    buffer_store_dwordx4 v[94:97], v17, s[4:7], s40 offen sc1
    s_add_u32 s41, s40, 4194304
    buffer_store_dwordx4 v[98:101], v17, s[4:7], s41 offen sc1
    s_sub_u32 s43, s31, 1
    v_mov_b32 v110, s43
    buffer_store_dword v110, off, s[4:7], s78 sc1
L_w3last_65:
    s_waitcnt lgkmcnt(0)
    v_smfmac_f32_16x16x64_bf16 v[82:85], v[34:37], a[160:167], v3
    v_smfmac_f32_16x16x64_bf16 v[86:89], v[34:37], a[240:247], v3
    v_smfmac_f32_16x16x64_bf16 v[82:85], v[38:41], a[168:175], v3
    v_smfmac_f32_16x16x64_bf16 v[86:89], v[38:41], a[248:255], v3
    v_smfmac_f32_16x16x64_bf16 v[82:85], v[42:45], a[176:183], v3
    v_smfmac_f32_16x16x64_bf16 v[86:89], v[42:45], v[112:119], v3
    v_smfmac_f32_16x16x64_bf16 v[82:85], v[46:49], a[184:191], v3
    v_smfmac_f32_16x16x64_bf16 v[86:89], v[46:49], v[120:127], v3
    v_smfmac_f32_16x16x64_bf16 v[82:85], v[50:53], a[192:199], v3
    v_smfmac_f32_16x16x64_bf16 v[86:89], v[50:53], v[128:135], v3
    v_smfmac_f32_16x16x64_bf16 v[82:85], v[54:57], a[200:207], v3
    v_smfmac_f32_16x16x64_bf16 v[86:89], v[54:57], v[136:143], v3
    v_smfmac_f32_16x16x64_bf16 v[82:85], v[58:61], a[208:215], v3
    v_smfmac_f32_16x16x64_bf16 v[86:89], v[58:61], v[144:151], v3
    v_smfmac_f32_16x16x64_bf16 v[82:85], v[62:65], a[216:223], v3
    v_smfmac_f32_16x16x64_bf16 v[86:89], v[62:65], v[152:159], v3
    v_smfmac_f32_16x16x64_bf16 v[82:85], v[66:69], a[224:231], v3
    v_smfmac_f32_16x16x64_bf16 v[86:89], v[66:69], v[160:167], v3
    v_smfmac_f32_16x16x64_bf16 v[82:85], v[70:73], a[232:239], v3
    v_smfmac_f32_16x16x64_bf16 v[86:89], v[70:73], v[168:175], v3
    v_smfmac_f32_16x16x64_bf16 v[90:93], v[34:37], v[176:183], v3
    v_smfmac_f32_16x16x64_bf16 v[90:93], v[38:41], v[184:191], v3
    v_smfmac_f32_16x16x64_bf16 v[90:93], v[42:45], v[192:199], v3
    v_smfmac_f32_16x16x64_bf16 v[90:93], v[46:49], v[200:207], v3
    v_smfmac_f32_16x16x64_bf16 v[90:93], v[50:53], v[208:215], v3
    v_smfmac_f32_16x16x64_bf16 v[90:93], v[54:57], v[216:223], v3
    v_smfmac_f32_16x16x64_bf16 v[90:93], v[58:61], v[224:231], v3
    v_smfmac_f32_16x16x64_bf16 v[90:93], v[62:65], v[232:239], v3
    v_smfmac_f32_16x16x64_bf16 v[90:93], v[66:69], v[240:247], v3
    v_smfmac_f32_16x16x64_bf16 v[90:93], v[70:73], v[248:255], v3
    v_permlane32_swap_b32 v82, v86
    v_permlane32_swap_b32 v83, v87
    v_permlane32_swap_b32 v84, v88
    v_permlane32_swap_b32 v85, v89
    v_add_f32 v82, v82, v86
    v_add_f32 v83, v83, v87
    v_add_f32 v84, v84, v88
    v_add_f32 v85, v85, v89
    v_cvt_pk_bf16_f32 v82, v82, v83
    v_cvt_pk_bf16_f32 v83, v84, v85
    ds_write_b64 v4, v[82:83] offset:2048
    v_cvt_pk_bf16_f32 v110, v90, v91
    v_cvt_pk_bf16_f32 v111, v92, v93
    ds_write_b64 v8, v[110:111]
    s_waitcnt lgkmcnt(0)
    s_barrier
L_last_49:
    s_cmp_lg_u32 s26, 3
    s_cbranch_scc1 L_endw_66
    v_and_b32 v34, 0x7f0, v17
    v_add_u32 v34, 99328, v34
    ds_read_b128 v[94:97], v34
    ds_read_b64 v[42:43], v18 offset:0
    ds_read_b64 v[44:45], v18 offset:128
    ds_read_b64 v[46:47], v18 offset:256
    ds_read_b64 v[48:49], v18 offset:384
    s_lshl_b32 s40, s31, 16
    s_add_u32 s40, s40, 83886080
    s_waitcnt lgkmcnt(0)
    v_lshlrev_b32 v50, 16, v42
    v_and_b32 v51, 0xffff0000, v42
    v_lshlrev_b32 v52, 16, v46
    v_and_b32 v53, 0xffff0000, v46
    v_add_f32 v50, v50, v52
    v_add_f32 v51, v51, v53
    v_cvt_pk_bf16_f32 v98, v50, v51
    v_lshlrev_b32 v50, 16, v43
    v_and_b32 v51, 0xffff0000, v43
    v_lshlrev_b32 v52, 16, v47
    v_and_b32 v53, 0xffff0000, v47
    v_add_f32 v50, v50, v52
    v_add_f32 v51, v51, v53
    v_cvt_pk_bf16_f32 v99, v50, v51
    v_lshlrev_b32 v50, 16, v44
    v_and_b32 v51, 0xffff0000, v44
    v_lshlrev_b32 v52, 16, v48
    v_and_b32 v53, 0xffff0000, v48
    v_add_f32 v50, v50, v52
    v_add_f32 v51, v51, v53
    v_cvt_pk_bf16_f32 v100, v50, v51
    v_lshlrev_b32 v50, 16, v45
    v_and_b32 v51, 0xffff0000, v45
    v_lshlrev_b32 v52, 16, v49
    v_and_b32 v53, 0xffff0000, v49
    v_add_f32 v50, v50, v52
    v_add_f32 v51, v51, v53
    v_cvt_pk_bf16_f32 v101, v50, v51
    buffer_store_dwordx4 v[94:97], v17, s[4:7], s40 offen sc1
    s_add_u32 s41, s40, 4194304
    buffer_store_dwordx4 v[98:101], v17, s[4:7], s41 offen sc1
    s_waitcnt vmcnt(0)
    s_mov_b32 s43, 64
    v_mov_b32 v78, s43
    buffer_store_dword v78, off, s[4:7], s78 sc1
    s_waitcnt vmcnt(0)
L_endw_66:
    s_branch main_kernel_chain_done
main_kernel_worker:
    s_mov_b32 s70, s28
    s_lshr_b32 s71, s70, 5
    s_and_b32 s72, s70, 31
    s_load_dwordx2 s[100:101], s[0:1], 120
    s_waitcnt lgkmcnt(0)
    s_lshl_b32 s80, s71, 4
    s_and_b32 s81, s72, 15
    s_add_u32 s80, s80, s81
    s_lshr_b32 s82, s80, 5
    s_lshl_b32 s83, s82, 3
    s_add_u32 s83, s83, 16
    s_load_dwordx2 s[8:9], s[0:1], s83
    s_and_b32 s80, s80, 31
    s_waitcnt lgkmcnt(0)
    s_and_b32 s9, s9, 0xffff
    s_mov_b32 s10, 5242880
    s_mov_b32 s11, 0x20000
    s_cmp_ge_u32 s70, 64
    s_cbranch_scc1 L_p0_67
    s_load_dwordx2 s[12:13], s[0:1], 24
    s_load_dwordx2 s[16:17], s[0:1], 32
    s_load_dwordx2 s[20:21], s[0:1], 16
    s_load_dwordx2 s[28:29], s[0:1], 40
    v_and_b32 v1, 255, v0
    v_lshlrev_b32 v1, 7, v1
    s_waitcnt lgkmcnt(0)
    s_and_b32 s13, s13, 0xffff
    s_mov_b32 s14, 5242880
    s_mov_b32 s15, 0x20000
    s_and_b32 s17, s17, 0xffff
    s_mov_b32 s18, 5242880
    s_mov_b32 s19, 0x20000
    s_and_b32 s21, s21, 0xffff
    s_mov_b32 s22, 5242880
    s_mov_b32 s23, 0x20000
    s_and_b32 s29, s29, 0xffff
    s_mov_b32 s30, 5242880
    s_mov_b32 s31, 0x20000
    s_sleep 16
    s_sleep 16
    s_lshl_b32 s81, s70, 15
    buffer_load_dword v230, v1, s[12:15], s81 offen
    buffer_load_dword v231, v1, s[16:19], s81 offen
    buffer_load_dword v232, v1, s[20:23], s81 offen
    s_add_u32 s81, s81, 2097152
    buffer_load_dword v233, v1, s[12:15], s81 offen
    buffer_load_dword v234, v1, s[16:19], s81 offen
    buffer_load_dword v235, v1, s[20:23], s81 offen
    s_add_u32 s81, s81, 2097152
    buffer_load_dword v236, v1, s[12:15], s81 offen
    buffer_load_dword v237, v1, s[16:19], s81 offen
    buffer_load_dword v238, v1, s[20:23], s81 offen
    s_add_u32 s81, s81, 2097152
    s_lshl_b32 s81, s70, 15
    buffer_load_dword v239, v1, s[28:31], s81 offen
    s_add_u32 s81, s81, 2097152
    buffer_load_dword v240, v1, s[28:31], s81 offen
    s_add_u32 s81, s81, 2097152
    buffer_load_dword v241, v1, s[28:31], s81 offen
    s_add_u32 s81, s81, 2097152
L_p0_67:
    s_load_dwordx2 s[12:13], s[0:1], 0
    s_waitcnt lgkmcnt(0)
    s_and_b32 s13, s13, 0xffff
    s_mov_b32 s14, 2621440
    s_mov_b32 s15, 0x20000
    s_lshr_b32 s20, s72, 4
    s_lshl_b32 s20, s20, 6
    s_sub_u32 s21, s71, 2
    s_lshl_b32 s21, s21, 4
    s_add_u32 s20, s20, s21
    s_and_b32 s21, s72, 15
    s_add_u32 s20, s20, s21
    s_add_u32 s21, s70, 128
    s_cmp_lt_u32 s71, 2
    s_cselect_b32 s20, s21, s20
    s_lshl_b32 s20, s20, 2
    s_lshr_b32 s74, s20, 7
    s_add_u32 s20, s20, s26
    v_and_b32 v1, 63, v0
    s_mov_b32 s21, 0
    s_mov_b32 s22, 2560
    v_lshlrev_b32 v2, 2, v1
    v_lshlrev_b32 v3, 3, v1
    s_add_u32 s24, s20, 0
    s_mul_i32 s24, s24, 1280
    s_add_u32 s25, s24, 0
    buffer_load_dword v15, v2, s[12:15], s25 offen offset:0
    buffer_load_dword v16, v2, s[12:15], s25 offen offset:256
    buffer_load_dword v17, v2, s[12:15], s25 offen offset:512
    buffer_load_dword v18, v2, s[12:15], s25 offen offset:768
    buffer_load_dword v19, v2, s[12:15], s25 offen offset:1024
    s_cmp_lg_u32 s26, 0
    s_cbranch_scc1 L_dd_71
    s_sleep 32
    s_sleep 32
    s_mov_b32 s79, 0x200000
    v_mov_b32 v60, 132
L_dw_70:
    global_load_dword v61, v60, s[100:101] sc1
    s_waitcnt vmcnt(0)
    v_readfirstlane_b32 s78, v61
    s_nop 0
    s_cmp_ge_u32 s78, 1
    s_cbranch_scc1 L_dd_71
    s_sleep 6
    s_sub_u32 s79, s79, 1
    s_cbranch_scc0 L_dw_70
L_dd_71:
    s_barrier
    s_cmp_lg_u32 s26, 0
    s_cbranch_scc1 L_dd_73
    s_mov_b32 s79, 0x200000
    v_mov_b32 v60, 128
L_dw_72:
    global_load_dword v61, v60, s[100:101] sc1
    s_waitcnt vmcnt(0)
    v_readfirstlane_b32 s78, v61
    s_nop 0
    s_cmp_ge_u32 s78, 20
    s_cbranch_scc1 L_dd_73
    s_sleep 6
    s_sub_u32 s79, s79, 1
    s_cbranch_scc0 L_dw_72
L_dd_73:
    s_barrier
    buffer_load_dwordx2 v[40:41], v3, s[4:7], s21 offen offset:0 sc1
    buffer_load_dwordx2 v[50:51], v3, s[4:7], s22 offen offset:0 sc1
    buffer_load_dwordx2 v[42:43], v3, s[4:7], s21 offen offset:512 sc1
    buffer_load_dwordx2 v[52:53], v3, s[4:7], s22 offen offset:512 sc1
    buffer_load_dwordx2 v[44:45], v3, s[4:7], s21 offen offset:1024 sc1
    buffer_load_dwordx2 v[54:55], v3, s[4:7], s22 offen offset:1024 sc1
    buffer_load_dwordx2 v[46:47], v3, s[4:7], s21 offen offset:1536 sc1
    buffer_load_dwordx2 v[56:57], v3, s[4:7], s22 offen offset:1536 sc1
    buffer_load_dwordx2 v[48:49], v3, s[4:7], s21 offen offset:2048 sc1
    buffer_load_dwordx2 v[58:59], v3, s[4:7], s22 offen offset:2048 sc1
    s_waitcnt vmcnt(0)
    v_lshlrev_b32 v30, 16, v15
    v_and_b32 v31, 0xffff0000, v15
    v_lshlrev_b32 v32, 16, v16
    v_and_b32 v33, 0xffff0000, v16
    v_lshlrev_b32 v34, 16, v17
    v_and_b32 v35, 0xffff0000, v17
    v_lshlrev_b32 v36, 16, v18
    v_and_b32 v37, 0xffff0000, v18
    v_lshlrev_b32 v38, 16, v19
    v_and_b32 v39, 0xffff0000, v19
    v_add_f32 v4, v30, v31
    v_add_f32 v4, v4, v32
    v_add_f32 v4, v4, v33
    v_add_f32 v4, v4, v34
    v_add_f32 v4, v4, v35
    v_add_f32 v4, v4, v36
    v_add_f32 v4, v4, v37
    v_add_f32 v4, v4, v38
    v_add_f32 v4, v4, v39
    s_nop 1
    v_add_f32_dpp v4, v4, v4 row_ror:1 row_mask:0xf bank_mask:0xf
    s_nop 1
    v_add_f32_dpp v4, v4, v4 row_ror:2 row_mask:0xf bank_mask:0xf
    s_nop 1
    v_add_f32_dpp v4, v4, v4 row_ror:4 row_mask:0xf bank_mask:0xf
    s_nop 1
    v_add_f32_dpp v4, v4, v4 row_ror:8 row_mask:0xf bank_mask:0xf
    v_mov_b32 v5, v4
    s_nop 1
    v_permlane16_swap_b32 v4, v5
    v_add_f32 v4, v4, v5
    v_mov_b32 v5, v4
    s_nop 1
    v_permlane32_swap_b32 v4, v5
    v_add_f32 v4, v4, v5
    v_mul_f32 v4, 0x3acccccd, v4
    v_mov_b32 v6, 0
    v_sub_f32 v5, v30, v4
    v_fmac_f32 v6, v5, v5
    v_sub_f32 v5, v31, v4
    v_fmac_f32 v6, v5, v5
    v_sub_f32 v5, v32, v4
    v_fmac_f32 v6, v5, v5
    v_sub_f32 v5, v33, v4
    v_fmac_f32 v6, v5, v5
    v_sub_f32 v5, v34, v4
    v_fmac_f32 v6, v5, v5
    v_sub_f32 v5, v35, v4
    v_fmac_f32 v6, v5, v5
    v_sub_f32 v5, v36, v4
    v_fmac_f32 v6, v5, v5
    v_sub_f32 v5, v37, v4
    v_fmac_f32 v6, v5, v5
    v_sub_f32 v5, v38, v4
    v_fmac_f32 v6, v5, v5
    v_sub_f32 v5, v39, v4
    v_fmac_f32 v6, v5, v5
    s_nop 1
    v_add_f32_dpp v6, v6, v6 row_ror:1 row_mask:0xf bank_mask:0xf
    s_nop 1
    v_add_f32_dpp v6, v6, v6 row_ror:2 row_mask:0xf bank_mask:0xf
    s_nop 1
    v_add_f32_dpp v6, v6, v6 row_ror:4 row_mask:0xf bank_mask:0xf
    s_nop 1
    v_add_f32_dpp v6, v6, v6 row_ror:8 row_mask:0xf bank_mask:0xf
    v_mov_b32 v5, v6
    s_nop 1
    v_permlane16_swap_b32 v6, v5
    v_add_f32 v6, v6, v5
    v_mov_b32 v5, v6
    s_nop 1
    v_permlane32_swap_b32 v6, v5
    v_add_f32 v6, v6, v5
    v_mul_f32 v6, 0x3acccccd, v6
    v_cvt_pk_bf16_f32 v6, v6, v6
    v_and_b32 v6, 0xffff0000, v6
    v_add_f32 v6, 0x3727c5ac, v6
    v_cvt_pk_bf16_f32 v6, v6, v6
    v_and_b32 v6, 0xffff0000, v6
    v_sqrt_f32 v6, v6
    s_nop 0
    v_cvt_pk_bf16_f32 v6, v6, v6
    v_and_b32 v6, 0xffff0000, v6
    v_rcp_f32 v7, v6
    v_cvt_pk_bf16_f32 v4, v4, v4
    v_and_b32 v4, 0xffff0000, v4
    v_sub_f32 v30, v30, v4
    v_cvt_pk_bf16_f32 v30, v30, v30
    v_and_b32 v30, 0xffff0000, v30
    v_mul_f32 v5, v30, v7
    v_fma_f32 v8, -v5, v6, v30
    v_fma_f32 v30, v8, v7, v5
    v_cvt_pk_bf16_f32 v30, v30, v30
    v_and_b32 v30, 0xffff0000, v30
    v_mul_f32 v30, v30, v50
    v_cvt_pk_bf16_f32 v30, v30, v30
    v_and_b32 v30, 0xffff0000, v30
    v_add_f32 v30, v30, v40
    v_sub_f32 v31, v31, v4
    v_cvt_pk_bf16_f32 v31, v31, v31
    v_and_b32 v31, 0xffff0000, v31
    v_mul_f32 v5, v31, v7
    v_fma_f32 v8, -v5, v6, v31
    v_fma_f32 v31, v8, v7, v5
    v_cvt_pk_bf16_f32 v31, v31, v31
    v_and_b32 v31, 0xffff0000, v31
    v_mul_f32 v31, v31, v51
    v_cvt_pk_bf16_f32 v31, v31, v31
    v_and_b32 v31, 0xffff0000, v31
    v_add_f32 v31, v31, v41
    v_sub_f32 v32, v32, v4
    v_cvt_pk_bf16_f32 v32, v32, v32
    v_and_b32 v32, 0xffff0000, v32
    v_mul_f32 v5, v32, v7
    v_fma_f32 v8, -v5, v6, v32
    v_fma_f32 v32, v8, v7, v5
    v_cvt_pk_bf16_f32 v32, v32, v32
    v_and_b32 v32, 0xffff0000, v32
    v_mul_f32 v32, v32, v52
    v_cvt_pk_bf16_f32 v32, v32, v32
    v_and_b32 v32, 0xffff0000, v32
    v_add_f32 v32, v32, v42
    v_sub_f32 v33, v33, v4
    v_cvt_pk_bf16_f32 v33, v33, v33
    v_and_b32 v33, 0xffff0000, v33
    v_mul_f32 v5, v33, v7
    v_fma_f32 v8, -v5, v6, v33
    v_fma_f32 v33, v8, v7, v5
    v_cvt_pk_bf16_f32 v33, v33, v33
    v_and_b32 v33, 0xffff0000, v33
    v_mul_f32 v33, v33, v53
    v_cvt_pk_bf16_f32 v33, v33, v33
    v_and_b32 v33, 0xffff0000, v33
    v_add_f32 v33, v33, v43
    v_sub_f32 v34, v34, v4
    v_cvt_pk_bf16_f32 v34, v34, v34
    v_and_b32 v34, 0xffff0000, v34
    v_mul_f32 v5, v34, v7
    v_fma_f32 v8, -v5, v6, v34
    v_fma_f32 v34, v8, v7, v5
    v_cvt_pk_bf16_f32 v34, v34, v34
    v_and_b32 v34, 0xffff0000, v34
    v_mul_f32 v34, v34, v54
    v_cvt_pk_bf16_f32 v34, v34, v34
    v_and_b32 v34, 0xffff0000, v34
    v_add_f32 v34, v34, v44
    v_sub_f32 v35, v35, v4
    v_cvt_pk_bf16_f32 v35, v35, v35
    v_and_b32 v35, 0xffff0000, v35
    v_mul_f32 v5, v35, v7
    v_fma_f32 v8, -v5, v6, v35
    v_fma_f32 v35, v8, v7, v5
    v_cvt_pk_bf16_f32 v35, v35, v35
    v_and_b32 v35, 0xffff0000, v35
    v_mul_f32 v35, v35, v55
    v_cvt_pk_bf16_f32 v35, v35, v35
    v_and_b32 v35, 0xffff0000, v35
    v_add_f32 v35, v35, v45
    v_sub_f32 v36, v36, v4
    v_cvt_pk_bf16_f32 v36, v36, v36
    v_and_b32 v36, 0xffff0000, v36
    v_mul_f32 v5, v36, v7
    v_fma_f32 v8, -v5, v6, v36
    v_fma_f32 v36, v8, v7, v5
    v_cvt_pk_bf16_f32 v36, v36, v36
    v_and_b32 v36, 0xffff0000, v36
    v_mul_f32 v36, v36, v56
    v_cvt_pk_bf16_f32 v36, v36, v36
    v_and_b32 v36, 0xffff0000, v36
    v_add_f32 v36, v36, v46
    v_sub_f32 v37, v37, v4
    v_cvt_pk_bf16_f32 v37, v37, v37
    v_and_b32 v37, 0xffff0000, v37
    v_mul_f32 v5, v37, v7
    v_fma_f32 v8, -v5, v6, v37
    v_fma_f32 v37, v8, v7, v5
    v_cvt_pk_bf16_f32 v37, v37, v37
    v_and_b32 v37, 0xffff0000, v37
    v_mul_f32 v37, v37, v57
    v_cvt_pk_bf16_f32 v37, v37, v37
    v_and_b32 v37, 0xffff0000, v37
    v_add_f32 v37, v37, v47
    v_sub_f32 v38, v38, v4
    v_cvt_pk_bf16_f32 v38, v38, v38
    v_and_b32 v38, 0xffff0000, v38
    v_mul_f32 v5, v38, v7
    v_fma_f32 v8, -v5, v6, v38
    v_fma_f32 v38, v8, v7, v5
    v_cvt_pk_bf16_f32 v38, v38, v38
    v_and_b32 v38, 0xffff0000, v38
    v_mul_f32 v38, v38, v58
    v_cvt_pk_bf16_f32 v38, v38, v38
    v_and_b32 v38, 0xffff0000, v38
    v_add_f32 v38, v38, v48
    v_sub_f32 v39, v39, v4
    v_cvt_pk_bf16_f32 v39, v39, v39
    v_and_b32 v39, 0xffff0000, v39
    v_mul_f32 v5, v39, v7
    v_fma_f32 v8, -v5, v6, v39
    v_fma_f32 v39, v8, v7, v5
    v_cvt_pk_bf16_f32 v39, v39, v39
    v_and_b32 v39, 0xffff0000, v39
    v_mul_f32 v39, v39, v59
    v_cvt_pk_bf16_f32 v39, v39, v39
    v_and_b32 v39, 0xffff0000, v39
    v_add_f32 v39, v39, v49
    s_add_u32 s25, s24, 1048576
    v_cvt_pk_bf16_f32 v10, v30, v31
    buffer_store_dword v10, v2, s[4:7], s25 offen offset:0 sc1
    v_cvt_pk_bf16_f32 v11, v32, v33
    buffer_store_dword v11, v2, s[4:7], s25 offen offset:256 sc1
    v_cvt_pk_bf16_f32 v12, v34, v35
    buffer_store_dword v12, v2, s[4:7], s25 offen offset:512 sc1
    v_cvt_pk_bf16_f32 v13, v36, v37
    buffer_store_dword v13, v2, s[4:7], s25 offen offset:768 sc1
    v_cvt_pk_bf16_f32 v14, v38, v39
    buffer_store_dword v14, v2, s[4:7], s25 offen offset:1024 sc1
    s_lshl_b32 s77, s74, 7
    s_add_u32 s77, s77, 819200
    s_waitcnt vmcnt(0)
    s_barrier
    s_cmp_lg_u32 s26, 0
    s_cbranch_scc1 L_sig_74
    v_mov_b32 v1, 0
    v_mov_b32 v2, 1
    s_mov_b64 exec, 1
    buffer_atomic_add v2, v1, s[4:7], s77 offen
    s_mov_b64 exec, -1
L_sig_74:
L_lns_69:
    s_load_dwordx2 s[8:9], s[0:1], s83
    v_and_b32 v144, 63, v0
    v_and_b32 v145, 15, v144
    v_lshrrev_b32 v146, 4, v144
    v_lshrrev_b32 v147, 6, v0
    s_nop 0
    v_readfirstlane_b32 s40, v147
    s_nop 0
    s_and_b32 s41, s40, 1
    s_lshr_b32 s42, s40, 1
    s_waitcnt lgkmcnt(0)
    s_and_b32 s9, s9, 0xffff
    s_mov_b32 s10, 5242880
    s_mov_b32 s11, 0x20000
    s_mul_i32 s48, s40, 4
    s_add_u32 s48, s48, 0
    v_lshrrev_b32 v148, 3, v144
    s_lshl_b32 s49, s48, 3
    v_add_u32 v148, s49, v148
    v_and_b32 v149, 7, v144
    v_bfe_u32 v150, v148, 1, 3
    v_xor_b32 v149, v149, v150
    s_mov_b32 s49, 1280
    v_mul_lo_u32 v148, v148, s49
    v_lshl_add_u32 v130, v149, 4, v148
    s_mul_i32 s48, s40, 4
    s_add_u32 s48, s48, 1
    v_lshrrev_b32 v148, 3, v144
    s_lshl_b32 s49, s48, 3
    v_add_u32 v148, s49, v148
    v_and_b32 v149, 7, v144
    v_bfe_u32 v150, v148, 1, 3
    v_xor_b32 v149, v149, v150
    s_mov_b32 s49, 1280
    v_mul_lo_u32 v148, v148, s49
    v_lshl_add_u32 v131, v149, 4, v148
    s_mul_i32 s48, s40, 4
    s_add_u32 s48, s48, 2
    v_lshrrev_b32 v148, 3, v144
    s_lshl_b32 s49, s48, 3
    v_add_u32 v148, s49, v148
    v_and_b32 v149, 7, v144
    v_bfe_u32 v150, v148, 1, 3
    v_xor_b32 v149, v149, v150
    s_mov_b32 s49, 1280
    v_mul_lo_u32 v148, v148, s49
    v_lshl_add_u32 v132, v149, 4, v148
    s_mul_i32 s48, s40, 4
    s_add_u32 s48, s48, 3
    v_lshrrev_b32 v148, 3, v144
    s_lshl_b32 s49, s48, 3
    v_add_u32 v148, s49, v148
    v_and_b32 v149, 7, v144
    v_bfe_u32 v150, v148, 1, 3
    v_xor_b32 v149, v149, v150
    s_mov_b32 s49, 1280
    v_mul_lo_u32 v148, v148, s49
    v_lshl_add_u32 v133, v149, 4, v148
    s_mul_i32 s48, s40, 4
    s_add_u32 s48, s48, 0
    v_lshrrev_b32 v148, 4, v144
    s_mul_i32 s49, s48, 4
    v_add_u32 v148, s49, v148
    v_and_b32 v149, 15, v144
    v_and_b32 v150, 3, v148
    v_bfe_u32 v151, v148, 3, 1
    v_lshl_add_u32 v150, v151, 2, v150
    v_lshlrev_b32 v150, 1, v150
    v_xor_b32 v149, v149, v150
    s_mov_b32 s49, 8192
    v_mul_lo_u32 v148, v148, s49
    v_lshl_add_u32 v134, v149, 4, v148
    s_mul_i32 s48, s40, 4
    s_add_u32 s48, s48, 1
    v_lshrrev_b32 v148, 4, v144
    s_mul_i32 s49, s48, 4
    v_add_u32 v148, s49, v148
    v_and_b32 v149, 15, v144
    v_and_b32 v150, 3, v148
    v_bfe_u32 v151, v148, 3, 1
    v_lshl_add_u32 v150, v151, 2, v150
    v_lshlrev_b32 v150, 1, v150
    v_xor_b32 v149, v149, v150
    s_mov_b32 s49, 8192
    v_mul_lo_u32 v148, v148, s49
    v_lshl_add_u32 v135, v149, 4, v148
    s_mul_i32 s48, s40, 4
    s_add_u32 s48, s48, 2
    v_lshrrev_b32 v148, 4, v144
    s_mul_i32 s49, s48, 4
    v_add_u32 v148, s49, v148
    v_and_b32 v149, 15, v144
    v_and_b32 v150, 3, v148
    v_bfe_u32 v151, v148, 3, 1
    v_lshl_add_u32 v150, v151, 2, v150
    v_lshlrev_b32 v150, 1, v150
    v_xor_b32 v149, v149, v150
    s_mov_b32 s49, 8192
    v_mul_lo_u32 v148, v148, s49
    v_lshl_add_u32 v136, v149, 4, v148
    s_mul_i32 s48, s40, 4
    s_add_u32 s48, s48, 3
    v_lshrrev_b32 v148, 4, v144
    s_mul_i32 s49, s48, 4
    v_add_u32 v148, s49, v148
    v_and_b32 v149, 15, v144
    v_and_b32 v150, 3, v148
    v_bfe_u32 v151, v148, 3, 1
    v_lshl_add_u32 v150, v151, 2, v150
    v_lshlrev_b32 v150, 1, v150
    v_xor_b32 v149, v149, v150
    s_mov_b32 s49, 8192
    v_mul_lo_u32 v148, v148, s49
    v_lshl_add_u32 v137, v149, 4, v148
    v_bfe_u32 v148, v145, 1, 3
    v_xor_b32 v148, v148, v146
    v_lshlrev_b32 v148, 4, v148
    v_lshl_add_u32 v148, v145, 7, v148
    s_mul_i32 s48, s41, 8192
    s_add_u32 s48, s48, 0
    v_add_u32 v138, s48, v148
    v_xor_b32 v139, 64, v138
    v_lshrrev_b32 v148, 2, v145
    v_and_b32 v149, 3, v145
    v_and_b32 v151, 1, v146
    v_lshl_add_u32 v150, v151, 2, v148
    v_lshlrev_b32 v150, 1, v150
    v_lshrrev_b32 v151, 1, v149
    v_xor_b32 v150, v150, v151
    v_lshlrev_b32 v150, 4, v150
    v_and_b32 v151, 1, v149
    v_lshl_add_u32 v150, v151, 3, v150
    v_lshl_add_u32 v151, v146, 3, v148
    s_mov_b32 s48, 256
    v_mul_lo_u32 v151, v151, s48
    v_add_u32 v150, v150, v151
    s_mul_i32 s48, s42, 4
    s_add_u32 s48, s48, 0
    s_and_b32 s49, s48, 7
    s_lshl_b32 s49, s49, 5
    v_xor_b32 v140, s49, v150
    s_lshr_b32 s48, s48, 3
    s_lshl_b32 s48, s48, 8
    s_add_u32 s48, s48, 16384
    v_add_u32 v140, s48, v140
    s_mul_i32 s48, s42, 4
    s_add_u32 s48, s48, 1
    s_and_b32 s49, s48, 7
    s_lshl_b32 s49, s49, 5
    v_xor_b32 v141, s49, v150
    s_lshr_b32 s48, s48, 3
    s_lshl_b32 s48, s48, 8
    s_add_u32 s48, s48, 16384
    v_add_u32 v141, s48, v141
    s_mul_i32 s48, s42, 4
    s_add_u32 s48, s48, 2
    s_and_b32 s49, s48, 7
    s_lshl_b32 s49, s49, 5
    v_xor_b32 v142, s49, v150
    s_lshr_b32 s48, s48, 3
    s_lshl_b32 s48, s48, 8
    s_add_u32 s48, s48, 16384
    v_add_u32 v142, s48, v142
    s_mul_i32 s48, s42, 4
    s_add_u32 s48, s48, 3
    s_and_b32 s49, s48, 7
    s_lshl_b32 s49, s49, 5
    v_xor_b32 v143, s49, v150
    s_lshr_b32 s48, s48, 3
    s_lshl_b32 s48, s48, 8
    s_add_u32 s48, s48, 16384
    v_add_u32 v143, s48, v143
    s_lshr_b32 s74, s72, 4
    s_add_u32 s74, s74, 0
    s_mul_i32 s43, s74, 163840
    s_add_u32 s43, s43, 1048576
    s_mul_i32 s44, s80, 256
    s_lshl_b32 s16, s82, 24
    s_add_u32 s16, s16, 16777216
    s_mul_i32 s17, s74, 1048576
    s_add_u32 s16, s16, s17
    s_mul_i32 s17, s80, 256
    s_add_u32 s16, s16, s17
    s_mul_i32 s54, s40, 4096
    s_mul_i32 s55, s40, 4096
    s_mov_b32 s46, 0
    s_mov_b32 s51, 0
    s_mov_b32 s52, s54
    s_mov_b32 s53, s55
    s_add_u32 s50, s44, 0
    s_add_u32 s53, s55, 0
    s_add_u32 m0, s53, 16384
    s_nop 0
    buffer_load_dwordx4 v134, s[8:11], s50 offen lds
    s_add_u32 m0, s53, 17408
    s_nop 0
    buffer_load_dwordx4 v135, s[8:11], s50 offen lds
    s_add_u32 m0, s53, 18432
    s_nop 0
    buffer_load_dwordx4 v136, s[8:11], s50 offen lds
    s_add_u32 m0, s53, 19456
    s_nop 0
    buffer_load_dwordx4 v137, s[8:11], s50 offen lds
    s_add_u32 s50, s44, 524288
    s_add_u32 s53, s55, 32768
    s_add_u32 m0, s53, 16384
    s_nop 0
    buffer_load_dwordx4 v134, s[8:11], s50 offen lds
    s_add_u32 m0, s53, 17408
    s_nop 0
    buffer_load_dwordx4 v135, s[8:11], s50 offen lds
    s_add_u32 m0, s53, 18432
    s_nop 0
    buffer_load_dwordx4 v136, s[8:11], s50 offen lds
    s_add_u32 m0, s53, 19456
    s_nop 0
    buffer_load_dwordx4 v137, s[8:11], s50 offen lds
    s_add_u32 s50, s44, 1048576
    s_add_u32 s53, s55, 65536
    s_add_u32 m0, s53, 16384
    s_nop 0
    buffer_load_dwordx4 v134, s[8:11], s50 offen lds
    s_add_u32 m0, s53, 17408
    s_nop 0
    buffer_load_dwordx4 v135, s[8:11], s50 offen lds
    s_add_u32 m0, s53, 18432
    s_nop 0
    buffer_load_dwordx4 v136, s[8:11], s50 offen lds
    s_add_u32 m0, s53, 19456
    s_nop 0
    buffer_load_dwordx4 v137, s[8:11], s50 offen lds
    s_add_u32 s50, s44, 1572864
    s_add_u32 s53, s55, 98304
    s_add_u32 m0, s53, 16384
    s_nop 0
    buffer_load_dwordx4 v134, s[8:11], s50 offen lds
    s_add_u32 m0, s53, 17408
    s_nop 0
    buffer_load_dwordx4 v135, s[8:11], s50 offen lds
    s_add_u32 m0, s53, 18432
    s_nop 0
    buffer_load_dwordx4 v136, s[8:11], s50 offen lds
    s_add_u32 m0, s53, 19456
    s_nop 0
    buffer_load_dwordx4 v137, s[8:11], s50 offen lds
    s_add_u32 s50, s44, 2097152
    s_add_u32 s53, s55, 131072
    s_add_u32 m0, s53, 16384
    s_nop 0
    buffer_load_dwordx4 v134, s[8:11], s50 offen lds
    s_add_u32 m0, s53, 17408
    s_nop 0
    buffer_load_dwordx4 v135, s[8:11], s50 offen lds
    s_add_u32 m0, s53, 18432
    s_nop 0
    buffer_load_dwordx4 v136, s[8:11], s50 offen lds
    s_add_u32 m0, s53, 19456
    s_nop 0
    buffer_load_dwordx4 v137, s[8:11], s50 offen lds
    s_lshl_b32 s77, s74, 7
    s_add_u32 s77, s77, 819200
    s_cmp_lg_u32 s26, 0
    s_cbranch_scc1 L_wgw_75
    s_mov_b32 s79, 0x200000
    v_mov_b32 v152, 0
L_cw_76:
    buffer_load_dword v153, v152, s[4:7], s77 offen sc1
    s_waitcnt vmcnt(0)
    v_readfirstlane_b32 s78, v153
    s_nop 0
    s_cmp_ge_u32 s78, 32
    s_cbranch_scc1 L_cd_77
    s_sleep 2
    s_sub_u32 s79, s79, 1
    s_cbranch_scc0 L_cw_76
L_cd_77:
L_wgw_75:
    s_barrier
    s_add_u32 s50, s43, 0
    s_add_u32 s52, s54, 0
    s_add_u32 m0, s52, 0
    s_nop 0
    buffer_load_dwordx4 v130, s[4:7], s50 offen sc1 lds
    s_add_u32 m0, s52, 1024
    s_nop 0
    buffer_load_dwordx4 v131, s[4:7], s50 offen sc1 lds
    s_add_u32 m0, s52, 2048
    s_nop 0
    buffer_load_dwordx4 v132, s[4:7], s50 offen sc1 lds
    s_add_u32 m0, s52, 3072
    s_nop 0
    buffer_load_dwordx4 v133, s[4:7], s50 offen sc1 lds
    s_add_u32 s50, s43, 128
    s_add_u32 s52, s54, 32768
    s_add_u32 m0, s52, 0
    s_nop 0
    buffer_load_dwordx4 v130, s[4:7], s50 offen sc1 lds
    s_add_u32 m0, s52, 1024
    s_nop 0
    buffer_load_dwordx4 v131, s[4:7], s50 offen sc1 lds
    s_add_u32 m0, s52, 2048
    s_nop 0
    buffer_load_dwordx4 v132, s[4:7], s50 offen sc1 lds
    s_add_u32 m0, s52, 3072
    s_nop 0
    buffer_load_dwordx4 v133, s[4:7], s50 offen sc1 lds
    s_add_u32 s50, s43, 256
    s_add_u32 s52, s54, 65536
    s_add_u32 m0, s52, 0
    s_nop 0
    buffer_load_dwordx4 v130, s[4:7], s50 offen sc1 lds
    s_add_u32 m0, s52, 1024
    s_nop 0
    buffer_load_dwordx4 v131, s[4:7], s50 offen sc1 lds
    s_add_u32 m0, s52, 2048
    s_nop 0
    buffer_load_dwordx4 v132, s[4:7], s50 offen sc1 lds
    s_add_u32 m0, s52, 3072
    s_nop 0
    buffer_load_dwordx4 v133, s[4:7], s50 offen sc1 lds
    s_add_u32 s50, s43, 384
    s_add_u32 s52, s54, 98304
    s_add_u32 m0, s52, 0
    s_nop 0
    buffer_load_dwordx4 v130, s[4:7], s50 offen sc1 lds
    s_add_u32 m0, s52, 1024
    s_nop 0
    buffer_load_dwordx4 v131, s[4:7], s50 offen sc1 lds
    s_add_u32 m0, s52, 2048
    s_nop 0
    buffer_load_dwordx4 v132, s[4:7], s50 offen sc1 lds
    s_add_u32 m0, s52, 3072
    s_nop 0
    buffer_load_dwordx4 v133, s[4:7], s50 offen sc1 lds
    s_add_u32 s50, s43, 512
    s_add_u32 s52, s54, 131072
    s_add_u32 m0, s52, 0
    s_nop 0
    buffer_load_dwordx4 v130, s[4:7], s50 offen sc1 lds
    s_add_u32 m0, s52, 1024
    s_nop 0
    buffer_load_dwordx4 v131, s[4:7], s50 offen sc1 lds
    s_add_u32 m0, s52, 2048
    s_nop 0
    buffer_load_dwordx4 v132, s[4:7], s50 offen sc1 lds
    s_add_u32 m0, s52, 3072
    s_nop 0
    buffer_load_dwordx4 v133, s[4:7], s50 offen sc1 lds
    s_add_u32 s43, s43, 128
    s_add_u32 s44, s44, 524288
    s_add_u32 s51, s51, 1
    s_cmp_ge_u32 s51, 10
    s_cmov_b32 s43, 0x40000000
    s_cmov_b32 s44, 0x40000000
    s_add_u32 s46, s46, 32768
    s_cmp_eq_u32 s46, 163840
    s_cmov_b32 s46, 0
    s_add_u32 s52, s46, s54
    s_add_u32 s53, s46, s55
    s_add_u32 s43, s43, 128
    s_add_u32 s44, s44, 524288
    s_add_u32 s51, s51, 1
    s_cmp_ge_u32 s51, 10
    s_cmov_b32 s43, 0x40000000
    s_cmov_b32 s44, 0x40000000
    s_add_u32 s46, s46, 32768
    s_cmp_eq_u32 s46, 163840
    s_cmov_b32 s46, 0
    s_add_u32 s52, s46, s54
    s_add_u32 s53, s46, s55
    s_add_u32 s43, s43, 128
    s_add_u32 s44, s44, 524288
    s_add_u32 s51, s51, 1
    s_cmp_ge_u32 s51, 10
    s_cmov_b32 s43, 0x40000000
    s_cmov_b32 s44, 0x40000000
    s_add_u32 s46, s46, 32768
    s_cmp_eq_u32 s46, 163840
    s_cmov_b32 s46, 0
    s_add_u32 s52, s46, s54
    s_add_u32 s53, s46, s55
    s_add_u32 s43, s43, 128
    s_add_u32 s44, s44, 524288
    s_add_u32 s51, s51, 1
    s_cmp_ge_u32 s51, 10
    s_cmov_b32 s43, 0x40000000
    s_cmov_b32 s44, 0x40000000
    s_add_u32 s46, s46, 32768
    s_cmp_eq_u32 s46, 163840
    s_cmov_b32 s46, 0
    s_add_u32 s52, s46, s54
    s_add_u32 s53, s46, s55
    s_add_u32 s43, s43, 128
    s_add_u32 s44, s44, 524288
    s_add_u32 s51, s51, 1
    s_cmp_ge_u32 s51, 10
    s_cmov_b32 s43, 0x40000000
    s_cmov_b32 s44, 0x40000000
    s_add_u32 s46, s46, 32768
    s_cmp_eq_u32 s46, 163840
    s_cmov_b32 s46, 0
    s_add_u32 s52, s46, s54
    s_add_u32 s53, s46, s55
    v_mov_b32 v2, 0
    v_mov_b32 v3, 0
    v_mov_b32 v4, 0
    v_mov_b32 v5, 0
    v_mov_b32 v6, 0
    v_mov_b32 v7, 0
    v_mov_b32 v8, 0
    v_mov_b32 v9, 0
    v_mov_b32 v10, 0
    v_mov_b32 v11, 0
    v_mov_b32 v12, 0
    v_mov_b32 v13, 0
    v_mov_b32 v14, 0
    v_mov_b32 v15, 0
    v_mov_b32 v16, 0
    v_mov_b32 v17, 0
    v_mov_b32 v18, 0
    v_mov_b32 v19, 0
    v_mov_b32 v20, 0
    v_mov_b32 v21, 0
    v_mov_b32 v22, 0
    v_mov_b32 v23, 0
    v_mov_b32 v24, 0
    v_mov_b32 v25, 0
    v_mov_b32 v26, 0
    v_mov_b32 v27, 0
    v_mov_b32 v28, 0
    v_mov_b32 v29, 0
    v_mov_b32 v30, 0
    v_mov_b32 v31, 0
    v_mov_b32 v32, 0
    v_mov_b32 v33, 0
    v_mov_b32 v34, 0
    v_mov_b32 v35, 0
    v_mov_b32 v36, 0
    v_mov_b32 v37, 0
    v_mov_b32 v38, 0
    v_mov_b32 v39, 0
    v_mov_b32 v40, 0
    v_mov_b32 v41, 0
    v_mov_b32 v42, 0
    v_mov_b32 v43, 0
    v_mov_b32 v44, 0
    v_mov_b32 v45, 0
    v_mov_b32 v46, 0
    v_mov_b32 v47, 0
    v_mov_b32 v48, 0
    v_mov_b32 v49, 0
    v_mov_b32 v50, 0
    v_mov_b32 v51, 0
    v_mov_b32 v52, 0
    v_mov_b32 v53, 0
    v_mov_b32 v54, 0
    v_mov_b32 v55, 0
    v_mov_b32 v56, 0
    v_mov_b32 v57, 0
    v_mov_b32 v58, 0
    v_mov_b32 v59, 0
    v_mov_b32 v60, 0
    v_mov_b32 v61, 0
    v_mov_b32 v62, 0
    v_mov_b32 v63, 0
    v_mov_b32 v64, 0
    v_mov_b32 v65, 0
    s_mov_b32 s45, 0
    s_mov_b32 s47, 0
    s_waitcnt vmcnt(16)
    s_barrier
    ds_read_b64_tr_b16 v[98:99], v140 offset:0
    ds_read_b64_tr_b16 v[100:101], v140 offset:1024
    ds_read_b64_tr_b16 v[102:103], v141 offset:0
    ds_read_b64_tr_b16 v[104:105], v141 offset:1024
    ds_read_b64_tr_b16 v[106:107], v142 offset:0
    ds_read_b64_tr_b16 v[108:109], v142 offset:1024
    ds_read_b64_tr_b16 v[110:111], v143 offset:0
    ds_read_b64_tr_b16 v[112:113], v143 offset:1024
    ds_read_b128 v[66:69], v138 offset:0
    ds_read_b128 v[70:73], v138 offset:2048
    ds_read_b128 v[74:77], v138 offset:4096
    ds_read_b128 v[78:81], v138 offset:6144
    s_waitcnt lgkmcnt(0)
    v_mfma_f32_16x16x32_bf16 v[2:5], v[98:101], v[66:69], v[2:5]
    ds_read_b64_tr_b16 v[114:115], v140 offset:8192
    v_mfma_f32_16x16x32_bf16 v[6:9], v[98:101], v[70:73], v[6:9]
    ds_read_b64_tr_b16 v[116:117], v140 offset:9216
    v_mfma_f32_16x16x32_bf16 v[10:13], v[98:101], v[74:77], v[10:13]
    ds_read_b64_tr_b16 v[118:119], v141 offset:8192
    v_mfma_f32_16x16x32_bf16 v[14:17], v[98:101], v[78:81], v[14:17]
    ds_read_b64_tr_b16 v[120:121], v141 offset:9216
    v_mfma_f32_16x16x32_bf16 v[18:21], v[102:105], v[66:69], v[18:21]
    ds_read_b64_tr_b16 v[122:123], v142 offset:8192
    v_mfma_f32_16x16x32_bf16 v[22:25], v[102:105], v[70:73], v[22:25]
    ds_read_b64_tr_b16 v[124:125], v142 offset:9216
    v_mfma_f32_16x16x32_bf16 v[26:29], v[102:105], v[74:77], v[26:29]
    ds_read_b64_tr_b16 v[126:127], v143 offset:8192
    v_mfma_f32_16x16x32_bf16 v[30:33], v[102:105], v[78:81], v[30:33]
    ds_read_b64_tr_b16 v[128:129], v143 offset:9216
    v_mfma_f32_16x16x32_bf16 v[34:37], v[106:109], v[66:69], v[34:37]
    ds_read_b128 v[82:85], v139 offset:0
    v_mfma_f32_16x16x32_bf16 v[38:41], v[106:109], v[70:73], v[38:41]
    ds_read_b128 v[86:89], v139 offset:2048
    v_mfma_f32_16x16x32_bf16 v[42:45], v[106:109], v[74:77], v[42:45]
    ds_read_b128 v[90:93], v139 offset:4096
    v_mfma_f32_16x16x32_bf16 v[46:49], v[106:109], v[78:81], v[46:49]
    ds_read_b128 v[94:97], v139 offset:6144
    v_mfma_f32_16x16x32_bf16 v[50:53], v[110:113], v[66:69], v[50:53]
    v_mfma_f32_16x16x32_bf16 v[54:57], v[110:113], v[70:73], v[54:57]
    v_mfma_f32_16x16x32_bf16 v[58:61], v[110:113], v[74:77], v[58:61]
    v_mfma_f32_16x16x32_bf16 v[62:65], v[110:113], v[78:81], v[62:65]
    s_add_u32 s47, s47, 1
    s_cmp_eq_u32 s47, 5
    s_mov_b32 s49, 32768
    s_cmov_b32 s49, 0xfffe0000
    s_cmov_b32 s47, 0
    s_waitcnt lgkmcnt(0)
    v_add_u32 v138, s49, v138
    v_add_u32 v139, s49, v139
    v_add_u32 v140, s49, v140
    v_add_u32 v141, s49, v141
    v_add_u32 v142, s49, v142
    v_add_u32 v143, s49, v143
    s_waitcnt vmcnt(12)
    s_barrier
    v_mfma_f32_16x16x32_bf16 v[2:5], v[114:117], v[82:85], v[2:5]
    ds_read_b64_tr_b16 v[98:99], v140 offset:0
    v_mfma_f32_16x16x32_bf16 v[6:9], v[114:117], v[86:89], v[6:9]
    ds_read_b64_tr_b16 v[100:101], v140 offset:1024
    s_add_u32 m0, s52, 0
    s_nop 0
    buffer_load_dwordx4 v130, s[4:7], s43 offen sc1 lds
    v_mfma_f32_16x16x32_bf16 v[10:13], v[114:117], v[90:93], v[10:13]
    ds_read_b64_tr_b16 v[102:103], v141 offset:0
    v_mfma_f32_16x16x32_bf16 v[14:17], v[114:117], v[94:97], v[14:17]
    ds_read_b64_tr_b16 v[104:105], v141 offset:1024
    s_add_u32 m0, s52, 1024
    s_nop 0
    buffer_load_dwordx4 v131, s[4:7], s43 offen sc1 lds
    v_mfma_f32_16x16x32_bf16 v[18:21], v[118:121], v[82:85], v[18:21]
    ds_read_b64_tr_b16 v[106:107], v142 offset:0
    v_mfma_f32_16x16x32_bf16 v[22:25], v[118:121], v[86:89], v[22:25]
    ds_read_b64_tr_b16 v[108:109], v142 offset:1024
    s_add_u32 m0, s52, 2048
    s_nop 0
    buffer_load_dwordx4 v132, s[4:7], s43 offen sc1 lds
    v_mfma_f32_16x16x32_bf16 v[26:29], v[118:121], v[90:93], v[26:29]
    ds_read_b64_tr_b16 v[110:111], v143 offset:0
    v_mfma_f32_16x16x32_bf16 v[30:33], v[118:121], v[94:97], v[30:33]
    ds_read_b64_tr_b16 v[112:113], v143 offset:1024
    s_add_u32 m0, s52, 3072
    s_nop 0
    buffer_load_dwordx4 v133, s[4:7], s43 offen sc1 lds
    v_mfma_f32_16x16x32_bf16 v[34:37], v[122:125], v[82:85], v[34:37]
    ds_read_b128 v[66:69], v138 offset:0
    v_mfma_f32_16x16x32_bf16 v[38:41], v[122:125], v[86:89], v[38:41]
    ds_read_b128 v[70:73], v138 offset:2048
    s_add_u32 m0, s53, 16384
    s_nop 0
    buffer_load_dwordx4 v134, s[8:11], s44 offen lds
    v_mfma_f32_16x16x32_bf16 v[42:45], v[122:125], v[90:93], v[42:45]
    ds_read_b128 v[74:77], v138 offset:4096
    v_mfma_f32_16x16x32_bf16 v[46:49], v[122:125], v[94:97], v[46:49]
    ds_read_b128 v[78:81], v138 offset:6144
    s_add_u32 m0, s53, 17408
    s_nop 0
    buffer_load_dwordx4 v135, s[8:11], s44 offen lds
    v_mfma_f32_16x16x32_bf16 v[50:53], v[126:129], v[82:85], v[50:53]
    v_mfma_f32_16x16x32_bf16 v[54:57], v[126:129], v[86:89], v[54:57]
    s_add_u32 m0, s53, 18432
    s_nop 0
    buffer_load_dwordx4 v136, s[8:11], s44 offen lds
    v_mfma_f32_16x16x32_bf16 v[58:61], v[126:129], v[90:93], v[58:61]
    v_mfma_f32_16x16x32_bf16 v[62:65], v[126:129], v[94:97], v[62:65]
    s_add_u32 m0, s53, 19456
    s_nop 0
    buffer_load_dwordx4 v137, s[8:11], s44 offen lds
    s_add_u32 s43, s43, 128
    s_add_u32 s44, s44, 524288
    s_add_u32 s46, s46, 32768
    s_cmp_eq_u32 s46, 163840
    s_cmov_b32 s46, 0
    s_add_u32 s52, s46, s54
    s_add_u32 s53, s46, s55
    s_waitcnt lgkmcnt(0)
    v_mfma_f32_16x16x32_bf16 v[2:5], v[98:101], v[66:69], v[2:5]
    ds_read_b64_tr_b16 v[114:115], v140 offset:8192
    v_mfma_f32_16x16x32_bf16 v[6:9], v[98:101], v[70:73], v[6:9]
    ds_read_b64_tr_b16 v[116:117], v140 offset:9216
    v_mfma_f32_16x16x32_bf16 v[10:13], v[98:101], v[74:77], v[10:13]
    ds_read_b64_tr_b16 v[118:119], v141 offset:8192
    v_mfma_f32_16x16x32_bf16 v[14:17], v[98:101], v[78:81], v[14:17]
    ds_read_b64_tr_b16 v[120:121], v141 offset:9216
    v_mfma_f32_16x16x32_bf16 v[18:21], v[102:105], v[66:69], v[18:21]
    ds_read_b64_tr_b16 v[122:123], v142 offset:8192
    v_mfma_f32_16x16x32_bf16 v[22:25], v[102:105], v[70:73], v[22:25]
    ds_read_b64_tr_b16 v[124:125], v142 offset:9216
    v_mfma_f32_16x16x32_bf16 v[26:29], v[102:105], v[74:77], v[26:29]
    ds_read_b64_tr_b16 v[126:127], v143 offset:8192
    v_mfma_f32_16x16x32_bf16 v[30:33], v[102:105], v[78:81], v[30:33]
    ds_read_b64_tr_b16 v[128:129], v143 offset:9216
    v_mfma_f32_16x16x32_bf16 v[34:37], v[106:109], v[66:69], v[34:37]
    ds_read_b128 v[82:85], v139 offset:0
    v_mfma_f32_16x16x32_bf16 v[38:41], v[106:109], v[70:73], v[38:41]
    ds_read_b128 v[86:89], v139 offset:2048
    v_mfma_f32_16x16x32_bf16 v[42:45], v[106:109], v[74:77], v[42:45]
    ds_read_b128 v[90:93], v139 offset:4096
    v_mfma_f32_16x16x32_bf16 v[46:49], v[106:109], v[78:81], v[46:49]
    ds_read_b128 v[94:97], v139 offset:6144
    v_mfma_f32_16x16x32_bf16 v[50:53], v[110:113], v[66:69], v[50:53]
    v_mfma_f32_16x16x32_bf16 v[54:57], v[110:113], v[70:73], v[54:57]
    v_mfma_f32_16x16x32_bf16 v[58:61], v[110:113], v[74:77], v[58:61]
    v_mfma_f32_16x16x32_bf16 v[62:65], v[110:113], v[78:81], v[62:65]
    s_add_u32 s47, s47, 1
    s_cmp_eq_u32 s47, 5
    s_mov_b32 s49, 32768
    s_cmov_b32 s49, 0xfffe0000
    s_cmov_b32 s47, 0
    s_waitcnt lgkmcnt(0)
    v_add_u32 v138, s49, v138
    v_add_u32 v139, s49, v139
    v_add_u32 v140, s49, v140
    v_add_u32 v141, s49, v141
    v_add_u32 v142, s49, v142
    v_add_u32 v143, s49, v143
    s_waitcnt vmcnt(16)
    s_barrier
    v_mfma_f32_16x16x32_bf16 v[2:5], v[114:117], v[82:85], v[2:5]
    ds_read_b64_tr_b16 v[98:99], v140 offset:0
    v_mfma_f32_16x16x32_bf16 v[6:9], v[114:117], v[86:89], v[6:9]
    ds_read_b64_tr_b16 v[100:101], v140 offset:1024
    s_add_u32 m0, s52, 0
    s_nop 0
    buffer_load_dwordx4 v130, s[4:7], s43 offen sc1 lds
    v_mfma_f32_16x16x32_bf16 v[10:13], v[114:117], v[90:93], v[10:13]
    ds_read_b64_tr_b16 v[102:103], v141 offset:0
    v_mfma_f32_16x16x32_bf16 v[14:17], v[114:117], v[94:97], v[14:17]
    ds_read_b64_tr_b16 v[104:105], v141 offset:1024
    s_add_u32 m0, s52, 1024
    s_nop 0
    buffer_load_dwordx4 v131, s[4:7], s43 offen sc1 lds
    v_mfma_f32_16x16x32_bf16 v[18:21], v[118:121], v[82:85], v[18:21]
    ds_read_b64_tr_b16 v[106:107], v142 offset:0
    v_mfma_f32_16x16x32_bf16 v[22:25], v[118:121], v[86:89], v[22:25]
    ds_read_b64_tr_b16 v[108:109], v142 offset:1024
    s_add_u32 m0, s52, 2048
    s_nop 0
    buffer_load_dwordx4 v132, s[4:7], s43 offen sc1 lds
    v_mfma_f32_16x16x32_bf16 v[26:29], v[118:121], v[90:93], v[26:29]
    ds_read_b64_tr_b16 v[110:111], v143 offset:0
    v_mfma_f32_16x16x32_bf16 v[30:33], v[118:121], v[94:97], v[30:33]
    ds_read_b64_tr_b16 v[112:113], v143 offset:1024
    s_add_u32 m0, s52, 3072
    s_nop 0
    buffer_load_dwordx4 v133, s[4:7], s43 offen sc1 lds
    v_mfma_f32_16x16x32_bf16 v[34:37], v[122:125], v[82:85], v[34:37]
    ds_read_b128 v[66:69], v138 offset:0
    v_mfma_f32_16x16x32_bf16 v[38:41], v[122:125], v[86:89], v[38:41]
    ds_read_b128 v[70:73], v138 offset:2048
    s_add_u32 m0, s53, 16384
    s_nop 0
    buffer_load_dwordx4 v134, s[8:11], s44 offen lds
    v_mfma_f32_16x16x32_bf16 v[42:45], v[122:125], v[90:93], v[42:45]
    ds_read_b128 v[74:77], v138 offset:4096
    v_mfma_f32_16x16x32_bf16 v[46:49], v[122:125], v[94:97], v[46:49]
    ds_read_b128 v[78:81], v138 offset:6144
    s_add_u32 m0, s53, 17408
    s_nop 0
    buffer_load_dwordx4 v135, s[8:11], s44 offen lds
    v_mfma_f32_16x16x32_bf16 v[50:53], v[126:129], v[82:85], v[50:53]
    v_mfma_f32_16x16x32_bf16 v[54:57], v[126:129], v[86:89], v[54:57]
    s_add_u32 m0, s53, 18432
    s_nop 0
    buffer_load_dwordx4 v136, s[8:11], s44 offen lds
    v_mfma_f32_16x16x32_bf16 v[58:61], v[126:129], v[90:93], v[58:61]
    v_mfma_f32_16x16x32_bf16 v[62:65], v[126:129], v[94:97], v[62:65]
    s_add_u32 m0, s53, 19456
    s_nop 0
    buffer_load_dwordx4 v137, s[8:11], s44 offen lds
    s_add_u32 s43, s43, 128
    s_add_u32 s44, s44, 524288
    s_add_u32 s46, s46, 32768
    s_cmp_eq_u32 s46, 163840
    s_cmov_b32 s46, 0
    s_add_u32 s52, s46, s54
    s_add_u32 s53, s46, s55
    s_waitcnt lgkmcnt(0)
    v_mfma_f32_16x16x32_bf16 v[2:5], v[98:101], v[66:69], v[2:5]
    ds_read_b64_tr_b16 v[114:115], v140 offset:8192
    v_mfma_f32_16x16x32_bf16 v[6:9], v[98:101], v[70:73], v[6:9]
    ds_read_b64_tr_b16 v[116:117], v140 offset:9216
    v_mfma_f32_16x16x32_bf16 v[10:13], v[98:101], v[74:77], v[10:13]
    ds_read_b64_tr_b16 v[118:119], v141 offset:8192
    v_mfma_f32_16x16x32_bf16 v[14:17], v[98:101], v[78:81], v[14:17]
    ds_read_b64_tr_b16 v[120:121], v141 offset:9216
    v_mfma_f32_16x16x32_bf16 v[18:21], v[102:105], v[66:69], v[18:21]
    ds_read_b64_tr_b16 v[122:123], v142 offset:8192
    v_mfma_f32_16x16x32_bf16 v[22:25], v[102:105], v[70:73], v[22:25]
    ds_read_b64_tr_b16 v[124:125], v142 offset:9216
    v_mfma_f32_16x16x32_bf16 v[26:29], v[102:105], v[74:77], v[26:29]
    ds_read_b64_tr_b16 v[126:127], v143 offset:8192
    v_mfma_f32_16x16x32_bf16 v[30:33], v[102:105], v[78:81], v[30:33]
    ds_read_b64_tr_b16 v[128:129], v143 offset:9216
    v_mfma_f32_16x16x32_bf16 v[34:37], v[106:109], v[66:69], v[34:37]
    ds_read_b128 v[82:85], v139 offset:0
    v_mfma_f32_16x16x32_bf16 v[38:41], v[106:109], v[70:73], v[38:41]
    ds_read_b128 v[86:89], v139 offset:2048
    v_mfma_f32_16x16x32_bf16 v[42:45], v[106:109], v[74:77], v[42:45]
    ds_read_b128 v[90:93], v139 offset:4096
    v_mfma_f32_16x16x32_bf16 v[46:49], v[106:109], v[78:81], v[46:49]
    ds_read_b128 v[94:97], v139 offset:6144
    v_mfma_f32_16x16x32_bf16 v[50:53], v[110:113], v[66:69], v[50:53]
    v_mfma_f32_16x16x32_bf16 v[54:57], v[110:113], v[70:73], v[54:57]
    v_mfma_f32_16x16x32_bf16 v[58:61], v[110:113], v[74:77], v[58:61]
    v_mfma_f32_16x16x32_bf16 v[62:65], v[110:113], v[78:81], v[62:65]
    s_add_u32 s47, s47, 1
    s_cmp_eq_u32 s47, 5
    s_mov_b32 s49, 32768
    s_cmov_b32 s49, 0xfffe0000
    s_cmov_b32 s47, 0
    s_waitcnt lgkmcnt(0)
    v_add_u32 v138, s49, v138
    v_add_u32 v139, s49, v139
    v_add_u32 v140, s49, v140
    v_add_u32 v141, s49, v141
    v_add_u32 v142, s49, v142
    v_add_u32 v143, s49, v143
    s_waitcnt vmcnt(20)
    s_barrier
    v_mfma_f32_16x16x32_bf16 v[2:5], v[114:117], v[82:85], v[2:5]
    ds_read_b64_tr_b16 v[98:99], v140 offset:0
    v_mfma_f32_16x16x32_bf16 v[6:9], v[114:117], v[86:89], v[6:9]
    ds_read_b64_tr_b16 v[100:101], v140 offset:1024
    s_add_u32 m0, s52, 0
    s_nop 0
    buffer_load_dwordx4 v130, s[4:7], s43 offen sc1 lds
    v_mfma_f32_16x16x32_bf16 v[10:13], v[114:117], v[90:93], v[10:13]
    ds_read_b64_tr_b16 v[102:103], v141 offset:0
    v_mfma_f32_16x16x32_bf16 v[14:17], v[114:117], v[94:97], v[14:17]
    ds_read_b64_tr_b16 v[104:105], v141 offset:1024
    s_add_u32 m0, s52, 1024
    s_nop 0
    buffer_load_dwordx4 v131, s[4:7], s43 offen sc1 lds
    v_mfma_f32_16x16x32_bf16 v[18:21], v[118:121], v[82:85], v[18:21]
    ds_read_b64_tr_b16 v[106:107], v142 offset:0
    v_mfma_f32_16x16x32_bf16 v[22:25], v[118:121], v[86:89], v[22:25]
    ds_read_b64_tr_b16 v[108:109], v142 offset:1024
    s_add_u32 m0, s52, 2048
    s_nop 0
    buffer_load_dwordx4 v132, s[4:7], s43 offen sc1 lds
    v_mfma_f32_16x16x32_bf16 v[26:29], v[118:121], v[90:93], v[26:29]
    ds_read_b64_tr_b16 v[110:111], v143 offset:0
    v_mfma_f32_16x16x32_bf16 v[30:33], v[118:121], v[94:97], v[30:33]
    ds_read_b64_tr_b16 v[112:113], v143 offset:1024
    s_add_u32 m0, s52, 3072
    s_nop 0
    buffer_load_dwordx4 v133, s[4:7], s43 offen sc1 lds
    v_mfma_f32_16x16x32_bf16 v[34:37], v[122:125], v[82:85], v[34:37]
    ds_read_b128 v[66:69], v138 offset:0
    v_mfma_f32_16x16x32_bf16 v[38:41], v[122:125], v[86:89], v[38:41]
    ds_read_b128 v[70:73], v138 offset:2048
    s_add_u32 m0, s53, 16384
    s_nop 0
    buffer_load_dwordx4 v134, s[8:11], s44 offen lds
    v_mfma_f32_16x16x32_bf16 v[42:45], v[122:125], v[90:93], v[42:45]
    ds_read_b128 v[74:77], v138 offset:4096
    v_mfma_f32_16x16x32_bf16 v[46:49], v[122:125], v[94:97], v[46:49]
    ds_read_b128 v[78:81], v138 offset:6144
    s_add_u32 m0, s53, 17408
    s_nop 0
    buffer_load_dwordx4 v135, s[8:11], s44 offen lds
    v_mfma_f32_16x16x32_bf16 v[50:53], v[126:129], v[82:85], v[50:53]
    v_mfma_f32_16x16x32_bf16 v[54:57], v[126:129], v[86:89], v[54:57]
    s_add_u32 m0, s53, 18432
    s_nop 0
    buffer_load_dwordx4 v136, s[8:11], s44 offen lds
    v_mfma_f32_16x16x32_bf16 v[58:61], v[126:129], v[90:93], v[58:61]
    v_mfma_f32_16x16x32_bf16 v[62:65], v[126:129], v[94:97], v[62:65]
    s_add_u32 m0, s53, 19456
    s_nop 0
    buffer_load_dwordx4 v137, s[8:11], s44 offen lds
    s_add_u32 s43, s43, 128
    s_add_u32 s44, s44, 524288
    s_add_u32 s46, s46, 32768
    s_cmp_eq_u32 s46, 163840
    s_cmov_b32 s46, 0
    s_add_u32 s52, s46, s54
    s_add_u32 s53, s46, s55
    s_waitcnt lgkmcnt(0)
    s_mov_b32 s45, 3
L_gk_78:
    v_mfma_f32_16x16x32_bf16 v[2:5], v[98:101], v[66:69], v[2:5]
    ds_read_b64_tr_b16 v[114:115], v140 offset:8192
    v_mfma_f32_16x16x32_bf16 v[6:9], v[98:101], v[70:73], v[6:9]
    ds_read_b64_tr_b16 v[116:117], v140 offset:9216
    v_mfma_f32_16x16x32_bf16 v[10:13], v[98:101], v[74:77], v[10:13]
    ds_read_b64_tr_b16 v[118:119], v141 offset:8192
    v_mfma_f32_16x16x32_bf16 v[14:17], v[98:101], v[78:81], v[14:17]
    ds_read_b64_tr_b16 v[120:121], v141 offset:9216
    v_mfma_f32_16x16x32_bf16 v[18:21], v[102:105], v[66:69], v[18:21]
    ds_read_b64_tr_b16 v[122:123], v142 offset:8192
    v_mfma_f32_16x16x32_bf16 v[22:25], v[102:105], v[70:73], v[22:25]
    ds_read_b64_tr_b16 v[124:125], v142 offset:9216
    v_mfma_f32_16x16x32_bf16 v[26:29], v[102:105], v[74:77], v[26:29]
    ds_read_b64_tr_b16 v[126:127], v143 offset:8192
    v_mfma_f32_16x16x32_bf16 v[30:33], v[102:105], v[78:81], v[30:33]
    ds_read_b64_tr_b16 v[128:129], v143 offset:9216
    v_mfma_f32_16x16x32_bf16 v[34:37], v[106:109], v[66:69], v[34:37]
    ds_read_b128 v[82:85], v139 offset:0
    v_mfma_f32_16x16x32_bf16 v[38:41], v[106:109], v[70:73], v[38:41]
    ds_read_b128 v[86:89], v139 offset:2048
    v_mfma_f32_16x16x32_bf16 v[42:45], v[106:109], v[74:77], v[42:45]
    ds_read_b128 v[90:93], v139 offset:4096
    v_mfma_f32_16x16x32_bf16 v[46:49], v[106:109], v[78:81], v[46:49]
    ds_read_b128 v[94:97], v139 offset:6144
    v_mfma_f32_16x16x32_bf16 v[50:53], v[110:113], v[66:69], v[50:53]
    v_mfma_f32_16x16x32_bf16 v[54:57], v[110:113], v[70:73], v[54:57]
    v_mfma_f32_16x16x32_bf16 v[58:61], v[110:113], v[74:77], v[58:61]
    v_mfma_f32_16x16x32_bf16 v[62:65], v[110:113], v[78:81], v[62:65]
    s_add_u32 s47, s47, 1
    s_cmp_eq_u32 s47, 5
    s_mov_b32 s49, 32768
    s_cmov_b32 s49, 0xfffe0000
    s_cmov_b32 s47, 0
    s_waitcnt lgkmcnt(0)
    v_add_u32 v138, s49, v138
    v_add_u32 v139, s49, v139
    v_add_u32 v140, s49, v140
    v_add_u32 v141, s49, v141
    v_add_u32 v142, s49, v142
    v_add_u32 v143, s49, v143
    s_waitcnt vmcnt(24)
    s_barrier
    v_mfma_f32_16x16x32_bf16 v[2:5], v[114:117], v[82:85], v[2:5]
    ds_read_b64_tr_b16 v[98:99], v140 offset:0
    v_mfma_f32_16x16x32_bf16 v[6:9], v[114:117], v[86:89], v[6:9]
    ds_read_b64_tr_b16 v[100:101], v140 offset:1024
    s_add_u32 m0, s52, 0
    s_nop 0
    buffer_load_dwordx4 v130, s[4:7], s43 offen sc1 lds
    v_mfma_f32_16x16x32_bf16 v[10:13], v[114:117], v[90:93], v[10:13]
    ds_read_b64_tr_b16 v[102:103], v141 offset:0
    v_mfma_f32_16x16x32_bf16 v[14:17], v[114:117], v[94:97], v[14:17]
    ds_read_b64_tr_b16 v[104:105], v141 offset:1024
    s_add_u32 m0, s52, 1024
    s_nop 0
    buffer_load_dwordx4 v131, s[4:7], s43 offen sc1 lds
    v_mfma_f32_16x16x32_bf16 v[18:21], v[118:121], v[82:85], v[18:21]
    ds_read_b64_tr_b16 v[106:107], v142 offset:0
    v_mfma_f32_16x16x32_bf16 v[22:25], v[118:121], v[86:89], v[22:25]
    ds_read_b64_tr_b16 v[108:109], v142 offset:1024
    s_add_u32 m0, s52, 2048
    s_nop 0
    buffer_load_dwordx4 v132, s[4:7], s43 offen sc1 lds
    v_mfma_f32_16x16x32_bf16 v[26:29], v[118:121], v[90:93], v[26:29]
    ds_read_b64_tr_b16 v[110:111], v143 offset:0
    v_mfma_f32_16x16x32_bf16 v[30:33], v[118:121], v[94:97], v[30:33]
    ds_read_b64_tr_b16 v[112:113], v143 offset:1024
    s_add_u32 m0, s52, 3072
    s_nop 0
    buffer_load_dwordx4 v133, s[4:7], s43 offen sc1 lds
    v_mfma_f32_16x16x32_bf16 v[34:37], v[122:125], v[82:85], v[34:37]
    ds_read_b128 v[66:69], v138 offset:0
    v_mfma_f32_16x16x32_bf16 v[38:41], v[122:125], v[86:89], v[38:41]
    ds_read_b128 v[70:73], v138 offset:2048
    s_add_u32 m0, s53, 16384
    s_nop 0
    buffer_load_dwordx4 v134, s[8:11], s44 offen lds
    v_mfma_f32_16x16x32_bf16 v[42:45], v[122:125], v[90:93], v[42:45]
    ds_read_b128 v[74:77], v138 offset:4096
    v_mfma_f32_16x16x32_bf16 v[46:49], v[122:125], v[94:97], v[46:49]
    ds_read_b128 v[78:81], v138 offset:6144
    s_add_u32 m0, s53, 17408
    s_nop 0
    buffer_load_dwordx4 v135, s[8:11], s44 offen lds
    v_mfma_f32_16x16x32_bf16 v[50:53], v[126:129], v[82:85], v[50:53]
    v_mfma_f32_16x16x32_bf16 v[54:57], v[126:129], v[86:89], v[54:57]
    s_add_u32 m0, s53, 18432
    s_nop 0
    buffer_load_dwordx4 v136, s[8:11], s44 offen lds
    v_mfma_f32_16x16x32_bf16 v[58:61], v[126:129], v[90:93], v[58:61]
    v_mfma_f32_16x16x32_bf16 v[62:65], v[126:129], v[94:97], v[62:65]
    s_add_u32 m0, s53, 19456
    s_nop 0
    buffer_load_dwordx4 v137, s[8:11], s44 offen lds
    s_add_u32 s43, s43, 128
    s_add_u32 s44, s44, 524288
    s_add_u32 s46, s46, 32768
    s_cmp_eq_u32 s46, 163840
    s_cmov_b32 s46, 0
    s_add_u32 s52, s46, s54
    s_add_u32 s53, s46, s55
    s_add_u32 s45, s45, 1
    s_cmp_lt_u32 s45, 5
    s_waitcnt lgkmcnt(0)
    s_cbranch_scc1 L_gk_78
    v_mfma_f32_16x16x32_bf16 v[2:5], v[98:101], v[66:69], v[2:5]
    ds_read_b64_tr_b16 v[114:115], v140 offset:8192
    v_mfma_f32_16x16x32_bf16 v[6:9], v[98:101], v[70:73], v[6:9]
    ds_read_b64_tr_b16 v[116:117], v140 offset:9216
    v_mfma_f32_16x16x32_bf16 v[10:13], v[98:101], v[74:77], v[10:13]
    ds_read_b64_tr_b16 v[118:119], v141 offset:8192
    v_mfma_f32_16x16x32_bf16 v[14:17], v[98:101], v[78:81], v[14:17]
    ds_read_b64_tr_b16 v[120:121], v141 offset:9216
    v_mfma_f32_16x16x32_bf16 v[18:21], v[102:105], v[66:69], v[18:21]
    ds_read_b64_tr_b16 v[122:123], v142 offset:8192
    v_mfma_f32_16x16x32_bf16 v[22:25], v[102:105], v[70:73], v[22:25]
    ds_read_b64_tr_b16 v[124:125], v142 offset:9216
    v_mfma_f32_16x16x32_bf16 v[26:29], v[102:105], v[74:77], v[26:29]
    ds_read_b64_tr_b16 v[126:127], v143 offset:8192
    v_mfma_f32_16x16x32_bf16 v[30:33], v[102:105], v[78:81], v[30:33]
    ds_read_b64_tr_b16 v[128:129], v143 offset:9216
    v_mfma_f32_16x16x32_bf16 v[34:37], v[106:109], v[66:69], v[34:37]
    ds_read_b128 v[82:85], v139 offset:0
    v_mfma_f32_16x16x32_bf16 v[38:41], v[106:109], v[70:73], v[38:41]
    ds_read_b128 v[86:89], v139 offset:2048
    v_mfma_f32_16x16x32_bf16 v[42:45], v[106:109], v[74:77], v[42:45]
    ds_read_b128 v[90:93], v139 offset:4096
    v_mfma_f32_16x16x32_bf16 v[46:49], v[106:109], v[78:81], v[46:49]
    ds_read_b128 v[94:97], v139 offset:6144
    v_mfma_f32_16x16x32_bf16 v[50:53], v[110:113], v[66:69], v[50:53]
    v_mfma_f32_16x16x32_bf16 v[54:57], v[110:113], v[70:73], v[54:57]
    v_mfma_f32_16x16x32_bf16 v[58:61], v[110:113], v[74:77], v[58:61]
    v_mfma_f32_16x16x32_bf16 v[62:65], v[110:113], v[78:81], v[62:65]
    s_add_u32 s47, s47, 1
    s_cmp_eq_u32 s47, 5
    s_mov_b32 s49, 32768
    s_cmov_b32 s49, 0xfffe0000
    s_cmov_b32 s47, 0
    s_waitcnt lgkmcnt(0)
    v_add_u32 v138, s49, v138
    v_add_u32 v139, s49, v139
    v_add_u32 v140, s49, v140
    v_add_u32 v141, s49, v141
    v_add_u32 v142, s49, v142
    v_add_u32 v143, s49, v143
    s_waitcnt vmcnt(24)
    s_barrier
    v_mfma_f32_16x16x32_bf16 v[2:5], v[114:117], v[82:85], v[2:5]
    ds_read_b64_tr_b16 v[98:99], v140 offset:0
    v_mfma_f32_16x16x32_bf16 v[6:9], v[114:117], v[86:89], v[6:9]
    ds_read_b64_tr_b16 v[100:101], v140 offset:1024
    v_mfma_f32_16x16x32_bf16 v[10:13], v[114:117], v[90:93], v[10:13]
    ds_read_b64_tr_b16 v[102:103], v141 offset:0
    v_mfma_f32_16x16x32_bf16 v[14:17], v[114:117], v[94:97], v[14:17]
    ds_read_b64_tr_b16 v[104:105], v141 offset:1024
    v_mfma_f32_16x16x32_bf16 v[18:21], v[118:121], v[82:85], v[18:21]
    ds_read_b64_tr_b16 v[106:107], v142 offset:0
    v_mfma_f32_16x16x32_bf16 v[22:25], v[118:121], v[86:89], v[22:25]
    ds_read_b64_tr_b16 v[108:109], v142 offset:1024
    v_mfma_f32_16x16x32_bf16 v[26:29], v[118:121], v[90:93], v[26:29]
    ds_read_b64_tr_b16 v[110:111], v143 offset:0
    v_mfma_f32_16x16x32_bf16 v[30:33], v[118:121], v[94:97], v[30:33]
    ds_read_b64_tr_b16 v[112:113], v143 offset:1024
    v_mfma_f32_16x16x32_bf16 v[34:37], v[122:125], v[82:85], v[34:37]
    ds_read_b128 v[66:69], v138 offset:0
    v_mfma_f32_16x16x32_bf16 v[38:41], v[122:125], v[86:89], v[38:41]
    ds_read_b128 v[70:73], v138 offset:2048
    v_mfma_f32_16x16x32_bf16 v[42:45], v[122:125], v[90:93], v[42:45]
    ds_read_b128 v[74:77], v138 offset:4096
    v_mfma_f32_16x16x32_bf16 v[46:49], v[122:125], v[94:97], v[46:49]
    ds_read_b128 v[78:81], v138 offset:6144
    v_mfma_f32_16x16x32_bf16 v[50:53], v[126:129], v[82:85], v[50:53]
    v_mfma_f32_16x16x32_bf16 v[54:57], v[126:129], v[86:89], v[54:57]
    v_mfma_f32_16x16x32_bf16 v[58:61], v[126:129], v[90:93], v[58:61]
    v_mfma_f32_16x16x32_bf16 v[62:65], v[126:129], v[94:97], v[62:65]
    s_waitcnt lgkmcnt(0)
    v_mfma_f32_16x16x32_bf16 v[2:5], v[98:101], v[66:69], v[2:5]
    ds_read_b64_tr_b16 v[114:115], v140 offset:8192
    v_mfma_f32_16x16x32_bf16 v[6:9], v[98:101], v[70:73], v[6:9]
    ds_read_b64_tr_b16 v[116:117], v140 offset:9216
    v_mfma_f32_16x16x32_bf16 v[10:13], v[98:101], v[74:77], v[10:13]
    ds_read_b64_tr_b16 v[118:119], v141 offset:8192
    v_mfma_f32_16x16x32_bf16 v[14:17], v[98:101], v[78:81], v[14:17]
    ds_read_b64_tr_b16 v[120:121], v141 offset:9216
    v_mfma_f32_16x16x32_bf16 v[18:21], v[102:105], v[66:69], v[18:21]
    ds_read_b64_tr_b16 v[122:123], v142 offset:8192
    v_mfma_f32_16x16x32_bf16 v[22:25], v[102:105], v[70:73], v[22:25]
    ds_read_b64_tr_b16 v[124:125], v142 offset:9216
    v_mfma_f32_16x16x32_bf16 v[26:29], v[102:105], v[74:77], v[26:29]
    ds_read_b64_tr_b16 v[126:127], v143 offset:8192
    v_mfma_f32_16x16x32_bf16 v[30:33], v[102:105], v[78:81], v[30:33]
    ds_read_b64_tr_b16 v[128:129], v143 offset:9216
    v_mfma_f32_16x16x32_bf16 v[34:37], v[106:109], v[66:69], v[34:37]
    ds_read_b128 v[82:85], v139 offset:0
    v_mfma_f32_16x16x32_bf16 v[38:41], v[106:109], v[70:73], v[38:41]
    ds_read_b128 v[86:89], v139 offset:2048
    v_mfma_f32_16x16x32_bf16 v[42:45], v[106:109], v[74:77], v[42:45]
    ds_read_b128 v[90:93], v139 offset:4096
    v_mfma_f32_16x16x32_bf16 v[46:49], v[106:109], v[78:81], v[46:49]
    ds_read_b128 v[94:97], v139 offset:6144
    v_mfma_f32_16x16x32_bf16 v[50:53], v[110:113], v[66:69], v[50:53]
    v_mfma_f32_16x16x32_bf16 v[54:57], v[110:113], v[70:73], v[54:57]
    v_mfma_f32_16x16x32_bf16 v[58:61], v[110:113], v[74:77], v[58:61]
    v_mfma_f32_16x16x32_bf16 v[62:65], v[110:113], v[78:81], v[62:65]
    s_add_u32 s47, s47, 1
    s_cmp_eq_u32 s47, 5
    s_mov_b32 s49, 32768
    s_cmov_b32 s49, 0xfffe0000
    s_cmov_b32 s47, 0
    s_waitcnt lgkmcnt(0)
    v_add_u32 v138, s49, v138
    v_add_u32 v139, s49, v139
    v_add_u32 v140, s49, v140
    v_add_u32 v141, s49, v141
    v_add_u32 v142, s49, v142
    v_add_u32 v143, s49, v143
    s_waitcnt vmcnt(16)
    s_barrier
    v_mfma_f32_16x16x32_bf16 v[2:5], v[114:117], v[82:85], v[2:5]
    ds_read_b64_tr_b16 v[98:99], v140 offset:0
    v_mfma_f32_16x16x32_bf16 v[6:9], v[114:117], v[86:89], v[6:9]
    ds_read_b64_tr_b16 v[100:101], v140 offset:1024
    v_mfma_f32_16x16x32_bf16 v[10:13], v[114:117], v[90:93], v[10:13]
    ds_read_b64_tr_b16 v[102:103], v141 offset:0
    v_mfma_f32_16x16x32_bf16 v[14:17], v[114:117], v[94:97], v[14:17]
    ds_read_b64_tr_b16 v[104:105], v141 offset:1024
    v_mfma_f32_16x16x32_bf16 v[18:21], v[118:121], v[82:85], v[18:21]
    ds_read_b64_tr_b16 v[106:107], v142 offset:0
    v_mfma_f32_16x16x32_bf16 v[22:25], v[118:121], v[86:89], v[22:25]
    ds_read_b64_tr_b16 v[108:109], v142 offset:1024
    v_mfma_f32_16x16x32_bf16 v[26:29], v[118:121], v[90:93], v[26:29]
    ds_read_b64_tr_b16 v[110:111], v143 offset:0
    v_mfma_f32_16x16x32_bf16 v[30:33], v[118:121], v[94:97], v[30:33]
    ds_read_b64_tr_b16 v[112:113], v143 offset:1024
    v_mfma_f32_16x16x32_bf16 v[34:37], v[122:125], v[82:85], v[34:37]
    ds_read_b128 v[66:69], v138 offset:0
    v_mfma_f32_16x16x32_bf16 v[38:41], v[122:125], v[86:89], v[38:41]
    ds_read_b128 v[70:73], v138 offset:2048
    v_mfma_f32_16x16x32_bf16 v[42:45], v[122:125], v[90:93], v[42:45]
    ds_read_b128 v[74:77], v138 offset:4096
    v_mfma_f32_16x16x32_bf16 v[46:49], v[122:125], v[94:97], v[46:49]
    ds_read_b128 v[78:81], v138 offset:6144
    v_mfma_f32_16x16x32_bf16 v[50:53], v[126:129], v[82:85], v[50:53]
    v_mfma_f32_16x16x32_bf16 v[54:57], v[126:129], v[86:89], v[54:57]
    v_mfma_f32_16x16x32_bf16 v[58:61], v[126:129], v[90:93], v[58:61]
    v_mfma_f32_16x16x32_bf16 v[62:65], v[126:129], v[94:97], v[62:65]
    s_waitcnt lgkmcnt(0)
    v_mfma_f32_16x16x32_bf16 v[2:5], v[98:101], v[66:69], v[2:5]
    ds_read_b64_tr_b16 v[114:115], v140 offset:8192
    v_mfma_f32_16x16x32_bf16 v[6:9], v[98:101], v[70:73], v[6:9]
    ds_read_b64_tr_b16 v[116:117], v140 offset:9216
    v_mfma_f32_16x16x32_bf16 v[10:13], v[98:101], v[74:77], v[10:13]
    ds_read_b64_tr_b16 v[118:119], v141 offset:8192
    v_mfma_f32_16x16x32_bf16 v[14:17], v[98:101], v[78:81], v[14:17]
    ds_read_b64_tr_b16 v[120:121], v141 offset:9216
    v_mfma_f32_16x16x32_bf16 v[18:21], v[102:105], v[66:69], v[18:21]
    ds_read_b64_tr_b16 v[122:123], v142 offset:8192
    v_mfma_f32_16x16x32_bf16 v[22:25], v[102:105], v[70:73], v[22:25]
    ds_read_b64_tr_b16 v[124:125], v142 offset:9216
    v_mfma_f32_16x16x32_bf16 v[26:29], v[102:105], v[74:77], v[26:29]
    ds_read_b64_tr_b16 v[126:127], v143 offset:8192
    v_mfma_f32_16x16x32_bf16 v[30:33], v[102:105], v[78:81], v[30:33]
    ds_read_b64_tr_b16 v[128:129], v143 offset:9216
    v_mfma_f32_16x16x32_bf16 v[34:37], v[106:109], v[66:69], v[34:37]
    ds_read_b128 v[82:85], v139 offset:0
    v_mfma_f32_16x16x32_bf16 v[38:41], v[106:109], v[70:73], v[38:41]
    ds_read_b128 v[86:89], v139 offset:2048
    v_mfma_f32_16x16x32_bf16 v[42:45], v[106:109], v[74:77], v[42:45]
    ds_read_b128 v[90:93], v139 offset:4096
    v_mfma_f32_16x16x32_bf16 v[46:49], v[106:109], v[78:81], v[46:49]
    ds_read_b128 v[94:97], v139 offset:6144
    v_mfma_f32_16x16x32_bf16 v[50:53], v[110:113], v[66:69], v[50:53]
    v_mfma_f32_16x16x32_bf16 v[54:57], v[110:113], v[70:73], v[54:57]
    v_mfma_f32_16x16x32_bf16 v[58:61], v[110:113], v[74:77], v[58:61]
    v_mfma_f32_16x16x32_bf16 v[62:65], v[110:113], v[78:81], v[62:65]
    s_add_u32 s47, s47, 1
    s_cmp_eq_u32 s47, 5
    s_mov_b32 s49, 32768
    s_cmov_b32 s49, 0xfffe0000
    s_cmov_b32 s47, 0
    s_waitcnt lgkmcnt(0)
    v_add_u32 v138, s49, v138
    v_add_u32 v139, s49, v139
    v_add_u32 v140, s49, v140
    v_add_u32 v141, s49, v141
    v_add_u32 v142, s49, v142
    v_add_u32 v143, s49, v143
    s_waitcnt vmcnt(8)
    s_barrier
    v_mfma_f32_16x16x32_bf16 v[2:5], v[114:117], v[82:85], v[2:5]
    ds_read_b64_tr_b16 v[98:99], v140 offset:0
    v_mfma_f32_16x16x32_bf16 v[6:9], v[114:117], v[86:89], v[6:9]
    ds_read_b64_tr_b16 v[100:101], v140 offset:1024
    v_mfma_f32_16x16x32_bf16 v[10:13], v[114:117], v[90:93], v[10:13]
    ds_read_b64_tr_b16 v[102:103], v141 offset:0
    v_mfma_f32_16x16x32_bf16 v[14:17], v[114:117], v[94:97], v[14:17]
    ds_read_b64_tr_b16 v[104:105], v141 offset:1024
    v_mfma_f32_16x16x32_bf16 v[18:21], v[118:121], v[82:85], v[18:21]
    ds_read_b64_tr_b16 v[106:107], v142 offset:0
    v_mfma_f32_16x16x32_bf16 v[22:25], v[118:121], v[86:89], v[22:25]
    ds_read_b64_tr_b16 v[108:109], v142 offset:1024
    v_mfma_f32_16x16x32_bf16 v[26:29], v[118:121], v[90:93], v[26:29]
    ds_read_b64_tr_b16 v[110:111], v143 offset:0
    v_mfma_f32_16x16x32_bf16 v[30:33], v[118:121], v[94:97], v[30:33]
    ds_read_b64_tr_b16 v[112:113], v143 offset:1024
    v_mfma_f32_16x16x32_bf16 v[34:37], v[122:125], v[82:85], v[34:37]
    ds_read_b128 v[66:69], v138 offset:0
    v_mfma_f32_16x16x32_bf16 v[38:41], v[122:125], v[86:89], v[38:41]
    ds_read_b128 v[70:73], v138 offset:2048
    v_mfma_f32_16x16x32_bf16 v[42:45], v[122:125], v[90:93], v[42:45]
    ds_read_b128 v[74:77], v138 offset:4096
    v_mfma_f32_16x16x32_bf16 v[46:49], v[122:125], v[94:97], v[46:49]
    ds_read_b128 v[78:81], v138 offset:6144
    v_mfma_f32_16x16x32_bf16 v[50:53], v[126:129], v[82:85], v[50:53]
    v_mfma_f32_16x16x32_bf16 v[54:57], v[126:129], v[86:89], v[54:57]
    v_mfma_f32_16x16x32_bf16 v[58:61], v[126:129], v[90:93], v[58:61]
    v_mfma_f32_16x16x32_bf16 v[62:65], v[126:129], v[94:97], v[62:65]
    s_waitcnt lgkmcnt(0)
    v_mfma_f32_16x16x32_bf16 v[2:5], v[98:101], v[66:69], v[2:5]
    ds_read_b64_tr_b16 v[114:115], v140 offset:8192
    v_mfma_f32_16x16x32_bf16 v[6:9], v[98:101], v[70:73], v[6:9]
    ds_read_b64_tr_b16 v[116:117], v140 offset:9216
    v_mfma_f32_16x16x32_bf16 v[10:13], v[98:101], v[74:77], v[10:13]
    ds_read_b64_tr_b16 v[118:119], v141 offset:8192
    v_mfma_f32_16x16x32_bf16 v[14:17], v[98:101], v[78:81], v[14:17]
    ds_read_b64_tr_b16 v[120:121], v141 offset:9216
    v_mfma_f32_16x16x32_bf16 v[18:21], v[102:105], v[66:69], v[18:21]
    ds_read_b64_tr_b16 v[122:123], v142 offset:8192
    v_mfma_f32_16x16x32_bf16 v[22:25], v[102:105], v[70:73], v[22:25]
    ds_read_b64_tr_b16 v[124:125], v142 offset:9216
    v_mfma_f32_16x16x32_bf16 v[26:29], v[102:105], v[74:77], v[26:29]
    ds_read_b64_tr_b16 v[126:127], v143 offset:8192
    v_mfma_f32_16x16x32_bf16 v[30:33], v[102:105], v[78:81], v[30:33]
    ds_read_b64_tr_b16 v[128:129], v143 offset:9216
    v_mfma_f32_16x16x32_bf16 v[34:37], v[106:109], v[66:69], v[34:37]
    ds_read_b128 v[82:85], v139 offset:0
    v_mfma_f32_16x16x32_bf16 v[38:41], v[106:109], v[70:73], v[38:41]
    ds_read_b128 v[86:89], v139 offset:2048
    v_mfma_f32_16x16x32_bf16 v[42:45], v[106:109], v[74:77], v[42:45]
    ds_read_b128 v[90:93], v139 offset:4096
    v_mfma_f32_16x16x32_bf16 v[46:49], v[106:109], v[78:81], v[46:49]
    ds_read_b128 v[94:97], v139 offset:6144
    v_mfma_f32_16x16x32_bf16 v[50:53], v[110:113], v[66:69], v[50:53]
    v_mfma_f32_16x16x32_bf16 v[54:57], v[110:113], v[70:73], v[54:57]
    v_mfma_f32_16x16x32_bf16 v[58:61], v[110:113], v[74:77], v[58:61]
    v_mfma_f32_16x16x32_bf16 v[62:65], v[110:113], v[78:81], v[62:65]
    s_add_u32 s47, s47, 1
    s_cmp_eq_u32 s47, 5
    s_mov_b32 s49, 32768
    s_cmov_b32 s49, 0xfffe0000
    s_cmov_b32 s47, 0
    s_waitcnt lgkmcnt(0)
    v_add_u32 v138, s49, v138
    v_add_u32 v139, s49, v139
    v_add_u32 v140, s49, v140
    v_add_u32 v141, s49, v141
    v_add_u32 v142, s49, v142
    v_add_u32 v143, s49, v143
    s_waitcnt vmcnt(0)
    s_barrier
    v_mfma_f32_16x16x32_bf16 v[2:5], v[114:117], v[82:85], v[2:5]
    ds_read_b64_tr_b16 v[98:99], v140 offset:0
    v_mfma_f32_16x16x32_bf16 v[6:9], v[114:117], v[86:89], v[6:9]
    ds_read_b64_tr_b16 v[100:101], v140 offset:1024
    v_mfma_f32_16x16x32_bf16 v[10:13], v[114:117], v[90:93], v[10:13]
    ds_read_b64_tr_b16 v[102:103], v141 offset:0
    v_mfma_f32_16x16x32_bf16 v[14:17], v[114:117], v[94:97], v[14:17]
    ds_read_b64_tr_b16 v[104:105], v141 offset:1024
    v_mfma_f32_16x16x32_bf16 v[18:21], v[118:121], v[82:85], v[18:21]
    ds_read_b64_tr_b16 v[106:107], v142 offset:0
    v_mfma_f32_16x16x32_bf16 v[22:25], v[118:121], v[86:89], v[22:25]
    ds_read_b64_tr_b16 v[108:109], v142 offset:1024
    v_mfma_f32_16x16x32_bf16 v[26:29], v[118:121], v[90:93], v[26:29]
    ds_read_b64_tr_b16 v[110:111], v143 offset:0
    v_mfma_f32_16x16x32_bf16 v[30:33], v[118:121], v[94:97], v[30:33]
    ds_read_b64_tr_b16 v[112:113], v143 offset:1024
    v_mfma_f32_16x16x32_bf16 v[34:37], v[122:125], v[82:85], v[34:37]
    ds_read_b128 v[66:69], v138 offset:0
    v_mfma_f32_16x16x32_bf16 v[38:41], v[122:125], v[86:89], v[38:41]
    ds_read_b128 v[70:73], v138 offset:2048
    v_mfma_f32_16x16x32_bf16 v[42:45], v[122:125], v[90:93], v[42:45]
    ds_read_b128 v[74:77], v138 offset:4096
    v_mfma_f32_16x16x32_bf16 v[46:49], v[122:125], v[94:97], v[46:49]
    ds_read_b128 v[78:81], v138 offset:6144
    v_mfma_f32_16x16x32_bf16 v[50:53], v[126:129], v[82:85], v[50:53]
    v_mfma_f32_16x16x32_bf16 v[54:57], v[126:129], v[86:89], v[54:57]
    v_mfma_f32_16x16x32_bf16 v[58:61], v[126:129], v[90:93], v[58:61]
    v_mfma_f32_16x16x32_bf16 v[62:65], v[126:129], v[94:97], v[62:65]
    s_waitcnt lgkmcnt(0)
    v_mfma_f32_16x16x32_bf16 v[2:5], v[98:101], v[66:69], v[2:5]
    ds_read_b64_tr_b16 v[114:115], v140 offset:8192
    v_mfma_f32_16x16x32_bf16 v[6:9], v[98:101], v[70:73], v[6:9]
    ds_read_b64_tr_b16 v[116:117], v140 offset:9216
    v_mfma_f32_16x16x32_bf16 v[10:13], v[98:101], v[74:77], v[10:13]
    ds_read_b64_tr_b16 v[118:119], v141 offset:8192
    v_mfma_f32_16x16x32_bf16 v[14:17], v[98:101], v[78:81], v[14:17]
    ds_read_b64_tr_b16 v[120:121], v141 offset:9216
    v_mfma_f32_16x16x32_bf16 v[18:21], v[102:105], v[66:69], v[18:21]
    ds_read_b64_tr_b16 v[122:123], v142 offset:8192
    v_mfma_f32_16x16x32_bf16 v[22:25], v[102:105], v[70:73], v[22:25]
    ds_read_b64_tr_b16 v[124:125], v142 offset:9216
    v_mfma_f32_16x16x32_bf16 v[26:29], v[102:105], v[74:77], v[26:29]
    ds_read_b64_tr_b16 v[126:127], v143 offset:8192
    v_mfma_f32_16x16x32_bf16 v[30:33], v[102:105], v[78:81], v[30:33]
    ds_read_b64_tr_b16 v[128:129], v143 offset:9216
    v_mfma_f32_16x16x32_bf16 v[34:37], v[106:109], v[66:69], v[34:37]
    ds_read_b128 v[82:85], v139 offset:0
    v_mfma_f32_16x16x32_bf16 v[38:41], v[106:109], v[70:73], v[38:41]
    ds_read_b128 v[86:89], v139 offset:2048
    v_mfma_f32_16x16x32_bf16 v[42:45], v[106:109], v[74:77], v[42:45]
    ds_read_b128 v[90:93], v139 offset:4096
    v_mfma_f32_16x16x32_bf16 v[46:49], v[106:109], v[78:81], v[46:49]
    ds_read_b128 v[94:97], v139 offset:6144
    v_mfma_f32_16x16x32_bf16 v[50:53], v[110:113], v[66:69], v[50:53]
    v_mfma_f32_16x16x32_bf16 v[54:57], v[110:113], v[70:73], v[54:57]
    v_mfma_f32_16x16x32_bf16 v[58:61], v[110:113], v[74:77], v[58:61]
    v_mfma_f32_16x16x32_bf16 v[62:65], v[110:113], v[78:81], v[62:65]
    s_waitcnt lgkmcnt(0)
    v_mfma_f32_16x16x32_bf16 v[2:5], v[114:117], v[82:85], v[2:5]
    v_mfma_f32_16x16x32_bf16 v[6:9], v[114:117], v[86:89], v[6:9]
    v_mfma_f32_16x16x32_bf16 v[10:13], v[114:117], v[90:93], v[10:13]
    v_mfma_f32_16x16x32_bf16 v[14:17], v[114:117], v[94:97], v[14:17]
    v_mfma_f32_16x16x32_bf16 v[18:21], v[118:121], v[82:85], v[18:21]
    v_mfma_f32_16x16x32_bf16 v[22:25], v[118:121], v[86:89], v[22:25]
    v_mfma_f32_16x16x32_bf16 v[26:29], v[118:121], v[90:93], v[26:29]
    v_mfma_f32_16x16x32_bf16 v[30:33], v[118:121], v[94:97], v[30:33]
    v_mfma_f32_16x16x32_bf16 v[34:37], v[122:125], v[82:85], v[34:37]
    v_mfma_f32_16x16x32_bf16 v[38:41], v[122:125], v[86:89], v[38:41]
    v_mfma_f32_16x16x32_bf16 v[42:45], v[122:125], v[90:93], v[42:45]
    v_mfma_f32_16x16x32_bf16 v[46:49], v[122:125], v[94:97], v[46:49]
    v_mfma_f32_16x16x32_bf16 v[50:53], v[126:129], v[82:85], v[50:53]
    v_mfma_f32_16x16x32_bf16 v[54:57], v[126:129], v[86:89], v[54:57]
    v_mfma_f32_16x16x32_bf16 v[58:61], v[126:129], v[90:93], v[58:61]
    v_mfma_f32_16x16x32_bf16 v[62:65], v[126:129], v[94:97], v[62:65]
    s_waitcnt vmcnt(0)
    s_nop 7
    s_nop 3
    s_barrier
    s_mul_i32 s48, s40, 9216
    s_add_u32 s48, s48, 0
    v_mul_u32_u24 v148, 144, v145
    v_lshl_add_u32 v148, v146, 3, v148
    v_add_u32 v148, s48, v148
    v_cvt_pk_bf16_f32 v2, v2, v3
    v_cvt_pk_bf16_f32 v3, v4, v5
    ds_write_b64 v148, v[2:3] offset:0
    v_cvt_pk_bf16_f32 v6, v6, v7
    v_cvt_pk_bf16_f32 v7, v8, v9
    ds_write_b64 v148, v[6:7] offset:2304
    v_cvt_pk_bf16_f32 v10, v10, v11
    v_cvt_pk_bf16_f32 v11, v12, v13
    ds_write_b64 v148, v[10:11] offset:4608
    v_cvt_pk_bf16_f32 v14, v14, v15
    v_cvt_pk_bf16_f32 v15, v16, v17
    ds_write_b64 v148, v[14:15] offset:6912
    v_cvt_pk_bf16_f32 v18, v18, v19
    v_cvt_pk_bf16_f32 v19, v20, v21
    ds_write_b64 v148, v[18:19] offset:32
    v_cvt_pk_bf16_f32 v22, v22, v23
    v_cvt_pk_bf16_f32 v23, v24, v25
    ds_write_b64 v148, v[22:23] offset:2336
    v_cvt_pk_bf16_f32 v26, v26, v27
    v_cvt_pk_bf16_f32 v27, v28, v29
    ds_write_b64 v148, v[26:27] offset:4640
    v_cvt_pk_bf16_f32 v30, v30, v31
    v_cvt_pk_bf16_f32 v31, v32, v33
    ds_write_b64 v148, v[30:31] offset:6944
    v_cvt_pk_bf16_f32 v34, v34, v35
    v_cvt_pk_bf16_f32 v35, v36, v37
    ds_write_b64 v148, v[34:35] offset:64
    v_cvt_pk_bf16_f32 v38, v38, v39
    v_cvt_pk_bf16_f32 v39, v40, v41
    ds_write_b64 v148, v[38:39] offset:2368
    v_cvt_pk_bf16_f32 v42, v42, v43
    v_cvt_pk_bf16_f32 v43, v44, v45
    ds_write_b64 v148, v[42:43] offset:4672
    v_cvt_pk_bf16_f32 v46, v46, v47
    v_cvt_pk_bf16_f32 v47, v48, v49
    ds_write_b64 v148, v[46:47] offset:6976
    v_cvt_pk_bf16_f32 v50, v50, v51
    v_cvt_pk_bf16_f32 v51, v52, v53
    ds_write_b64 v148, v[50:51] offset:96
    v_cvt_pk_bf16_f32 v54, v54, v55
    v_cvt_pk_bf16_f32 v55, v56, v57
    ds_write_b64 v148, v[54:55] offset:2400
    v_cvt_pk_bf16_f32 v58, v58, v59
    v_cvt_pk_bf16_f32 v59, v60, v61
    ds_write_b64 v148, v[58:59] offset:4704
    v_cvt_pk_bf16_f32 v62, v62, v63
    v_cvt_pk_bf16_f32 v63, v64, v65
    ds_write_b64 v148, v[62:63] offset:7008
    v_lshrrev_b32 v149, 3, v144
    v_and_b32 v150, 7, v144
    s_mov_b32 s50, 8192
    v_mul_lo_u32 v151, v149, s50
    v_mul_u32_u24 v149, 144, v149
    v_lshl_add_u32 v149, v150, 4, v149
    v_add_u32 v149, s48, v149
    v_lshl_add_u32 v150, v150, 4, v151
    s_mul_i32 s48, s41, 524288
    s_mul_i32 s49, s42, 128
    s_add_u32 s48, s48, s49
    s_add_u32 s48, s48, s16
    s_waitcnt lgkmcnt(0)
    ds_read_b128 v[2:5], v149 offset:0
    ds_read_b128 v[6:9], v149 offset:1152
    ds_read_b128 v[10:13], v149 offset:2304
    ds_read_b128 v[14:17], v149 offset:3456
    ds_read_b128 v[18:21], v149 offset:4608
    ds_read_b128 v[22:25], v149 offset:5760
    ds_read_b128 v[26:29], v149 offset:6912
    ds_read_b128 v[30:33], v149 offset:8064
    s_waitcnt lgkmcnt(7)
    buffer_store_dwordx4 v[2:5], v150, s[4:7], s48 offen sc1
    s_add_u32 s48, s48, 65536
    s_waitcnt lgkmcnt(6)
    buffer_store_dwordx4 v[6:9], v150, s[4:7], s48 offen sc1
    s_add_u32 s48, s48, 65536
    s_waitcnt lgkmcnt(5)
    buffer_store_dwordx4 v[10:13], v150, s[4:7], s48 offen sc1
    s_add_u32 s48, s48, 65536
    s_waitcnt lgkmcnt(4)
    buffer_store_dwordx4 v[14:17], v150, s[4:7], s48 offen sc1
    s_add_u32 s48, s48, 65536
    s_waitcnt lgkmcnt(3)
    buffer_store_dwordx4 v[18:21], v150, s[4:7], s48 offen sc1
    s_add_u32 s48, s48, 65536
    s_waitcnt lgkmcnt(2)
    buffer_store_dwordx4 v[22:25], v150, s[4:7], s48 offen sc1
    s_add_u32 s48, s48, 65536
    s_waitcnt lgkmcnt(1)
    buffer_store_dwordx4 v[26:29], v150, s[4:7], s48 offen sc1
    s_add_u32 s48, s48, 65536
    s_waitcnt lgkmcnt(0)
    buffer_store_dwordx4 v[30:33], v150, s[4:7], s48 offen sc1
    s_add_u32 s48, s48, 65536
    v_subrev_u32 v138, 131072, v138
    v_subrev_u32 v139, 131072, v139
    v_subrev_u32 v140, 131072, v140
    v_subrev_u32 v141, 131072, v141
    v_subrev_u32 v142, 131072, v142
    v_subrev_u32 v143, 131072, v143
    s_cmp_eq_u32 s82, 0
    s_cselect_b32 s77, 16, 0
    s_add_u32 s77, s77, s74
    s_lshl_b32 s77, s77, 7
    s_add_u32 s77, s77, 786432
    s_waitcnt vmcnt(0)
    s_barrier
    s_cmp_lg_u32 s26, 0
    s_cbranch_scc1 L_sig_79
    v_mov_b32 v1, 0
    v_mov_b32 v2, 1
    s_mov_b64 exec, 1
    buffer_atomic_add v2, v1, s[4:7], s77 offen
    s_mov_b64 exec, -1
L_sig_79:
    s_mov_b32 s73, 0
    s_cmp_lt_u32 s70, 20
    s_cbranch_scc1 L_m2_80
    s_cmp_ge_u32 s70, 60
    s_cbranch_scc1 L_m2_80
    s_mov_b32 s20, s70
    s_load_dwordx2 s[8:9], s[0:1], 96
    s_load_dwordx2 s[12:13], s[0:1], 104
    v_and_b32 v1, 63, v0
    v_lshrrev_b32 v2, 6, v0
    v_lshrrev_b32 v3, 3, v1
    v_lshl_add_u32 v3, v2, 3, v3
    v_and_b32 v4, 7, v1
    s_waitcnt lgkmcnt(0)
    s_and_b32 s9, s9, 0xffff
    s_mov_b32 s10, 1280
    s_mov_b32 s11, 0x20000
    s_and_b32 s13, s13, 0xffff
    s_mov_b32 s14, 4915200
    s_mov_b32 s15, 0x20000
    s_movk_i32 s16, 7680
    v_mul_lo_u32 v5, v3, s16
    v_lshl_add_u32 v5, v4, 4, v5
    s_lshl_b32 s17, s20, 7
    v_lshlrev_b32 v6, 1, v3
    buffer_load_ushort v100, v6, s[8:11], 0 offen offset:0
    buffer_load_ushort v101, v6, s[8:11], 0 offen offset:64
    buffer_load_ushort v102, v6, s[8:11], 0 offen offset:128
    buffer_load_ushort v103, v6, s[8:11], 0 offen offset:192
    buffer_load_ushort v104, v6, s[8:11], 0 offen offset:256
    buffer_load_ushort v105, v6, s[8:11], 0 offen offset:320
    buffer_load_ushort v106, v6, s[8:11], 0 offen offset:384
    buffer_load_ushort v107, v6, s[8:11], 0 offen offset:448
    buffer_load_ushort v108, v6, s[8:11], 0 offen offset:512
    buffer_load_ushort v109, v6, s[8:11], 0 offen offset:576
    buffer_load_ushort v110, v6, s[8:11], 0 offen offset:640
    buffer_load_ushort v111, v6, s[8:11], 0 offen offset:704
    buffer_load_ushort v112, v6, s[8:11], 0 offen offset:768
    buffer_load_ushort v113, v6, s[8:11], 0 offen offset:832
    buffer_load_ushort v114, v6, s[8:11], 0 offen offset:896
    buffer_load_ushort v115, v6, s[8:11], 0 offen offset:960
    buffer_load_ushort v116, v6, s[8:11], 0 offen offset:1024
    buffer_load_ushort v117, v6, s[8:11], 0 offen offset:1088
    buffer_load_ushort v118, v6, s[8:11], 0 offen offset:1152
    buffer_load_ushort v119, v6, s[8:11], 0 offen offset:1216
    buffer_load_dwordx4 v[20:23], v5, s[12:15], s17 offen
    s_add_u32 s17, s17, 245760
    buffer_load_dwordx4 v[24:27], v5, s[12:15], s17 offen
    s_add_u32 s17, s17, 245760
    buffer_load_dwordx4 v[28:31], v5, s[12:15], s17 offen
    s_add_u32 s17, s17, 245760
    buffer_load_dwordx4 v[32:35], v5, s[12:15], s17 offen
    s_add_u32 s17, s17, 245760
    buffer_load_dwordx4 v[36:39], v5, s[12:15], s17 offen
    s_add_u32 s17, s17, 245760
    buffer_load_dwordx4 v[40:43], v5, s[12:15], s17 offen
    s_add_u32 s17, s17, 245760
    buffer_load_dwordx4 v[44:47], v5, s[12:15], s17 offen
    s_add_u32 s17, s17, 245760
    buffer_load_dwordx4 v[48:51], v5, s[12:15], s17 offen
    s_add_u32 s17, s17, 245760
    buffer_load_dwordx4 v[52:55], v5, s[12:15], s17 offen
    s_add_u32 s17, s17, 245760
    buffer_load_dwordx4 v[56:59], v5, s[12:15], s17 offen
    s_add_u32 s17, s17, 245760
    buffer_load_dwordx4 v[60:63], v5, s[12:15], s17 offen
    s_add_u32 s17, s17, 245760
    buffer_load_dwordx4 v[64:67], v5, s[12:15], s17 offen
    s_add_u32 s17, s17, 245760
    buffer_load_dwordx4 v[68:71], v5, s[12:15], s17 offen
    s_add_u32 s17, s17, 245760
    buffer_load_dwordx4 v[72:75], v5, s[12:15], s17 offen
    s_add_u32 s17, s17, 245760
    buffer_load_dwordx4 v[76:79], v5, s[12:15], s17 offen
    s_add_u32 s17, s17, 245760
    buffer_load_dwordx4 v[80:83], v5, s[12:15], s17 offen
    s_add_u32 s17, s17, 245760
    buffer_load_dwordx4 v[84:87], v5, s[12:15], s17 offen
    s_add_u32 s17, s17, 245760
    buffer_load_dwordx4 v[88:91], v5, s[12:15], s17 offen
    s_add_u32 s17, s17, 245760
    buffer_load_dwordx4 v[92:95], v5, s[12:15], s17 offen
    s_add_u32 s17, s17, 245760
    buffer_load_dwordx4 v[96:99], v5, s[12:15], s17 offen
    s_add_u32 s17, s17, 245760
    v_mov_b32 v10, 0
    v_mov_b32 v11, 0
    v_mov_b32 v12, 0
    v_mov_b32 v13, 0
    v_mov_b32 v14, 0
    v_mov_b32 v15, 0
    v_mov_b32 v16, 0
    v_mov_b32 v17, 0
    s_waitcnt vmcnt(20)
    v_lshlrev_b32 v100, 16, v100
    v_mul_f32 v7, 0xbfb8aa3b, v100
    v_exp_f32 v7, v7
    s_nop 0
    v_add_f32 v7, 1.0, v7
    v_rcp_f32 v7, v7
    s_nop 0
    v_mul_f32 v100, v100, v7
    v_cvt_pk_bf16_f32 v100, v100, v100
    v_and_b32 v100, 0xffff0000, v100
    v_lshlrev_b32 v101, 16, v101
    v_mul_f32 v7, 0xbfb8aa3b, v101
    v_exp_f32 v7, v7
    s_nop 0
    v_add_f32 v7, 1.0, v7
    v_rcp_f32 v7, v7
    s_nop 0
    v_mul_f32 v101, v101, v7
    v_cvt_pk_bf16_f32 v101, v101, v101
    v_and_b32 v101, 0xffff0000, v101
    v_lshlrev_b32 v102, 16, v102
    v_mul_f32 v7, 0xbfb8aa3b, v102
    v_exp_f32 v7, v7
    s_nop 0
    v_add_f32 v7, 1.0, v7
    v_rcp_f32 v7, v7
    s_nop 0
    v_mul_f32 v102, v102, v7
    v_cvt_pk_bf16_f32 v102, v102, v102
    v_and_b32 v102, 0xffff0000, v102
    v_lshlrev_b32 v103, 16, v103
    v_mul_f32 v7, 0xbfb8aa3b, v103
    v_exp_f32 v7, v7
    s_nop 0
    v_add_f32 v7, 1.0, v7
    v_rcp_f32 v7, v7
    s_nop 0
    v_mul_f32 v103, v103, v7
    v_cvt_pk_bf16_f32 v103, v103, v103
    v_and_b32 v103, 0xffff0000, v103
    v_lshlrev_b32 v104, 16, v104
    v_mul_f32 v7, 0xbfb8aa3b, v104
    v_exp_f32 v7, v7
    s_nop 0
    v_add_f32 v7, 1.0, v7
    v_rcp_f32 v7, v7
    s_nop 0
    v_mul_f32 v104, v104, v7
    v_cvt_pk_bf16_f32 v104, v104, v104
    v_and_b32 v104, 0xffff0000, v104
    v_lshlrev_b32 v105, 16, v105
    v_mul_f32 v7, 0xbfb8aa3b, v105
    v_exp_f32 v7, v7
    s_nop 0
    v_add_f32 v7, 1.0, v7
    v_rcp_f32 v7, v7
    s_nop 0
    v_mul_f32 v105, v105, v7
    v_cvt_pk_bf16_f32 v105, v105, v105
    v_and_b32 v105, 0xffff0000, v105
    v_lshlrev_b32 v106, 16, v106
    v_mul_f32 v7, 0xbfb8aa3b, v106
    v_exp_f32 v7, v7
    s_nop 0
    v_add_f32 v7, 1.0, v7
    v_rcp_f32 v7, v7
    s_nop 0
    v_mul_f32 v106, v106, v7
    v_cvt_pk_bf16_f32 v106, v106, v106
    v_and_b32 v106, 0xffff0000, v106
    v_lshlrev_b32 v107, 16, v107
    v_mul_f32 v7, 0xbfb8aa3b, v107
    v_exp_f32 v7, v7
    s_nop 0
    v_add_f32 v7, 1.0, v7
    v_rcp_f32 v7, v7
    s_nop 0
    v_mul_f32 v107, v107, v7
    v_cvt_pk_bf16_f32 v107, v107, v107
    v_and_b32 v107, 0xffff0000, v107
    v_lshlrev_b32 v108, 16, v108
    v_mul_f32 v7, 0xbfb8aa3b, v108
    v_exp_f32 v7, v7
    s_nop 0
    v_add_f32 v7, 1.0, v7
    v_rcp_f32 v7, v7
    s_nop 0
    v_mul_f32 v108, v108, v7
    v_cvt_pk_bf16_f32 v108, v108, v108
    v_and_b32 v108, 0xffff0000, v108
    v_lshlrev_b32 v109, 16, v109
    v_mul_f32 v7, 0xbfb8aa3b, v109
    v_exp_f32 v7, v7
    s_nop 0
    v_add_f32 v7, 1.0, v7
    v_rcp_f32 v7, v7
    s_nop 0
    v_mul_f32 v109, v109, v7
    v_cvt_pk_bf16_f32 v109, v109, v109
    v_and_b32 v109, 0xffff0000, v109
    v_lshlrev_b32 v110, 16, v110
    v_mul_f32 v7, 0xbfb8aa3b, v110
    v_exp_f32 v7, v7
    s_nop 0
    v_add_f32 v7, 1.0, v7
    v_rcp_f32 v7, v7
    s_nop 0
    v_mul_f32 v110, v110, v7
    v_cvt_pk_bf16_f32 v110, v110, v110
    v_and_b32 v110, 0xffff0000, v110
    v_lshlrev_b32 v111, 16, v111
    v_mul_f32 v7, 0xbfb8aa3b, v111
    v_exp_f32 v7, v7
    s_nop 0
    v_add_f32 v7, 1.0, v7
    v_rcp_f32 v7, v7
    s_nop 0
    v_mul_f32 v111, v111, v7
    v_cvt_pk_bf16_f32 v111, v111, v111
    v_and_b32 v111, 0xffff0000, v111
    v_lshlrev_b32 v112, 16, v112
    v_mul_f32 v7, 0xbfb8aa3b, v112
    v_exp_f32 v7, v7
    s_nop 0
    v_add_f32 v7, 1.0, v7
    v_rcp_f32 v7, v7
    s_nop 0
    v_mul_f32 v112, v112, v7
    v_cvt_pk_bf16_f32 v112, v112, v112
    v_and_b32 v112, 0xffff0000, v112
    v_lshlrev_b32 v113, 16, v113
    v_mul_f32 v7, 0xbfb8aa3b, v113
    v_exp_f32 v7, v7
    s_nop 0
    v_add_f32 v7, 1.0, v7
    v_rcp_f32 v7, v7
    s_nop 0
    v_mul_f32 v113, v113, v7
    v_cvt_pk_bf16_f32 v113, v113, v113
    v_and_b32 v113, 0xffff0000, v113
    v_lshlrev_b32 v114, 16, v114
    v_mul_f32 v7, 0xbfb8aa3b, v114
    v_exp_f32 v7, v7
    s_nop 0
    v_add_f32 v7, 1.0, v7
    v_rcp_f32 v7, v7
    s_nop 0
    v_mul_f32 v114, v114, v7
    v_cvt_pk_bf16_f32 v114, v114, v114
    v_and_b32 v114, 0xffff0000, v114
    v_lshlrev_b32 v115, 16, v115
    v_mul_f32 v7, 0xbfb8aa3b, v115
    v_exp_f32 v7, v7
    s_nop 0
    v_add_f32 v7, 1.0, v7
    v_rcp_f32 v7, v7
    s_nop 0
    v_mul_f32 v115, v115, v7
    v_cvt_pk_bf16_f32 v115, v115, v115
    v_and_b32 v115, 0xffff0000, v115
    v_lshlrev_b32 v116, 16, v116
    v_mul_f32 v7, 0xbfb8aa3b, v116
    v_exp_f32 v7, v7
    s_nop 0
    v_add_f32 v7, 1.0, v7
    v_rcp_f32 v7, v7
    s_nop 0
    v_mul_f32 v116, v116, v7
    v_cvt_pk_bf16_f32 v116, v116, v116
    v_and_b32 v116, 0xffff0000, v116
    v_lshlrev_b32 v117, 16, v117
    v_mul_f32 v7, 0xbfb8aa3b, v117
    v_exp_f32 v7, v7
    s_nop 0
    v_add_f32 v7, 1.0, v7
    v_rcp_f32 v7, v7
    s_nop 0
    v_mul_f32 v117, v117, v7
    v_cvt_pk_bf16_f32 v117, v117, v117
    v_and_b32 v117, 0xffff0000, v117
    v_lshlrev_b32 v118, 16, v118
    v_mul_f32 v7, 0xbfb8aa3b, v118
    v_exp_f32 v7, v7
    s_nop 0
    v_add_f32 v7, 1.0, v7
    v_rcp_f32 v7, v7
    s_nop 0
    v_mul_f32 v118, v118, v7
    v_cvt_pk_bf16_f32 v118, v118, v118
    v_and_b32 v118, 0xffff0000, v118
    v_lshlrev_b32 v119, 16, v119
    v_mul_f32 v7, 0xbfb8aa3b, v119
    v_exp_f32 v7, v7
    s_nop 0
    v_add_f32 v7, 1.0, v7
    v_rcp_f32 v7, v7
    s_nop 0
    v_mul_f32 v119, v119, v7
    v_cvt_pk_bf16_f32 v119, v119, v119
    v_and_b32 v119, 0xffff0000, v119
    s_waitcnt vmcnt(19)
    v_lshlrev_b32 v8, 16, v20
    v_and_b32 v9, 0xffff0000, v20
    v_fmac_f32 v10, v8, v100
    v_fmac_f32 v11, v9, v100
    v_lshlrev_b32 v8, 16, v21
    v_and_b32 v9, 0xffff0000, v21
    v_fmac_f32 v12, v8, v100
    v_fmac_f32 v13, v9, v100
    v_lshlrev_b32 v8, 16, v22
    v_and_b32 v9, 0xffff0000, v22
    v_fmac_f32 v14, v8, v100
    v_fmac_f32 v15, v9, v100
    v_lshlrev_b32 v8, 16, v23
    v_and_b32 v9, 0xffff0000, v23
    v_fmac_f32 v16, v8, v100
    v_fmac_f32 v17, v9, v100
    s_waitcnt vmcnt(18)
    v_lshlrev_b32 v8, 16, v24
    v_and_b32 v9, 0xffff0000, v24
    v_fmac_f32 v10, v8, v101
    v_fmac_f32 v11, v9, v101
    v_lshlrev_b32 v8, 16, v25
    v_and_b32 v9, 0xffff0000, v25
    v_fmac_f32 v12, v8, v101
    v_fmac_f32 v13, v9, v101
    v_lshlrev_b32 v8, 16, v26
    v_and_b32 v9, 0xffff0000, v26
    v_fmac_f32 v14, v8, v101
    v_fmac_f32 v15, v9, v101
    v_lshlrev_b32 v8, 16, v27
    v_and_b32 v9, 0xffff0000, v27
    v_fmac_f32 v16, v8, v101
    v_fmac_f32 v17, v9, v101
    s_waitcnt vmcnt(17)
    v_lshlrev_b32 v8, 16, v28
    v_and_b32 v9, 0xffff0000, v28
    v_fmac_f32 v10, v8, v102
    v_fmac_f32 v11, v9, v102
    v_lshlrev_b32 v8, 16, v29
    v_and_b32 v9, 0xffff0000, v29
    v_fmac_f32 v12, v8, v102
    v_fmac_f32 v13, v9, v102
    v_lshlrev_b32 v8, 16, v30
    v_and_b32 v9, 0xffff0000, v30
    v_fmac_f32 v14, v8, v102
    v_fmac_f32 v15, v9, v102
    v_lshlrev_b32 v8, 16, v31
    v_and_b32 v9, 0xffff0000, v31
    v_fmac_f32 v16, v8, v102
    v_fmac_f32 v17, v9, v102
    s_waitcnt vmcnt(16)
    v_lshlrev_b32 v8, 16, v32
    v_and_b32 v9, 0xffff0000, v32
    v_fmac_f32 v10, v8, v103
    v_fmac_f32 v11, v9, v103
    v_lshlrev_b32 v8, 16, v33
    v_and_b32 v9, 0xffff0000, v33
    v_fmac_f32 v12, v8, v103
    v_fmac_f32 v13, v9, v103
    v_lshlrev_b32 v8, 16, v34
    v_and_b32 v9, 0xffff0000, v34
    v_fmac_f32 v14, v8, v103
    v_fmac_f32 v15, v9, v103
    v_lshlrev_b32 v8, 16, v35
    v_and_b32 v9, 0xffff0000, v35
    v_fmac_f32 v16, v8, v103
    v_fmac_f32 v17, v9, v103
    s_waitcnt vmcnt(15)
    v_lshlrev_b32 v8, 16, v36
    v_and_b32 v9, 0xffff0000, v36
    v_fmac_f32 v10, v8, v104
    v_fmac_f32 v11, v9, v104
    v_lshlrev_b32 v8, 16, v37
    v_and_b32 v9, 0xffff0000, v37
    v_fmac_f32 v12, v8, v104
    v_fmac_f32 v13, v9, v104
    v_lshlrev_b32 v8, 16, v38
    v_and_b32 v9, 0xffff0000, v38
    v_fmac_f32 v14, v8, v104
    v_fmac_f32 v15, v9, v104
    v_lshlrev_b32 v8, 16, v39
    v_and_b32 v9, 0xffff0000, v39
    v_fmac_f32 v16, v8, v104
    v_fmac_f32 v17, v9, v104
    s_waitcnt vmcnt(14)
    v_lshlrev_b32 v8, 16, v40
    v_and_b32 v9, 0xffff0000, v40
    v_fmac_f32 v10, v8, v105
    v_fmac_f32 v11, v9, v105
    v_lshlrev_b32 v8, 16, v41
    v_and_b32 v9, 0xffff0000, v41
    v_fmac_f32 v12, v8, v105
    v_fmac_f32 v13, v9, v105
    v_lshlrev_b32 v8, 16, v42
    v_and_b32 v9, 0xffff0000, v42
    v_fmac_f32 v14, v8, v105
    v_fmac_f32 v15, v9, v105
    v_lshlrev_b32 v8, 16, v43
    v_and_b32 v9, 0xffff0000, v43
    v_fmac_f32 v16, v8, v105
    v_fmac_f32 v17, v9, v105
    s_waitcnt vmcnt(13)
    v_lshlrev_b32 v8, 16, v44
    v_and_b32 v9, 0xffff0000, v44
    v_fmac_f32 v10, v8, v106
    v_fmac_f32 v11, v9, v106
    v_lshlrev_b32 v8, 16, v45
    v_and_b32 v9, 0xffff0000, v45
    v_fmac_f32 v12, v8, v106
    v_fmac_f32 v13, v9, v106
    v_lshlrev_b32 v8, 16, v46
    v_and_b32 v9, 0xffff0000, v46
    v_fmac_f32 v14, v8, v106
    v_fmac_f32 v15, v9, v106
    v_lshlrev_b32 v8, 16, v47
    v_and_b32 v9, 0xffff0000, v47
    v_fmac_f32 v16, v8, v106
    v_fmac_f32 v17, v9, v106
    s_waitcnt vmcnt(12)
    v_lshlrev_b32 v8, 16, v48
    v_and_b32 v9, 0xffff0000, v48
    v_fmac_f32 v10, v8, v107
    v_fmac_f32 v11, v9, v107
    v_lshlrev_b32 v8, 16, v49
    v_and_b32 v9, 0xffff0000, v49
    v_fmac_f32 v12, v8, v107
    v_fmac_f32 v13, v9, v107
    v_lshlrev_b32 v8, 16, v50
    v_and_b32 v9, 0xffff0000, v50
    v_fmac_f32 v14, v8, v107
    v_fmac_f32 v15, v9, v107
    v_lshlrev_b32 v8, 16, v51
    v_and_b32 v9, 0xffff0000, v51
    v_fmac_f32 v16, v8, v107
    v_fmac_f32 v17, v9, v107
    s_waitcnt vmcnt(11)
    v_lshlrev_b32 v8, 16, v52
    v_and_b32 v9, 0xffff0000, v52
    v_fmac_f32 v10, v8, v108
    v_fmac_f32 v11, v9, v108
    v_lshlrev_b32 v8, 16, v53
    v_and_b32 v9, 0xffff0000, v53
    v_fmac_f32 v12, v8, v108
    v_fmac_f32 v13, v9, v108
    v_lshlrev_b32 v8, 16, v54
    v_and_b32 v9, 0xffff0000, v54
    v_fmac_f32 v14, v8, v108
    v_fmac_f32 v15, v9, v108
    v_lshlrev_b32 v8, 16, v55
    v_and_b32 v9, 0xffff0000, v55
    v_fmac_f32 v16, v8, v108
    v_fmac_f32 v17, v9, v108
    s_waitcnt vmcnt(10)
    v_lshlrev_b32 v8, 16, v56
    v_and_b32 v9, 0xffff0000, v56
    v_fmac_f32 v10, v8, v109
    v_fmac_f32 v11, v9, v109
    v_lshlrev_b32 v8, 16, v57
    v_and_b32 v9, 0xffff0000, v57
    v_fmac_f32 v12, v8, v109
    v_fmac_f32 v13, v9, v109
    v_lshlrev_b32 v8, 16, v58
    v_and_b32 v9, 0xffff0000, v58
    v_fmac_f32 v14, v8, v109
    v_fmac_f32 v15, v9, v109
    v_lshlrev_b32 v8, 16, v59
    v_and_b32 v9, 0xffff0000, v59
    v_fmac_f32 v16, v8, v109
    v_fmac_f32 v17, v9, v109
    s_waitcnt vmcnt(9)
    v_lshlrev_b32 v8, 16, v60
    v_and_b32 v9, 0xffff0000, v60
    v_fmac_f32 v10, v8, v110
    v_fmac_f32 v11, v9, v110
    v_lshlrev_b32 v8, 16, v61
    v_and_b32 v9, 0xffff0000, v61
    v_fmac_f32 v12, v8, v110
    v_fmac_f32 v13, v9, v110
    v_lshlrev_b32 v8, 16, v62
    v_and_b32 v9, 0xffff0000, v62
    v_fmac_f32 v14, v8, v110
    v_fmac_f32 v15, v9, v110
    v_lshlrev_b32 v8, 16, v63
    v_and_b32 v9, 0xffff0000, v63
    v_fmac_f32 v16, v8, v110
    v_fmac_f32 v17, v9, v110
    s_waitcnt vmcnt(8)
    v_lshlrev_b32 v8, 16, v64
    v_and_b32 v9, 0xffff0000, v64
    v_fmac_f32 v10, v8, v111
    v_fmac_f32 v11, v9, v111
    v_lshlrev_b32 v8, 16, v65
    v_and_b32 v9, 0xffff0000, v65
    v_fmac_f32 v12, v8, v111
    v_fmac_f32 v13, v9, v111
    v_lshlrev_b32 v8, 16, v66
    v_and_b32 v9, 0xffff0000, v66
    v_fmac_f32 v14, v8, v111
    v_fmac_f32 v15, v9, v111
    v_lshlrev_b32 v8, 16, v67
    v_and_b32 v9, 0xffff0000, v67
    v_fmac_f32 v16, v8, v111
    v_fmac_f32 v17, v9, v111
    s_waitcnt vmcnt(7)
    v_lshlrev_b32 v8, 16, v68
    v_and_b32 v9, 0xffff0000, v68
    v_fmac_f32 v10, v8, v112
    v_fmac_f32 v11, v9, v112
    v_lshlrev_b32 v8, 16, v69
    v_and_b32 v9, 0xffff0000, v69
    v_fmac_f32 v12, v8, v112
    v_fmac_f32 v13, v9, v112
    v_lshlrev_b32 v8, 16, v70
    v_and_b32 v9, 0xffff0000, v70
    v_fmac_f32 v14, v8, v112
    v_fmac_f32 v15, v9, v112
    v_lshlrev_b32 v8, 16, v71
    v_and_b32 v9, 0xffff0000, v71
    v_fmac_f32 v16, v8, v112
    v_fmac_f32 v17, v9, v112
    s_waitcnt vmcnt(6)
    v_lshlrev_b32 v8, 16, v72
    v_and_b32 v9, 0xffff0000, v72
    v_fmac_f32 v10, v8, v113
    v_fmac_f32 v11, v9, v113
    v_lshlrev_b32 v8, 16, v73
    v_and_b32 v9, 0xffff0000, v73
    v_fmac_f32 v12, v8, v113
    v_fmac_f32 v13, v9, v113
    v_lshlrev_b32 v8, 16, v74
    v_and_b32 v9, 0xffff0000, v74
    v_fmac_f32 v14, v8, v113
    v_fmac_f32 v15, v9, v113
    v_lshlrev_b32 v8, 16, v75
    v_and_b32 v9, 0xffff0000, v75
    v_fmac_f32 v16, v8, v113
    v_fmac_f32 v17, v9, v113
    s_waitcnt vmcnt(5)
    v_lshlrev_b32 v8, 16, v76
    v_and_b32 v9, 0xffff0000, v76
    v_fmac_f32 v10, v8, v114
    v_fmac_f32 v11, v9, v114
    v_lshlrev_b32 v8, 16, v77
    v_and_b32 v9, 0xffff0000, v77
    v_fmac_f32 v12, v8, v114
    v_fmac_f32 v13, v9, v114
    v_lshlrev_b32 v8, 16, v78
    v_and_b32 v9, 0xffff0000, v78
    v_fmac_f32 v14, v8, v114
    v_fmac_f32 v15, v9, v114
    v_lshlrev_b32 v8, 16, v79
    v_and_b32 v9, 0xffff0000, v79
    v_fmac_f32 v16, v8, v114
    v_fmac_f32 v17, v9, v114
    s_waitcnt vmcnt(4)
    v_lshlrev_b32 v8, 16, v80
    v_and_b32 v9, 0xffff0000, v80
    v_fmac_f32 v10, v8, v115
    v_fmac_f32 v11, v9, v115
    v_lshlrev_b32 v8, 16, v81
    v_and_b32 v9, 0xffff0000, v81
    v_fmac_f32 v12, v8, v115
    v_fmac_f32 v13, v9, v115
    v_lshlrev_b32 v8, 16, v82
    v_and_b32 v9, 0xffff0000, v82
    v_fmac_f32 v14, v8, v115
    v_fmac_f32 v15, v9, v115
    v_lshlrev_b32 v8, 16, v83
    v_and_b32 v9, 0xffff0000, v83
    v_fmac_f32 v16, v8, v115
    v_fmac_f32 v17, v9, v115
    s_waitcnt vmcnt(3)
    v_lshlrev_b32 v8, 16, v84
    v_and_b32 v9, 0xffff0000, v84
    v_fmac_f32 v10, v8, v116
    v_fmac_f32 v11, v9, v116
    v_lshlrev_b32 v8, 16, v85
    v_and_b32 v9, 0xffff0000, v85
    v_fmac_f32 v12, v8, v116
    v_fmac_f32 v13, v9, v116
    v_lshlrev_b32 v8, 16, v86
    v_and_b32 v9, 0xffff0000, v86
    v_fmac_f32 v14, v8, v116
    v_fmac_f32 v15, v9, v116
    v_lshlrev_b32 v8, 16, v87
    v_and_b32 v9, 0xffff0000, v87
    v_fmac_f32 v16, v8, v116
    v_fmac_f32 v17, v9, v116
    s_waitcnt vmcnt(2)
    v_lshlrev_b32 v8, 16, v88
    v_and_b32 v9, 0xffff0000, v88
    v_fmac_f32 v10, v8, v117
    v_fmac_f32 v11, v9, v117
    v_lshlrev_b32 v8, 16, v89
    v_and_b32 v9, 0xffff0000, v89
    v_fmac_f32 v12, v8, v117
    v_fmac_f32 v13, v9, v117
    v_lshlrev_b32 v8, 16, v90
    v_and_b32 v9, 0xffff0000, v90
    v_fmac_f32 v14, v8, v117
    v_fmac_f32 v15, v9, v117
    v_lshlrev_b32 v8, 16, v91
    v_and_b32 v9, 0xffff0000, v91
    v_fmac_f32 v16, v8, v117
    v_fmac_f32 v17, v9, v117
    s_waitcnt vmcnt(1)
    v_lshlrev_b32 v8, 16, v92
    v_and_b32 v9, 0xffff0000, v92
    v_fmac_f32 v10, v8, v118
    v_fmac_f32 v11, v9, v118
    v_lshlrev_b32 v8, 16, v93
    v_and_b32 v9, 0xffff0000, v93
    v_fmac_f32 v12, v8, v118
    v_fmac_f32 v13, v9, v118
    v_lshlrev_b32 v8, 16, v94
    v_and_b32 v9, 0xffff0000, v94
    v_fmac_f32 v14, v8, v118
    v_fmac_f32 v15, v9, v118
    v_lshlrev_b32 v8, 16, v95
    v_and_b32 v9, 0xffff0000, v95
    v_fmac_f32 v16, v8, v118
    v_fmac_f32 v17, v9, v118
    s_waitcnt vmcnt(0)
    v_lshlrev_b32 v8, 16, v96
    v_and_b32 v9, 0xffff0000, v96
    v_fmac_f32 v10, v8, v119
    v_fmac_f32 v11, v9, v119
    v_lshlrev_b32 v8, 16, v97
    v_and_b32 v9, 0xffff0000, v97
    v_fmac_f32 v12, v8, v119
    v_fmac_f32 v13, v9, v119
    v_lshlrev_b32 v8, 16, v98
    v_and_b32 v9, 0xffff0000, v98
    v_fmac_f32 v14, v8, v119
    v_fmac_f32 v15, v9, v119
    v_lshlrev_b32 v8, 16, v99
    v_and_b32 v9, 0xffff0000, v99
    v_fmac_f32 v16, v8, v119
    v_fmac_f32 v17, v9, v119
    v_add_f32_dpp v10, v10, v10 row_ror:8 row_mask:0xf bank_mask:0xf
    v_add_f32_dpp v11, v11, v11 row_ror:8 row_mask:0xf bank_mask:0xf
    v_add_f32_dpp v12, v12, v12 row_ror:8 row_mask:0xf bank_mask:0xf
    v_add_f32_dpp v13, v13, v13 row_ror:8 row_mask:0xf bank_mask:0xf
    v_add_f32_dpp v14, v14, v14 row_ror:8 row_mask:0xf bank_mask:0xf
    v_add_f32_dpp v15, v15, v15 row_ror:8 row_mask:0xf bank_mask:0xf
    v_add_f32_dpp v16, v16, v16 row_ror:8 row_mask:0xf bank_mask:0xf
    v_add_f32_dpp v17, v17, v17 row_ror:8 row_mask:0xf bank_mask:0xf
    v_mov_b32 v20, v10
    v_mov_b32 v21, v11
    v_mov_b32 v22, v12
    v_mov_b32 v23, v13
    v_mov_b32 v24, v14
    v_mov_b32 v25, v15
    v_mov_b32 v26, v16
    v_mov_b32 v27, v17
    v_permlane16_swap_b32 v10, v20
    v_permlane16_swap_b32 v11, v21
    v_permlane16_swap_b32 v12, v22
    v_permlane16_swap_b32 v13, v23
    v_permlane16_swap_b32 v14, v24
    v_permlane16_swap_b32 v15, v25
    v_permlane16_swap_b32 v16, v26
    v_permlane16_swap_b32 v17, v27
    v_add_f32 v10, v10, v20
    v_add_f32 v11, v11, v21
    v_add_f32 v12, v12, v22
    v_add_f32 v13, v13, v23
    v_add_f32 v14, v14, v24
    v_add_f32 v15, v15, v25
    v_add_f32 v16, v16, v26
    v_add_f32 v17, v17, v27
    v_mov_b32 v20, v10
    v_mov_b32 v21, v11
    v_mov_b32 v22, v12
    v_mov_b32 v23, v13
    v_mov_b32 v24, v14
    v_mov_b32 v25, v15
    v_mov_b32 v26, v16
    v_mov_b32 v27, v17
    v_permlane32_swap_b32 v10, v20
    v_permlane32_swap_b32 v11, v21
    v_permlane32_swap_b32 v12, v22
    v_permlane32_swap_b32 v13, v23
    v_permlane32_swap_b32 v14, v24
    v_permlane32_swap_b32 v15, v25
    v_permlane32_swap_b32 v16, v26
    v_permlane32_swap_b32 v17, v27
    v_add_f32 v10, v10, v20
    v_add_f32 v11, v11, v21
    v_add_f32 v12, v12, v22
    v_add_f32 v13, v13, v23
    v_add_f32 v14, v14, v24
    v_add_f32 v15, v15, v25
    v_add_f32 v16, v16, v26
    v_add_f32 v17, v17, v27
    v_lshlrev_b32 v8, 5, v4
    v_lshl_add_u32 v8, v2, 8, v8
    s_mov_b64 exec, 0xff
    ds_write_b128 v8, v[10:13]
    ds_write_b128 v8, v[14:17] offset:16
    s_mov_b64 exec, -1
    s_waitcnt lgkmcnt(0)
    s_barrier
    v_readfirstlane_b32 s18, v2
    s_nop 0
    s_cmp_lg_u32 s18, 0
    s_cbranch_scc1 L_modw_81
    v_lshlrev_b32 v8, 2, v1
    ds_read_b32 v10, v8 offset:0
    ds_read_b32 v11, v8 offset:256
    ds_read_b32 v12, v8 offset:512
    ds_read_b32 v13, v8 offset:768
    s_waitcnt lgkmcnt(0)
    v_add_f32 v10, v10, v11
    v_add_f32 v12, v12, v13
    v_add_f32 v10, v10, v12
    v_cvt_pk_bf16_f32 v10, v10, v10
    v_and_b32 v10, 0xffff0000, v10
    s_cmp_ge_u32 s20, 10
    s_cselect_b32 s18, 1, 0
    s_cmp_lt_u32 s20, 20
    s_cselect_b32 s18, s18, 0
    s_cmp_ge_u32 s20, 40
    s_cselect_b32 s19, 1, 0
    s_cmp_lt_u32 s20, 50
    s_cselect_b32 s19, s19, 0
    s_or_b32 s18, s18, s19
    s_cmp_eq_u32 s18, 0
    s_cbranch_scc1 L_mod1_82
    v_add_f32 v10, 1.0, v10
    v_cvt_pk_bf16_f32 v10, v10, v10
    v_and_b32 v10, 0xffff0000, v10
L_mod1_82:
    s_lshl_b32 s17, s20, 8
    s_add_u32 s17, s17, 0
    buffer_store_dword v10, v8, s[4:7], s17 offen sc1
    s_waitcnt vmcnt(0)
L_modw_81:
    s_mov_b32 s77, 136
    s_waitcnt vmcnt(0)
    s_barrier
    s_cmp_lg_u32 s26, 0
    s_cbranch_scc1 L_ds_83
    v_mov_b32 v1, s77
    v_mov_b32 v2, 1
    s_mov_b64 exec, 1
    global_atomic_add v1, v2, s[100:101]
    s_mov_b64 exec, -1
L_ds_83:
L_m2_80:
    s_load_dwordx2 s[12:13], s[0:1], 0
    s_load_dwordx2 s[8:9], s[0:1], s83
    s_waitcnt lgkmcnt(0)
    s_and_b32 s13, s13, 0xffff
    s_mov_b32 s14, 2621440
    s_mov_b32 s15, 0x20000
    s_and_b32 s9, s9, 0xffff
    s_mov_b32 s10, 5242880
    s_mov_b32 s11, 0x20000
    s_lshl_b32 s20, s70, 2
    s_add_u32 s20, s20, 768
    s_lshr_b32 s74, s20, 7
    s_add_u32 s20, s20, s26
    v_and_b32 v1, 63, v0
    s_mov_b32 s21, 0
    s_mov_b32 s22, 2560
    v_lshlrev_b32 v2, 2, v1
    v_lshlrev_b32 v3, 3, v1
    s_add_u32 s24, s20, 0
    s_mul_i32 s24, s24, 1280
    s_add_u32 s25, s24, 0
    buffer_load_dword v15, v2, s[12:15], s25 offen offset:0
    buffer_load_dword v16, v2, s[12:15], s25 offen offset:256
    buffer_load_dword v17, v2, s[12:15], s25 offen offset:512
    buffer_load_dword v18, v2, s[12:15], s25 offen offset:768
    buffer_load_dword v19, v2, s[12:15], s25 offen offset:1024
    buffer_load_dwordx2 v[40:41], v3, s[4:7], s21 offen offset:0 sc1
    buffer_load_dwordx2 v[50:51], v3, s[4:7], s22 offen offset:0 sc1
    buffer_load_dwordx2 v[42:43], v3, s[4:7], s21 offen offset:512 sc1
    buffer_load_dwordx2 v[52:53], v3, s[4:7], s22 offen offset:512 sc1
    buffer_load_dwordx2 v[44:45], v3, s[4:7], s21 offen offset:1024 sc1
    buffer_load_dwordx2 v[54:55], v3, s[4:7], s22 offen offset:1024 sc1
    buffer_load_dwordx2 v[46:47], v3, s[4:7], s21 offen offset:1536 sc1
    buffer_load_dwordx2 v[56:57], v3, s[4:7], s22 offen offset:1536 sc1
    buffer_load_dwordx2 v[48:49], v3, s[4:7], s21 offen offset:2048 sc1
    buffer_load_dwordx2 v[58:59], v3, s[4:7], s22 offen offset:2048 sc1
    s_waitcnt vmcnt(0)
    v_lshlrev_b32 v30, 16, v15
    v_and_b32 v31, 0xffff0000, v15
    v_lshlrev_b32 v32, 16, v16
    v_and_b32 v33, 0xffff0000, v16
    v_lshlrev_b32 v34, 16, v17
    v_and_b32 v35, 0xffff0000, v17
    v_lshlrev_b32 v36, 16, v18
    v_and_b32 v37, 0xffff0000, v18
    v_lshlrev_b32 v38, 16, v19
    v_and_b32 v39, 0xffff0000, v19
    v_add_f32 v4, v30, v31
    v_add_f32 v4, v4, v32
    v_add_f32 v4, v4, v33
    v_add_f32 v4, v4, v34
    v_add_f32 v4, v4, v35
    v_add_f32 v4, v4, v36
    v_add_f32 v4, v4, v37
    v_add_f32 v4, v4, v38
    v_add_f32 v4, v4, v39
    s_nop 1
    v_add_f32_dpp v4, v4, v4 row_ror:1 row_mask:0xf bank_mask:0xf
    s_nop 1
    v_add_f32_dpp v4, v4, v4 row_ror:2 row_mask:0xf bank_mask:0xf
    s_nop 1
    v_add_f32_dpp v4, v4, v4 row_ror:4 row_mask:0xf bank_mask:0xf
    s_nop 1
    v_add_f32_dpp v4, v4, v4 row_ror:8 row_mask:0xf bank_mask:0xf
    v_mov_b32 v5, v4
    s_nop 1
    v_permlane16_swap_b32 v4, v5
    v_add_f32 v4, v4, v5
    v_mov_b32 v5, v4
    s_nop 1
    v_permlane32_swap_b32 v4, v5
    v_add_f32 v4, v4, v5
    v_mul_f32 v4, 0x3acccccd, v4
    v_mov_b32 v6, 0
    v_sub_f32 v5, v30, v4
    v_fmac_f32 v6, v5, v5
    v_sub_f32 v5, v31, v4
    v_fmac_f32 v6, v5, v5
    v_sub_f32 v5, v32, v4
    v_fmac_f32 v6, v5, v5
    v_sub_f32 v5, v33, v4
    v_fmac_f32 v6, v5, v5
    v_sub_f32 v5, v34, v4
    v_fmac_f32 v6, v5, v5
    v_sub_f32 v5, v35, v4
    v_fmac_f32 v6, v5, v5
    v_sub_f32 v5, v36, v4
    v_fmac_f32 v6, v5, v5
    v_sub_f32 v5, v37, v4
    v_fmac_f32 v6, v5, v5
    v_sub_f32 v5, v38, v4
    v_fmac_f32 v6, v5, v5
    v_sub_f32 v5, v39, v4
    v_fmac_f32 v6, v5, v5
    s_nop 1
    v_add_f32_dpp v6, v6, v6 row_ror:1 row_mask:0xf bank_mask:0xf
    s_nop 1
    v_add_f32_dpp v6, v6, v6 row_ror:2 row_mask:0xf bank_mask:0xf
    s_nop 1
    v_add_f32_dpp v6, v6, v6 row_ror:4 row_mask:0xf bank_mask:0xf
    s_nop 1
    v_add_f32_dpp v6, v6, v6 row_ror:8 row_mask:0xf bank_mask:0xf
    v_mov_b32 v5, v6
    s_nop 1
    v_permlane16_swap_b32 v6, v5
    v_add_f32 v6, v6, v5
    v_mov_b32 v5, v6
    s_nop 1
    v_permlane32_swap_b32 v6, v5
    v_add_f32 v6, v6, v5
    v_mul_f32 v6, 0x3acccccd, v6
    v_cvt_pk_bf16_f32 v6, v6, v6
    v_and_b32 v6, 0xffff0000, v6
    v_add_f32 v6, 0x3727c5ac, v6
    v_cvt_pk_bf16_f32 v6, v6, v6
    v_and_b32 v6, 0xffff0000, v6
    v_sqrt_f32 v6, v6
    s_nop 0
    v_cvt_pk_bf16_f32 v6, v6, v6
    v_and_b32 v6, 0xffff0000, v6
    v_rcp_f32 v7, v6
    v_cvt_pk_bf16_f32 v4, v4, v4
    v_and_b32 v4, 0xffff0000, v4
    v_sub_f32 v30, v30, v4
    v_cvt_pk_bf16_f32 v30, v30, v30
    v_and_b32 v30, 0xffff0000, v30
    v_mul_f32 v5, v30, v7
    v_fma_f32 v8, -v5, v6, v30
    v_fma_f32 v30, v8, v7, v5
    v_cvt_pk_bf16_f32 v30, v30, v30
    v_and_b32 v30, 0xffff0000, v30
    v_mul_f32 v30, v30, v50
    v_cvt_pk_bf16_f32 v30, v30, v30
    v_and_b32 v30, 0xffff0000, v30
    v_add_f32 v30, v30, v40
    v_sub_f32 v31, v31, v4
    v_cvt_pk_bf16_f32 v31, v31, v31
    v_and_b32 v31, 0xffff0000, v31
    v_mul_f32 v5, v31, v7
    v_fma_f32 v8, -v5, v6, v31
    v_fma_f32 v31, v8, v7, v5
    v_cvt_pk_bf16_f32 v31, v31, v31
    v_and_b32 v31, 0xffff0000, v31
    v_mul_f32 v31, v31, v51
    v_cvt_pk_bf16_f32 v31, v31, v31
    v_and_b32 v31, 0xffff0000, v31
    v_add_f32 v31, v31, v41
    v_sub_f32 v32, v32, v4
    v_cvt_pk_bf16_f32 v32, v32, v32
    v_and_b32 v32, 0xffff0000, v32
    v_mul_f32 v5, v32, v7
    v_fma_f32 v8, -v5, v6, v32
    v_fma_f32 v32, v8, v7, v5
    v_cvt_pk_bf16_f32 v32, v32, v32
    v_and_b32 v32, 0xffff0000, v32
    v_mul_f32 v32, v32, v52
    v_cvt_pk_bf16_f32 v32, v32, v32
    v_and_b32 v32, 0xffff0000, v32
    v_add_f32 v32, v32, v42
    v_sub_f32 v33, v33, v4
    v_cvt_pk_bf16_f32 v33, v33, v33
    v_and_b32 v33, 0xffff0000, v33
    v_mul_f32 v5, v33, v7
    v_fma_f32 v8, -v5, v6, v33
    v_fma_f32 v33, v8, v7, v5
    v_cvt_pk_bf16_f32 v33, v33, v33
    v_and_b32 v33, 0xffff0000, v33
    v_mul_f32 v33, v33, v53
    v_cvt_pk_bf16_f32 v33, v33, v33
    v_and_b32 v33, 0xffff0000, v33
    v_add_f32 v33, v33, v43
    v_sub_f32 v34, v34, v4
    v_cvt_pk_bf16_f32 v34, v34, v34
    v_and_b32 v34, 0xffff0000, v34
    v_mul_f32 v5, v34, v7
    v_fma_f32 v8, -v5, v6, v34
    v_fma_f32 v34, v8, v7, v5
    v_cvt_pk_bf16_f32 v34, v34, v34
    v_and_b32 v34, 0xffff0000, v34
    v_mul_f32 v34, v34, v54
    v_cvt_pk_bf16_f32 v34, v34, v34
    v_and_b32 v34, 0xffff0000, v34
    v_add_f32 v34, v34, v44
    v_sub_f32 v35, v35, v4
    v_cvt_pk_bf16_f32 v35, v35, v35
    v_and_b32 v35, 0xffff0000, v35
    v_mul_f32 v5, v35, v7
    v_fma_f32 v8, -v5, v6, v35
    v_fma_f32 v35, v8, v7, v5
    v_cvt_pk_bf16_f32 v35, v35, v35
    v_and_b32 v35, 0xffff0000, v35
    v_mul_f32 v35, v35, v55
    v_cvt_pk_bf16_f32 v35, v35, v35
    v_and_b32 v35, 0xffff0000, v35
    v_add_f32 v35, v35, v45
    v_sub_f32 v36, v36, v4
    v_cvt_pk_bf16_f32 v36, v36, v36
    v_and_b32 v36, 0xffff0000, v36
    v_mul_f32 v5, v36, v7
    v_fma_f32 v8, -v5, v6, v36
    v_fma_f32 v36, v8, v7, v5
    v_cvt_pk_bf16_f32 v36, v36, v36
    v_and_b32 v36, 0xffff0000, v36
    v_mul_f32 v36, v36, v56
    v_cvt_pk_bf16_f32 v36, v36, v36
    v_and_b32 v36, 0xffff0000, v36
    v_add_f32 v36, v36, v46
    v_sub_f32 v37, v37, v4
    v_cvt_pk_bf16_f32 v37, v37, v37
    v_and_b32 v37, 0xffff0000, v37
    v_mul_f32 v5, v37, v7
    v_fma_f32 v8, -v5, v6, v37
    v_fma_f32 v37, v8, v7, v5
    v_cvt_pk_bf16_f32 v37, v37, v37
    v_and_b32 v37, 0xffff0000, v37
    v_mul_f32 v37, v37, v57
    v_cvt_pk_bf16_f32 v37, v37, v37
    v_and_b32 v37, 0xffff0000, v37
    v_add_f32 v37, v37, v47
    v_sub_f32 v38, v38, v4
    v_cvt_pk_bf16_f32 v38, v38, v38
    v_and_b32 v38, 0xffff0000, v38
    v_mul_f32 v5, v38, v7
    v_fma_f32 v8, -v5, v6, v38
    v_fma_f32 v38, v8, v7, v5
    v_cvt_pk_bf16_f32 v38, v38, v38
    v_and_b32 v38, 0xffff0000, v38
    v_mul_f32 v38, v38, v58
    v_cvt_pk_bf16_f32 v38, v38, v38
    v_and_b32 v38, 0xffff0000, v38
    v_add_f32 v38, v38, v48
    v_sub_f32 v39, v39, v4
    v_cvt_pk_bf16_f32 v39, v39, v39
    v_and_b32 v39, 0xffff0000, v39
    v_mul_f32 v5, v39, v7
    v_fma_f32 v8, -v5, v6, v39
    v_fma_f32 v39, v8, v7, v5
    v_cvt_pk_bf16_f32 v39, v39, v39
    v_and_b32 v39, 0xffff0000, v39
    v_mul_f32 v39, v39, v59
    v_cvt_pk_bf16_f32 v39, v39, v39
    v_and_b32 v39, 0xffff0000, v39
    v_add_f32 v39, v39, v49
    s_add_u32 s25, s24, 1048576
    v_cvt_pk_bf16_f32 v10, v30, v31
    buffer_store_dword v10, v2, s[4:7], s25 offen offset:0 sc1
    v_cvt_pk_bf16_f32 v11, v32, v33
    buffer_store_dword v11, v2, s[4:7], s25 offen offset:256 sc1
    v_cvt_pk_bf16_f32 v12, v34, v35
    buffer_store_dword v12, v2, s[4:7], s25 offen offset:512 sc1
    v_cvt_pk_bf16_f32 v13, v36, v37
    buffer_store_dword v13, v2, s[4:7], s25 offen offset:768 sc1
    v_cvt_pk_bf16_f32 v14, v38, v39
    buffer_store_dword v14, v2, s[4:7], s25 offen offset:1024 sc1
    s_lshl_b32 s77, s74, 7
    s_add_u32 s77, s77, 819200
    s_waitcnt vmcnt(0)
    s_barrier
    s_cmp_lg_u32 s26, 0
    s_cbranch_scc1 L_sig_85
    v_mov_b32 v1, 0
    v_mov_b32 v2, 1
    s_mov_b64 exec, 1
    buffer_atomic_add v2, v1, s[4:7], s77 offen
    s_mov_b64 exec, -1
L_sig_85:
L_lns_84:
    s_lshl_b32 s20, s70, 2
    s_add_u32 s20, s20, 1536
    s_cmp_ge_u32 s20, 2048
    s_cbranch_scc1 L_lns_86
    s_lshr_b32 s74, s20, 7
    s_add_u32 s20, s20, s26
    v_and_b32 v1, 63, v0
    s_mov_b32 s21, 0
    s_mov_b32 s22, 2560
    v_lshlrev_b32 v2, 2, v1
    v_lshlrev_b32 v3, 3, v1
    s_add_u32 s24, s20, 0
    s_mul_i32 s24, s24, 1280
    s_add_u32 s25, s24, 0
    buffer_load_dword v15, v2, s[12:15], s25 offen offset:0
    buffer_load_dword v16, v2, s[12:15], s25 offen offset:256
    buffer_load_dword v17, v2, s[12:15], s25 offen offset:512
    buffer_load_dword v18, v2, s[12:15], s25 offen offset:768
    buffer_load_dword v19, v2, s[12:15], s25 offen offset:1024
    buffer_load_dwordx2 v[40:41], v3, s[4:7], s21 offen offset:0 sc1
    buffer_load_dwordx2 v[50:51], v3, s[4:7], s22 offen offset:0 sc1
    buffer_load_dwordx2 v[42:43], v3, s[4:7], s21 offen offset:512 sc1
    buffer_load_dwordx2 v[52:53], v3, s[4:7], s22 offen offset:512 sc1
    buffer_load_dwordx2 v[44:45], v3, s[4:7], s21 offen offset:1024 sc1
    buffer_load_dwordx2 v[54:55], v3, s[4:7], s22 offen offset:1024 sc1
    buffer_load_dwordx2 v[46:47], v3, s[4:7], s21 offen offset:1536 sc1
    buffer_load_dwordx2 v[56:57], v3, s[4:7], s22 offen offset:1536 sc1
    buffer_load_dwordx2 v[48:49], v3, s[4:7], s21 offen offset:2048 sc1
    buffer_load_dwordx2 v[58:59], v3, s[4:7], s22 offen offset:2048 sc1
    s_waitcnt vmcnt(0)
    v_lshlrev_b32 v30, 16, v15
    v_and_b32 v31, 0xffff0000, v15
    v_lshlrev_b32 v32, 16, v16
    v_and_b32 v33, 0xffff0000, v16
    v_lshlrev_b32 v34, 16, v17
    v_and_b32 v35, 0xffff0000, v17
    v_lshlrev_b32 v36, 16, v18
    v_and_b32 v37, 0xffff0000, v18
    v_lshlrev_b32 v38, 16, v19
    v_and_b32 v39, 0xffff0000, v19
    v_add_f32 v4, v30, v31
    v_add_f32 v4, v4, v32
    v_add_f32 v4, v4, v33
    v_add_f32 v4, v4, v34
    v_add_f32 v4, v4, v35
    v_add_f32 v4, v4, v36
    v_add_f32 v4, v4, v37
    v_add_f32 v4, v4, v38
    v_add_f32 v4, v4, v39
    s_nop 1
    v_add_f32_dpp v4, v4, v4 row_ror:1 row_mask:0xf bank_mask:0xf
    s_nop 1
    v_add_f32_dpp v4, v4, v4 row_ror:2 row_mask:0xf bank_mask:0xf
    s_nop 1
    v_add_f32_dpp v4, v4, v4 row_ror:4 row_mask:0xf bank_mask:0xf
    s_nop 1
    v_add_f32_dpp v4, v4, v4 row_ror:8 row_mask:0xf bank_mask:0xf
    v_mov_b32 v5, v4
    s_nop 1
    v_permlane16_swap_b32 v4, v5
    v_add_f32 v4, v4, v5
    v_mov_b32 v5, v4
    s_nop 1
    v_permlane32_swap_b32 v4, v5
    v_add_f32 v4, v4, v5
    v_mul_f32 v4, 0x3acccccd, v4
    v_mov_b32 v6, 0
    v_sub_f32 v5, v30, v4
    v_fmac_f32 v6, v5, v5
    v_sub_f32 v5, v31, v4
    v_fmac_f32 v6, v5, v5
    v_sub_f32 v5, v32, v4
    v_fmac_f32 v6, v5, v5
    v_sub_f32 v5, v33, v4
    v_fmac_f32 v6, v5, v5
    v_sub_f32 v5, v34, v4
    v_fmac_f32 v6, v5, v5
    v_sub_f32 v5, v35, v4
    v_fmac_f32 v6, v5, v5
    v_sub_f32 v5, v36, v4
    v_fmac_f32 v6, v5, v5
    v_sub_f32 v5, v37, v4
    v_fmac_f32 v6, v5, v5
    v_sub_f32 v5, v38, v4
    v_fmac_f32 v6, v5, v5
    v_sub_f32 v5, v39, v4
    v_fmac_f32 v6, v5, v5
    s_nop 1
    v_add_f32_dpp v6, v6, v6 row_ror:1 row_mask:0xf bank_mask:0xf
    s_nop 1
    v_add_f32_dpp v6, v6, v6 row_ror:2 row_mask:0xf bank_mask:0xf
    s_nop 1
    v_add_f32_dpp v6, v6, v6 row_ror:4 row_mask:0xf bank_mask:0xf
    s_nop 1
    v_add_f32_dpp v6, v6, v6 row_ror:8 row_mask:0xf bank_mask:0xf
    v_mov_b32 v5, v6
    s_nop 1
    v_permlane16_swap_b32 v6, v5
    v_add_f32 v6, v6, v5
    v_mov_b32 v5, v6
    s_nop 1
    v_permlane32_swap_b32 v6, v5
    v_add_f32 v6, v6, v5
    v_mul_f32 v6, 0x3acccccd, v6
    v_cvt_pk_bf16_f32 v6, v6, v6
    v_and_b32 v6, 0xffff0000, v6
    v_add_f32 v6, 0x3727c5ac, v6
    v_cvt_pk_bf16_f32 v6, v6, v6
    v_and_b32 v6, 0xffff0000, v6
    v_sqrt_f32 v6, v6
    s_nop 0
    v_cvt_pk_bf16_f32 v6, v6, v6
    v_and_b32 v6, 0xffff0000, v6
    v_rcp_f32 v7, v6
    v_cvt_pk_bf16_f32 v4, v4, v4
    v_and_b32 v4, 0xffff0000, v4
    v_sub_f32 v30, v30, v4
    v_cvt_pk_bf16_f32 v30, v30, v30
    v_and_b32 v30, 0xffff0000, v30
    v_mul_f32 v5, v30, v7
    v_fma_f32 v8, -v5, v6, v30
    v_fma_f32 v30, v8, v7, v5
    v_cvt_pk_bf16_f32 v30, v30, v30
    v_and_b32 v30, 0xffff0000, v30
    v_mul_f32 v30, v30, v50
    v_cvt_pk_bf16_f32 v30, v30, v30
    v_and_b32 v30, 0xffff0000, v30
    v_add_f32 v30, v30, v40
    v_sub_f32 v31, v31, v4
    v_cvt_pk_bf16_f32 v31, v31, v31
    v_and_b32 v31, 0xffff0000, v31
    v_mul_f32 v5, v31, v7
    v_fma_f32 v8, -v5, v6, v31
    v_fma_f32 v31, v8, v7, v5
    v_cvt_pk_bf16_f32 v31, v31, v31
    v_and_b32 v31, 0xffff0000, v31
    v_mul_f32 v31, v31, v51
    v_cvt_pk_bf16_f32 v31, v31, v31
    v_and_b32 v31, 0xffff0000, v31
    v_add_f32 v31, v31, v41
    v_sub_f32 v32, v32, v4
    v_cvt_pk_bf16_f32 v32, v32, v32
    v_and_b32 v32, 0xffff0000, v32
    v_mul_f32 v5, v32, v7
    v_fma_f32 v8, -v5, v6, v32
    v_fma_f32 v32, v8, v7, v5
    v_cvt_pk_bf16_f32 v32, v32, v32
    v_and_b32 v32, 0xffff0000, v32
    v_mul_f32 v32, v32, v52
    v_cvt_pk_bf16_f32 v32, v32, v32
    v_and_b32 v32, 0xffff0000, v32
    v_add_f32 v32, v32, v42
    v_sub_f32 v33, v33, v4
    v_cvt_pk_bf16_f32 v33, v33, v33
    v_and_b32 v33, 0xffff0000, v33
    v_mul_f32 v5, v33, v7
    v_fma_f32 v8, -v5, v6, v33
    v_fma_f32 v33, v8, v7, v5
    v_cvt_pk_bf16_f32 v33, v33, v33
    v_and_b32 v33, 0xffff0000, v33
    v_mul_f32 v33, v33, v53
    v_cvt_pk_bf16_f32 v33, v33, v33
    v_and_b32 v33, 0xffff0000, v33
    v_add_f32 v33, v33, v43
    v_sub_f32 v34, v34, v4
    v_cvt_pk_bf16_f32 v34, v34, v34
    v_and_b32 v34, 0xffff0000, v34
    v_mul_f32 v5, v34, v7
    v_fma_f32 v8, -v5, v6, v34
    v_fma_f32 v34, v8, v7, v5
    v_cvt_pk_bf16_f32 v34, v34, v34
    v_and_b32 v34, 0xffff0000, v34
    v_mul_f32 v34, v34, v54
    v_cvt_pk_bf16_f32 v34, v34, v34
    v_and_b32 v34, 0xffff0000, v34
    v_add_f32 v34, v34, v44
    v_sub_f32 v35, v35, v4
    v_cvt_pk_bf16_f32 v35, v35, v35
    v_and_b32 v35, 0xffff0000, v35
    v_mul_f32 v5, v35, v7
    v_fma_f32 v8, -v5, v6, v35
    v_fma_f32 v35, v8, v7, v5
    v_cvt_pk_bf16_f32 v35, v35, v35
    v_and_b32 v35, 0xffff0000, v35
    v_mul_f32 v35, v35, v55
    v_cvt_pk_bf16_f32 v35, v35, v35
    v_and_b32 v35, 0xffff0000, v35
    v_add_f32 v35, v35, v45
    v_sub_f32 v36, v36, v4
    v_cvt_pk_bf16_f32 v36, v36, v36
    v_and_b32 v36, 0xffff0000, v36
    v_mul_f32 v5, v36, v7
    v_fma_f32 v8, -v5, v6, v36
    v_fma_f32 v36, v8, v7, v5
    v_cvt_pk_bf16_f32 v36, v36, v36
    v_and_b32 v36, 0xffff0000, v36
    v_mul_f32 v36, v36, v56
    v_cvt_pk_bf16_f32 v36, v36, v36
    v_and_b32 v36, 0xffff0000, v36
    v_add_f32 v36, v36, v46
    v_sub_f32 v37, v37, v4
    v_cvt_pk_bf16_f32 v37, v37, v37
    v_and_b32 v37, 0xffff0000, v37
    v_mul_f32 v5, v37, v7
    v_fma_f32 v8, -v5, v6, v37
    v_fma_f32 v37, v8, v7, v5
    v_cvt_pk_bf16_f32 v37, v37, v37
    v_and_b32 v37, 0xffff0000, v37
    v_mul_f32 v37, v37, v57
    v_cvt_pk_bf16_f32 v37, v37, v37
    v_and_b32 v37, 0xffff0000, v37
    v_add_f32 v37, v37, v47
    v_sub_f32 v38, v38, v4
    v_cvt_pk_bf16_f32 v38, v38, v38
    v_and_b32 v38, 0xffff0000, v38
    v_mul_f32 v5, v38, v7
    v_fma_f32 v8, -v5, v6, v38
    v_fma_f32 v38, v8, v7, v5
    v_cvt_pk_bf16_f32 v38, v38, v38
    v_and_b32 v38, 0xffff0000, v38
    v_mul_f32 v38, v38, v58
    v_cvt_pk_bf16_f32 v38, v38, v38
    v_and_b32 v38, 0xffff0000, v38
    v_add_f32 v38, v38, v48
    v_sub_f32 v39, v39, v4
    v_cvt_pk_bf16_f32 v39, v39, v39
    v_and_b32 v39, 0xffff0000, v39
    v_mul_f32 v5, v39, v7
    v_fma_f32 v8, -v5, v6, v39
    v_fma_f32 v39, v8, v7, v5
    v_cvt_pk_bf16_f32 v39, v39, v39
    v_and_b32 v39, 0xffff0000, v39
    v_mul_f32 v39, v39, v59
    v_cvt_pk_bf16_f32 v39, v39, v39
    v_and_b32 v39, 0xffff0000, v39
    v_add_f32 v39, v39, v49
    s_add_u32 s25, s24, 1048576
    v_cvt_pk_bf16_f32 v10, v30, v31
    buffer_store_dword v10, v2, s[4:7], s25 offen offset:0 sc1
    v_cvt_pk_bf16_f32 v11, v32, v33
    buffer_store_dword v11, v2, s[4:7], s25 offen offset:256 sc1
    v_cvt_pk_bf16_f32 v12, v34, v35
    buffer_store_dword v12, v2, s[4:7], s25 offen offset:512 sc1
    v_cvt_pk_bf16_f32 v13, v36, v37
    buffer_store_dword v13, v2, s[4:7], s25 offen offset:768 sc1
    v_cvt_pk_bf16_f32 v14, v38, v39
    buffer_store_dword v14, v2, s[4:7], s25 offen offset:1024 sc1
    s_lshl_b32 s77, s74, 7
    s_add_u32 s77, s77, 819200
    s_waitcnt vmcnt(0)
    s_barrier
    s_cmp_lg_u32 s26, 0
    s_cbranch_scc1 L_sig_87
    v_mov_b32 v1, 0
    v_mov_b32 v2, 1
    s_mov_b64 exec, 1
    buffer_atomic_add v2, v1, s[4:7], s77 offen
    s_mov_b64 exec, -1
L_sig_87:
L_lns_86:
    v_and_b32 v144, 63, v0
    v_and_b32 v145, 15, v144
    v_lshrrev_b32 v146, 4, v144
    v_lshrrev_b32 v147, 6, v0
    s_nop 0
    v_readfirstlane_b32 s40, v147
    s_nop 0
    s_and_b32 s41, s40, 1
    s_lshr_b32 s42, s40, 1
    s_waitcnt lgkmcnt(0)
    s_mul_i32 s48, s40, 4
    s_add_u32 s48, s48, 0
    v_lshrrev_b32 v148, 3, v144
    s_lshl_b32 s49, s48, 3
    v_add_u32 v148, s49, v148
    v_and_b32 v149, 7, v144
    v_bfe_u32 v150, v148, 1, 3
    v_xor_b32 v149, v149, v150
    s_mov_b32 s49, 1280
    v_mul_lo_u32 v148, v148, s49
    v_lshl_add_u32 v130, v149, 4, v148
    s_mul_i32 s48, s40, 4
    s_add_u32 s48, s48, 1
    v_lshrrev_b32 v148, 3, v144
    s_lshl_b32 s49, s48, 3
    v_add_u32 v148, s49, v148
    v_and_b32 v149, 7, v144
    v_bfe_u32 v150, v148, 1, 3
    v_xor_b32 v149, v149, v150
    s_mov_b32 s49, 1280
    v_mul_lo_u32 v148, v148, s49
    v_lshl_add_u32 v131, v149, 4, v148
    s_mul_i32 s48, s40, 4
    s_add_u32 s48, s48, 2
    v_lshrrev_b32 v148, 3, v144
    s_lshl_b32 s49, s48, 3
    v_add_u32 v148, s49, v148
    v_and_b32 v149, 7, v144
    v_bfe_u32 v150, v148, 1, 3
    v_xor_b32 v149, v149, v150
    s_mov_b32 s49, 1280
    v_mul_lo_u32 v148, v148, s49
    v_lshl_add_u32 v132, v149, 4, v148
    s_mul_i32 s48, s40, 4
    s_add_u32 s48, s48, 3
    v_lshrrev_b32 v148, 3, v144
    s_lshl_b32 s49, s48, 3
    v_add_u32 v148, s49, v148
    v_and_b32 v149, 7, v144
    v_bfe_u32 v150, v148, 1, 3
    v_xor_b32 v149, v149, v150
    s_mov_b32 s49, 1280
    v_mul_lo_u32 v148, v148, s49
    v_lshl_add_u32 v133, v149, 4, v148
    s_mul_i32 s48, s40, 4
    s_add_u32 s48, s48, 0
    v_lshrrev_b32 v148, 4, v144
    s_mul_i32 s49, s48, 4
    v_add_u32 v148, s49, v148
    v_and_b32 v149, 15, v144
    v_and_b32 v150, 3, v148
    v_bfe_u32 v151, v148, 3, 1
    v_lshl_add_u32 v150, v151, 2, v150
    v_lshlrev_b32 v150, 1, v150
    v_xor_b32 v149, v149, v150
    s_mov_b32 s49, 8192
    v_mul_lo_u32 v148, v148, s49
    v_lshl_add_u32 v134, v149, 4, v148
    s_mul_i32 s48, s40, 4
    s_add_u32 s48, s48, 1
    v_lshrrev_b32 v148, 4, v144
    s_mul_i32 s49, s48, 4
    v_add_u32 v148, s49, v148
    v_and_b32 v149, 15, v144
    v_and_b32 v150, 3, v148
    v_bfe_u32 v151, v148, 3, 1
    v_lshl_add_u32 v150, v151, 2, v150
    v_lshlrev_b32 v150, 1, v150
    v_xor_b32 v149, v149, v150
    s_mov_b32 s49, 8192
    v_mul_lo_u32 v148, v148, s49
    v_lshl_add_u32 v135, v149, 4, v148
    s_mul_i32 s48, s40, 4
    s_add_u32 s48, s48, 2
    v_lshrrev_b32 v148, 4, v144
    s_mul_i32 s49, s48, 4
    v_add_u32 v148, s49, v148
    v_and_b32 v149, 15, v144
    v_and_b32 v150, 3, v148
    v_bfe_u32 v151, v148, 3, 1
    v_lshl_add_u32 v150, v151, 2, v150
    v_lshlrev_b32 v150, 1, v150
    v_xor_b32 v149, v149, v150
    s_mov_b32 s49, 8192
    v_mul_lo_u32 v148, v148, s49
    v_lshl_add_u32 v136, v149, 4, v148
    s_mul_i32 s48, s40, 4
    s_add_u32 s48, s48, 3
    v_lshrrev_b32 v148, 4, v144
    s_mul_i32 s49, s48, 4
    v_add_u32 v148, s49, v148
    v_and_b32 v149, 15, v144
    v_and_b32 v150, 3, v148
    v_bfe_u32 v151, v148, 3, 1
    v_lshl_add_u32 v150, v151, 2, v150
    v_lshlrev_b32 v150, 1, v150
    v_xor_b32 v149, v149, v150
    s_mov_b32 s49, 8192
    v_mul_lo_u32 v148, v148, s49
    v_lshl_add_u32 v137, v149, 4, v148
    v_bfe_u32 v148, v145, 1, 3
    v_xor_b32 v148, v148, v146
    v_lshlrev_b32 v148, 4, v148
    v_lshl_add_u32 v148, v145, 7, v148
    s_mul_i32 s48, s41, 8192
    s_add_u32 s48, s48, 0
    v_add_u32 v138, s48, v148
    v_xor_b32 v139, 64, v138
    v_lshrrev_b32 v148, 2, v145
    v_and_b32 v149, 3, v145
    v_and_b32 v151, 1, v146
    v_lshl_add_u32 v150, v151, 2, v148
    v_lshlrev_b32 v150, 1, v150
    v_lshrrev_b32 v151, 1, v149
    v_xor_b32 v150, v150, v151
    v_lshlrev_b32 v150, 4, v150
    v_and_b32 v151, 1, v149
    v_lshl_add_u32 v150, v151, 3, v150
    v_lshl_add_u32 v151, v146, 3, v148
    s_mov_b32 s48, 256
    v_mul_lo_u32 v151, v151, s48
    v_add_u32 v150, v150, v151
    s_mul_i32 s48, s42, 4
    s_add_u32 s48, s48, 0
    s_and_b32 s49, s48, 7
    s_lshl_b32 s49, s49, 5
    v_xor_b32 v140, s49, v150
    s_lshr_b32 s48, s48, 3
    s_lshl_b32 s48, s48, 8
    s_add_u32 s48, s48, 16384
    v_add_u32 v140, s48, v140
    s_mul_i32 s48, s42, 4
    s_add_u32 s48, s48, 1
    s_and_b32 s49, s48, 7
    s_lshl_b32 s49, s49, 5
    v_xor_b32 v141, s49, v150
    s_lshr_b32 s48, s48, 3
    s_lshl_b32 s48, s48, 8
    s_add_u32 s48, s48, 16384
    v_add_u32 v141, s48, v141
    s_mul_i32 s48, s42, 4
    s_add_u32 s48, s48, 2
    s_and_b32 s49, s48, 7
    s_lshl_b32 s49, s49, 5
    v_xor_b32 v142, s49, v150
    s_lshr_b32 s48, s48, 3
    s_lshl_b32 s48, s48, 8
    s_add_u32 s48, s48, 16384
    v_add_u32 v142, s48, v142
    s_mul_i32 s48, s42, 4
    s_add_u32 s48, s48, 3
    s_and_b32 s49, s48, 7
    s_lshl_b32 s49, s49, 5
    v_xor_b32 v143, s49, v150
    s_lshr_b32 s48, s48, 3
    s_lshl_b32 s48, s48, 8
    s_add_u32 s48, s48, 16384
    v_add_u32 v143, s48, v143
    s_lshr_b32 s74, s72, 4
    s_add_u32 s74, s74, 2
    s_mul_i32 s43, s74, 163840
    s_add_u32 s43, s43, 1048576
    s_mul_i32 s44, s80, 256
    s_lshl_b32 s16, s82, 24
    s_add_u32 s16, s16, 16777216
    s_mul_i32 s17, s74, 1048576
    s_add_u32 s16, s16, s17
    s_mul_i32 s17, s80, 256
    s_add_u32 s16, s16, s17
    s_mul_i32 s54, s40, 4096
    s_mul_i32 s55, s40, 4096
    s_mov_b32 s46, 0
    s_mov_b32 s51, 0
    s_mov_b32 s52, s54
    s_mov_b32 s53, s55
    s_add_u32 s50, s44, 0
    s_add_u32 s53, s55, 0
    s_add_u32 m0, s53, 16384
    s_nop 0
    buffer_load_dwordx4 v134, s[8:11], s50 offen lds
    s_add_u32 m0, s53, 17408
    s_nop 0
    buffer_load_dwordx4 v135, s[8:11], s50 offen lds
    s_add_u32 m0, s53, 18432
    s_nop 0
    buffer_load_dwordx4 v136, s[8:11], s50 offen lds
    s_add_u32 m0, s53, 19456
    s_nop 0
    buffer_load_dwordx4 v137, s[8:11], s50 offen lds
    s_add_u32 s50, s44, 524288
    s_add_u32 s53, s55, 32768
    s_add_u32 m0, s53, 16384
    s_nop 0
    buffer_load_dwordx4 v134, s[8:11], s50 offen lds
    s_add_u32 m0, s53, 17408
    s_nop 0
    buffer_load_dwordx4 v135, s[8:11], s50 offen lds
    s_add_u32 m0, s53, 18432
    s_nop 0
    buffer_load_dwordx4 v136, s[8:11], s50 offen lds
    s_add_u32 m0, s53, 19456
    s_nop 0
    buffer_load_dwordx4 v137, s[8:11], s50 offen lds
    s_add_u32 s50, s44, 1048576
    s_add_u32 s53, s55, 65536
    s_add_u32 m0, s53, 16384
    s_nop 0
    buffer_load_dwordx4 v134, s[8:11], s50 offen lds
    s_add_u32 m0, s53, 17408
    s_nop 0
    buffer_load_dwordx4 v135, s[8:11], s50 offen lds
    s_add_u32 m0, s53, 18432
    s_nop 0
    buffer_load_dwordx4 v136, s[8:11], s50 offen lds
    s_add_u32 m0, s53, 19456
    s_nop 0
    buffer_load_dwordx4 v137, s[8:11], s50 offen lds
    s_add_u32 s50, s44, 1572864
    s_add_u32 s53, s55, 98304
    s_add_u32 m0, s53, 16384
    s_nop 0
    buffer_load_dwordx4 v134, s[8:11], s50 offen lds
    s_add_u32 m0, s53, 17408
    s_nop 0
    buffer_load_dwordx4 v135, s[8:11], s50 offen lds
    s_add_u32 m0, s53, 18432
    s_nop 0
    buffer_load_dwordx4 v136, s[8:11], s50 offen lds
    s_add_u32 m0, s53, 19456
    s_nop 0
    buffer_load_dwordx4 v137, s[8:11], s50 offen lds
    s_add_u32 s50, s44, 2097152
    s_add_u32 s53, s55, 131072
    s_add_u32 m0, s53, 16384
    s_nop 0
    buffer_load_dwordx4 v134, s[8:11], s50 offen lds
    s_add_u32 m0, s53, 17408
    s_nop 0
    buffer_load_dwordx4 v135, s[8:11], s50 offen lds
    s_add_u32 m0, s53, 18432
    s_nop 0
    buffer_load_dwordx4 v136, s[8:11], s50 offen lds
    s_add_u32 m0, s53, 19456
    s_nop 0
    buffer_load_dwordx4 v137, s[8:11], s50 offen lds
    s_lshl_b32 s77, s74, 7
    s_add_u32 s77, s77, 819200
    s_cmp_lg_u32 s26, 0
    s_cbranch_scc1 L_wgw_88
    s_mov_b32 s79, 0x200000
    v_mov_b32 v152, 0
L_cw_89:
    buffer_load_dword v153, v152, s[4:7], s77 offen sc1
    s_waitcnt vmcnt(0)
    v_readfirstlane_b32 s78, v153
    s_nop 0
    s_cmp_ge_u32 s78, 32
    s_cbranch_scc1 L_cd_90
    s_sleep 2
    s_sub_u32 s79, s79, 1
    s_cbranch_scc0 L_cw_89
L_cd_90:
L_wgw_88:
    s_barrier
    s_add_u32 s50, s43, 0
    s_add_u32 s52, s54, 0
    s_add_u32 m0, s52, 0
    s_nop 0
    buffer_load_dwordx4 v130, s[4:7], s50 offen sc1 lds
    s_add_u32 m0, s52, 1024
    s_nop 0
    buffer_load_dwordx4 v131, s[4:7], s50 offen sc1 lds
    s_add_u32 m0, s52, 2048
    s_nop 0
    buffer_load_dwordx4 v132, s[4:7], s50 offen sc1 lds
    s_add_u32 m0, s52, 3072
    s_nop 0
    buffer_load_dwordx4 v133, s[4:7], s50 offen sc1 lds
    s_add_u32 s50, s43, 128
    s_add_u32 s52, s54, 32768
    s_add_u32 m0, s52, 0
    s_nop 0
    buffer_load_dwordx4 v130, s[4:7], s50 offen sc1 lds
    s_add_u32 m0, s52, 1024
    s_nop 0
    buffer_load_dwordx4 v131, s[4:7], s50 offen sc1 lds
    s_add_u32 m0, s52, 2048
    s_nop 0
    buffer_load_dwordx4 v132, s[4:7], s50 offen sc1 lds
    s_add_u32 m0, s52, 3072
    s_nop 0
    buffer_load_dwordx4 v133, s[4:7], s50 offen sc1 lds
    s_add_u32 s50, s43, 256
    s_add_u32 s52, s54, 65536
    s_add_u32 m0, s52, 0
    s_nop 0
    buffer_load_dwordx4 v130, s[4:7], s50 offen sc1 lds
    s_add_u32 m0, s52, 1024
    s_nop 0
    buffer_load_dwordx4 v131, s[4:7], s50 offen sc1 lds
    s_add_u32 m0, s52, 2048
    s_nop 0
    buffer_load_dwordx4 v132, s[4:7], s50 offen sc1 lds
    s_add_u32 m0, s52, 3072
    s_nop 0
    buffer_load_dwordx4 v133, s[4:7], s50 offen sc1 lds
    s_add_u32 s50, s43, 384
    s_add_u32 s52, s54, 98304
    s_add_u32 m0, s52, 0
    s_nop 0
    buffer_load_dwordx4 v130, s[4:7], s50 offen sc1 lds
    s_add_u32 m0, s52, 1024
    s_nop 0
    buffer_load_dwordx4 v131, s[4:7], s50 offen sc1 lds
    s_add_u32 m0, s52, 2048
    s_nop 0
    buffer_load_dwordx4 v132, s[4:7], s50 offen sc1 lds
    s_add_u32 m0, s52, 3072
    s_nop 0
    buffer_load_dwordx4 v133, s[4:7], s50 offen sc1 lds
    s_add_u32 s50, s43, 512
    s_add_u32 s52, s54, 131072
    s_add_u32 m0, s52, 0
    s_nop 0
    buffer_load_dwordx4 v130, s[4:7], s50 offen sc1 lds
    s_add_u32 m0, s52, 1024
    s_nop 0
    buffer_load_dwordx4 v131, s[4:7], s50 offen sc1 lds
    s_add_u32 m0, s52, 2048
    s_nop 0
    buffer_load_dwordx4 v132, s[4:7], s50 offen sc1 lds
    s_add_u32 m0, s52, 3072
    s_nop 0
    buffer_load_dwordx4 v133, s[4:7], s50 offen sc1 lds
    s_add_u32 s43, s43, 128
    s_add_u32 s44, s44, 524288
    s_add_u32 s51, s51, 1
    s_cmp_ge_u32 s51, 10
    s_cmov_b32 s43, 0x40000000
    s_cmov_b32 s44, 0x40000000
    s_add_u32 s46, s46, 32768
    s_cmp_eq_u32 s46, 163840
    s_cmov_b32 s46, 0
    s_add_u32 s52, s46, s54
    s_add_u32 s53, s46, s55
    s_add_u32 s43, s43, 128
    s_add_u32 s44, s44, 524288
    s_add_u32 s51, s51, 1
    s_cmp_ge_u32 s51, 10
    s_cmov_b32 s43, 0x40000000
    s_cmov_b32 s44, 0x40000000
    s_add_u32 s46, s46, 32768
    s_cmp_eq_u32 s46, 163840
    s_cmov_b32 s46, 0
    s_add_u32 s52, s46, s54
    s_add_u32 s53, s46, s55
    s_add_u32 s43, s43, 128
    s_add_u32 s44, s44, 524288
    s_add_u32 s51, s51, 1
    s_cmp_ge_u32 s51, 10
    s_cmov_b32 s43, 0x40000000
    s_cmov_b32 s44, 0x40000000
    s_add_u32 s46, s46, 32768
    s_cmp_eq_u32 s46, 163840
    s_cmov_b32 s46, 0
    s_add_u32 s52, s46, s54
    s_add_u32 s53, s46, s55
    s_add_u32 s43, s43, 128
    s_add_u32 s44, s44, 524288
    s_add_u32 s51, s51, 1
    s_cmp_ge_u32 s51, 10
    s_cmov_b32 s43, 0x40000000
    s_cmov_b32 s44, 0x40000000
    s_add_u32 s46, s46, 32768
    s_cmp_eq_u32 s46, 163840
    s_cmov_b32 s46, 0
    s_add_u32 s52, s46, s54
    s_add_u32 s53, s46, s55
    s_add_u32 s43, s43, 128
    s_add_u32 s44, s44, 524288
    s_add_u32 s51, s51, 1
    s_cmp_ge_u32 s51, 10
    s_cmov_b32 s43, 0x40000000
    s_cmov_b32 s44, 0x40000000
    s_add_u32 s46, s46, 32768
    s_cmp_eq_u32 s46, 163840
    s_cmov_b32 s46, 0
    s_add_u32 s52, s46, s54
    s_add_u32 s53, s46, s55
    v_mov_b32 v2, 0
    v_mov_b32 v3, 0
    v_mov_b32 v4, 0
    v_mov_b32 v5, 0
    v_mov_b32 v6, 0
    v_mov_b32 v7, 0
    v_mov_b32 v8, 0
    v_mov_b32 v9, 0
    v_mov_b32 v10, 0
    v_mov_b32 v11, 0
    v_mov_b32 v12, 0
    v_mov_b32 v13, 0
    v_mov_b32 v14, 0
    v_mov_b32 v15, 0
    v_mov_b32 v16, 0
    v_mov_b32 v17, 0
    v_mov_b32 v18, 0
    v_mov_b32 v19, 0
    v_mov_b32 v20, 0
    v_mov_b32 v21, 0
    v_mov_b32 v22, 0
    v_mov_b32 v23, 0
    v_mov_b32 v24, 0
    v_mov_b32 v25, 0
    v_mov_b32 v26, 0
    v_mov_b32 v27, 0
    v_mov_b32 v28, 0
    v_mov_b32 v29, 0
    v_mov_b32 v30, 0
    v_mov_b32 v31, 0
    v_mov_b32 v32, 0
    v_mov_b32 v33, 0
    v_mov_b32 v34, 0
    v_mov_b32 v35, 0
    v_mov_b32 v36, 0
    v_mov_b32 v37, 0
    v_mov_b32 v38, 0
    v_mov_b32 v39, 0
    v_mov_b32 v40, 0
    v_mov_b32 v41, 0
    v_mov_b32 v42, 0
    v_mov_b32 v43, 0
    v_mov_b32 v44, 0
    v_mov_b32 v45, 0
    v_mov_b32 v46, 0
    v_mov_b32 v47, 0
    v_mov_b32 v48, 0
    v_mov_b32 v49, 0
    v_mov_b32 v50, 0
    v_mov_b32 v51, 0
    v_mov_b32 v52, 0
    v_mov_b32 v53, 0
    v_mov_b32 v54, 0
    v_mov_b32 v55, 0
    v_mov_b32 v56, 0
    v_mov_b32 v57, 0
    v_mov_b32 v58, 0
    v_mov_b32 v59, 0
    v_mov_b32 v60, 0
    v_mov_b32 v61, 0
    v_mov_b32 v62, 0
    v_mov_b32 v63, 0
    v_mov_b32 v64, 0
    v_mov_b32 v65, 0
    s_mov_b32 s45, 0
    s_mov_b32 s47, 0
    s_waitcnt vmcnt(16)
    s_barrier
    ds_read_b64_tr_b16 v[98:99], v140 offset:0
    ds_read_b64_tr_b16 v[100:101], v140 offset:1024
    ds_read_b64_tr_b16 v[102:103], v141 offset:0
    ds_read_b64_tr_b16 v[104:105], v141 offset:1024
    ds_read_b64_tr_b16 v[106:107], v142 offset:0
    ds_read_b64_tr_b16 v[108:109], v142 offset:1024
    ds_read_b64_tr_b16 v[110:111], v143 offset:0
    ds_read_b64_tr_b16 v[112:113], v143 offset:1024
    ds_read_b128 v[66:69], v138 offset:0
    ds_read_b128 v[70:73], v138 offset:2048
    ds_read_b128 v[74:77], v138 offset:4096
    ds_read_b128 v[78:81], v138 offset:6144
    s_waitcnt lgkmcnt(0)
    v_mfma_f32_16x16x32_bf16 v[2:5], v[98:101], v[66:69], v[2:5]
    ds_read_b64_tr_b16 v[114:115], v140 offset:8192
    v_mfma_f32_16x16x32_bf16 v[6:9], v[98:101], v[70:73], v[6:9]
    ds_read_b64_tr_b16 v[116:117], v140 offset:9216
    v_mfma_f32_16x16x32_bf16 v[10:13], v[98:101], v[74:77], v[10:13]
    ds_read_b64_tr_b16 v[118:119], v141 offset:8192
    v_mfma_f32_16x16x32_bf16 v[14:17], v[98:101], v[78:81], v[14:17]
    ds_read_b64_tr_b16 v[120:121], v141 offset:9216
    v_mfma_f32_16x16x32_bf16 v[18:21], v[102:105], v[66:69], v[18:21]
    ds_read_b64_tr_b16 v[122:123], v142 offset:8192
    v_mfma_f32_16x16x32_bf16 v[22:25], v[102:105], v[70:73], v[22:25]
    ds_read_b64_tr_b16 v[124:125], v142 offset:9216
    v_mfma_f32_16x16x32_bf16 v[26:29], v[102:105], v[74:77], v[26:29]
    ds_read_b64_tr_b16 v[126:127], v143 offset:8192
    v_mfma_f32_16x16x32_bf16 v[30:33], v[102:105], v[78:81], v[30:33]
    ds_read_b64_tr_b16 v[128:129], v143 offset:9216
    v_mfma_f32_16x16x32_bf16 v[34:37], v[106:109], v[66:69], v[34:37]
    ds_read_b128 v[82:85], v139 offset:0
    v_mfma_f32_16x16x32_bf16 v[38:41], v[106:109], v[70:73], v[38:41]
    ds_read_b128 v[86:89], v139 offset:2048
    v_mfma_f32_16x16x32_bf16 v[42:45], v[106:109], v[74:77], v[42:45]
    ds_read_b128 v[90:93], v139 offset:4096
    v_mfma_f32_16x16x32_bf16 v[46:49], v[106:109], v[78:81], v[46:49]
    ds_read_b128 v[94:97], v139 offset:6144
    v_mfma_f32_16x16x32_bf16 v[50:53], v[110:113], v[66:69], v[50:53]
    v_mfma_f32_16x16x32_bf16 v[54:57], v[110:113], v[70:73], v[54:57]
    v_mfma_f32_16x16x32_bf16 v[58:61], v[110:113], v[74:77], v[58:61]
    v_mfma_f32_16x16x32_bf16 v[62:65], v[110:113], v[78:81], v[62:65]
    s_add_u32 s47, s47, 1
    s_cmp_eq_u32 s47, 5
    s_mov_b32 s49, 32768
    s_cmov_b32 s49, 0xfffe0000
    s_cmov_b32 s47, 0
    s_waitcnt lgkmcnt(0)
    v_add_u32 v138, s49, v138
    v_add_u32 v139, s49, v139
    v_add_u32 v140, s49, v140
    v_add_u32 v141, s49, v141
    v_add_u32 v142, s49, v142
    v_add_u32 v143, s49, v143
    s_waitcnt vmcnt(12)
    s_barrier
    v_mfma_f32_16x16x32_bf16 v[2:5], v[114:117], v[82:85], v[2:5]
    ds_read_b64_tr_b16 v[98:99], v140 offset:0
    v_mfma_f32_16x16x32_bf16 v[6:9], v[114:117], v[86:89], v[6:9]
    ds_read_b64_tr_b16 v[100:101], v140 offset:1024
    s_add_u32 m0, s52, 0
    s_nop 0
    buffer_load_dwordx4 v130, s[4:7], s43 offen sc1 lds
    v_mfma_f32_16x16x32_bf16 v[10:13], v[114:117], v[90:93], v[10:13]
    ds_read_b64_tr_b16 v[102:103], v141 offset:0
    v_mfma_f32_16x16x32_bf16 v[14:17], v[114:117], v[94:97], v[14:17]
    ds_read_b64_tr_b16 v[104:105], v141 offset:1024
    s_add_u32 m0, s52, 1024
    s_nop 0
    buffer_load_dwordx4 v131, s[4:7], s43 offen sc1 lds
    v_mfma_f32_16x16x32_bf16 v[18:21], v[118:121], v[82:85], v[18:21]
    ds_read_b64_tr_b16 v[106:107], v142 offset:0
    v_mfma_f32_16x16x32_bf16 v[22:25], v[118:121], v[86:89], v[22:25]
    ds_read_b64_tr_b16 v[108:109], v142 offset:1024
    s_add_u32 m0, s52, 2048
    s_nop 0
    buffer_load_dwordx4 v132, s[4:7], s43 offen sc1 lds
    v_mfma_f32_16x16x32_bf16 v[26:29], v[118:121], v[90:93], v[26:29]
    ds_read_b64_tr_b16 v[110:111], v143 offset:0
    v_mfma_f32_16x16x32_bf16 v[30:33], v[118:121], v[94:97], v[30:33]
    ds_read_b64_tr_b16 v[112:113], v143 offset:1024
    s_add_u32 m0, s52, 3072
    s_nop 0
    buffer_load_dwordx4 v133, s[4:7], s43 offen sc1 lds
    v_mfma_f32_16x16x32_bf16 v[34:37], v[122:125], v[82:85], v[34:37]
    ds_read_b128 v[66:69], v138 offset:0
    v_mfma_f32_16x16x32_bf16 v[38:41], v[122:125], v[86:89], v[38:41]
    ds_read_b128 v[70:73], v138 offset:2048
    s_add_u32 m0, s53, 16384
    s_nop 0
    buffer_load_dwordx4 v134, s[8:11], s44 offen lds
    v_mfma_f32_16x16x32_bf16 v[42:45], v[122:125], v[90:93], v[42:45]
    ds_read_b128 v[74:77], v138 offset:4096
    v_mfma_f32_16x16x32_bf16 v[46:49], v[122:125], v[94:97], v[46:49]
    ds_read_b128 v[78:81], v138 offset:6144
    s_add_u32 m0, s53, 17408
    s_nop 0
    buffer_load_dwordx4 v135, s[8:11], s44 offen lds
    v_mfma_f32_16x16x32_bf16 v[50:53], v[126:129], v[82:85], v[50:53]
    v_mfma_f32_16x16x32_bf16 v[54:57], v[126:129], v[86:89], v[54:57]
    s_add_u32 m0, s53, 18432
    s_nop 0
    buffer_load_dwordx4 v136, s[8:11], s44 offen lds
    v_mfma_f32_16x16x32_bf16 v[58:61], v[126:129], v[90:93], v[58:61]
    v_mfma_f32_16x16x32_bf16 v[62:65], v[126:129], v[94:97], v[62:65]
    s_add_u32 m0, s53, 19456
    s_nop 0
    buffer_load_dwordx4 v137, s[8:11], s44 offen lds
    s_add_u32 s43, s43, 128
    s_add_u32 s44, s44, 524288
    s_add_u32 s46, s46, 32768
    s_cmp_eq_u32 s46, 163840
    s_cmov_b32 s46, 0
    s_add_u32 s52, s46, s54
    s_add_u32 s53, s46, s55
    s_waitcnt lgkmcnt(0)
    v_mfma_f32_16x16x32_bf16 v[2:5], v[98:101], v[66:69], v[2:5]
    ds_read_b64_tr_b16 v[114:115], v140 offset:8192
    v_mfma_f32_16x16x32_bf16 v[6:9], v[98:101], v[70:73], v[6:9]
    ds_read_b64_tr_b16 v[116:117], v140 offset:9216
    v_mfma_f32_16x16x32_bf16 v[10:13], v[98:101], v[74:77], v[10:13]
    ds_read_b64_tr_b16 v[118:119], v141 offset:8192
    v_mfma_f32_16x16x32_bf16 v[14:17], v[98:101], v[78:81], v[14:17]
    ds_read_b64_tr_b16 v[120:121], v141 offset:9216
    v_mfma_f32_16x16x32_bf16 v[18:21], v[102:105], v[66:69], v[18:21]
    ds_read_b64_tr_b16 v[122:123], v142 offset:8192
    v_mfma_f32_16x16x32_bf16 v[22:25], v[102:105], v[70:73], v[22:25]
    ds_read_b64_tr_b16 v[124:125], v142 offset:9216
    v_mfma_f32_16x16x32_bf16 v[26:29], v[102:105], v[74:77], v[26:29]
    ds_read_b64_tr_b16 v[126:127], v143 offset:8192
    v_mfma_f32_16x16x32_bf16 v[30:33], v[102:105], v[78:81], v[30:33]
    ds_read_b64_tr_b16 v[128:129], v143 offset:9216
    v_mfma_f32_16x16x32_bf16 v[34:37], v[106:109], v[66:69], v[34:37]
    ds_read_b128 v[82:85], v139 offset:0
    v_mfma_f32_16x16x32_bf16 v[38:41], v[106:109], v[70:73], v[38:41]
    ds_read_b128 v[86:89], v139 offset:2048
    v_mfma_f32_16x16x32_bf16 v[42:45], v[106:109], v[74:77], v[42:45]
    ds_read_b128 v[90:93], v139 offset:4096
    v_mfma_f32_16x16x32_bf16 v[46:49], v[106:109], v[78:81], v[46:49]
    ds_read_b128 v[94:97], v139 offset:6144
    v_mfma_f32_16x16x32_bf16 v[50:53], v[110:113], v[66:69], v[50:53]
    v_mfma_f32_16x16x32_bf16 v[54:57], v[110:113], v[70:73], v[54:57]
    v_mfma_f32_16x16x32_bf16 v[58:61], v[110:113], v[74:77], v[58:61]
    v_mfma_f32_16x16x32_bf16 v[62:65], v[110:113], v[78:81], v[62:65]
    s_add_u32 s47, s47, 1
    s_cmp_eq_u32 s47, 5
    s_mov_b32 s49, 32768
    s_cmov_b32 s49, 0xfffe0000
    s_cmov_b32 s47, 0
    s_waitcnt lgkmcnt(0)
    v_add_u32 v138, s49, v138
    v_add_u32 v139, s49, v139
    v_add_u32 v140, s49, v140
    v_add_u32 v141, s49, v141
    v_add_u32 v142, s49, v142
    v_add_u32 v143, s49, v143
    s_waitcnt vmcnt(16)
    s_barrier
    v_mfma_f32_16x16x32_bf16 v[2:5], v[114:117], v[82:85], v[2:5]
    ds_read_b64_tr_b16 v[98:99], v140 offset:0
    v_mfma_f32_16x16x32_bf16 v[6:9], v[114:117], v[86:89], v[6:9]
    ds_read_b64_tr_b16 v[100:101], v140 offset:1024
    s_add_u32 m0, s52, 0
    s_nop 0
    buffer_load_dwordx4 v130, s[4:7], s43 offen sc1 lds
    v_mfma_f32_16x16x32_bf16 v[10:13], v[114:117], v[90:93], v[10:13]
    ds_read_b64_tr_b16 v[102:103], v141 offset:0
    v_mfma_f32_16x16x32_bf16 v[14:17], v[114:117], v[94:97], v[14:17]
    ds_read_b64_tr_b16 v[104:105], v141 offset:1024
    s_add_u32 m0, s52, 1024
    s_nop 0
    buffer_load_dwordx4 v131, s[4:7], s43 offen sc1 lds
    v_mfma_f32_16x16x32_bf16 v[18:21], v[118:121], v[82:85], v[18:21]
    ds_read_b64_tr_b16 v[106:107], v142 offset:0
    v_mfma_f32_16x16x32_bf16 v[22:25], v[118:121], v[86:89], v[22:25]
    ds_read_b64_tr_b16 v[108:109], v142 offset:1024
    s_add_u32 m0, s52, 2048
    s_nop 0
    buffer_load_dwordx4 v132, s[4:7], s43 offen sc1 lds
    v_mfma_f32_16x16x32_bf16 v[26:29], v[118:121], v[90:93], v[26:29]
    ds_read_b64_tr_b16 v[110:111], v143 offset:0
    v_mfma_f32_16x16x32_bf16 v[30:33], v[118:121], v[94:97], v[30:33]
    ds_read_b64_tr_b16 v[112:113], v143 offset:1024
    s_add_u32 m0, s52, 3072
    s_nop 0
    buffer_load_dwordx4 v133, s[4:7], s43 offen sc1 lds
    v_mfma_f32_16x16x32_bf16 v[34:37], v[122:125], v[82:85], v[34:37]
    ds_read_b128 v[66:69], v138 offset:0
    v_mfma_f32_16x16x32_bf16 v[38:41], v[122:125], v[86:89], v[38:41]
    ds_read_b128 v[70:73], v138 offset:2048
    s_add_u32 m0, s53, 16384
    s_nop 0
    buffer_load_dwordx4 v134, s[8:11], s44 offen lds
    v_mfma_f32_16x16x32_bf16 v[42:45], v[122:125], v[90:93], v[42:45]
    ds_read_b128 v[74:77], v138 offset:4096
    v_mfma_f32_16x16x32_bf16 v[46:49], v[122:125], v[94:97], v[46:49]
    ds_read_b128 v[78:81], v138 offset:6144
    s_add_u32 m0, s53, 17408
    s_nop 0
    buffer_load_dwordx4 v135, s[8:11], s44 offen lds
    v_mfma_f32_16x16x32_bf16 v[50:53], v[126:129], v[82:85], v[50:53]
    v_mfma_f32_16x16x32_bf16 v[54:57], v[126:129], v[86:89], v[54:57]
    s_add_u32 m0, s53, 18432
    s_nop 0
    buffer_load_dwordx4 v136, s[8:11], s44 offen lds
    v_mfma_f32_16x16x32_bf16 v[58:61], v[126:129], v[90:93], v[58:61]
    v_mfma_f32_16x16x32_bf16 v[62:65], v[126:129], v[94:97], v[62:65]
    s_add_u32 m0, s53, 19456
    s_nop 0
    buffer_load_dwordx4 v137, s[8:11], s44 offen lds
    s_add_u32 s43, s43, 128
    s_add_u32 s44, s44, 524288
    s_add_u32 s46, s46, 32768
    s_cmp_eq_u32 s46, 163840
    s_cmov_b32 s46, 0
    s_add_u32 s52, s46, s54
    s_add_u32 s53, s46, s55
    s_waitcnt lgkmcnt(0)
    v_mfma_f32_16x16x32_bf16 v[2:5], v[98:101], v[66:69], v[2:5]
    ds_read_b64_tr_b16 v[114:115], v140 offset:8192
    v_mfma_f32_16x16x32_bf16 v[6:9], v[98:101], v[70:73], v[6:9]
    ds_read_b64_tr_b16 v[116:117], v140 offset:9216
    v_mfma_f32_16x16x32_bf16 v[10:13], v[98:101], v[74:77], v[10:13]
    ds_read_b64_tr_b16 v[118:119], v141 offset:8192
    v_mfma_f32_16x16x32_bf16 v[14:17], v[98:101], v[78:81], v[14:17]
    ds_read_b64_tr_b16 v[120:121], v141 offset:9216
    v_mfma_f32_16x16x32_bf16 v[18:21], v[102:105], v[66:69], v[18:21]
    ds_read_b64_tr_b16 v[122:123], v142 offset:8192
    v_mfma_f32_16x16x32_bf16 v[22:25], v[102:105], v[70:73], v[22:25]
    ds_read_b64_tr_b16 v[124:125], v142 offset:9216
    v_mfma_f32_16x16x32_bf16 v[26:29], v[102:105], v[74:77], v[26:29]
    ds_read_b64_tr_b16 v[126:127], v143 offset:8192
    v_mfma_f32_16x16x32_bf16 v[30:33], v[102:105], v[78:81], v[30:33]
    ds_read_b64_tr_b16 v[128:129], v143 offset:9216
    v_mfma_f32_16x16x32_bf16 v[34:37], v[106:109], v[66:69], v[34:37]
    ds_read_b128 v[82:85], v139 offset:0
    v_mfma_f32_16x16x32_bf16 v[38:41], v[106:109], v[70:73], v[38:41]
    ds_read_b128 v[86:89], v139 offset:2048
    v_mfma_f32_16x16x32_bf16 v[42:45], v[106:109], v[74:77], v[42:45]
    ds_read_b128 v[90:93], v139 offset:4096
    v_mfma_f32_16x16x32_bf16 v[46:49], v[106:109], v[78:81], v[46:49]
    ds_read_b128 v[94:97], v139 offset:6144
    v_mfma_f32_16x16x32_bf16 v[50:53], v[110:113], v[66:69], v[50:53]
    v_mfma_f32_16x16x32_bf16 v[54:57], v[110:113], v[70:73], v[54:57]
    v_mfma_f32_16x16x32_bf16 v[58:61], v[110:113], v[74:77], v[58:61]
    v_mfma_f32_16x16x32_bf16 v[62:65], v[110:113], v[78:81], v[62:65]
    s_add_u32 s47, s47, 1
    s_cmp_eq_u32 s47, 5
    s_mov_b32 s49, 32768
    s_cmov_b32 s49, 0xfffe0000
    s_cmov_b32 s47, 0
    s_waitcnt lgkmcnt(0)
    v_add_u32 v138, s49, v138
    v_add_u32 v139, s49, v139
    v_add_u32 v140, s49, v140
    v_add_u32 v141, s49, v141
    v_add_u32 v142, s49, v142
    v_add_u32 v143, s49, v143
    s_waitcnt vmcnt(20)
    s_barrier
    v_mfma_f32_16x16x32_bf16 v[2:5], v[114:117], v[82:85], v[2:5]
    ds_read_b64_tr_b16 v[98:99], v140 offset:0
    v_mfma_f32_16x16x32_bf16 v[6:9], v[114:117], v[86:89], v[6:9]
    ds_read_b64_tr_b16 v[100:101], v140 offset:1024
    s_add_u32 m0, s52, 0
    s_nop 0
    buffer_load_dwordx4 v130, s[4:7], s43 offen sc1 lds
    v_mfma_f32_16x16x32_bf16 v[10:13], v[114:117], v[90:93], v[10:13]
    ds_read_b64_tr_b16 v[102:103], v141 offset:0
    v_mfma_f32_16x16x32_bf16 v[14:17], v[114:117], v[94:97], v[14:17]
    ds_read_b64_tr_b16 v[104:105], v141 offset:1024
    s_add_u32 m0, s52, 1024
    s_nop 0
    buffer_load_dwordx4 v131, s[4:7], s43 offen sc1 lds
    v_mfma_f32_16x16x32_bf16 v[18:21], v[118:121], v[82:85], v[18:21]
    ds_read_b64_tr_b16 v[106:107], v142 offset:0
    v_mfma_f32_16x16x32_bf16 v[22:25], v[118:121], v[86:89], v[22:25]
    ds_read_b64_tr_b16 v[108:109], v142 offset:1024
    s_add_u32 m0, s52, 2048
    s_nop 0
    buffer_load_dwordx4 v132, s[4:7], s43 offen sc1 lds
    v_mfma_f32_16x16x32_bf16 v[26:29], v[118:121], v[90:93], v[26:29]
    ds_read_b64_tr_b16 v[110:111], v143 offset:0
    v_mfma_f32_16x16x32_bf16 v[30:33], v[118:121], v[94:97], v[30:33]
    ds_read_b64_tr_b16 v[112:113], v143 offset:1024
    s_add_u32 m0, s52, 3072
    s_nop 0
    buffer_load_dwordx4 v133, s[4:7], s43 offen sc1 lds
    v_mfma_f32_16x16x32_bf16 v[34:37], v[122:125], v[82:85], v[34:37]
    ds_read_b128 v[66:69], v138 offset:0
    v_mfma_f32_16x16x32_bf16 v[38:41], v[122:125], v[86:89], v[38:41]
    ds_read_b128 v[70:73], v138 offset:2048
    s_add_u32 m0, s53, 16384
    s_nop 0
    buffer_load_dwordx4 v134, s[8:11], s44 offen lds
    v_mfma_f32_16x16x32_bf16 v[42:45], v[122:125], v[90:93], v[42:45]
    ds_read_b128 v[74:77], v138 offset:4096
    v_mfma_f32_16x16x32_bf16 v[46:49], v[122:125], v[94:97], v[46:49]
    ds_read_b128 v[78:81], v138 offset:6144
    s_add_u32 m0, s53, 17408
    s_nop 0
    buffer_load_dwordx4 v135, s[8:11], s44 offen lds
    v_mfma_f32_16x16x32_bf16 v[50:53], v[126:129], v[82:85], v[50:53]
    v_mfma_f32_16x16x32_bf16 v[54:57], v[126:129], v[86:89], v[54:57]
    s_add_u32 m0, s53, 18432
    s_nop 0
    buffer_load_dwordx4 v136, s[8:11], s44 offen lds
    v_mfma_f32_16x16x32_bf16 v[58:61], v[126:129], v[90:93], v[58:61]
    v_mfma_f32_16x16x32_bf16 v[62:65], v[126:129], v[94:97], v[62:65]
    s_add_u32 m0, s53, 19456
    s_nop 0
    buffer_load_dwordx4 v137, s[8:11], s44 offen lds
    s_add_u32 s43, s43, 128
    s_add_u32 s44, s44, 524288
    s_add_u32 s46, s46, 32768
    s_cmp_eq_u32 s46, 163840
    s_cmov_b32 s46, 0
    s_add_u32 s52, s46, s54
    s_add_u32 s53, s46, s55
    s_waitcnt lgkmcnt(0)
    s_mov_b32 s45, 3
L_gk_91:
    v_mfma_f32_16x16x32_bf16 v[2:5], v[98:101], v[66:69], v[2:5]
    ds_read_b64_tr_b16 v[114:115], v140 offset:8192
    v_mfma_f32_16x16x32_bf16 v[6:9], v[98:101], v[70:73], v[6:9]
    ds_read_b64_tr_b16 v[116:117], v140 offset:9216
    v_mfma_f32_16x16x32_bf16 v[10:13], v[98:101], v[74:77], v[10:13]
    ds_read_b64_tr_b16 v[118:119], v141 offset:8192
    v_mfma_f32_16x16x32_bf16 v[14:17], v[98:101], v[78:81], v[14:17]
    ds_read_b64_tr_b16 v[120:121], v141 offset:9216
    v_mfma_f32_16x16x32_bf16 v[18:21], v[102:105], v[66:69], v[18:21]
    ds_read_b64_tr_b16 v[122:123], v142 offset:8192
    v_mfma_f32_16x16x32_bf16 v[22:25], v[102:105], v[70:73], v[22:25]
    ds_read_b64_tr_b16 v[124:125], v142 offset:9216
    v_mfma_f32_16x16x32_bf16 v[26:29], v[102:105], v[74:77], v[26:29]
    ds_read_b64_tr_b16 v[126:127], v143 offset:8192
    v_mfma_f32_16x16x32_bf16 v[30:33], v[102:105], v[78:81], v[30:33]
    ds_read_b64_tr_b16 v[128:129], v143 offset:9216
    v_mfma_f32_16x16x32_bf16 v[34:37], v[106:109], v[66:69], v[34:37]
    ds_read_b128 v[82:85], v139 offset:0
    v_mfma_f32_16x16x32_bf16 v[38:41], v[106:109], v[70:73], v[38:41]
    ds_read_b128 v[86:89], v139 offset:2048
    v_mfma_f32_16x16x32_bf16 v[42:45], v[106:109], v[74:77], v[42:45]
    ds_read_b128 v[90:93], v139 offset:4096
    v_mfma_f32_16x16x32_bf16 v[46:49], v[106:109], v[78:81], v[46:49]
    ds_read_b128 v[94:97], v139 offset:6144
    v_mfma_f32_16x16x32_bf16 v[50:53], v[110:113], v[66:69], v[50:53]
    v_mfma_f32_16x16x32_bf16 v[54:57], v[110:113], v[70:73], v[54:57]
    v_mfma_f32_16x16x32_bf16 v[58:61], v[110:113], v[74:77], v[58:61]
    v_mfma_f32_16x16x32_bf16 v[62:65], v[110:113], v[78:81], v[62:65]
    s_add_u32 s47, s47, 1
    s_cmp_eq_u32 s47, 5
    s_mov_b32 s49, 32768
    s_cmov_b32 s49, 0xfffe0000
    s_cmov_b32 s47, 0
    s_waitcnt lgkmcnt(0)
    v_add_u32 v138, s49, v138
    v_add_u32 v139, s49, v139
    v_add_u32 v140, s49, v140
    v_add_u32 v141, s49, v141
    v_add_u32 v142, s49, v142
    v_add_u32 v143, s49, v143
    s_waitcnt vmcnt(24)
    s_barrier
    v_mfma_f32_16x16x32_bf16 v[2:5], v[114:117], v[82:85], v[2:5]
    ds_read_b64_tr_b16 v[98:99], v140 offset:0
    v_mfma_f32_16x16x32_bf16 v[6:9], v[114:117], v[86:89], v[6:9]
    ds_read_b64_tr_b16 v[100:101], v140 offset:1024
    s_add_u32 m0, s52, 0
    s_nop 0
    buffer_load_dwordx4 v130, s[4:7], s43 offen sc1 lds
    v_mfma_f32_16x16x32_bf16 v[10:13], v[114:117], v[90:93], v[10:13]
    ds_read_b64_tr_b16 v[102:103], v141 offset:0
    v_mfma_f32_16x16x32_bf16 v[14:17], v[114:117], v[94:97], v[14:17]
    ds_read_b64_tr_b16 v[104:105], v141 offset:1024
    s_add_u32 m0, s52, 1024
    s_nop 0
    buffer_load_dwordx4 v131, s[4:7], s43 offen sc1 lds
    v_mfma_f32_16x16x32_bf16 v[18:21], v[118:121], v[82:85], v[18:21]
    ds_read_b64_tr_b16 v[106:107], v142 offset:0
    v_mfma_f32_16x16x32_bf16 v[22:25], v[118:121], v[86:89], v[22:25]
    ds_read_b64_tr_b16 v[108:109], v142 offset:1024
    s_add_u32 m0, s52, 2048
    s_nop 0
    buffer_load_dwordx4 v132, s[4:7], s43 offen sc1 lds
    v_mfma_f32_16x16x32_bf16 v[26:29], v[118:121], v[90:93], v[26:29]
    ds_read_b64_tr_b16 v[110:111], v143 offset:0
    v_mfma_f32_16x16x32_bf16 v[30:33], v[118:121], v[94:97], v[30:33]
    ds_read_b64_tr_b16 v[112:113], v143 offset:1024
    s_add_u32 m0, s52, 3072
    s_nop 0
    buffer_load_dwordx4 v133, s[4:7], s43 offen sc1 lds
    v_mfma_f32_16x16x32_bf16 v[34:37], v[122:125], v[82:85], v[34:37]
    ds_read_b128 v[66:69], v138 offset:0
    v_mfma_f32_16x16x32_bf16 v[38:41], v[122:125], v[86:89], v[38:41]
    ds_read_b128 v[70:73], v138 offset:2048
    s_add_u32 m0, s53, 16384
    s_nop 0
    buffer_load_dwordx4 v134, s[8:11], s44 offen lds
    v_mfma_f32_16x16x32_bf16 v[42:45], v[122:125], v[90:93], v[42:45]
    ds_read_b128 v[74:77], v138 offset:4096
    v_mfma_f32_16x16x32_bf16 v[46:49], v[122:125], v[94:97], v[46:49]
    ds_read_b128 v[78:81], v138 offset:6144
    s_add_u32 m0, s53, 17408
    s_nop 0
    buffer_load_dwordx4 v135, s[8:11], s44 offen lds
    v_mfma_f32_16x16x32_bf16 v[50:53], v[126:129], v[82:85], v[50:53]
    v_mfma_f32_16x16x32_bf16 v[54:57], v[126:129], v[86:89], v[54:57]
    s_add_u32 m0, s53, 18432
    s_nop 0
    buffer_load_dwordx4 v136, s[8:11], s44 offen lds
    v_mfma_f32_16x16x32_bf16 v[58:61], v[126:129], v[90:93], v[58:61]
    v_mfma_f32_16x16x32_bf16 v[62:65], v[126:129], v[94:97], v[62:65]
    s_add_u32 m0, s53, 19456
    s_nop 0
    buffer_load_dwordx4 v137, s[8:11], s44 offen lds
    s_add_u32 s43, s43, 128
    s_add_u32 s44, s44, 524288
    s_add_u32 s46, s46, 32768
    s_cmp_eq_u32 s46, 163840
    s_cmov_b32 s46, 0
    s_add_u32 s52, s46, s54
    s_add_u32 s53, s46, s55
    s_add_u32 s45, s45, 1
    s_cmp_lt_u32 s45, 5
    s_waitcnt lgkmcnt(0)
    s_cbranch_scc1 L_gk_91
    v_mfma_f32_16x16x32_bf16 v[2:5], v[98:101], v[66:69], v[2:5]
    ds_read_b64_tr_b16 v[114:115], v140 offset:8192
    v_mfma_f32_16x16x32_bf16 v[6:9], v[98:101], v[70:73], v[6:9]
    ds_read_b64_tr_b16 v[116:117], v140 offset:9216
    v_mfma_f32_16x16x32_bf16 v[10:13], v[98:101], v[74:77], v[10:13]
    ds_read_b64_tr_b16 v[118:119], v141 offset:8192
    v_mfma_f32_16x16x32_bf16 v[14:17], v[98:101], v[78:81], v[14:17]
    ds_read_b64_tr_b16 v[120:121], v141 offset:9216
    v_mfma_f32_16x16x32_bf16 v[18:21], v[102:105], v[66:69], v[18:21]
    ds_read_b64_tr_b16 v[122:123], v142 offset:8192
    v_mfma_f32_16x16x32_bf16 v[22:25], v[102:105], v[70:73], v[22:25]
    ds_read_b64_tr_b16 v[124:125], v142 offset:9216
    v_mfma_f32_16x16x32_bf16 v[26:29], v[102:105], v[74:77], v[26:29]
    ds_read_b64_tr_b16 v[126:127], v143 offset:8192
    v_mfma_f32_16x16x32_bf16 v[30:33], v[102:105], v[78:81], v[30:33]
    ds_read_b64_tr_b16 v[128:129], v143 offset:9216
    v_mfma_f32_16x16x32_bf16 v[34:37], v[106:109], v[66:69], v[34:37]
    ds_read_b128 v[82:85], v139 offset:0
    v_mfma_f32_16x16x32_bf16 v[38:41], v[106:109], v[70:73], v[38:41]
    ds_read_b128 v[86:89], v139 offset:2048
    v_mfma_f32_16x16x32_bf16 v[42:45], v[106:109], v[74:77], v[42:45]
    ds_read_b128 v[90:93], v139 offset:4096
    v_mfma_f32_16x16x32_bf16 v[46:49], v[106:109], v[78:81], v[46:49]
    ds_read_b128 v[94:97], v139 offset:6144
    v_mfma_f32_16x16x32_bf16 v[50:53], v[110:113], v[66:69], v[50:53]
    v_mfma_f32_16x16x32_bf16 v[54:57], v[110:113], v[70:73], v[54:57]
    v_mfma_f32_16x16x32_bf16 v[58:61], v[110:113], v[74:77], v[58:61]
    v_mfma_f32_16x16x32_bf16 v[62:65], v[110:113], v[78:81], v[62:65]
    s_add_u32 s47, s47, 1
    s_cmp_eq_u32 s47, 5
    s_mov_b32 s49, 32768
    s_cmov_b32 s49, 0xfffe0000
    s_cmov_b32 s47, 0
    s_waitcnt lgkmcnt(0)
    v_add_u32 v138, s49, v138
    v_add_u32 v139, s49, v139
    v_add_u32 v140, s49, v140
    v_add_u32 v141, s49, v141
    v_add_u32 v142, s49, v142
    v_add_u32 v143, s49, v143
    s_waitcnt vmcnt(24)
    s_barrier
    v_mfma_f32_16x16x32_bf16 v[2:5], v[114:117], v[82:85], v[2:5]
    ds_read_b64_tr_b16 v[98:99], v140 offset:0
    v_mfma_f32_16x16x32_bf16 v[6:9], v[114:117], v[86:89], v[6:9]
    ds_read_b64_tr_b16 v[100:101], v140 offset:1024
    v_mfma_f32_16x16x32_bf16 v[10:13], v[114:117], v[90:93], v[10:13]
    ds_read_b64_tr_b16 v[102:103], v141 offset:0
    v_mfma_f32_16x16x32_bf16 v[14:17], v[114:117], v[94:97], v[14:17]
    ds_read_b64_tr_b16 v[104:105], v141 offset:1024
    v_mfma_f32_16x16x32_bf16 v[18:21], v[118:121], v[82:85], v[18:21]
    ds_read_b64_tr_b16 v[106:107], v142 offset:0
    v_mfma_f32_16x16x32_bf16 v[22:25], v[118:121], v[86:89], v[22:25]
    ds_read_b64_tr_b16 v[108:109], v142 offset:1024
    v_mfma_f32_16x16x32_bf16 v[26:29], v[118:121], v[90:93], v[26:29]
    ds_read_b64_tr_b16 v[110:111], v143 offset:0
    v_mfma_f32_16x16x32_bf16 v[30:33], v[118:121], v[94:97], v[30:33]
    ds_read_b64_tr_b16 v[112:113], v143 offset:1024
    v_mfma_f32_16x16x32_bf16 v[34:37], v[122:125], v[82:85], v[34:37]
    ds_read_b128 v[66:69], v138 offset:0
    v_mfma_f32_16x16x32_bf16 v[38:41], v[122:125], v[86:89], v[38:41]
    ds_read_b128 v[70:73], v138 offset:2048
    v_mfma_f32_16x16x32_bf16 v[42:45], v[122:125], v[90:93], v[42:45]
    ds_read_b128 v[74:77], v138 offset:4096
    v_mfma_f32_16x16x32_bf16 v[46:49], v[122:125], v[94:97], v[46:49]
    ds_read_b128 v[78:81], v138 offset:6144
    v_mfma_f32_16x16x32_bf16 v[50:53], v[126:129], v[82:85], v[50:53]
    v_mfma_f32_16x16x32_bf16 v[54:57], v[126:129], v[86:89], v[54:57]
    v_mfma_f32_16x16x32_bf16 v[58:61], v[126:129], v[90:93], v[58:61]
    v_mfma_f32_16x16x32_bf16 v[62:65], v[126:129], v[94:97], v[62:65]
    s_waitcnt lgkmcnt(0)
    v_mfma_f32_16x16x32_bf16 v[2:5], v[98:101], v[66:69], v[2:5]
    ds_read_b64_tr_b16 v[114:115], v140 offset:8192
    v_mfma_f32_16x16x32_bf16 v[6:9], v[98:101], v[70:73], v[6:9]
    ds_read_b64_tr_b16 v[116:117], v140 offset:9216
    v_mfma_f32_16x16x32_bf16 v[10:13], v[98:101], v[74:77], v[10:13]
    ds_read_b64_tr_b16 v[118:119], v141 offset:8192
    v_mfma_f32_16x16x32_bf16 v[14:17], v[98:101], v[78:81], v[14:17]
    ds_read_b64_tr_b16 v[120:121], v141 offset:9216
    v_mfma_f32_16x16x32_bf16 v[18:21], v[102:105], v[66:69], v[18:21]
    ds_read_b64_tr_b16 v[122:123], v142 offset:8192
    v_mfma_f32_16x16x32_bf16 v[22:25], v[102:105], v[70:73], v[22:25]
    ds_read_b64_tr_b16 v[124:125], v142 offset:9216
    v_mfma_f32_16x16x32_bf16 v[26:29], v[102:105], v[74:77], v[26:29]
    ds_read_b64_tr_b16 v[126:127], v143 offset:8192
    v_mfma_f32_16x16x32_bf16 v[30:33], v[102:105], v[78:81], v[30:33]
    ds_read_b64_tr_b16 v[128:129], v143 offset:9216
    v_mfma_f32_16x16x32_bf16 v[34:37], v[106:109], v[66:69], v[34:37]
    ds_read_b128 v[82:85], v139 offset:0
    v_mfma_f32_16x16x32_bf16 v[38:41], v[106:109], v[70:73], v[38:41]
    ds_read_b128 v[86:89], v139 offset:2048
    v_mfma_f32_16x16x32_bf16 v[42:45], v[106:109], v[74:77], v[42:45]
    ds_read_b128 v[90:93], v139 offset:4096
    v_mfma_f32_16x16x32_bf16 v[46:49], v[106:109], v[78:81], v[46:49]
    ds_read_b128 v[94:97], v139 offset:6144
    v_mfma_f32_16x16x32_bf16 v[50:53], v[110:113], v[66:69], v[50:53]
    v_mfma_f32_16x16x32_bf16 v[54:57], v[110:113], v[70:73], v[54:57]
    v_mfma_f32_16x16x32_bf16 v[58:61], v[110:113], v[74:77], v[58:61]
    v_mfma_f32_16x16x32_bf16 v[62:65], v[110:113], v[78:81], v[62:65]
    s_add_u32 s47, s47, 1
    s_cmp_eq_u32 s47, 5
    s_mov_b32 s49, 32768
    s_cmov_b32 s49, 0xfffe0000
    s_cmov_b32 s47, 0
    s_waitcnt lgkmcnt(0)
    v_add_u32 v138, s49, v138
    v_add_u32 v139, s49, v139
    v_add_u32 v140, s49, v140
    v_add_u32 v141, s49, v141
    v_add_u32 v142, s49, v142
    v_add_u32 v143, s49, v143
    s_waitcnt vmcnt(16)
    s_barrier
    v_mfma_f32_16x16x32_bf16 v[2:5], v[114:117], v[82:85], v[2:5]
    ds_read_b64_tr_b16 v[98:99], v140 offset:0
    v_mfma_f32_16x16x32_bf16 v[6:9], v[114:117], v[86:89], v[6:9]
    ds_read_b64_tr_b16 v[100:101], v140 offset:1024
    v_mfma_f32_16x16x32_bf16 v[10:13], v[114:117], v[90:93], v[10:13]
    ds_read_b64_tr_b16 v[102:103], v141 offset:0
    v_mfma_f32_16x16x32_bf16 v[14:17], v[114:117], v[94:97], v[14:17]
    ds_read_b64_tr_b16 v[104:105], v141 offset:1024
    v_mfma_f32_16x16x32_bf16 v[18:21], v[118:121], v[82:85], v[18:21]
    ds_read_b64_tr_b16 v[106:107], v142 offset:0
    v_mfma_f32_16x16x32_bf16 v[22:25], v[118:121], v[86:89], v[22:25]
    ds_read_b64_tr_b16 v[108:109], v142 offset:1024
    v_mfma_f32_16x16x32_bf16 v[26:29], v[118:121], v[90:93], v[26:29]
    ds_read_b64_tr_b16 v[110:111], v143 offset:0
    v_mfma_f32_16x16x32_bf16 v[30:33], v[118:121], v[94:97], v[30:33]
    ds_read_b64_tr_b16 v[112:113], v143 offset:1024
    v_mfma_f32_16x16x32_bf16 v[34:37], v[122:125], v[82:85], v[34:37]
    ds_read_b128 v[66:69], v138 offset:0
    v_mfma_f32_16x16x32_bf16 v[38:41], v[122:125], v[86:89], v[38:41]
    ds_read_b128 v[70:73], v138 offset:2048
    v_mfma_f32_16x16x32_bf16 v[42:45], v[122:125], v[90:93], v[42:45]
    ds_read_b128 v[74:77], v138 offset:4096
    v_mfma_f32_16x16x32_bf16 v[46:49], v[122:125], v[94:97], v[46:49]
    ds_read_b128 v[78:81], v138 offset:6144
    v_mfma_f32_16x16x32_bf16 v[50:53], v[126:129], v[82:85], v[50:53]
    v_mfma_f32_16x16x32_bf16 v[54:57], v[126:129], v[86:89], v[54:57]
    v_mfma_f32_16x16x32_bf16 v[58:61], v[126:129], v[90:93], v[58:61]
    v_mfma_f32_16x16x32_bf16 v[62:65], v[126:129], v[94:97], v[62:65]
    s_waitcnt lgkmcnt(0)
    v_mfma_f32_16x16x32_bf16 v[2:5], v[98:101], v[66:69], v[2:5]
    ds_read_b64_tr_b16 v[114:115], v140 offset:8192
    v_mfma_f32_16x16x32_bf16 v[6:9], v[98:101], v[70:73], v[6:9]
    ds_read_b64_tr_b16 v[116:117], v140 offset:9216
    v_mfma_f32_16x16x32_bf16 v[10:13], v[98:101], v[74:77], v[10:13]
    ds_read_b64_tr_b16 v[118:119], v141 offset:8192
    v_mfma_f32_16x16x32_bf16 v[14:17], v[98:101], v[78:81], v[14:17]
    ds_read_b64_tr_b16 v[120:121], v141 offset:9216
    v_mfma_f32_16x16x32_bf16 v[18:21], v[102:105], v[66:69], v[18:21]
    ds_read_b64_tr_b16 v[122:123], v142 offset:8192
    v_mfma_f32_16x16x32_bf16 v[22:25], v[102:105], v[70:73], v[22:25]
    ds_read_b64_tr_b16 v[124:125], v142 offset:9216
    v_mfma_f32_16x16x32_bf16 v[26:29], v[102:105], v[74:77], v[26:29]
    ds_read_b64_tr_b16 v[126:127], v143 offset:8192
    v_mfma_f32_16x16x32_bf16 v[30:33], v[102:105], v[78:81], v[30:33]
    ds_read_b64_tr_b16 v[128:129], v143 offset:9216
    v_mfma_f32_16x16x32_bf16 v[34:37], v[106:109], v[66:69], v[34:37]
    ds_read_b128 v[82:85], v139 offset:0
    v_mfma_f32_16x16x32_bf16 v[38:41], v[106:109], v[70:73], v[38:41]
    ds_read_b128 v[86:89], v139 offset:2048
    v_mfma_f32_16x16x32_bf16 v[42:45], v[106:109], v[74:77], v[42:45]
    ds_read_b128 v[90:93], v139 offset:4096
    v_mfma_f32_16x16x32_bf16 v[46:49], v[106:109], v[78:81], v[46:49]
    ds_read_b128 v[94:97], v139 offset:6144
    v_mfma_f32_16x16x32_bf16 v[50:53], v[110:113], v[66:69], v[50:53]
    v_mfma_f32_16x16x32_bf16 v[54:57], v[110:113], v[70:73], v[54:57]
    v_mfma_f32_16x16x32_bf16 v[58:61], v[110:113], v[74:77], v[58:61]
    v_mfma_f32_16x16x32_bf16 v[62:65], v[110:113], v[78:81], v[62:65]
    s_add_u32 s47, s47, 1
    s_cmp_eq_u32 s47, 5
    s_mov_b32 s49, 32768
    s_cmov_b32 s49, 0xfffe0000
    s_cmov_b32 s47, 0
    s_waitcnt lgkmcnt(0)
    v_add_u32 v138, s49, v138
    v_add_u32 v139, s49, v139
    v_add_u32 v140, s49, v140
    v_add_u32 v141, s49, v141
    v_add_u32 v142, s49, v142
    v_add_u32 v143, s49, v143
    s_waitcnt vmcnt(8)
    s_barrier
    v_mfma_f32_16x16x32_bf16 v[2:5], v[114:117], v[82:85], v[2:5]
    ds_read_b64_tr_b16 v[98:99], v140 offset:0
    v_mfma_f32_16x16x32_bf16 v[6:9], v[114:117], v[86:89], v[6:9]
    ds_read_b64_tr_b16 v[100:101], v140 offset:1024
    v_mfma_f32_16x16x32_bf16 v[10:13], v[114:117], v[90:93], v[10:13]
    ds_read_b64_tr_b16 v[102:103], v141 offset:0
    v_mfma_f32_16x16x32_bf16 v[14:17], v[114:117], v[94:97], v[14:17]
    ds_read_b64_tr_b16 v[104:105], v141 offset:1024
    v_mfma_f32_16x16x32_bf16 v[18:21], v[118:121], v[82:85], v[18:21]
    ds_read_b64_tr_b16 v[106:107], v142 offset:0
    v_mfma_f32_16x16x32_bf16 v[22:25], v[118:121], v[86:89], v[22:25]
    ds_read_b64_tr_b16 v[108:109], v142 offset:1024
    v_mfma_f32_16x16x32_bf16 v[26:29], v[118:121], v[90:93], v[26:29]
    ds_read_b64_tr_b16 v[110:111], v143 offset:0
    v_mfma_f32_16x16x32_bf16 v[30:33], v[118:121], v[94:97], v[30:33]
    ds_read_b64_tr_b16 v[112:113], v143 offset:1024
    v_mfma_f32_16x16x32_bf16 v[34:37], v[122:125], v[82:85], v[34:37]
    ds_read_b128 v[66:69], v138 offset:0
    v_mfma_f32_16x16x32_bf16 v[38:41], v[122:125], v[86:89], v[38:41]
    ds_read_b128 v[70:73], v138 offset:2048
    v_mfma_f32_16x16x32_bf16 v[42:45], v[122:125], v[90:93], v[42:45]
    ds_read_b128 v[74:77], v138 offset:4096
    v_mfma_f32_16x16x32_bf16 v[46:49], v[122:125], v[94:97], v[46:49]
    ds_read_b128 v[78:81], v138 offset:6144
    v_mfma_f32_16x16x32_bf16 v[50:53], v[126:129], v[82:85], v[50:53]
    v_mfma_f32_16x16x32_bf16 v[54:57], v[126:129], v[86:89], v[54:57]
    v_mfma_f32_16x16x32_bf16 v[58:61], v[126:129], v[90:93], v[58:61]
    v_mfma_f32_16x16x32_bf16 v[62:65], v[126:129], v[94:97], v[62:65]
    s_waitcnt lgkmcnt(0)
    v_mfma_f32_16x16x32_bf16 v[2:5], v[98:101], v[66:69], v[2:5]
    ds_read_b64_tr_b16 v[114:115], v140 offset:8192
    v_mfma_f32_16x16x32_bf16 v[6:9], v[98:101], v[70:73], v[6:9]
    ds_read_b64_tr_b16 v[116:117], v140 offset:9216
    v_mfma_f32_16x16x32_bf16 v[10:13], v[98:101], v[74:77], v[10:13]
    ds_read_b64_tr_b16 v[118:119], v141 offset:8192
    v_mfma_f32_16x16x32_bf16 v[14:17], v[98:101], v[78:81], v[14:17]
    ds_read_b64_tr_b16 v[120:121], v141 offset:9216
    v_mfma_f32_16x16x32_bf16 v[18:21], v[102:105], v[66:69], v[18:21]
    ds_read_b64_tr_b16 v[122:123], v142 offset:8192
    v_mfma_f32_16x16x32_bf16 v[22:25], v[102:105], v[70:73], v[22:25]
    ds_read_b64_tr_b16 v[124:125], v142 offset:9216
    v_mfma_f32_16x16x32_bf16 v[26:29], v[102:105], v[74:77], v[26:29]
    ds_read_b64_tr_b16 v[126:127], v143 offset:8192
    v_mfma_f32_16x16x32_bf16 v[30:33], v[102:105], v[78:81], v[30:33]
    ds_read_b64_tr_b16 v[128:129], v143 offset:9216
    v_mfma_f32_16x16x32_bf16 v[34:37], v[106:109], v[66:69], v[34:37]
    ds_read_b128 v[82:85], v139 offset:0
    v_mfma_f32_16x16x32_bf16 v[38:41], v[106:109], v[70:73], v[38:41]
    ds_read_b128 v[86:89], v139 offset:2048
    v_mfma_f32_16x16x32_bf16 v[42:45], v[106:109], v[74:77], v[42:45]
    ds_read_b128 v[90:93], v139 offset:4096
    v_mfma_f32_16x16x32_bf16 v[46:49], v[106:109], v[78:81], v[46:49]
    ds_read_b128 v[94:97], v139 offset:6144
    v_mfma_f32_16x16x32_bf16 v[50:53], v[110:113], v[66:69], v[50:53]
    v_mfma_f32_16x16x32_bf16 v[54:57], v[110:113], v[70:73], v[54:57]
    v_mfma_f32_16x16x32_bf16 v[58:61], v[110:113], v[74:77], v[58:61]
    v_mfma_f32_16x16x32_bf16 v[62:65], v[110:113], v[78:81], v[62:65]
    s_add_u32 s47, s47, 1
    s_cmp_eq_u32 s47, 5
    s_mov_b32 s49, 32768
    s_cmov_b32 s49, 0xfffe0000
    s_cmov_b32 s47, 0
    s_waitcnt lgkmcnt(0)
    v_add_u32 v138, s49, v138
    v_add_u32 v139, s49, v139
    v_add_u32 v140, s49, v140
    v_add_u32 v141, s49, v141
    v_add_u32 v142, s49, v142
    v_add_u32 v143, s49, v143
    s_waitcnt vmcnt(0)
    s_barrier
    v_mfma_f32_16x16x32_bf16 v[2:5], v[114:117], v[82:85], v[2:5]
    ds_read_b64_tr_b16 v[98:99], v140 offset:0
    v_mfma_f32_16x16x32_bf16 v[6:9], v[114:117], v[86:89], v[6:9]
    ds_read_b64_tr_b16 v[100:101], v140 offset:1024
    v_mfma_f32_16x16x32_bf16 v[10:13], v[114:117], v[90:93], v[10:13]
    ds_read_b64_tr_b16 v[102:103], v141 offset:0
    v_mfma_f32_16x16x32_bf16 v[14:17], v[114:117], v[94:97], v[14:17]
    ds_read_b64_tr_b16 v[104:105], v141 offset:1024
    v_mfma_f32_16x16x32_bf16 v[18:21], v[118:121], v[82:85], v[18:21]
    ds_read_b64_tr_b16 v[106:107], v142 offset:0
    v_mfma_f32_16x16x32_bf16 v[22:25], v[118:121], v[86:89], v[22:25]
    ds_read_b64_tr_b16 v[108:109], v142 offset:1024
    v_mfma_f32_16x16x32_bf16 v[26:29], v[118:121], v[90:93], v[26:29]
    ds_read_b64_tr_b16 v[110:111], v143 offset:0
    v_mfma_f32_16x16x32_bf16 v[30:33], v[118:121], v[94:97], v[30:33]
    ds_read_b64_tr_b16 v[112:113], v143 offset:1024
    v_mfma_f32_16x16x32_bf16 v[34:37], v[122:125], v[82:85], v[34:37]
    ds_read_b128 v[66:69], v138 offset:0
    v_mfma_f32_16x16x32_bf16 v[38:41], v[122:125], v[86:89], v[38:41]
    ds_read_b128 v[70:73], v138 offset:2048
    v_mfma_f32_16x16x32_bf16 v[42:45], v[122:125], v[90:93], v[42:45]
    ds_read_b128 v[74:77], v138 offset:4096
    v_mfma_f32_16x16x32_bf16 v[46:49], v[122:125], v[94:97], v[46:49]
    ds_read_b128 v[78:81], v138 offset:6144
    v_mfma_f32_16x16x32_bf16 v[50:53], v[126:129], v[82:85], v[50:53]
    v_mfma_f32_16x16x32_bf16 v[54:57], v[126:129], v[86:89], v[54:57]
    v_mfma_f32_16x16x32_bf16 v[58:61], v[126:129], v[90:93], v[58:61]
    v_mfma_f32_16x16x32_bf16 v[62:65], v[126:129], v[94:97], v[62:65]
    s_waitcnt lgkmcnt(0)
    v_mfma_f32_16x16x32_bf16 v[2:5], v[98:101], v[66:69], v[2:5]
    ds_read_b64_tr_b16 v[114:115], v140 offset:8192
    v_mfma_f32_16x16x32_bf16 v[6:9], v[98:101], v[70:73], v[6:9]
    ds_read_b64_tr_b16 v[116:117], v140 offset:9216
    v_mfma_f32_16x16x32_bf16 v[10:13], v[98:101], v[74:77], v[10:13]
    ds_read_b64_tr_b16 v[118:119], v141 offset:8192
    v_mfma_f32_16x16x32_bf16 v[14:17], v[98:101], v[78:81], v[14:17]
    ds_read_b64_tr_b16 v[120:121], v141 offset:9216
    v_mfma_f32_16x16x32_bf16 v[18:21], v[102:105], v[66:69], v[18:21]
    ds_read_b64_tr_b16 v[122:123], v142 offset:8192
    v_mfma_f32_16x16x32_bf16 v[22:25], v[102:105], v[70:73], v[22:25]
    ds_read_b64_tr_b16 v[124:125], v142 offset:9216
    v_mfma_f32_16x16x32_bf16 v[26:29], v[102:105], v[74:77], v[26:29]
    ds_read_b64_tr_b16 v[126:127], v143 offset:8192
    v_mfma_f32_16x16x32_bf16 v[30:33], v[102:105], v[78:81], v[30:33]
    ds_read_b64_tr_b16 v[128:129], v143 offset:9216
    v_mfma_f32_16x16x32_bf16 v[34:37], v[106:109], v[66:69], v[34:37]
    ds_read_b128 v[82:85], v139 offset:0
    v_mfma_f32_16x16x32_bf16 v[38:41], v[106:109], v[70:73], v[38:41]
    ds_read_b128 v[86:89], v139 offset:2048
    v_mfma_f32_16x16x32_bf16 v[42:45], v[106:109], v[74:77], v[42:45]
    ds_read_b128 v[90:93], v139 offset:4096
    v_mfma_f32_16x16x32_bf16 v[46:49], v[106:109], v[78:81], v[46:49]
    ds_read_b128 v[94:97], v139 offset:6144
    v_mfma_f32_16x16x32_bf16 v[50:53], v[110:113], v[66:69], v[50:53]
    v_mfma_f32_16x16x32_bf16 v[54:57], v[110:113], v[70:73], v[54:57]
    v_mfma_f32_16x16x32_bf16 v[58:61], v[110:113], v[74:77], v[58:61]
    v_mfma_f32_16x16x32_bf16 v[62:65], v[110:113], v[78:81], v[62:65]
    s_waitcnt lgkmcnt(0)
    v_mfma_f32_16x16x32_bf16 v[2:5], v[114:117], v[82:85], v[2:5]
    v_mfma_f32_16x16x32_bf16 v[6:9], v[114:117], v[86:89], v[6:9]
    v_mfma_f32_16x16x32_bf16 v[10:13], v[114:117], v[90:93], v[10:13]
    v_mfma_f32_16x16x32_bf16 v[14:17], v[114:117], v[94:97], v[14:17]
    v_mfma_f32_16x16x32_bf16 v[18:21], v[118:121], v[82:85], v[18:21]
    v_mfma_f32_16x16x32_bf16 v[22:25], v[118:121], v[86:89], v[22:25]
    v_mfma_f32_16x16x32_bf16 v[26:29], v[118:121], v[90:93], v[26:29]
    v_mfma_f32_16x16x32_bf16 v[30:33], v[118:121], v[94:97], v[30:33]
    v_mfma_f32_16x16x32_bf16 v[34:37], v[122:125], v[82:85], v[34:37]
    v_mfma_f32_16x16x32_bf16 v[38:41], v[122:125], v[86:89], v[38:41]
    v_mfma_f32_16x16x32_bf16 v[42:45], v[122:125], v[90:93], v[42:45]
    v_mfma_f32_16x16x32_bf16 v[46:49], v[122:125], v[94:97], v[46:49]
    v_mfma_f32_16x16x32_bf16 v[50:53], v[126:129], v[82:85], v[50:53]
    v_mfma_f32_16x16x32_bf16 v[54:57], v[126:129], v[86:89], v[54:57]
    v_mfma_f32_16x16x32_bf16 v[58:61], v[126:129], v[90:93], v[58:61]
    v_mfma_f32_16x16x32_bf16 v[62:65], v[126:129], v[94:97], v[62:65]
    s_waitcnt vmcnt(0)
    s_nop 7
    s_nop 3
    s_barrier
    s_mul_i32 s48, s40, 9216
    s_add_u32 s48, s48, 0
    v_mul_u32_u24 v148, 144, v145
    v_lshl_add_u32 v148, v146, 3, v148
    v_add_u32 v148, s48, v148
    v_cvt_pk_bf16_f32 v2, v2, v3
    v_cvt_pk_bf16_f32 v3, v4, v5
    ds_write_b64 v148, v[2:3] offset:0
    v_cvt_pk_bf16_f32 v6, v6, v7
    v_cvt_pk_bf16_f32 v7, v8, v9
    ds_write_b64 v148, v[6:7] offset:2304
    v_cvt_pk_bf16_f32 v10, v10, v11
    v_cvt_pk_bf16_f32 v11, v12, v13
    ds_write_b64 v148, v[10:11] offset:4608
    v_cvt_pk_bf16_f32 v14, v14, v15
    v_cvt_pk_bf16_f32 v15, v16, v17
    ds_write_b64 v148, v[14:15] offset:6912
    v_cvt_pk_bf16_f32 v18, v18, v19
    v_cvt_pk_bf16_f32 v19, v20, v21
    ds_write_b64 v148, v[18:19] offset:32
    v_cvt_pk_bf16_f32 v22, v22, v23
    v_cvt_pk_bf16_f32 v23, v24, v25
    ds_write_b64 v148, v[22:23] offset:2336
    v_cvt_pk_bf16_f32 v26, v26, v27
    v_cvt_pk_bf16_f32 v27, v28, v29
    ds_write_b64 v148, v[26:27] offset:4640
    v_cvt_pk_bf16_f32 v30, v30, v31
    v_cvt_pk_bf16_f32 v31, v32, v33
    ds_write_b64 v148, v[30:31] offset:6944
    v_cvt_pk_bf16_f32 v34, v34, v35
    v_cvt_pk_bf16_f32 v35, v36, v37
    ds_write_b64 v148, v[34:35] offset:64
    v_cvt_pk_bf16_f32 v38, v38, v39
    v_cvt_pk_bf16_f32 v39, v40, v41
    ds_write_b64 v148, v[38:39] offset:2368
    v_cvt_pk_bf16_f32 v42, v42, v43
    v_cvt_pk_bf16_f32 v43, v44, v45
    ds_write_b64 v148, v[42:43] offset:4672
    v_cvt_pk_bf16_f32 v46, v46, v47
    v_cvt_pk_bf16_f32 v47, v48, v49
    ds_write_b64 v148, v[46:47] offset:6976
    v_cvt_pk_bf16_f32 v50, v50, v51
    v_cvt_pk_bf16_f32 v51, v52, v53
    ds_write_b64 v148, v[50:51] offset:96
    v_cvt_pk_bf16_f32 v54, v54, v55
    v_cvt_pk_bf16_f32 v55, v56, v57
    ds_write_b64 v148, v[54:55] offset:2400
    v_cvt_pk_bf16_f32 v58, v58, v59
    v_cvt_pk_bf16_f32 v59, v60, v61
    ds_write_b64 v148, v[58:59] offset:4704
    v_cvt_pk_bf16_f32 v62, v62, v63
    v_cvt_pk_bf16_f32 v63, v64, v65
    ds_write_b64 v148, v[62:63] offset:7008
    v_lshrrev_b32 v149, 3, v144
    v_and_b32 v150, 7, v144
    s_mov_b32 s50, 8192
    v_mul_lo_u32 v151, v149, s50
    v_mul_u32_u24 v149, 144, v149
    v_lshl_add_u32 v149, v150, 4, v149
    v_add_u32 v149, s48, v149
    v_lshl_add_u32 v150, v150, 4, v151
    s_mul_i32 s48, s41, 524288
    s_mul_i32 s49, s42, 128
    s_add_u32 s48, s48, s49
    s_add_u32 s48, s48, s16
    s_waitcnt lgkmcnt(0)
    ds_read_b128 v[2:5], v149 offset:0
    ds_read_b128 v[6:9], v149 offset:1152
    ds_read_b128 v[10:13], v149 offset:2304
    ds_read_b128 v[14:17], v149 offset:3456
    ds_read_b128 v[18:21], v149 offset:4608
    ds_read_b128 v[22:25], v149 offset:5760
    ds_read_b128 v[26:29], v149 offset:6912
    ds_read_b128 v[30:33], v149 offset:8064
    s_waitcnt lgkmcnt(7)
    buffer_store_dwordx4 v[2:5], v150, s[4:7], s48 offen sc1
    s_add_u32 s48, s48, 65536
    s_waitcnt lgkmcnt(6)
    buffer_store_dwordx4 v[6:9], v150, s[4:7], s48 offen sc1
    s_add_u32 s48, s48, 65536
    s_waitcnt lgkmcnt(5)
    buffer_store_dwordx4 v[10:13], v150, s[4:7], s48 offen sc1
    s_add_u32 s48, s48, 65536
    s_waitcnt lgkmcnt(4)
    buffer_store_dwordx4 v[14:17], v150, s[4:7], s48 offen sc1
    s_add_u32 s48, s48, 65536
    s_waitcnt lgkmcnt(3)
    buffer_store_dwordx4 v[18:21], v150, s[4:7], s48 offen sc1
    s_add_u32 s48, s48, 65536
    s_waitcnt lgkmcnt(2)
    buffer_store_dwordx4 v[22:25], v150, s[4:7], s48 offen sc1
    s_add_u32 s48, s48, 65536
    s_waitcnt lgkmcnt(1)
    buffer_store_dwordx4 v[26:29], v150, s[4:7], s48 offen sc1
    s_add_u32 s48, s48, 65536
    s_waitcnt lgkmcnt(0)
    buffer_store_dwordx4 v[30:33], v150, s[4:7], s48 offen sc1
    s_add_u32 s48, s48, 65536
    v_subrev_u32 v138, 131072, v138
    v_subrev_u32 v139, 131072, v139
    v_subrev_u32 v140, 131072, v140
    v_subrev_u32 v141, 131072, v141
    v_subrev_u32 v142, 131072, v142
    v_subrev_u32 v143, 131072, v143
    s_cmp_eq_u32 s82, 0
    s_cselect_b32 s77, 16, 0
    s_add_u32 s77, s77, s74
    s_lshl_b32 s77, s77, 7
    s_add_u32 s77, s77, 786432
    s_waitcnt vmcnt(0)
    s_barrier
    s_cmp_lg_u32 s26, 0
    s_cbranch_scc1 L_sig_92
    v_mov_b32 v1, 0
    v_mov_b32 v2, 1
    s_mov_b64 exec, 1
    buffer_atomic_add v2, v1, s[4:7], s77 offen
    s_mov_b64 exec, -1
L_sig_92:
    s_lshl_b32 s80, s71, 3
    s_and_b32 s81, s72, 7
    s_add_u32 s80, s80, s81
    s_lshr_b32 s82, s80, 4
    s_lshl_b32 s83, s82, 3
    s_add_u32 s83, s83, 16
    s_load_dwordx2 s[8:9], s[0:1], s83
    s_and_b32 s80, s80, 15
    v_and_b32 v248, 63, v0
    v_and_b32 v249, 15, v248
    v_lshrrev_b32 v250, 4, v248
    v_lshrrev_b32 v251, 6, v0
    s_nop 0
    v_readfirstlane_b32 s40, v251
    s_nop 0
    s_and_b32 s41, s40, 1
    s_lshr_b32 s42, s40, 1
    s_waitcnt lgkmcnt(0)
    s_and_b32 s9, s9, 0xffff
    s_mov_b32 s10, 5242880
    s_mov_b32 s11, 0x20000
    s_mul_i32 s48, s40, 4
    s_add_u32 s48, s48, 0
    v_lshrrev_b32 v252, 3, v248
    s_lshl_b32 s49, s48, 3
    v_add_u32 v252, s49, v252
    v_and_b32 v253, 7, v248
    v_bfe_u32 v254, v252, 1, 3
    v_xor_b32 v253, v253, v254
    s_mov_b32 s49, 1280
    v_mul_lo_u32 v252, v252, s49
    v_lshl_add_u32 v226, v253, 4, v252
    s_mul_i32 s48, s40, 4
    s_add_u32 s48, s48, 1
    v_lshrrev_b32 v252, 3, v248
    s_lshl_b32 s49, s48, 3
    v_add_u32 v252, s49, v252
    v_and_b32 v253, 7, v248
    v_bfe_u32 v254, v252, 1, 3
    v_xor_b32 v253, v253, v254
    s_mov_b32 s49, 1280
    v_mul_lo_u32 v252, v252, s49
    v_lshl_add_u32 v227, v253, 4, v252
    s_mul_i32 s48, s40, 4
    s_add_u32 s48, s48, 2
    v_lshrrev_b32 v252, 3, v248
    s_lshl_b32 s49, s48, 3
    v_add_u32 v252, s49, v252
    v_and_b32 v253, 7, v248
    v_bfe_u32 v254, v252, 1, 3
    v_xor_b32 v253, v253, v254
    s_mov_b32 s49, 1280
    v_mul_lo_u32 v252, v252, s49
    v_lshl_add_u32 v228, v253, 4, v252
    s_mul_i32 s48, s40, 4
    s_add_u32 s48, s48, 3
    v_lshrrev_b32 v252, 3, v248
    s_lshl_b32 s49, s48, 3
    v_add_u32 v252, s49, v252
    v_and_b32 v253, 7, v248
    v_bfe_u32 v254, v252, 1, 3
    v_xor_b32 v253, v253, v254
    s_mov_b32 s49, 1280
    v_mul_lo_u32 v252, v252, s49
    v_lshl_add_u32 v229, v253, 4, v252
    s_mul_i32 s48, s40, 8
    s_add_u32 s48, s48, 0
    v_lshrrev_b32 v252, 5, v248
    s_mul_i32 s49, s48, 2
    v_add_u32 v252, s49, v252
    v_and_b32 v253, 31, v248
    v_and_b32 v254, 3, v252
    v_bfe_u32 v255, v252, 3, 1
    v_lshl_add_u32 v254, v255, 2, v254
    v_lshlrev_b32 v254, 1, v254
    v_xor_b32 v253, v253, v254
    s_mov_b32 s49, 8192
    v_mul_lo_u32 v252, v252, s49
    v_lshl_add_u32 v230, v253, 4, v252
    s_mul_i32 s48, s40, 8
    s_add_u32 s48, s48, 1
    v_lshrrev_b32 v252, 5, v248
    s_mul_i32 s49, s48, 2
    v_add_u32 v252, s49, v252
    v_and_b32 v253, 31, v248
    v_and_b32 v254, 3, v252
    v_bfe_u32 v255, v252, 3, 1
    v_lshl_add_u32 v254, v255, 2, v254
    v_lshlrev_b32 v254, 1, v254
    v_xor_b32 v253, v253, v254
    s_mov_b32 s49, 8192
    v_mul_lo_u32 v252, v252, s49
    v_lshl_add_u32 v231, v253, 4, v252
    s_mul_i32 s48, s40, 8
    s_add_u32 s48, s48, 2
    v_lshrrev_b32 v252, 5, v248
    s_mul_i32 s49, s48, 2
    v_add_u32 v252, s49, v252
    v_and_b32 v253, 31, v248
    v_and_b32 v254, 3, v252
    v_bfe_u32 v255, v252, 3, 1
    v_lshl_add_u32 v254, v255, 2, v254
    v_lshlrev_b32 v254, 1, v254
    v_xor_b32 v253, v253, v254
    s_mov_b32 s49, 8192
    v_mul_lo_u32 v252, v252, s49
    v_lshl_add_u32 v232, v253, 4, v252
    s_mul_i32 s48, s40, 8
    s_add_u32 s48, s48, 3
    v_lshrrev_b32 v252, 5, v248
    s_mul_i32 s49, s48, 2
    v_add_u32 v252, s49, v252
    v_and_b32 v253, 31, v248
    v_and_b32 v254, 3, v252
    v_bfe_u32 v255, v252, 3, 1
    v_lshl_add_u32 v254, v255, 2, v254
    v_lshlrev_b32 v254, 1, v254
    v_xor_b32 v253, v253, v254
    s_mov_b32 s49, 8192
    v_mul_lo_u32 v252, v252, s49
    v_lshl_add_u32 v233, v253, 4, v252
    s_mul_i32 s48, s40, 8
    s_add_u32 s48, s48, 4
    v_lshrrev_b32 v252, 5, v248
    s_mul_i32 s49, s48, 2
    v_add_u32 v252, s49, v252
    v_and_b32 v253, 31, v248
    v_and_b32 v254, 3, v252
    v_bfe_u32 v255, v252, 3, 1
    v_lshl_add_u32 v254, v255, 2, v254
    v_lshlrev_b32 v254, 1, v254
    v_xor_b32 v253, v253, v254
    s_mov_b32 s49, 8192
    v_mul_lo_u32 v252, v252, s49
    v_lshl_add_u32 v234, v253, 4, v252
    s_mul_i32 s48, s40, 8
    s_add_u32 s48, s48, 5
    v_lshrrev_b32 v252, 5, v248
    s_mul_i32 s49, s48, 2
    v_add_u32 v252, s49, v252
    v_and_b32 v253, 31, v248
    v_and_b32 v254, 3, v252
    v_bfe_u32 v255, v252, 3, 1
    v_lshl_add_u32 v254, v255, 2, v254
    v_lshlrev_b32 v254, 1, v254
    v_xor_b32 v253, v253, v254
    s_mov_b32 s49, 8192
    v_mul_lo_u32 v252, v252, s49
    v_lshl_add_u32 v235, v253, 4, v252
    s_mul_i32 s48, s40, 8
    s_add_u32 s48, s48, 6
    v_lshrrev_b32 v252, 5, v248
    s_mul_i32 s49, s48, 2
    v_add_u32 v252, s49, v252
    v_and_b32 v253, 31, v248
    v_and_b32 v254, 3, v252
    v_bfe_u32 v255, v252, 3, 1
    v_lshl_add_u32 v254, v255, 2, v254
    v_lshlrev_b32 v254, 1, v254
    v_xor_b32 v253, v253, v254
    s_mov_b32 s49, 8192
    v_mul_lo_u32 v252, v252, s49
    v_lshl_add_u32 v236, v253, 4, v252
    s_mul_i32 s48, s40, 8
    s_add_u32 s48, s48, 7
    v_lshrrev_b32 v252, 5, v248
    s_mul_i32 s49, s48, 2
    v_add_u32 v252, s49, v252
    v_and_b32 v253, 31, v248
    v_and_b32 v254, 3, v252
    v_bfe_u32 v255, v252, 3, 1
    v_lshl_add_u32 v254, v255, 2, v254
    v_lshlrev_b32 v254, 1, v254
    v_xor_b32 v253, v253, v254
    s_mov_b32 s49, 8192
    v_mul_lo_u32 v252, v252, s49
    v_lshl_add_u32 v237, v253, 4, v252
    v_bfe_u32 v252, v249, 1, 3
    v_xor_b32 v252, v252, v250
    v_lshlrev_b32 v252, 4, v252
    v_lshl_add_u32 v252, v249, 7, v252
    s_mul_i32 s48, s41, 8192
    s_add_u32 s48, s48, 0
    v_add_u32 v238, s48, v252
    v_xor_b32 v239, 64, v238
    v_lshrrev_b32 v252, 2, v249
    v_and_b32 v253, 3, v249
    v_and_b32 v255, 1, v250
    v_lshl_add_u32 v254, v255, 2, v252
    v_lshlrev_b32 v254, 1, v254
    v_lshrrev_b32 v255, 1, v253
    v_xor_b32 v254, v254, v255
    v_lshlrev_b32 v254, 4, v254
    v_and_b32 v255, 1, v253
    v_lshl_add_u32 v254, v255, 3, v254
    v_lshl_add_u32 v255, v250, 3, v252
    s_mov_b32 s48, 512
    v_mul_lo_u32 v255, v255, s48
    v_add_u32 v254, v254, v255
    s_mul_i32 s48, s42, 8
    s_add_u32 s48, s48, 0
    s_and_b32 s49, s48, 7
    s_lshl_b32 s49, s49, 5
    v_xor_b32 v240, s49, v254
    s_lshr_b32 s48, s48, 3
    s_lshl_b32 s48, s48, 8
    s_add_u32 s48, s48, 16384
    v_add_u32 v240, s48, v240
    s_mul_i32 s48, s42, 8
    s_add_u32 s48, s48, 1
    s_and_b32 s49, s48, 7
    s_lshl_b32 s49, s49, 5
    v_xor_b32 v241, s49, v254
    s_lshr_b32 s48, s48, 3
    s_lshl_b32 s48, s48, 8
    s_add_u32 s48, s48, 16384
    v_add_u32 v241, s48, v241
    s_mul_i32 s48, s42, 8
    s_add_u32 s48, s48, 2
    s_and_b32 s49, s48, 7
    s_lshl_b32 s49, s49, 5
    v_xor_b32 v242, s49, v254
    s_lshr_b32 s48, s48, 3
    s_lshl_b32 s48, s48, 8
    s_add_u32 s48, s48, 16384
    v_add_u32 v242, s48, v242
    s_mul_i32 s48, s42, 8
    s_add_u32 s48, s48, 3
    s_and_b32 s49, s48, 7
    s_lshl_b32 s49, s49, 5
    v_xor_b32 v243, s49, v254
    s_lshr_b32 s48, s48, 3
    s_lshl_b32 s48, s48, 8
    s_add_u32 s48, s48, 16384
    v_add_u32 v243, s48, v243
    s_mul_i32 s48, s42, 8
    s_add_u32 s48, s48, 4
    s_and_b32 s49, s48, 7
    s_lshl_b32 s49, s49, 5
    v_xor_b32 v244, s49, v254
    s_lshr_b32 s48, s48, 3
    s_lshl_b32 s48, s48, 8
    s_add_u32 s48, s48, 16384
    v_add_u32 v244, s48, v244
    s_mul_i32 s48, s42, 8
    s_add_u32 s48, s48, 5
    s_and_b32 s49, s48, 7
    s_lshl_b32 s49, s49, 5
    v_xor_b32 v245, s49, v254
    s_lshr_b32 s48, s48, 3
    s_lshl_b32 s48, s48, 8
    s_add_u32 s48, s48, 16384
    v_add_u32 v245, s48, v245
    s_mul_i32 s48, s42, 8
    s_add_u32 s48, s48, 6
    s_and_b32 s49, s48, 7
    s_lshl_b32 s49, s49, 5
    v_xor_b32 v246, s49, v254
    s_lshr_b32 s48, s48, 3
    s_lshl_b32 s48, s48, 8
    s_add_u32 s48, s48, 16384
    v_add_u32 v246, s48, v246
    s_mul_i32 s48, s42, 8
    s_add_u32 s48, s48, 7
    s_and_b32 s49, s48, 7
    s_lshl_b32 s49, s49, 5
    v_xor_b32 v247, s49, v254
    s_lshr_b32 s48, s48, 3
    s_lshl_b32 s48, s48, 8
    s_add_u32 s48, s48, 16384
    v_add_u32 v247, s48, v247
    s_mov_b32 s73, 1
L_qkv_93:
    s_lshl_b32 s74, s73, 2
    s_lshr_b32 s81, s72, 3
    s_add_u32 s74, s74, s81
    s_mul_i32 s43, s74, 163840
    s_add_u32 s43, s43, 1048576
    s_mul_i32 s44, s80, 512
    s_lshl_b32 s16, s82, 24
    s_add_u32 s16, s16, 16777216
    s_mul_i32 s17, s74, 1048576
    s_add_u32 s16, s16, s17
    s_mul_i32 s17, s80, 512
    s_add_u32 s16, s16, s17
    s_mul_i32 s54, s40, 4096
    s_mul_i32 s55, s40, 8192
    s_mov_b32 s46, 0
    s_mov_b32 s51, 0
    s_mov_b32 s52, s54
    s_mov_b32 s53, s55
    s_add_u32 s50, s44, 0
    s_add_u32 s53, s55, 0
    s_add_u32 m0, s53, 16384
    s_nop 0
    buffer_load_dwordx4 v230, s[8:11], s50 offen lds
    s_add_u32 m0, s53, 17408
    s_nop 0
    buffer_load_dwordx4 v231, s[8:11], s50 offen lds
    s_add_u32 m0, s53, 18432
    s_nop 0
    buffer_load_dwordx4 v232, s[8:11], s50 offen lds
    s_add_u32 m0, s53, 19456
    s_nop 0
    buffer_load_dwordx4 v233, s[8:11], s50 offen lds
    s_add_u32 m0, s53, 20480
    s_nop 0
    buffer_load_dwordx4 v234, s[8:11], s50 offen lds
    s_add_u32 m0, s53, 21504
    s_nop 0
    buffer_load_dwordx4 v235, s[8:11], s50 offen lds
    s_add_u32 m0, s53, 22528
    s_nop 0
    buffer_load_dwordx4 v236, s[8:11], s50 offen lds
    s_add_u32 m0, s53, 23552
    s_nop 0
    buffer_load_dwordx4 v237, s[8:11], s50 offen lds
    s_add_u32 s50, s44, 524288
    s_add_u32 s53, s55, 49152
    s_add_u32 m0, s53, 16384
    s_nop 0
    buffer_load_dwordx4 v230, s[8:11], s50 offen lds
    s_add_u32 m0, s53, 17408
    s_nop 0
    buffer_load_dwordx4 v231, s[8:11], s50 offen lds
    s_add_u32 m0, s53, 18432
    s_nop 0
    buffer_load_dwordx4 v232, s[8:11], s50 offen lds
    s_add_u32 m0, s53, 19456
    s_nop 0
    buffer_load_dwordx4 v233, s[8:11], s50 offen lds
    s_add_u32 m0, s53, 20480
    s_nop 0
    buffer_load_dwordx4 v234, s[8:11], s50 offen lds
    s_add_u32 m0, s53, 21504
    s_nop 0
    buffer_load_dwordx4 v235, s[8:11], s50 offen lds
    s_add_u32 m0, s53, 22528
    s_nop 0
    buffer_load_dwordx4 v236, s[8:11], s50 offen lds
    s_add_u32 m0, s53, 23552
    s_nop 0
    buffer_load_dwordx4 v237, s[8:11], s50 offen lds
    s_add_u32 s50, s44, 1048576
    s_add_u32 s53, s55, 98304
    s_add_u32 m0, s53, 16384
    s_nop 0
    buffer_load_dwordx4 v230, s[8:11], s50 offen lds
    s_add_u32 m0, s53, 17408
    s_nop 0
    buffer_load_dwordx4 v231, s[8:11], s50 offen lds
    s_add_u32 m0, s53, 18432
    s_nop 0
    buffer_load_dwordx4 v232, s[8:11], s50 offen lds
    s_add_u32 m0, s53, 19456
    s_nop 0
    buffer_load_dwordx4 v233, s[8:11], s50 offen lds
    s_add_u32 m0, s53, 20480
    s_nop 0
    buffer_load_dwordx4 v234, s[8:11], s50 offen lds
    s_add_u32 m0, s53, 21504
    s_nop 0
    buffer_load_dwordx4 v235, s[8:11], s50 offen lds
    s_add_u32 m0, s53, 22528
    s_nop 0
    buffer_load_dwordx4 v236, s[8:11], s50 offen lds
    s_add_u32 m0, s53, 23552
    s_nop 0
    buffer_load_dwordx4 v237, s[8:11], s50 offen lds
    s_lshl_b32 s77, s74, 7
    s_add_u32 s77, s77, 819200
    s_cmp_lg_u32 s26, 0
    s_cbranch_scc1 L_wgw_94
    s_mov_b32 s79, 0x200000
    v_mov_b32 v2, 0
L_cw_95:
    buffer_load_dword v3, v2, s[4:7], s77 offen sc1
    s_waitcnt vmcnt(0)
    v_readfirstlane_b32 s78, v3
    s_nop 0
    s_cmp_ge_u32 s78, 32
    s_cbranch_scc1 L_cd_96
    s_sleep 2
    s_sub_u32 s79, s79, 1
    s_cbranch_scc0 L_cw_95
L_cd_96:
L_wgw_94:
    s_barrier
    s_add_u32 s50, s43, 0
    s_add_u32 s52, s54, 0
    s_add_u32 m0, s52, 0
    s_nop 0
    buffer_load_dwordx4 v226, s[4:7], s50 offen sc1 lds
    s_add_u32 m0, s52, 1024
    s_nop 0
    buffer_load_dwordx4 v227, s[4:7], s50 offen sc1 lds
    s_add_u32 m0, s52, 2048
    s_nop 0
    buffer_load_dwordx4 v228, s[4:7], s50 offen sc1 lds
    s_add_u32 m0, s52, 3072
    s_nop 0
    buffer_load_dwordx4 v229, s[4:7], s50 offen sc1 lds
    s_add_u32 s50, s43, 128
    s_add_u32 s52, s54, 49152
    s_add_u32 m0, s52, 0
    s_nop 0
    buffer_load_dwordx4 v226, s[4:7], s50 offen sc1 lds
    s_add_u32 m0, s52, 1024
    s_nop 0
    buffer_load_dwordx4 v227, s[4:7], s50 offen sc1 lds
    s_add_u32 m0, s52, 2048
    s_nop 0
    buffer_load_dwordx4 v228, s[4:7], s50 offen sc1 lds
    s_add_u32 m0, s52, 3072
    s_nop 0
    buffer_load_dwordx4 v229, s[4:7], s50 offen sc1 lds
    s_add_u32 s50, s43, 256
    s_add_u32 s52, s54, 98304
    s_add_u32 m0, s52, 0
    s_nop 0
    buffer_load_dwordx4 v226, s[4:7], s50 offen sc1 lds
    s_add_u32 m0, s52, 1024
    s_nop 0
    buffer_load_dwordx4 v227, s[4:7], s50 offen sc1 lds
    s_add_u32 m0, s52, 2048
    s_nop 0
    buffer_load_dwordx4 v228, s[4:7], s50 offen sc1 lds
    s_add_u32 m0, s52, 3072
    s_nop 0
    buffer_load_dwordx4 v229, s[4:7], s50 offen sc1 lds
    s_add_u32 s43, s43, 128
    s_add_u32 s44, s44, 524288
    s_add_u32 s51, s51, 1
    s_cmp_ge_u32 s51, 10
    s_cmov_b32 s43, 0x40000000
    s_cmov_b32 s44, 0x40000000
    s_add_u32 s46, s46, 49152
    s_cmp_eq_u32 s46, 147456
    s_cmov_b32 s46, 0
    s_add_u32 s52, s46, s54
    s_add_u32 s53, s46, s55
    s_add_u32 s43, s43, 128
    s_add_u32 s44, s44, 524288
    s_add_u32 s51, s51, 1
    s_cmp_ge_u32 s51, 10
    s_cmov_b32 s43, 0x40000000
    s_cmov_b32 s44, 0x40000000
    s_add_u32 s46, s46, 49152
    s_cmp_eq_u32 s46, 147456
    s_cmov_b32 s46, 0
    s_add_u32 s52, s46, s54
    s_add_u32 s53, s46, s55
    s_add_u32 s43, s43, 128
    s_add_u32 s44, s44, 524288
    s_add_u32 s51, s51, 1
    s_cmp_ge_u32 s51, 10
    s_cmov_b32 s43, 0x40000000
    s_cmov_b32 s44, 0x40000000
    s_add_u32 s46, s46, 49152
    s_cmp_eq_u32 s46, 147456
    s_cmov_b32 s46, 0
    s_add_u32 s52, s46, s54
    s_add_u32 s53, s46, s55
    v_mov_b32 v2, 0
    v_mov_b32 v3, 0
    v_mov_b32 v4, 0
    v_mov_b32 v5, 0
    v_mov_b32 v6, 0
    v_mov_b32 v7, 0
    v_mov_b32 v8, 0
    v_mov_b32 v9, 0
    v_mov_b32 v10, 0
    v_mov_b32 v11, 0
    v_mov_b32 v12, 0
    v_mov_b32 v13, 0
    v_mov_b32 v14, 0
    v_mov_b32 v15, 0
    v_mov_b32 v16, 0
    v_mov_b32 v17, 0
    v_mov_b32 v18, 0
    v_mov_b32 v19, 0
    v_mov_b32 v20, 0
    v_mov_b32 v21, 0
    v_mov_b32 v22, 0
    v_mov_b32 v23, 0
    v_mov_b32 v24, 0
    v_mov_b32 v25, 0
    v_mov_b32 v26, 0
    v_mov_b32 v27, 0
    v_mov_b32 v28, 0
    v_mov_b32 v29, 0
    v_mov_b32 v30, 0
    v_mov_b32 v31, 0
    v_mov_b32 v32, 0
    v_mov_b32 v33, 0
    v_mov_b32 v34, 0
    v_mov_b32 v35, 0
    v_mov_b32 v36, 0
    v_mov_b32 v37, 0
    v_mov_b32 v38, 0
    v_mov_b32 v39, 0
    v_mov_b32 v40, 0
    v_mov_b32 v41, 0
    v_mov_b32 v42, 0
    v_mov_b32 v43, 0
    v_mov_b32 v44, 0
    v_mov_b32 v45, 0
    v_mov_b32 v46, 0
    v_mov_b32 v47, 0
    v_mov_b32 v48, 0
    v_mov_b32 v49, 0
    v_mov_b32 v50, 0
    v_mov_b32 v51, 0
    v_mov_b32 v52, 0
    v_mov_b32 v53, 0
    v_mov_b32 v54, 0
    v_mov_b32 v55, 0
    v_mov_b32 v56, 0
    v_mov_b32 v57, 0
    v_mov_b32 v58, 0
    v_mov_b32 v59, 0
    v_mov_b32 v60, 0
    v_mov_b32 v61, 0
    v_mov_b32 v62, 0
    v_mov_b32 v63, 0
    v_mov_b32 v64, 0
    v_mov_b32 v65, 0
    v_mov_b32 v66, 0
    v_mov_b32 v67, 0
    v_mov_b32 v68, 0
    v_mov_b32 v69, 0
    v_mov_b32 v70, 0
    v_mov_b32 v71, 0
    v_mov_b32 v72, 0
    v_mov_b32 v73, 0
    v_mov_b32 v74, 0
    v_mov_b32 v75, 0
    v_mov_b32 v76, 0
    v_mov_b32 v77, 0
    v_mov_b32 v78, 0
    v_mov_b32 v79, 0
    v_mov_b32 v80, 0
    v_mov_b32 v81, 0
    v_mov_b32 v82, 0
    v_mov_b32 v83, 0
    v_mov_b32 v84, 0
    v_mov_b32 v85, 0
    v_mov_b32 v86, 0
    v_mov_b32 v87, 0
    v_mov_b32 v88, 0
    v_mov_b32 v89, 0
    v_mov_b32 v90, 0
    v_mov_b32 v91, 0
    v_mov_b32 v92, 0
    v_mov_b32 v93, 0
    v_mov_b32 v94, 0
    v_mov_b32 v95, 0
    v_mov_b32 v96, 0
    v_mov_b32 v97, 0
    v_mov_b32 v98, 0
    v_mov_b32 v99, 0
    v_mov_b32 v100, 0
    v_mov_b32 v101, 0
    v_mov_b32 v102, 0
    v_mov_b32 v103, 0
    v_mov_b32 v104, 0
    v_mov_b32 v105, 0
    v_mov_b32 v106, 0
    v_mov_b32 v107, 0
    v_mov_b32 v108, 0
    v_mov_b32 v109, 0
    v_mov_b32 v110, 0
    v_mov_b32 v111, 0
    v_mov_b32 v112, 0
    v_mov_b32 v113, 0
    v_mov_b32 v114, 0
    v_mov_b32 v115, 0
    v_mov_b32 v116, 0
    v_mov_b32 v117, 0
    v_mov_b32 v118, 0
    v_mov_b32 v119, 0
    v_mov_b32 v120, 0
    v_mov_b32 v121, 0
    v_mov_b32 v122, 0
    v_mov_b32 v123, 0
    v_mov_b32 v124, 0
    v_mov_b32 v125, 0
    v_mov_b32 v126, 0
    v_mov_b32 v127, 0
    v_mov_b32 v128, 0
    v_mov_b32 v129, 0
    s_mov_b32 s45, 0
    s_mov_b32 s47, 0
    s_waitcnt vmcnt(8)
    s_barrier
    ds_read_b64_tr_b16 v[162:163], v240 offset:0
    ds_read_b64_tr_b16 v[164:165], v240 offset:2048
    ds_read_b64_tr_b16 v[166:167], v241 offset:0
    ds_read_b64_tr_b16 v[168:169], v241 offset:2048
    ds_read_b64_tr_b16 v[170:171], v242 offset:0
    ds_read_b64_tr_b16 v[172:173], v242 offset:2048
    ds_read_b64_tr_b16 v[174:175], v243 offset:0
    ds_read_b64_tr_b16 v[176:177], v243 offset:2048
    ds_read_b64_tr_b16 v[178:179], v244 offset:0
    ds_read_b64_tr_b16 v[180:181], v244 offset:2048
    ds_read_b64_tr_b16 v[182:183], v245 offset:0
    ds_read_b64_tr_b16 v[184:185], v245 offset:2048
    ds_read_b64_tr_b16 v[186:187], v246 offset:0
    ds_read_b64_tr_b16 v[188:189], v246 offset:2048
    ds_read_b64_tr_b16 v[190:191], v247 offset:0
    ds_read_b64_tr_b16 v[192:193], v247 offset:2048
    ds_read_b128 v[130:133], v238 offset:0
    ds_read_b128 v[134:137], v238 offset:2048
    ds_read_b128 v[138:141], v238 offset:4096
    ds_read_b128 v[142:145], v238 offset:6144
    s_waitcnt lgkmcnt(0)
    v_mfma_f32_16x16x32_bf16 v[2:5], v[162:165], v[130:133], v[2:5]
    ds_read_b64_tr_b16 v[194:195], v240 offset:16384
    v_mfma_f32_16x16x32_bf16 v[6:9], v[162:165], v[134:137], v[6:9]
    ds_read_b64_tr_b16 v[196:197], v240 offset:18432
    v_mfma_f32_16x16x32_bf16 v[10:13], v[162:165], v[138:141], v[10:13]
    ds_read_b64_tr_b16 v[198:199], v241 offset:16384
    v_mfma_f32_16x16x32_bf16 v[14:17], v[162:165], v[142:145], v[14:17]
    ds_read_b64_tr_b16 v[200:201], v241 offset:18432
    v_mfma_f32_16x16x32_bf16 v[18:21], v[166:169], v[130:133], v[18:21]
    ds_read_b64_tr_b16 v[202:203], v242 offset:16384
    v_mfma_f32_16x16x32_bf16 v[22:25], v[166:169], v[134:137], v[22:25]
    v_mfma_f32_16x16x32_bf16 v[26:29], v[166:169], v[138:141], v[26:29]
    ds_read_b64_tr_b16 v[204:205], v242 offset:18432
    v_mfma_f32_16x16x32_bf16 v[30:33], v[166:169], v[142:145], v[30:33]
    ds_read_b64_tr_b16 v[206:207], v243 offset:16384
    v_mfma_f32_16x16x32_bf16 v[34:37], v[170:173], v[130:133], v[34:37]
    ds_read_b64_tr_b16 v[208:209], v243 offset:18432
    v_mfma_f32_16x16x32_bf16 v[38:41], v[170:173], v[134:137], v[38:41]
    ds_read_b64_tr_b16 v[210:211], v244 offset:16384
    v_mfma_f32_16x16x32_bf16 v[42:45], v[170:173], v[138:141], v[42:45]
    ds_read_b64_tr_b16 v[212:213], v244 offset:18432
    v_mfma_f32_16x16x32_bf16 v[46:49], v[170:173], v[142:145], v[46:49]
    v_mfma_f32_16x16x32_bf16 v[50:53], v[174:177], v[130:133], v[50:53]
    ds_read_b64_tr_b16 v[214:215], v245 offset:16384
    v_mfma_f32_16x16x32_bf16 v[54:57], v[174:177], v[134:137], v[54:57]
    ds_read_b64_tr_b16 v[216:217], v245 offset:18432
    v_mfma_f32_16x16x32_bf16 v[58:61], v[174:177], v[138:141], v[58:61]
    ds_read_b64_tr_b16 v[218:219], v246 offset:16384
    v_mfma_f32_16x16x32_bf16 v[62:65], v[174:177], v[142:145], v[62:65]
    ds_read_b64_tr_b16 v[220:221], v246 offset:18432
    v_mfma_f32_16x16x32_bf16 v[66:69], v[178:181], v[130:133], v[66:69]
    ds_read_b64_tr_b16 v[222:223], v247 offset:16384
    v_mfma_f32_16x16x32_bf16 v[70:73], v[178:181], v[134:137], v[70:73]
    v_mfma_f32_16x16x32_bf16 v[74:77], v[178:181], v[138:141], v[74:77]
    ds_read_b64_tr_b16 v[224:225], v247 offset:18432
    v_mfma_f32_16x16x32_bf16 v[78:81], v[178:181], v[142:145], v[78:81]
    ds_read_b128 v[146:149], v239 offset:0
    v_mfma_f32_16x16x32_bf16 v[82:85], v[182:185], v[130:133], v[82:85]
    ds_read_b128 v[150:153], v239 offset:2048
    v_mfma_f32_16x16x32_bf16 v[86:89], v[182:185], v[134:137], v[86:89]
    ds_read_b128 v[154:157], v239 offset:4096
    v_mfma_f32_16x16x32_bf16 v[90:93], v[182:185], v[138:141], v[90:93]
    ds_read_b128 v[158:161], v239 offset:6144
    v_mfma_f32_16x16x32_bf16 v[94:97], v[182:185], v[142:145], v[94:97]
    v_mfma_f32_16x16x32_bf16 v[98:101], v[186:189], v[130:133], v[98:101]
    v_mfma_f32_16x16x32_bf16 v[102:105], v[186:189], v[134:137], v[102:105]
    v_mfma_f32_16x16x32_bf16 v[106:109], v[186:189], v[138:141], v[106:109]
    v_mfma_f32_16x16x32_bf16 v[110:113], v[186:189], v[142:145], v[110:113]
    v_mfma_f32_16x16x32_bf16 v[114:117], v[190:193], v[130:133], v[114:117]
    v_mfma_f32_16x16x32_bf16 v[118:121], v[190:193], v[134:137], v[118:121]
    v_mfma_f32_16x16x32_bf16 v[122:125], v[190:193], v[138:141], v[122:125]
    v_mfma_f32_16x16x32_bf16 v[126:129], v[190:193], v[142:145], v[126:129]
    s_add_u32 s47, s47, 1
    s_cmp_eq_u32 s47, 3
    s_mov_b32 s49, 49152
    s_cmov_b32 s49, 0xfffe8000
    s_cmov_b32 s47, 0
    s_waitcnt lgkmcnt(0)
    v_add_u32 v238, s49, v238
    v_add_u32 v239, s49, v239
    v_add_u32 v240, s49, v240
    v_add_u32 v241, s49, v241
    v_add_u32 v242, s49, v242
    v_add_u32 v243, s49, v243
    v_add_u32 v244, s49, v244
    v_add_u32 v245, s49, v245
    v_add_u32 v246, s49, v246
    v_add_u32 v247, s49, v247
    s_waitcnt vmcnt(4)
    s_barrier
    v_mfma_f32_16x16x32_bf16 v[2:5], v[194:197], v[146:149], v[2:5]
    ds_read_b64_tr_b16 v[162:163], v240 offset:0
    v_mfma_f32_16x16x32_bf16 v[6:9], v[194:197], v[150:153], v[6:9]
    ds_read_b64_tr_b16 v[164:165], v240 offset:2048
    s_add_u32 m0, s52, 0
    s_nop 0
    buffer_load_dwordx4 v226, s[4:7], s43 offen sc1 lds
    v_mfma_f32_16x16x32_bf16 v[10:13], v[194:197], v[154:157], v[10:13]
    ds_read_b64_tr_b16 v[166:167], v241 offset:0
    v_mfma_f32_16x16x32_bf16 v[14:17], v[194:197], v[158:161], v[14:17]
    ds_read_b64_tr_b16 v[168:169], v241 offset:2048
    s_add_u32 m0, s52, 1024
    s_nop 0
    buffer_load_dwordx4 v227, s[4:7], s43 offen sc1 lds
    v_mfma_f32_16x16x32_bf16 v[18:21], v[198:201], v[146:149], v[18:21]
    ds_read_b64_tr_b16 v[170:171], v242 offset:0
    v_mfma_f32_16x16x32_bf16 v[22:25], v[198:201], v[150:153], v[22:25]
    v_mfma_f32_16x16x32_bf16 v[26:29], v[198:201], v[154:157], v[26:29]
    ds_read_b64_tr_b16 v[172:173], v242 offset:2048
    s_add_u32 m0, s52, 2048
    s_nop 0
    buffer_load_dwordx4 v228, s[4:7], s43 offen sc1 lds
    v_mfma_f32_16x16x32_bf16 v[30:33], v[198:201], v[158:161], v[30:33]
    ds_read_b64_tr_b16 v[174:175], v243 offset:0
    v_mfma_f32_16x16x32_bf16 v[34:37], v[202:205], v[146:149], v[34:37]
    ds_read_b64_tr_b16 v[176:177], v243 offset:2048
    v_mfma_f32_16x16x32_bf16 v[38:41], v[202:205], v[150:153], v[38:41]
    ds_read_b64_tr_b16 v[178:179], v244 offset:0
    s_add_u32 m0, s52, 3072
    s_nop 0
    buffer_load_dwordx4 v229, s[4:7], s43 offen sc1 lds
    v_mfma_f32_16x16x32_bf16 v[42:45], v[202:205], v[154:157], v[42:45]
    ds_read_b64_tr_b16 v[180:181], v244 offset:2048
    v_mfma_f32_16x16x32_bf16 v[46:49], v[202:205], v[158:161], v[46:49]
    s_add_u32 m0, s53, 16384
    s_nop 0
    buffer_load_dwordx4 v230, s[8:11], s44 offen lds
    v_mfma_f32_16x16x32_bf16 v[50:53], v[206:209], v[146:149], v[50:53]
    ds_read_b64_tr_b16 v[182:183], v245 offset:0
    v_mfma_f32_16x16x32_bf16 v[54:57], v[206:209], v[150:153], v[54:57]
    ds_read_b64_tr_b16 v[184:185], v245 offset:2048
    v_mfma_f32_16x16x32_bf16 v[58:61], v[206:209], v[154:157], v[58:61]
    ds_read_b64_tr_b16 v[186:187], v246 offset:0
    s_add_u32 m0, s53, 17408
    s_nop 0
    buffer_load_dwordx4 v231, s[8:11], s44 offen lds
    v_mfma_f32_16x16x32_bf16 v[62:65], v[206:209], v[158:161], v[62:65]
    ds_read_b64_tr_b16 v[188:189], v246 offset:2048
    v_mfma_f32_16x16x32_bf16 v[66:69], v[210:213], v[146:149], v[66:69]
    ds_read_b64_tr_b16 v[190:191], v247 offset:0
    v_mfma_f32_16x16x32_bf16 v[70:73], v[210:213], v[150:153], v[70:73]
    s_add_u32 m0, s53, 18432
    s_nop 0
    buffer_load_dwordx4 v232, s[8:11], s44 offen lds
    v_mfma_f32_16x16x32_bf16 v[74:77], v[210:213], v[154:157], v[74:77]
    ds_read_b64_tr_b16 v[192:193], v247 offset:2048
    v_mfma_f32_16x16x32_bf16 v[78:81], v[210:213], v[158:161], v[78:81]
    ds_read_b128 v[130:133], v238 offset:0
    s_add_u32 m0, s53, 19456
    s_nop 0
    buffer_load_dwordx4 v233, s[8:11], s44 offen lds
    v_mfma_f32_16x16x32_bf16 v[82:85], v[214:217], v[146:149], v[82:85]
    ds_read_b128 v[134:137], v238 offset:2048
    v_mfma_f32_16x16x32_bf16 v[86:89], v[214:217], v[150:153], v[86:89]
    ds_read_b128 v[138:141], v238 offset:4096
    v_mfma_f32_16x16x32_bf16 v[90:93], v[214:217], v[154:157], v[90:93]
    ds_read_b128 v[142:145], v238 offset:6144
    s_add_u32 m0, s53, 20480
    s_nop 0
    buffer_load_dwordx4 v234, s[8:11], s44 offen lds
    v_mfma_f32_16x16x32_bf16 v[94:97], v[214:217], v[158:161], v[94:97]
    v_mfma_f32_16x16x32_bf16 v[98:101], v[218:221], v[146:149], v[98:101]
    v_mfma_f32_16x16x32_bf16 v[102:105], v[218:221], v[150:153], v[102:105]
    s_add_u32 m0, s53, 21504
    s_nop 0
    buffer_load_dwordx4 v235, s[8:11], s44 offen lds
    v_mfma_f32_16x16x32_bf16 v[106:109], v[218:221], v[154:157], v[106:109]
    v_mfma_f32_16x16x32_bf16 v[110:113], v[218:221], v[158:161], v[110:113]
    s_add_u32 m0, s53, 22528
    s_nop 0
    buffer_load_dwordx4 v236, s[8:11], s44 offen lds
    v_mfma_f32_16x16x32_bf16 v[114:117], v[222:225], v[146:149], v[114:117]
    v_mfma_f32_16x16x32_bf16 v[118:121], v[222:225], v[150:153], v[118:121]
    v_mfma_f32_16x16x32_bf16 v[122:125], v[222:225], v[154:157], v[122:125]
    s_add_u32 m0, s53, 23552
    s_nop 0
    buffer_load_dwordx4 v237, s[8:11], s44 offen lds
    v_mfma_f32_16x16x32_bf16 v[126:129], v[222:225], v[158:161], v[126:129]
    s_add_u32 s43, s43, 128
    s_add_u32 s44, s44, 524288
    s_add_u32 s46, s46, 49152
    s_cmp_eq_u32 s46, 147456
    s_cmov_b32 s46, 0
    s_add_u32 s52, s46, s54
    s_add_u32 s53, s46, s55
    s_waitcnt lgkmcnt(0)
    s_mov_b32 s45, 1
L_gk_97:
    v_mfma_f32_16x16x32_bf16 v[2:5], v[162:165], v[130:133], v[2:5]
    ds_read_b64_tr_b16 v[194:195], v240 offset:16384
    v_mfma_f32_16x16x32_bf16 v[6:9], v[162:165], v[134:137], v[6:9]
    ds_read_b64_tr_b16 v[196:197], v240 offset:18432
    v_mfma_f32_16x16x32_bf16 v[10:13], v[162:165], v[138:141], v[10:13]
    ds_read_b64_tr_b16 v[198:199], v241 offset:16384
    v_mfma_f32_16x16x32_bf16 v[14:17], v[162:165], v[142:145], v[14:17]
    ds_read_b64_tr_b16 v[200:201], v241 offset:18432
    v_mfma_f32_16x16x32_bf16 v[18:21], v[166:169], v[130:133], v[18:21]
    ds_read_b64_tr_b16 v[202:203], v242 offset:16384
    v_mfma_f32_16x16x32_bf16 v[22:25], v[166:169], v[134:137], v[22:25]
    v_mfma_f32_16x16x32_bf16 v[26:29], v[166:169], v[138:141], v[26:29]
    ds_read_b64_tr_b16 v[204:205], v242 offset:18432
    v_mfma_f32_16x16x32_bf16 v[30:33], v[166:169], v[142:145], v[30:33]
    ds_read_b64_tr_b16 v[206:207], v243 offset:16384
    v_mfma_f32_16x16x32_bf16 v[34:37], v[170:173], v[130:133], v[34:37]
    ds_read_b64_tr_b16 v[208:209], v243 offset:18432
    v_mfma_f32_16x16x32_bf16 v[38:41], v[170:173], v[134:137], v[38:41]
    ds_read_b64_tr_b16 v[210:211], v244 offset:16384
    v_mfma_f32_16x16x32_bf16 v[42:45], v[170:173], v[138:141], v[42:45]
    ds_read_b64_tr_b16 v[212:213], v244 offset:18432
    v_mfma_f32_16x16x32_bf16 v[46:49], v[170:173], v[142:145], v[46:49]
    v_mfma_f32_16x16x32_bf16 v[50:53], v[174:177], v[130:133], v[50:53]
    ds_read_b64_tr_b16 v[214:215], v245 offset:16384
    v_mfma_f32_16x16x32_bf16 v[54:57], v[174:177], v[134:137], v[54:57]
    ds_read_b64_tr_b16 v[216:217], v245 offset:18432
    v_mfma_f32_16x16x32_bf16 v[58:61], v[174:177], v[138:141], v[58:61]
    ds_read_b64_tr_b16 v[218:219], v246 offset:16384
    v_mfma_f32_16x16x32_bf16 v[62:65], v[174:177], v[142:145], v[62:65]
    ds_read_b64_tr_b16 v[220:221], v246 offset:18432
    v_mfma_f32_16x16x32_bf16 v[66:69], v[178:181], v[130:133], v[66:69]
    ds_read_b64_tr_b16 v[222:223], v247 offset:16384
    v_mfma_f32_16x16x32_bf16 v[70:73], v[178:181], v[134:137], v[70:73]
    v_mfma_f32_16x16x32_bf16 v[74:77], v[178:181], v[138:141], v[74:77]
    ds_read_b64_tr_b16 v[224:225], v247 offset:18432
    v_mfma_f32_16x16x32_bf16 v[78:81], v[178:181], v[142:145], v[78:81]
    ds_read_b128 v[146:149], v239 offset:0
    v_mfma_f32_16x16x32_bf16 v[82:85], v[182:185], v[130:133], v[82:85]
    ds_read_b128 v[150:153], v239 offset:2048
    v_mfma_f32_16x16x32_bf16 v[86:89], v[182:185], v[134:137], v[86:89]
    ds_read_b128 v[154:157], v239 offset:4096
    v_mfma_f32_16x16x32_bf16 v[90:93], v[182:185], v[138:141], v[90:93]
    ds_read_b128 v[158:161], v239 offset:6144
    v_mfma_f32_16x16x32_bf16 v[94:97], v[182:185], v[142:145], v[94:97]
    v_mfma_f32_16x16x32_bf16 v[98:101], v[186:189], v[130:133], v[98:101]
    v_mfma_f32_16x16x32_bf16 v[102:105], v[186:189], v[134:137], v[102:105]
    v_mfma_f32_16x16x32_bf16 v[106:109], v[186:189], v[138:141], v[106:109]
    v_mfma_f32_16x16x32_bf16 v[110:113], v[186:189], v[142:145], v[110:113]
    v_mfma_f32_16x16x32_bf16 v[114:117], v[190:193], v[130:133], v[114:117]
    v_mfma_f32_16x16x32_bf16 v[118:121], v[190:193], v[134:137], v[118:121]
    v_mfma_f32_16x16x32_bf16 v[122:125], v[190:193], v[138:141], v[122:125]
    v_mfma_f32_16x16x32_bf16 v[126:129], v[190:193], v[142:145], v[126:129]
    s_add_u32 s47, s47, 1
    s_cmp_eq_u32 s47, 3
    s_mov_b32 s49, 49152
    s_cmov_b32 s49, 0xfffe8000
    s_cmov_b32 s47, 0
    s_waitcnt lgkmcnt(0)
    v_add_u32 v238, s49, v238
    v_add_u32 v239, s49, v239
    v_add_u32 v240, s49, v240
    v_add_u32 v241, s49, v241
    v_add_u32 v242, s49, v242
    v_add_u32 v243, s49, v243
    v_add_u32 v244, s49, v244
    v_add_u32 v245, s49, v245
    v_add_u32 v246, s49, v246
    v_add_u32 v247, s49, v247
    s_waitcnt vmcnt(12)
    s_barrier
    v_mfma_f32_16x16x32_bf16 v[2:5], v[194:197], v[146:149], v[2:5]
    ds_read_b64_tr_b16 v[162:163], v240 offset:0
    v_mfma_f32_16x16x32_bf16 v[6:9], v[194:197], v[150:153], v[6:9]
    ds_read_b64_tr_b16 v[164:165], v240 offset:2048
    s_add_u32 m0, s52, 0
    s_nop 0
    buffer_load_dwordx4 v226, s[4:7], s43 offen sc1 lds
    v_mfma_f32_16x16x32_bf16 v[10:13], v[194:197], v[154:157], v[10:13]
    ds_read_b64_tr_b16 v[166:167], v241 offset:0
    v_mfma_f32_16x16x32_bf16 v[14:17], v[194:197], v[158:161], v[14:17]
    ds_read_b64_tr_b16 v[168:169], v241 offset:2048
    s_add_u32 m0, s52, 1024
    s_nop 0
    buffer_load_dwordx4 v227, s[4:7], s43 offen sc1 lds
    v_mfma_f32_16x16x32_bf16 v[18:21], v[198:201], v[146:149], v[18:21]
    ds_read_b64_tr_b16 v[170:171], v242 offset:0
    v_mfma_f32_16x16x32_bf16 v[22:25], v[198:201], v[150:153], v[22:25]
    v_mfma_f32_16x16x32_bf16 v[26:29], v[198:201], v[154:157], v[26:29]
    ds_read_b64_tr_b16 v[172:173], v242 offset:2048
    s_add_u32 m0, s52, 2048
    s_nop 0
    buffer_load_dwordx4 v228, s[4:7], s43 offen sc1 lds
    v_mfma_f32_16x16x32_bf16 v[30:33], v[198:201], v[158:161], v[30:33]
    ds_read_b64_tr_b16 v[174:175], v243 offset:0
    v_mfma_f32_16x16x32_bf16 v[34:37], v[202:205], v[146:149], v[34:37]
    ds_read_b64_tr_b16 v[176:177], v243 offset:2048
    v_mfma_f32_16x16x32_bf16 v[38:41], v[202:205], v[150:153], v[38:41]
    ds_read_b64_tr_b16 v[178:179], v244 offset:0
    s_add_u32 m0, s52, 3072
    s_nop 0
    buffer_load_dwordx4 v229, s[4:7], s43 offen sc1 lds
    v_mfma_f32_16x16x32_bf16 v[42:45], v[202:205], v[154:157], v[42:45]
    ds_read_b64_tr_b16 v[180:181], v244 offset:2048
    v_mfma_f32_16x16x32_bf16 v[46:49], v[202:205], v[158:161], v[46:49]
    s_add_u32 m0, s53, 16384
    s_nop 0
    buffer_load_dwordx4 v230, s[8:11], s44 offen lds
    v_mfma_f32_16x16x32_bf16 v[50:53], v[206:209], v[146:149], v[50:53]
    ds_read_b64_tr_b16 v[182:183], v245 offset:0
    v_mfma_f32_16x16x32_bf16 v[54:57], v[206:209], v[150:153], v[54:57]
    ds_read_b64_tr_b16 v[184:185], v245 offset:2048
    v_mfma_f32_16x16x32_bf16 v[58:61], v[206:209], v[154:157], v[58:61]
    ds_read_b64_tr_b16 v[186:187], v246 offset:0
    s_add_u32 m0, s53, 17408
    s_nop 0
    buffer_load_dwordx4 v231, s[8:11], s44 offen lds
    v_mfma_f32_16x16x32_bf16 v[62:65], v[206:209], v[158:161], v[62:65]
    ds_read_b64_tr_b16 v[188:189], v246 offset:2048
    v_mfma_f32_16x16x32_bf16 v[66:69], v[210:213], v[146:149], v[66:69]
    ds_read_b64_tr_b16 v[190:191], v247 offset:0
    v_mfma_f32_16x16x32_bf16 v[70:73], v[210:213], v[150:153], v[70:73]
    s_add_u32 m0, s53, 18432
    s_nop 0
    buffer_load_dwordx4 v232, s[8:11], s44 offen lds
    v_mfma_f32_16x16x32_bf16 v[74:77], v[210:213], v[154:157], v[74:77]
    ds_read_b64_tr_b16 v[192:193], v247 offset:2048
    v_mfma_f32_16x16x32_bf16 v[78:81], v[210:213], v[158:161], v[78:81]
    ds_read_b128 v[130:133], v238 offset:0
    s_add_u32 m0, s53, 19456
    s_nop 0
    buffer_load_dwordx4 v233, s[8:11], s44 offen lds
    v_mfma_f32_16x16x32_bf16 v[82:85], v[214:217], v[146:149], v[82:85]
    ds_read_b128 v[134:137], v238 offset:2048
    v_mfma_f32_16x16x32_bf16 v[86:89], v[214:217], v[150:153], v[86:89]
    ds_read_b128 v[138:141], v238 offset:4096
    v_mfma_f32_16x16x32_bf16 v[90:93], v[214:217], v[154:157], v[90:93]
    ds_read_b128 v[142:145], v238 offset:6144
    s_add_u32 m0, s53, 20480
    s_nop 0
    buffer_load_dwordx4 v234, s[8:11], s44 offen lds
    v_mfma_f32_16x16x32_bf16 v[94:97], v[214:217], v[158:161], v[94:97]
    v_mfma_f32_16x16x32_bf16 v[98:101], v[218:221], v[146:149], v[98:101]
    v_mfma_f32_16x16x32_bf16 v[102:105], v[218:221], v[150:153], v[102:105]
    s_add_u32 m0, s53, 21504
    s_nop 0
    buffer_load_dwordx4 v235, s[8:11], s44 offen lds
    v_mfma_f32_16x16x32_bf16 v[106:109], v[218:221], v[154:157], v[106:109]
    v_mfma_f32_16x16x32_bf16 v[110:113], v[218:221], v[158:161], v[110:113]
    s_add_u32 m0, s53, 22528
    s_nop 0
    buffer_load_dwordx4 v236, s[8:11], s44 offen lds
    v_mfma_f32_16x16x32_bf16 v[114:117], v[222:225], v[146:149], v[114:117]
    v_mfma_f32_16x16x32_bf16 v[118:121], v[222:225], v[150:153], v[118:121]
    v_mfma_f32_16x16x32_bf16 v[122:125], v[222:225], v[154:157], v[122:125]
    s_add_u32 m0, s53, 23552
    s_nop 0
    buffer_load_dwordx4 v237, s[8:11], s44 offen lds
    v_mfma_f32_16x16x32_bf16 v[126:129], v[222:225], v[158:161], v[126:129]
    s_add_u32 s43, s43, 128
    s_add_u32 s44, s44, 524288
    s_add_u32 s46, s46, 49152
    s_cmp_eq_u32 s46, 147456
    s_cmov_b32 s46, 0
    s_add_u32 s52, s46, s54
    s_add_u32 s53, s46, s55
    s_add_u32 s45, s45, 1
    s_cmp_lt_u32 s45, 7
    s_waitcnt lgkmcnt(0)
    s_cbranch_scc1 L_gk_97
    v_mfma_f32_16x16x32_bf16 v[2:5], v[162:165], v[130:133], v[2:5]
    ds_read_b64_tr_b16 v[194:195], v240 offset:16384
    v_mfma_f32_16x16x32_bf16 v[6:9], v[162:165], v[134:137], v[6:9]
    ds_read_b64_tr_b16 v[196:197], v240 offset:18432
    v_mfma_f32_16x16x32_bf16 v[10:13], v[162:165], v[138:141], v[10:13]
    ds_read_b64_tr_b16 v[198:199], v241 offset:16384
    v_mfma_f32_16x16x32_bf16 v[14:17], v[162:165], v[142:145], v[14:17]
    ds_read_b64_tr_b16 v[200:201], v241 offset:18432
    v_mfma_f32_16x16x32_bf16 v[18:21], v[166:169], v[130:133], v[18:21]
    ds_read_b64_tr_b16 v[202:203], v242 offset:16384
    v_mfma_f32_16x16x32_bf16 v[22:25], v[166:169], v[134:137], v[22:25]
    v_mfma_f32_16x16x32_bf16 v[26:29], v[166:169], v[138:141], v[26:29]
    ds_read_b64_tr_b16 v[204:205], v242 offset:18432
    v_mfma_f32_16x16x32_bf16 v[30:33], v[166:169], v[142:145], v[30:33]
    ds_read_b64_tr_b16 v[206:207], v243 offset:16384
    v_mfma_f32_16x16x32_bf16 v[34:37], v[170:173], v[130:133], v[34:37]
    ds_read_b64_tr_b16 v[208:209], v243 offset:18432
    v_mfma_f32_16x16x32_bf16 v[38:41], v[170:173], v[134:137], v[38:41]
    ds_read_b64_tr_b16 v[210:211], v244 offset:16384
    v_mfma_f32_16x16x32_bf16 v[42:45], v[170:173], v[138:141], v[42:45]
    ds_read_b64_tr_b16 v[212:213], v244 offset:18432
    v_mfma_f32_16x16x32_bf16 v[46:49], v[170:173], v[142:145], v[46:49]
    v_mfma_f32_16x16x32_bf16 v[50:53], v[174:177], v[130:133], v[50:53]
    ds_read_b64_tr_b16 v[214:215], v245 offset:16384
    v_mfma_f32_16x16x32_bf16 v[54:57], v[174:177], v[134:137], v[54:57]
    ds_read_b64_tr_b16 v[216:217], v245 offset:18432
    v_mfma_f32_16x16x32_bf16 v[58:61], v[174:177], v[138:141], v[58:61]
    ds_read_b64_tr_b16 v[218:219], v246 offset:16384
    v_mfma_f32_16x16x32_bf16 v[62:65], v[174:177], v[142:145], v[62:65]
    ds_read_b64_tr_b16 v[220:221], v246 offset:18432
    v_mfma_f32_16x16x32_bf16 v[66:69], v[178:181], v[130:133], v[66:69]
    ds_read_b64_tr_b16 v[222:223], v247 offset:16384
    v_mfma_f32_16x16x32_bf16 v[70:73], v[178:181], v[134:137], v[70:73]
    v_mfma_f32_16x16x32_bf16 v[74:77], v[178:181], v[138:141], v[74:77]
    ds_read_b64_tr_b16 v[224:225], v247 offset:18432
    v_mfma_f32_16x16x32_bf16 v[78:81], v[178:181], v[142:145], v[78:81]
    ds_read_b128 v[146:149], v239 offset:0
    v_mfma_f32_16x16x32_bf16 v[82:85], v[182:185], v[130:133], v[82:85]
    ds_read_b128 v[150:153], v239 offset:2048
    v_mfma_f32_16x16x32_bf16 v[86:89], v[182:185], v[134:137], v[86:89]
    ds_read_b128 v[154:157], v239 offset:4096
    v_mfma_f32_16x16x32_bf16 v[90:93], v[182:185], v[138:141], v[90:93]
    ds_read_b128 v[158:161], v239 offset:6144
    v_mfma_f32_16x16x32_bf16 v[94:97], v[182:185], v[142:145], v[94:97]
    v_mfma_f32_16x16x32_bf16 v[98:101], v[186:189], v[130:133], v[98:101]
    v_mfma_f32_16x16x32_bf16 v[102:105], v[186:189], v[134:137], v[102:105]
    v_mfma_f32_16x16x32_bf16 v[106:109], v[186:189], v[138:141], v[106:109]
    v_mfma_f32_16x16x32_bf16 v[110:113], v[186:189], v[142:145], v[110:113]
    v_mfma_f32_16x16x32_bf16 v[114:117], v[190:193], v[130:133], v[114:117]
    v_mfma_f32_16x16x32_bf16 v[118:121], v[190:193], v[134:137], v[118:121]
    v_mfma_f32_16x16x32_bf16 v[122:125], v[190:193], v[138:141], v[122:125]
    v_mfma_f32_16x16x32_bf16 v[126:129], v[190:193], v[142:145], v[126:129]
    s_add_u32 s47, s47, 1
    s_cmp_eq_u32 s47, 3
    s_mov_b32 s49, 49152
    s_cmov_b32 s49, 0xfffe8000
    s_cmov_b32 s47, 0
    s_waitcnt lgkmcnt(0)
    v_add_u32 v238, s49, v238
    v_add_u32 v239, s49, v239
    v_add_u32 v240, s49, v240
    v_add_u32 v241, s49, v241
    v_add_u32 v242, s49, v242
    v_add_u32 v243, s49, v243
    v_add_u32 v244, s49, v244
    v_add_u32 v245, s49, v245
    v_add_u32 v246, s49, v246
    v_add_u32 v247, s49, v247
    s_waitcnt vmcnt(12)
    s_barrier
    v_mfma_f32_16x16x32_bf16 v[2:5], v[194:197], v[146:149], v[2:5]
    ds_read_b64_tr_b16 v[162:163], v240 offset:0
    v_mfma_f32_16x16x32_bf16 v[6:9], v[194:197], v[150:153], v[6:9]
    ds_read_b64_tr_b16 v[164:165], v240 offset:2048
    v_mfma_f32_16x16x32_bf16 v[10:13], v[194:197], v[154:157], v[10:13]
    ds_read_b64_tr_b16 v[166:167], v241 offset:0
    v_mfma_f32_16x16x32_bf16 v[14:17], v[194:197], v[158:161], v[14:17]
    ds_read_b64_tr_b16 v[168:169], v241 offset:2048
    v_mfma_f32_16x16x32_bf16 v[18:21], v[198:201], v[146:149], v[18:21]
    ds_read_b64_tr_b16 v[170:171], v242 offset:0
    v_mfma_f32_16x16x32_bf16 v[22:25], v[198:201], v[150:153], v[22:25]
    v_mfma_f32_16x16x32_bf16 v[26:29], v[198:201], v[154:157], v[26:29]
    ds_read_b64_tr_b16 v[172:173], v242 offset:2048
    v_mfma_f32_16x16x32_bf16 v[30:33], v[198:201], v[158:161], v[30:33]
    ds_read_b64_tr_b16 v[174:175], v243 offset:0
    v_mfma_f32_16x16x32_bf16 v[34:37], v[202:205], v[146:149], v[34:37]
    ds_read_b64_tr_b16 v[176:177], v243 offset:2048
    v_mfma_f32_16x16x32_bf16 v[38:41], v[202:205], v[150:153], v[38:41]
    ds_read_b64_tr_b16 v[178:179], v244 offset:0
    v_mfma_f32_16x16x32_bf16 v[42:45], v[202:205], v[154:157], v[42:45]
    ds_read_b64_tr_b16 v[180:181], v244 offset:2048
    v_mfma_f32_16x16x32_bf16 v[46:49], v[202:205], v[158:161], v[46:49]
    v_mfma_f32_16x16x32_bf16 v[50:53], v[206:209], v[146:149], v[50:53]
    ds_read_b64_tr_b16 v[182:183], v245 offset:0
    v_mfma_f32_16x16x32_bf16 v[54:57], v[206:209], v[150:153], v[54:57]
    ds_read_b64_tr_b16 v[184:185], v245 offset:2048
    v_mfma_f32_16x16x32_bf16 v[58:61], v[206:209], v[154:157], v[58:61]
    ds_read_b64_tr_b16 v[186:187], v246 offset:0
    v_mfma_f32_16x16x32_bf16 v[62:65], v[206:209], v[158:161], v[62:65]
    ds_read_b64_tr_b16 v[188:189], v246 offset:2048
    v_mfma_f32_16x16x32_bf16 v[66:69], v[210:213], v[146:149], v[66:69]
    ds_read_b64_tr_b16 v[190:191], v247 offset:0
    v_mfma_f32_16x16x32_bf16 v[70:73], v[210:213], v[150:153], v[70:73]
    v_mfma_f32_16x16x32_bf16 v[74:77], v[210:213], v[154:157], v[74:77]
    ds_read_b64_tr_b16 v[192:193], v247 offset:2048
    v_mfma_f32_16x16x32_bf16 v[78:81], v[210:213], v[158:161], v[78:81]
    ds_read_b128 v[130:133], v238 offset:0
    v_mfma_f32_16x16x32_bf16 v[82:85], v[214:217], v[146:149], v[82:85]
    ds_read_b128 v[134:137], v238 offset:2048
    v_mfma_f32_16x16x32_bf16 v[86:89], v[214:217], v[150:153], v[86:89]
    ds_read_b128 v[138:141], v238 offset:4096
    v_mfma_f32_16x16x32_bf16 v[90:93], v[214:217], v[154:157], v[90:93]
    ds_read_b128 v[142:145], v238 offset:6144
    v_mfma_f32_16x16x32_bf16 v[94:97], v[214:217], v[158:161], v[94:97]
    v_mfma_f32_16x16x32_bf16 v[98:101], v[218:221], v[146:149], v[98:101]
    v_mfma_f32_16x16x32_bf16 v[102:105], v[218:221], v[150:153], v[102:105]
    v_mfma_f32_16x16x32_bf16 v[106:109], v[218:221], v[154:157], v[106:109]
    v_mfma_f32_16x16x32_bf16 v[110:113], v[218:221], v[158:161], v[110:113]
    v_mfma_f32_16x16x32_bf16 v[114:117], v[222:225], v[146:149], v[114:117]
    v_mfma_f32_16x16x32_bf16 v[118:121], v[222:225], v[150:153], v[118:121]
    v_mfma_f32_16x16x32_bf16 v[122:125], v[222:225], v[154:157], v[122:125]
    v_mfma_f32_16x16x32_bf16 v[126:129], v[222:225], v[158:161], v[126:129]
    s_waitcnt lgkmcnt(0)
    v_mfma_f32_16x16x32_bf16 v[2:5], v[162:165], v[130:133], v[2:5]
    ds_read_b64_tr_b16 v[194:195], v240 offset:16384
    v_mfma_f32_16x16x32_bf16 v[6:9], v[162:165], v[134:137], v[6:9]
    ds_read_b64_tr_b16 v[196:197], v240 offset:18432
    v_mfma_f32_16x16x32_bf16 v[10:13], v[162:165], v[138:141], v[10:13]
    ds_read_b64_tr_b16 v[198:199], v241 offset:16384
    v_mfma_f32_16x16x32_bf16 v[14:17], v[162:165], v[142:145], v[14:17]
    ds_read_b64_tr_b16 v[200:201], v241 offset:18432
    v_mfma_f32_16x16x32_bf16 v[18:21], v[166:169], v[130:133], v[18:21]
    ds_read_b64_tr_b16 v[202:203], v242 offset:16384
    v_mfma_f32_16x16x32_bf16 v[22:25], v[166:169], v[134:137], v[22:25]
    v_mfma_f32_16x16x32_bf16 v[26:29], v[166:169], v[138:141], v[26:29]
    ds_read_b64_tr_b16 v[204:205], v242 offset:18432
    v_mfma_f32_16x16x32_bf16 v[30:33], v[166:169], v[142:145], v[30:33]
    ds_read_b64_tr_b16 v[206:207], v243 offset:16384
    v_mfma_f32_16x16x32_bf16 v[34:37], v[170:173], v[130:133], v[34:37]
    ds_read_b64_tr_b16 v[208:209], v243 offset:18432
    v_mfma_f32_16x16x32_bf16 v[38:41], v[170:173], v[134:137], v[38:41]
    ds_read_b64_tr_b16 v[210:211], v244 offset:16384
    v_mfma_f32_16x16x32_bf16 v[42:45], v[170:173], v[138:141], v[42:45]
    ds_read_b64_tr_b16 v[212:213], v244 offset:18432
    v_mfma_f32_16x16x32_bf16 v[46:49], v[170:173], v[142:145], v[46:49]
    v_mfma_f32_16x16x32_bf16 v[50:53], v[174:177], v[130:133], v[50:53]
    ds_read_b64_tr_b16 v[214:215], v245 offset:16384
    v_mfma_f32_16x16x32_bf16 v[54:57], v[174:177], v[134:137], v[54:57]
    ds_read_b64_tr_b16 v[216:217], v245 offset:18432
    v_mfma_f32_16x16x32_bf16 v[58:61], v[174:177], v[138:141], v[58:61]
    ds_read_b64_tr_b16 v[218:219], v246 offset:16384
    v_mfma_f32_16x16x32_bf16 v[62:65], v[174:177], v[142:145], v[62:65]
    ds_read_b64_tr_b16 v[220:221], v246 offset:18432
    v_mfma_f32_16x16x32_bf16 v[66:69], v[178:181], v[130:133], v[66:69]
    ds_read_b64_tr_b16 v[222:223], v247 offset:16384
    v_mfma_f32_16x16x32_bf16 v[70:73], v[178:181], v[134:137], v[70:73]
    v_mfma_f32_16x16x32_bf16 v[74:77], v[178:181], v[138:141], v[74:77]
    ds_read_b64_tr_b16 v[224:225], v247 offset:18432
    v_mfma_f32_16x16x32_bf16 v[78:81], v[178:181], v[142:145], v[78:81]
    ds_read_b128 v[146:149], v239 offset:0
    v_mfma_f32_16x16x32_bf16 v[82:85], v[182:185], v[130:133], v[82:85]
    ds_read_b128 v[150:153], v239 offset:2048
    v_mfma_f32_16x16x32_bf16 v[86:89], v[182:185], v[134:137], v[86:89]
    ds_read_b128 v[154:157], v239 offset:4096
    v_mfma_f32_16x16x32_bf16 v[90:93], v[182:185], v[138:141], v[90:93]
    ds_read_b128 v[158:161], v239 offset:6144
    v_mfma_f32_16x16x32_bf16 v[94:97], v[182:185], v[142:145], v[94:97]
    v_mfma_f32_16x16x32_bf16 v[98:101], v[186:189], v[130:133], v[98:101]
    v_mfma_f32_16x16x32_bf16 v[102:105], v[186:189], v[134:137], v[102:105]
    v_mfma_f32_16x16x32_bf16 v[106:109], v[186:189], v[138:141], v[106:109]
    v_mfma_f32_16x16x32_bf16 v[110:113], v[186:189], v[142:145], v[110:113]
    v_mfma_f32_16x16x32_bf16 v[114:117], v[190:193], v[130:133], v[114:117]
    v_mfma_f32_16x16x32_bf16 v[118:121], v[190:193], v[134:137], v[118:121]
    v_mfma_f32_16x16x32_bf16 v[122:125], v[190:193], v[138:141], v[122:125]
    v_mfma_f32_16x16x32_bf16 v[126:129], v[190:193], v[142:145], v[126:129]
    s_add_u32 s47, s47, 1
    s_cmp_eq_u32 s47, 3
    s_mov_b32 s49, 49152
    s_cmov_b32 s49, 0xfffe8000
    s_cmov_b32 s47, 0
    s_waitcnt lgkmcnt(0)
    v_add_u32 v238, s49, v238
    v_add_u32 v239, s49, v239
    v_add_u32 v240, s49, v240
    v_add_u32 v241, s49, v241
    v_add_u32 v242, s49, v242
    v_add_u32 v243, s49, v243
    v_add_u32 v244, s49, v244
    v_add_u32 v245, s49, v245
    v_add_u32 v246, s49, v246
    v_add_u32 v247, s49, v247
    s_waitcnt vmcnt(0)
    s_barrier
    v_mfma_f32_16x16x32_bf16 v[2:5], v[194:197], v[146:149], v[2:5]
    ds_read_b64_tr_b16 v[162:163], v240 offset:0
    v_mfma_f32_16x16x32_bf16 v[6:9], v[194:197], v[150:153], v[6:9]
    ds_read_b64_tr_b16 v[164:165], v240 offset:2048
    v_mfma_f32_16x16x32_bf16 v[10:13], v[194:197], v[154:157], v[10:13]
    ds_read_b64_tr_b16 v[166:167], v241 offset:0
    v_mfma_f32_16x16x32_bf16 v[14:17], v[194:197], v[158:161], v[14:17]
    ds_read_b64_tr_b16 v[168:169], v241 offset:2048
    v_mfma_f32_16x16x32_bf16 v[18:21], v[198:201], v[146:149], v[18:21]
    ds_read_b64_tr_b16 v[170:171], v242 offset:0
    v_mfma_f32_16x16x32_bf16 v[22:25], v[198:201], v[150:153], v[22:25]
    v_mfma_f32_16x16x32_bf16 v[26:29], v[198:201], v[154:157], v[26:29]
    ds_read_b64_tr_b16 v[172:173], v242 offset:2048
    v_mfma_f32_16x16x32_bf16 v[30:33], v[198:201], v[158:161], v[30:33]
    ds_read_b64_tr_b16 v[174:175], v243 offset:0
    v_mfma_f32_16x16x32_bf16 v[34:37], v[202:205], v[146:149], v[34:37]
    ds_read_b64_tr_b16 v[176:177], v243 offset:2048
    v_mfma_f32_16x16x32_bf16 v[38:41], v[202:205], v[150:153], v[38:41]
    ds_read_b64_tr_b16 v[178:179], v244 offset:0
    v_mfma_f32_16x16x32_bf16 v[42:45], v[202:205], v[154:157], v[42:45]
    ds_read_b64_tr_b16 v[180:181], v244 offset:2048
    v_mfma_f32_16x16x32_bf16 v[46:49], v[202:205], v[158:161], v[46:49]
    v_mfma_f32_16x16x32_bf16 v[50:53], v[206:209], v[146:149], v[50:53]
    ds_read_b64_tr_b16 v[182:183], v245 offset:0
    v_mfma_f32_16x16x32_bf16 v[54:57], v[206:209], v[150:153], v[54:57]
    ds_read_b64_tr_b16 v[184:185], v245 offset:2048
    v_mfma_f32_16x16x32_bf16 v[58:61], v[206:209], v[154:157], v[58:61]
    ds_read_b64_tr_b16 v[186:187], v246 offset:0
    v_mfma_f32_16x16x32_bf16 v[62:65], v[206:209], v[158:161], v[62:65]
    ds_read_b64_tr_b16 v[188:189], v246 offset:2048
    v_mfma_f32_16x16x32_bf16 v[66:69], v[210:213], v[146:149], v[66:69]
    ds_read_b64_tr_b16 v[190:191], v247 offset:0
    v_mfma_f32_16x16x32_bf16 v[70:73], v[210:213], v[150:153], v[70:73]
    v_mfma_f32_16x16x32_bf16 v[74:77], v[210:213], v[154:157], v[74:77]
    ds_read_b64_tr_b16 v[192:193], v247 offset:2048
    v_mfma_f32_16x16x32_bf16 v[78:81], v[210:213], v[158:161], v[78:81]
    ds_read_b128 v[130:133], v238 offset:0
    v_mfma_f32_16x16x32_bf16 v[82:85], v[214:217], v[146:149], v[82:85]
    ds_read_b128 v[134:137], v238 offset:2048
    v_mfma_f32_16x16x32_bf16 v[86:89], v[214:217], v[150:153], v[86:89]
    ds_read_b128 v[138:141], v238 offset:4096
    v_mfma_f32_16x16x32_bf16 v[90:93], v[214:217], v[154:157], v[90:93]
    ds_read_b128 v[142:145], v238 offset:6144
    v_mfma_f32_16x16x32_bf16 v[94:97], v[214:217], v[158:161], v[94:97]
    v_mfma_f32_16x16x32_bf16 v[98:101], v[218:221], v[146:149], v[98:101]
    v_mfma_f32_16x16x32_bf16 v[102:105], v[218:221], v[150:153], v[102:105]
    v_mfma_f32_16x16x32_bf16 v[106:109], v[218:221], v[154:157], v[106:109]
    v_mfma_f32_16x16x32_bf16 v[110:113], v[218:221], v[158:161], v[110:113]
    v_mfma_f32_16x16x32_bf16 v[114:117], v[222:225], v[146:149], v[114:117]
    v_mfma_f32_16x16x32_bf16 v[118:121], v[222:225], v[150:153], v[118:121]
    v_mfma_f32_16x16x32_bf16 v[122:125], v[222:225], v[154:157], v[122:125]
    v_mfma_f32_16x16x32_bf16 v[126:129], v[222:225], v[158:161], v[126:129]
    s_waitcnt lgkmcnt(0)
    v_mfma_f32_16x16x32_bf16 v[2:5], v[162:165], v[130:133], v[2:5]
    ds_read_b64_tr_b16 v[194:195], v240 offset:16384
    v_mfma_f32_16x16x32_bf16 v[6:9], v[162:165], v[134:137], v[6:9]
    ds_read_b64_tr_b16 v[196:197], v240 offset:18432
    v_mfma_f32_16x16x32_bf16 v[10:13], v[162:165], v[138:141], v[10:13]
    ds_read_b64_tr_b16 v[198:199], v241 offset:16384
    v_mfma_f32_16x16x32_bf16 v[14:17], v[162:165], v[142:145], v[14:17]
    ds_read_b64_tr_b16 v[200:201], v241 offset:18432
    v_mfma_f32_16x16x32_bf16 v[18:21], v[166:169], v[130:133], v[18:21]
    ds_read_b64_tr_b16 v[202:203], v242 offset:16384
    v_mfma_f32_16x16x32_bf16 v[22:25], v[166:169], v[134:137], v[22:25]
    v_mfma_f32_16x16x32_bf16 v[26:29], v[166:169], v[138:141], v[26:29]
    ds_read_b64_tr_b16 v[204:205], v242 offset:18432
    v_mfma_f32_16x16x32_bf16 v[30:33], v[166:169], v[142:145], v[30:33]
    ds_read_b64_tr_b16 v[206:207], v243 offset:16384
    v_mfma_f32_16x16x32_bf16 v[34:37], v[170:173], v[130:133], v[34:37]
    ds_read_b64_tr_b16 v[208:209], v243 offset:18432
    v_mfma_f32_16x16x32_bf16 v[38:41], v[170:173], v[134:137], v[38:41]
    ds_read_b64_tr_b16 v[210:211], v244 offset:16384
    v_mfma_f32_16x16x32_bf16 v[42:45], v[170:173], v[138:141], v[42:45]
    ds_read_b64_tr_b16 v[212:213], v244 offset:18432
    v_mfma_f32_16x16x32_bf16 v[46:49], v[170:173], v[142:145], v[46:49]
    v_mfma_f32_16x16x32_bf16 v[50:53], v[174:177], v[130:133], v[50:53]
    ds_read_b64_tr_b16 v[214:215], v245 offset:16384
    v_mfma_f32_16x16x32_bf16 v[54:57], v[174:177], v[134:137], v[54:57]
    ds_read_b64_tr_b16 v[216:217], v245 offset:18432
    v_mfma_f32_16x16x32_bf16 v[58:61], v[174:177], v[138:141], v[58:61]
    ds_read_b64_tr_b16 v[218:219], v246 offset:16384
    v_mfma_f32_16x16x32_bf16 v[62:65], v[174:177], v[142:145], v[62:65]
    ds_read_b64_tr_b16 v[220:221], v246 offset:18432
    v_mfma_f32_16x16x32_bf16 v[66:69], v[178:181], v[130:133], v[66:69]
    ds_read_b64_tr_b16 v[222:223], v247 offset:16384
    v_mfma_f32_16x16x32_bf16 v[70:73], v[178:181], v[134:137], v[70:73]
    v_mfma_f32_16x16x32_bf16 v[74:77], v[178:181], v[138:141], v[74:77]
    ds_read_b64_tr_b16 v[224:225], v247 offset:18432
    v_mfma_f32_16x16x32_bf16 v[78:81], v[178:181], v[142:145], v[78:81]
    ds_read_b128 v[146:149], v239 offset:0
    v_mfma_f32_16x16x32_bf16 v[82:85], v[182:185], v[130:133], v[82:85]
    ds_read_b128 v[150:153], v239 offset:2048
    v_mfma_f32_16x16x32_bf16 v[86:89], v[182:185], v[134:137], v[86:89]
    ds_read_b128 v[154:157], v239 offset:4096
    v_mfma_f32_16x16x32_bf16 v[90:93], v[182:185], v[138:141], v[90:93]
    ds_read_b128 v[158:161], v239 offset:6144
    v_mfma_f32_16x16x32_bf16 v[94:97], v[182:185], v[142:145], v[94:97]
    v_mfma_f32_16x16x32_bf16 v[98:101], v[186:189], v[130:133], v[98:101]
    v_mfma_f32_16x16x32_bf16 v[102:105], v[186:189], v[134:137], v[102:105]
    v_mfma_f32_16x16x32_bf16 v[106:109], v[186:189], v[138:141], v[106:109]
    v_mfma_f32_16x16x32_bf16 v[110:113], v[186:189], v[142:145], v[110:113]
    v_mfma_f32_16x16x32_bf16 v[114:117], v[190:193], v[130:133], v[114:117]
    v_mfma_f32_16x16x32_bf16 v[118:121], v[190:193], v[134:137], v[118:121]
    v_mfma_f32_16x16x32_bf16 v[122:125], v[190:193], v[138:141], v[122:125]
    v_mfma_f32_16x16x32_bf16 v[126:129], v[190:193], v[142:145], v[126:129]
    s_waitcnt lgkmcnt(0)
    v_mfma_f32_16x16x32_bf16 v[2:5], v[194:197], v[146:149], v[2:5]
    v_mfma_f32_16x16x32_bf16 v[6:9], v[194:197], v[150:153], v[6:9]
    v_mfma_f32_16x16x32_bf16 v[10:13], v[194:197], v[154:157], v[10:13]
    v_mfma_f32_16x16x32_bf16 v[14:17], v[194:197], v[158:161], v[14:17]
    v_mfma_f32_16x16x32_bf16 v[18:21], v[198:201], v[146:149], v[18:21]
    v_mfma_f32_16x16x32_bf16 v[22:25], v[198:201], v[150:153], v[22:25]
    v_mfma_f32_16x16x32_bf16 v[26:29], v[198:201], v[154:157], v[26:29]
    v_mfma_f32_16x16x32_bf16 v[30:33], v[198:201], v[158:161], v[30:33]
    v_mfma_f32_16x16x32_bf16 v[34:37], v[202:205], v[146:149], v[34:37]
    v_mfma_f32_16x16x32_bf16 v[38:41], v[202:205], v[150:153], v[38:41]
    v_mfma_f32_16x16x32_bf16 v[42:45], v[202:205], v[154:157], v[42:45]
    v_mfma_f32_16x16x32_bf16 v[46:49], v[202:205], v[158:161], v[46:49]
    v_mfma_f32_16x16x32_bf16 v[50:53], v[206:209], v[146:149], v[50:53]
    v_mfma_f32_16x16x32_bf16 v[54:57], v[206:209], v[150:153], v[54:57]
    v_mfma_f32_16x16x32_bf16 v[58:61], v[206:209], v[154:157], v[58:61]
    v_mfma_f32_16x16x32_bf16 v[62:65], v[206:209], v[158:161], v[62:65]
    v_mfma_f32_16x16x32_bf16 v[66:69], v[210:213], v[146:149], v[66:69]
    v_mfma_f32_16x16x32_bf16 v[70:73], v[210:213], v[150:153], v[70:73]
    v_mfma_f32_16x16x32_bf16 v[74:77], v[210:213], v[154:157], v[74:77]
    v_mfma_f32_16x16x32_bf16 v[78:81], v[210:213], v[158:161], v[78:81]
    v_mfma_f32_16x16x32_bf16 v[82:85], v[214:217], v[146:149], v[82:85]
    v_mfma_f32_16x16x32_bf16 v[86:89], v[214:217], v[150:153], v[86:89]
    v_mfma_f32_16x16x32_bf16 v[90:93], v[214:217], v[154:157], v[90:93]
    v_mfma_f32_16x16x32_bf16 v[94:97], v[214:217], v[158:161], v[94:97]
    v_mfma_f32_16x16x32_bf16 v[98:101], v[218:221], v[146:149], v[98:101]
    v_mfma_f32_16x16x32_bf16 v[102:105], v[218:221], v[150:153], v[102:105]
    v_mfma_f32_16x16x32_bf16 v[106:109], v[218:221], v[154:157], v[106:109]
    v_mfma_f32_16x16x32_bf16 v[110:113], v[218:221], v[158:161], v[110:113]
    v_mfma_f32_16x16x32_bf16 v[114:117], v[222:225], v[146:149], v[114:117]
    v_mfma_f32_16x16x32_bf16 v[118:121], v[222:225], v[150:153], v[118:121]
    v_mfma_f32_16x16x32_bf16 v[122:125], v[222:225], v[154:157], v[122:125]
    v_mfma_f32_16x16x32_bf16 v[126:129], v[222:225], v[158:161], v[126:129]
    s_waitcnt vmcnt(0)
    s_nop 7
    s_nop 3
    s_barrier
    s_mul_i32 s48, s40, 17408
    s_add_u32 s48, s48, 0
    v_mul_u32_u24 v252, 272, v249
    v_lshl_add_u32 v252, v250, 3, v252
    v_add_u32 v252, s48, v252
    v_cvt_pk_bf16_f32 v2, v2, v3
    v_cvt_pk_bf16_f32 v3, v4, v5
    ds_write_b64 v252, v[2:3] offset:0
    v_cvt_pk_bf16_f32 v6, v6, v7
    v_cvt_pk_bf16_f32 v7, v8, v9
    ds_write_b64 v252, v[6:7] offset:4352
    v_cvt_pk_bf16_f32 v10, v10, v11
    v_cvt_pk_bf16_f32 v11, v12, v13
    ds_write_b64 v252, v[10:11] offset:8704
    v_cvt_pk_bf16_f32 v14, v14, v15
    v_cvt_pk_bf16_f32 v15, v16, v17
    ds_write_b64 v252, v[14:15] offset:13056
    v_cvt_pk_bf16_f32 v18, v18, v19
    v_cvt_pk_bf16_f32 v19, v20, v21
    ds_write_b64 v252, v[18:19] offset:32
    v_cvt_pk_bf16_f32 v22, v22, v23
    v_cvt_pk_bf16_f32 v23, v24, v25
    ds_write_b64 v252, v[22:23] offset:4384
    v_cvt_pk_bf16_f32 v26, v26, v27
    v_cvt_pk_bf16_f32 v27, v28, v29
    ds_write_b64 v252, v[26:27] offset:8736
    v_cvt_pk_bf16_f32 v30, v30, v31
    v_cvt_pk_bf16_f32 v31, v32, v33
    ds_write_b64 v252, v[30:31] offset:13088
    v_cvt_pk_bf16_f32 v34, v34, v35
    v_cvt_pk_bf16_f32 v35, v36, v37
    ds_write_b64 v252, v[34:35] offset:64
    v_cvt_pk_bf16_f32 v38, v38, v39
    v_cvt_pk_bf16_f32 v39, v40, v41
    ds_write_b64 v252, v[38:39] offset:4416
    v_cvt_pk_bf16_f32 v42, v42, v43
    v_cvt_pk_bf16_f32 v43, v44, v45
    ds_write_b64 v252, v[42:43] offset:8768
    v_cvt_pk_bf16_f32 v46, v46, v47
    v_cvt_pk_bf16_f32 v47, v48, v49
    ds_write_b64 v252, v[46:47] offset:13120
    v_cvt_pk_bf16_f32 v50, v50, v51
    v_cvt_pk_bf16_f32 v51, v52, v53
    ds_write_b64 v252, v[50:51] offset:96
    v_cvt_pk_bf16_f32 v54, v54, v55
    v_cvt_pk_bf16_f32 v55, v56, v57
    ds_write_b64 v252, v[54:55] offset:4448
    v_cvt_pk_bf16_f32 v58, v58, v59
    v_cvt_pk_bf16_f32 v59, v60, v61
    ds_write_b64 v252, v[58:59] offset:8800
    v_cvt_pk_bf16_f32 v62, v62, v63
    v_cvt_pk_bf16_f32 v63, v64, v65
    ds_write_b64 v252, v[62:63] offset:13152
    v_cvt_pk_bf16_f32 v66, v66, v67
    v_cvt_pk_bf16_f32 v67, v68, v69
    ds_write_b64 v252, v[66:67] offset:128
    v_cvt_pk_bf16_f32 v70, v70, v71
    v_cvt_pk_bf16_f32 v71, v72, v73
    ds_write_b64 v252, v[70:71] offset:4480
    v_cvt_pk_bf16_f32 v74, v74, v75
    v_cvt_pk_bf16_f32 v75, v76, v77
    ds_write_b64 v252, v[74:75] offset:8832
    v_cvt_pk_bf16_f32 v78, v78, v79
    v_cvt_pk_bf16_f32 v79, v80, v81
    ds_write_b64 v252, v[78:79] offset:13184
    v_cvt_pk_bf16_f32 v82, v82, v83
    v_cvt_pk_bf16_f32 v83, v84, v85
    ds_write_b64 v252, v[82:83] offset:160
    v_cvt_pk_bf16_f32 v86, v86, v87
    v_cvt_pk_bf16_f32 v87, v88, v89
    ds_write_b64 v252, v[86:87] offset:4512
    v_cvt_pk_bf16_f32 v90, v90, v91
    v_cvt_pk_bf16_f32 v91, v92, v93
    ds_write_b64 v252, v[90:91] offset:8864
    v_cvt_pk_bf16_f32 v94, v94, v95
    v_cvt_pk_bf16_f32 v95, v96, v97
    ds_write_b64 v252, v[94:95] offset:13216
    v_cvt_pk_bf16_f32 v98, v98, v99
    v_cvt_pk_bf16_f32 v99, v100, v101
    ds_write_b64 v252, v[98:99] offset:192
    v_cvt_pk_bf16_f32 v102, v102, v103
    v_cvt_pk_bf16_f32 v103, v104, v105
    ds_write_b64 v252, v[102:103] offset:4544
    v_cvt_pk_bf16_f32 v106, v106, v107
    v_cvt_pk_bf16_f32 v107, v108, v109
    ds_write_b64 v252, v[106:107] offset:8896
    v_cvt_pk_bf16_f32 v110, v110, v111
    v_cvt_pk_bf16_f32 v111, v112, v113
    ds_write_b64 v252, v[110:111] offset:13248
    v_cvt_pk_bf16_f32 v114, v114, v115
    v_cvt_pk_bf16_f32 v115, v116, v117
    ds_write_b64 v252, v[114:115] offset:224
    v_cvt_pk_bf16_f32 v118, v118, v119
    v_cvt_pk_bf16_f32 v119, v120, v121
    ds_write_b64 v252, v[118:119] offset:4576
    v_cvt_pk_bf16_f32 v122, v122, v123
    v_cvt_pk_bf16_f32 v123, v124, v125
    ds_write_b64 v252, v[122:123] offset:8928
    v_cvt_pk_bf16_f32 v126, v126, v127
    v_cvt_pk_bf16_f32 v127, v128, v129
    ds_write_b64 v252, v[126:127] offset:13280
    v_lshrrev_b32 v253, 4, v248
    v_and_b32 v254, 15, v248
    s_mov_b32 s50, 8192
    v_mul_lo_u32 v255, v253, s50
    v_mul_u32_u24 v253, 272, v253
    v_lshl_add_u32 v253, v254, 4, v253
    v_add_u32 v253, s48, v253
    v_lshl_add_u32 v254, v254, 4, v255
    s_mul_i32 s48, s41, 524288
    s_mul_i32 s49, s42, 256
    s_add_u32 s48, s48, s49
    s_add_u32 s48, s48, s16
    s_waitcnt lgkmcnt(0)
    ds_read_b128 v[2:5], v253 offset:0
    ds_read_b128 v[6:9], v253 offset:1088
    ds_read_b128 v[10:13], v253 offset:2176
    ds_read_b128 v[14:17], v253 offset:3264
    ds_read_b128 v[18:21], v253 offset:4352
    ds_read_b128 v[22:25], v253 offset:5440
    ds_read_b128 v[26:29], v253 offset:6528
    ds_read_b128 v[30:33], v253 offset:7616
    ds_read_b128 v[34:37], v253 offset:8704
    ds_read_b128 v[38:41], v253 offset:9792
    ds_read_b128 v[42:45], v253 offset:10880
    ds_read_b128 v[46:49], v253 offset:11968
    ds_read_b128 v[50:53], v253 offset:13056
    ds_read_b128 v[54:57], v253 offset:14144
    ds_read_b128 v[58:61], v253 offset:15232
    ds_read_b128 v[62:65], v253 offset:16320
    s_waitcnt lgkmcnt(15)
    buffer_store_dwordx4 v[2:5], v254, s[4:7], s48 offen sc1
    s_add_u32 s48, s48, 32768
    s_waitcnt lgkmcnt(14)
    buffer_store_dwordx4 v[6:9], v254, s[4:7], s48 offen sc1
    s_add_u32 s48, s48, 32768
    s_waitcnt lgkmcnt(13)
    buffer_store_dwordx4 v[10:13], v254, s[4:7], s48 offen sc1
    s_add_u32 s48, s48, 32768
    s_waitcnt lgkmcnt(12)
    buffer_store_dwordx4 v[14:17], v254, s[4:7], s48 offen sc1
    s_add_u32 s48, s48, 32768
    s_waitcnt lgkmcnt(11)
    buffer_store_dwordx4 v[18:21], v254, s[4:7], s48 offen sc1
    s_add_u32 s48, s48, 32768
    s_waitcnt lgkmcnt(10)
    buffer_store_dwordx4 v[22:25], v254, s[4:7], s48 offen sc1
    s_add_u32 s48, s48, 32768
    s_waitcnt lgkmcnt(9)
    buffer_store_dwordx4 v[26:29], v254, s[4:7], s48 offen sc1
    s_add_u32 s48, s48, 32768
    s_waitcnt lgkmcnt(8)
    buffer_store_dwordx4 v[30:33], v254, s[4:7], s48 offen sc1
    s_add_u32 s48, s48, 32768
    s_waitcnt lgkmcnt(7)
    buffer_store_dwordx4 v[34:37], v254, s[4:7], s48 offen sc1
    s_add_u32 s48, s48, 32768
    s_waitcnt lgkmcnt(6)
    buffer_store_dwordx4 v[38:41], v254, s[4:7], s48 offen sc1
    s_add_u32 s48, s48, 32768
    s_waitcnt lgkmcnt(5)
    buffer_store_dwordx4 v[42:45], v254, s[4:7], s48 offen sc1
    s_add_u32 s48, s48, 32768
    s_waitcnt lgkmcnt(4)
    buffer_store_dwordx4 v[46:49], v254, s[4:7], s48 offen sc1
    s_add_u32 s48, s48, 32768
    s_waitcnt lgkmcnt(3)
    buffer_store_dwordx4 v[50:53], v254, s[4:7], s48 offen sc1
    s_add_u32 s48, s48, 32768
    s_waitcnt lgkmcnt(2)
    buffer_store_dwordx4 v[54:57], v254, s[4:7], s48 offen sc1
    s_add_u32 s48, s48, 32768
    s_waitcnt lgkmcnt(1)
    buffer_store_dwordx4 v[58:61], v254, s[4:7], s48 offen sc1
    s_add_u32 s48, s48, 32768
    s_waitcnt lgkmcnt(0)
    buffer_store_dwordx4 v[62:65], v254, s[4:7], s48 offen sc1
    s_add_u32 s48, s48, 32768
    s_cmp_eq_u32 s82, 0
    s_cselect_b32 s77, 16, 0
    s_add_u32 s77, s77, s74
    s_lshl_b32 s77, s77, 7
    s_add_u32 s77, s77, 786432
    s_waitcnt vmcnt(0)
    s_barrier
    s_cmp_lg_u32 s26, 0
    s_cbranch_scc1 L_sig_98
    v_mov_b32 v1, 0
    v_mov_b32 v2, 2
    s_mov_b64 exec, 1
    buffer_atomic_add v2, v1, s[4:7], s77 offen
    s_mov_b64 exec, -1
L_sig_98:
    s_add_u32 s73, s73, 1
    s_cmp_lt_u32 s73, 4
    s_cbranch_scc1 L_qkv_93
    s_mov_b32 s73, 4
    s_mov_b32 s90, 0
    s_cmp_lg_u32 s26, 0
    s_cbranch_scc1 L_dd_100
    s_mov_b32 s79, 0x200000
    v_mov_b32 v2, 136
L_dw_99:
    global_load_dword v3, v2, s[100:101] sc1
    s_waitcnt vmcnt(0)
    v_readfirstlane_b32 s78, v3
    s_nop 0
    s_cmp_ge_u32 s78, 40
    s_cbranch_scc1 L_dd_100
    s_sleep 6
    s_sub_u32 s79, s79, 1
    s_cbranch_scc0 L_dw_99
L_dd_100:
    s_barrier
    s_mov_b32 s75, s70
L_task_101:
    s_cmp_ge_u32 s75, 2062
    s_cbranch_scc1 L_wend_107
    s_sub_u32 s76, s75, 1870
    s_cmp_ge_u32 s75, 1870
    s_cbranch_scc1 L_m2t_109
    s_sub_u32 s76, s75, 1735
    s_cmp_ge_u32 s75, 1799
    s_cbranch_scc1 L_m1b_108
    s_mov_b32 s78, s75
    s_cmp_lt_u32 s75, 1144
    s_cbranch_scc1 L_reg_106
    s_sub_u32 s76, s75, 1144
    s_cmp_lt_u32 s76, 135
    s_cbranch_scc1 L_m1_105
    s_sub_u32 s78, s75, 135
L_reg_106:
    s_mul_hi_u32 s74, s78, 0x2762763
    s_mul_i32 s77, s74, 104
    s_sub_u32 s76, s78, s77
    s_cmp_ge_u32 s76, 72
    s_cbranch_scc1 L_fin_103
    s_cmp_ge_u32 s76, 32
    s_cbranch_scc1 L_wo_102
    s_lshl_b32 s21, s74, 2
    s_lshr_b32 s22, s76, 3
    s_add_u32 s21, s21, s22
    s_and_b32 s22, s76, 7
    s_lshl_b32 s22, s22, 2
    s_add_u32 s22, s22, s26
    s_mul_i32 s23, s26, 10240
    s_lshl_b32 s77, s74, 7
    s_add_u32 s77, s77, 788480
    s_cmp_lg_u32 s26, 0
    s_cbranch_scc1 L_wgw_110
    s_mov_b32 s79, 0x200000
    v_mov_b32 v2, 0
L_cw_111:
    buffer_load_dword v3, v2, s[4:7], s77 offen sc1
    s_waitcnt vmcnt(0)
    v_readfirstlane_b32 s78, v3
    s_nop 0
    s_cmp_ge_u32 s78, 32
    s_cbranch_scc1 L_cd_112
    s_sleep 2
    s_sub_u32 s79, s79, 1
    s_cbranch_scc0 L_cw_111
L_cd_112:
L_wgw_110:
    s_barrier
    s_lshl_b32 s77, s74, 7
    s_add_u32 s77, s77, 786432
    s_cmp_lg_u32 s26, 0
    s_cbranch_scc1 L_wgw_113
    s_mov_b32 s79, 0x200000
    v_mov_b32 v2, 0
L_cw_114:
    buffer_load_dword v3, v2, s[4:7], s77 offen sc1
    s_waitcnt vmcnt(0)
    v_readfirstlane_b32 s78, v3
    s_nop 0
    s_cmp_ge_u32 s78, 64
    s_cbranch_scc1 L_cd_115
    s_sleep 2
    s_sub_u32 s79, s79, 1
    s_cbranch_scc0 L_cw_114
L_cd_115:
L_wgw_113:
    s_barrier
    v_and_b32 v1, 63, v0
    v_and_b32 v2, 15, v1
    v_lshrrev_b32 v3, 4, v1
    s_lshl_b32 s30, s21, 18
    s_lshl_b32 s31, s22, 8
    s_add_u32 s30, s30, s31
    v_lshlrev_b32 v4, 13, v2
    v_lshl_add_u32 v4, v3, 4, v4
    s_add_u32 s31, s30, 16777216
    s_add_u32 s32, s30, 33554432
    s_add_u32 s33, s30, 50331648
    v_add_u32 v5, 0, v3
    v_lshlrev_b32 v5, 1, v5
    v_xor_b32 v5, v5, v2
    v_lshlrev_b32 v5, 4, v5
    v_lshl_add_u32 v5, v3, 13, v5
    s_add_u32 m0, s23, 0
    s_add_u32 s34, s33, 0
    buffer_load_dwordx4 v5, s[4:7], s34 offen sc1 lds
    v_add_u32 v5, 4, v3
    v_lshlrev_b32 v5, 1, v5
    v_xor_b32 v5, v5, v2
    v_lshlrev_b32 v5, 4, v5
    v_lshl_add_u32 v5, v3, 13, v5
    s_add_u32 m0, s23, 1024
    s_add_u32 s34, s33, 32768
    buffer_load_dwordx4 v5, s[4:7], s34 offen sc1 lds
    v_add_u32 v5, 0, v3
    v_lshlrev_b32 v5, 1, v5
    v_xor_b32 v5, v5, v2
    v_lshlrev_b32 v5, 4, v5
    v_lshl_add_u32 v5, v3, 13, v5
    s_add_u32 m0, s23, 2048
    s_add_u32 s34, s33, 65536
    buffer_load_dwordx4 v5, s[4:7], s34 offen sc1 lds
    v_add_u32 v5, 4, v3
    v_lshlrev_b32 v5, 1, v5
    v_xor_b32 v5, v5, v2
    v_lshlrev_b32 v5, 4, v5
    v_lshl_add_u32 v5, v3, 13, v5
    s_add_u32 m0, s23, 3072
    s_add_u32 s34, s33, 98304
    buffer_load_dwordx4 v5, s[4:7], s34 offen sc1 lds
    v_add_u32 v5, 0, v3
    v_lshlrev_b32 v5, 1, v5
    v_xor_b32 v5, v5, v2
    v_lshlrev_b32 v5, 4, v5
    v_lshl_add_u32 v5, v3, 13, v5
    s_add_u32 m0, s23, 4096
    s_add_u32 s34, s33, 131072
    buffer_load_dwordx4 v5, s[4:7], s34 offen sc1 lds
    v_add_u32 v5, 4, v3
    v_lshlrev_b32 v5, 1, v5
    v_xor_b32 v5, v5, v2
    v_lshlrev_b32 v5, 4, v5
    v_lshl_add_u32 v5, v3, 13, v5
    s_add_u32 m0, s23, 5120
    s_add_u32 s34, s33, 163840
    buffer_load_dwordx4 v5, s[4:7], s34 offen sc1 lds
    v_add_u32 v5, 0, v3
    v_lshlrev_b32 v5, 1, v5
    v_xor_b32 v5, v5, v2
    v_lshlrev_b32 v5, 4, v5
    v_lshl_add_u32 v5, v3, 13, v5
    s_add_u32 m0, s23, 6144
    s_add_u32 s34, s33, 196608
    buffer_load_dwordx4 v5, s[4:7], s34 offen sc1 lds
    v_add_u32 v5, 4, v3
    v_lshlrev_b32 v5, 1, v5
    v_xor_b32 v5, v5, v2
    v_lshlrev_b32 v5, 4, v5
    v_lshl_add_u32 v5, v3, 13, v5
    s_add_u32 m0, s23, 7168
    s_add_u32 s34, s33, 229376
    buffer_load_dwordx4 v5, s[4:7], s34 offen sc1 lds
    buffer_load_dwordx4 v[10:13], v4, s[4:7], s31 offen offset:0 sc1
    buffer_load_dwordx4 v[42:45], v4, s[4:7], s32 offen offset:0 sc1
    buffer_load_dwordx4 v[14:17], v4, s[4:7], s31 offen offset:64 sc1
    buffer_load_dwordx4 v[46:49], v4, s[4:7], s32 offen offset:64 sc1
    buffer_load_dwordx4 v[18:21], v4, s[4:7], s31 offen offset:128 sc1
    buffer_load_dwordx4 v[50:53], v4, s[4:7], s32 offen offset:128 sc1
    buffer_load_dwordx4 v[22:25], v4, s[4:7], s31 offen offset:192 sc1
    buffer_load_dwordx4 v[54:57], v4, s[4:7], s32 offen offset:192 sc1
    s_add_u32 s31, s31, 131072
    s_add_u32 s32, s32, 131072
    buffer_load_dwordx4 v[26:29], v4, s[4:7], s31 offen offset:0 sc1
    buffer_load_dwordx4 v[58:61], v4, s[4:7], s32 offen offset:0 sc1
    buffer_load_dwordx4 v[30:33], v4, s[4:7], s31 offen offset:64 sc1
    buffer_load_dwordx4 v[62:65], v4, s[4:7], s32 offen offset:64 sc1
    buffer_load_dwordx4 v[34:37], v4, s[4:7], s31 offen offset:128 sc1
    buffer_load_dwordx4 v[66:69], v4, s[4:7], s32 offen offset:128 sc1
    buffer_load_dwordx4 v[38:41], v4, s[4:7], s31 offen offset:192 sc1
    buffer_load_dwordx4 v[70:73], v4, s[4:7], s32 offen offset:192 sc1
    s_add_u32 s31, s31, 131072
    s_add_u32 s32, s32, 131072
    v_lshl_add_u32 v6, v3, 2, 0
    v_cmp_gt_u32 s[60:61], v6, v2
    v_lshl_add_u32 v6, v3, 2, 1
    v_cmp_gt_u32 s[62:63], v6, v2
    v_lshl_add_u32 v6, v3, 2, 2
    v_cmp_gt_u32 s[64:65], v6, v2
    v_lshl_add_u32 v6, v3, 2, 3
    v_cmp_gt_u32 s[66:67], v6, v2
    v_cmp_lt_u32 s[68:69], 1, v3
    v_mov_b32 v170, 0x3f803f80
    v_mov_b32 v171, 0x3f803f80
    v_mov_b32 v172, 0x3f803f80
    v_mov_b32 v173, 0x3f803f80
    v_lshrrev_b32 v6, 2, v2
    v_and_b32 v7, 3, v2
    v_lshl_add_u32 v8, v3, 3, v6
    v_lshlrev_b32 v8, 4, v8
    v_and_b32 v5, 1, v7
    v_lshl_add_u32 v8, v5, 3, v8
    v_add_u32 v8, s23, v8
    v_add_u32 v8, 8192, v8
    v_lshl_add_u32 v9, v3, 2, v6
    v_and_b32 v4, 7, v9
    v_lshlrev_b32 v4, 1, v4
    v_lshrrev_b32 v5, 1, v7
    v_xor_b32 v4, v4, v5
    v_lshlrev_b32 v4, 4, v4
    v_lshl_add_u32 v4, v9, 8, v4
    v_and_b32 v5, 1, v7
    v_lshl_add_u32 v4, v5, 3, v4
    v_add_u32 v9, s23, v4
    s_waitcnt vmcnt(0)
    v_xor_b32 v4, 0, v9
    ds_read_b64_tr_b16 v[106:107], v4
    ds_read_b64_tr_b16 v[108:109], v4 offset:4096
    v_xor_b32 v4, 32, v9
    ds_read_b64_tr_b16 v[110:111], v4
    ds_read_b64_tr_b16 v[112:113], v4 offset:4096
    v_xor_b32 v4, 64, v9
    ds_read_b64_tr_b16 v[114:115], v4
    ds_read_b64_tr_b16 v[116:117], v4 offset:4096
    v_xor_b32 v4, 96, v9
    ds_read_b64_tr_b16 v[118:119], v4
    ds_read_b64_tr_b16 v[120:121], v4 offset:4096
    v_xor_b32 v4, 128, v9
    ds_read_b64_tr_b16 v[122:123], v4
    ds_read_b64_tr_b16 v[124:125], v4 offset:4096
    v_xor_b32 v4, 160, v9
    ds_read_b64_tr_b16 v[126:127], v4
    ds_read_b64_tr_b16 v[128:129], v4 offset:4096
    v_xor_b32 v4, 192, v9
    ds_read_b64_tr_b16 v[130:131], v4
    ds_read_b64_tr_b16 v[132:133], v4 offset:4096
    v_xor_b32 v4, 224, v9
    ds_read_b64_tr_b16 v[134:135], v4
    ds_read_b64_tr_b16 v[136:137], v4 offset:4096
    v_mfma_f32_16x16x32_bf16 v[142:145], v[42:45], v[10:13], 0
    v_mfma_f32_16x16x32_bf16 v[150:153], v[42:45], v[26:29], 0
    v_mfma_f32_16x16x32_bf16 v[154:157], v[58:61], v[26:29], 0
    v_mfma_f32_16x16x32_bf16 v[142:145], v[46:49], v[14:17], v[142:145]
    v_mfma_f32_16x16x32_bf16 v[150:153], v[46:49], v[30:33], v[150:153]
    v_mfma_f32_16x16x32_bf16 v[154:157], v[62:65], v[30:33], v[154:157]
    v_mfma_f32_16x16x32_bf16 v[142:145], v[50:53], v[18:21], v[142:145]
    v_mfma_f32_16x16x32_bf16 v[150:153], v[50:53], v[34:37], v[150:153]
    v_mfma_f32_16x16x32_bf16 v[154:157], v[66:69], v[34:37], v[154:157]
    v_mfma_f32_16x16x32_bf16 v[142:145], v[54:57], v[22:25], v[142:145]
    v_mfma_f32_16x16x32_bf16 v[150:153], v[54:57], v[38:41], v[150:153]
    v_mfma_f32_16x16x32_bf16 v[154:157], v[70:73], v[38:41], v[154:157]
    s_cmp_lg_u32 s26, 0
    s_cbranch_scc1 L_pd_117
    s_and_b32 s77, s76, 7
    s_lshl_b32 s77, s77, 10
    s_add_u32 s77, s77, 794624
    v_and_b32 v6, 7, v0
    v_lshlrev_b32 v6, 7, v6
    s_mov_b32 s79, 0x200000
L_pw_116:
    buffer_load_dword v7, v6, s[4:7], s77 offen sc1
    s_waitcnt vmcnt(0)
    v_cmp_ge_u32 vcc, s21, v7
    s_cbranch_vccz L_pd_117
    s_sleep 2
    s_sub_u32 s79, s79, 1
    s_cbranch_scc0 L_pw_116
L_pd_117:
    s_barrier
    s_lshl_b32 s34, s21, 5
    s_add_u32 s34, s34, s22
    s_lshl_b32 s34, s34, 11
    s_add_u32 s35, s34, 83886080
    s_add_u32 s36, s34, 88080384
    v_lshlrev_b32 v5, 4, v1
    s_add_u32 m0, s23, 8192
    s_nop 0
    buffer_load_dwordx4 v5, s[4:7], s35 offen sc1 lds
    s_add_u32 s35, s35, 1024
    s_add_u32 m0, s23, 9216
    s_nop 0
    buffer_load_dwordx4 v5, s[4:7], s35 offen sc1 lds
    s_add_u32 s35, s35, 1024
    v_and_b32 v5, 1, v3
    v_lshlrev_b32 v5, 3, v5
    v_lshl_add_u32 v5, v2, 4, v5
    buffer_load_dwordx2 v[90:91], v5, s[4:7], s36 offen offset:0 sc1
    buffer_load_dwordx2 v[92:93], v5, s[4:7], s36 offen offset:256 sc1
    buffer_load_dwordx2 v[94:95], v5, s[4:7], s36 offen offset:512 sc1
    buffer_load_dwordx2 v[96:97], v5, s[4:7], s36 offen offset:768 sc1
    buffer_load_dwordx2 v[98:99], v5, s[4:7], s36 offen offset:1024 sc1
    buffer_load_dwordx2 v[100:101], v5, s[4:7], s36 offen offset:1280 sc1
    buffer_load_dwordx2 v[102:103], v5, s[4:7], s36 offen offset:1536 sc1
    buffer_load_dwordx2 v[104:105], v5, s[4:7], s36 offen offset:1792 sc1
    s_waitcnt vmcnt(8)
    ds_read_b64_tr_b16 v[74:75], v8 offset:0
    ds_read_b64_tr_b16 v[76:77], v8 offset:64
    ds_read_b64_tr_b16 v[78:79], v8 offset:512
    ds_read_b64_tr_b16 v[80:81], v8 offset:576
    ds_read_b64_tr_b16 v[82:83], v8 offset:1024
    ds_read_b64_tr_b16 v[84:85], v8 offset:1088
    ds_read_b64_tr_b16 v[86:87], v8 offset:1536
    ds_read_b64_tr_b16 v[88:89], v8 offset:1600
    s_waitcnt lgkmcnt(0)
    v_mfma_f32_16x16x32_bf16 v[138:141], v[74:77], v[10:13], 0
    v_mfma_f32_16x16x32_bf16 v[146:149], v[74:77], v[26:29], 0
    v_mfma_f32_16x16x32_bf16 v[138:141], v[78:81], v[14:17], v[138:141]
    v_mfma_f32_16x16x32_bf16 v[146:149], v[78:81], v[30:33], v[146:149]
    v_mfma_f32_16x16x32_bf16 v[138:141], v[82:85], v[18:21], v[138:141]
    v_mfma_f32_16x16x32_bf16 v[146:149], v[82:85], v[34:37], v[146:149]
    v_mfma_f32_16x16x32_bf16 v[138:141], v[86:89], v[22:25], v[138:141]
    v_mfma_f32_16x16x32_bf16 v[146:149], v[86:89], v[38:41], v[146:149]
    v_mov_b32 v5, 0xf149f2ca
    s_mov_b32 s37, 0x3e0293ee
    s_mov_b32 s38, 0xbe0293ee
    s_nop 7
    s_nop 3
    v_cndmask_b32 v142, v142, v5, s[60:61]
    v_cndmask_b32 v138, v138, v5, s[68:69]
    v_cndmask_b32 v143, v143, v5, s[62:63]
    v_cndmask_b32 v139, v139, v5, s[68:69]
    v_cndmask_b32 v144, v144, v5, s[64:65]
    v_cndmask_b32 v140, v140, v5, s[68:69]
    v_cndmask_b32 v145, v145, v5, s[66:67]
    v_cndmask_b32 v141, v141, v5, s[68:69]
    v_max3_f32 v6, v138, v139, v140
    v_max3_f32 v6, v6, v141, v142
    v_max3_f32 v6, v6, v143, v144
    v_max_f32 v6, v6, v145
    v_mov_b32 v7, v6
    s_nop 1
    v_permlane32_swap_b32 v6, v7
    v_max_f32 v6, v6, v7
    v_mov_b32 v7, v6
    s_nop 1
    v_permlane16_swap_b32 v6, v7
    v_max_f32 v6, v6, v7
    v_mul_f32 v6, s38, v6
    v_fma_f32 v138, v138, s37, v6
    v_exp_f32 v138, v138
    v_fma_f32 v139, v139, s37, v6
    v_exp_f32 v139, v139
    v_fma_f32 v140, v140, s37, v6
    v_exp_f32 v140, v140
    v_fma_f32 v141, v141, s37, v6
    v_exp_f32 v141, v141
    v_fma_f32 v142, v142, s37, v6
    v_exp_f32 v142, v142
    v_fma_f32 v143, v143, s37, v6
    v_exp_f32 v143, v143
    v_fma_f32 v144, v144, s37, v6
    v_exp_f32 v144, v144
    v_fma_f32 v145, v145, s37, v6
    v_exp_f32 v145, v145
    v_cvt_pk_bf16_f32 v158, v142, v143
    v_cvt_pk_bf16_f32 v159, v144, v145
    v_mov_b32 v160, 0
    v_mov_b32 v161, 0
    v_cvt_pk_bf16_f32 v162, v138, v139
    v_cvt_pk_bf16_f32 v163, v140, v141
    v_cndmask_b32 v154, v154, v5, s[60:61]
    v_cndmask_b32 v146, v146, v5, s[68:69]
    v_cndmask_b32 v155, v155, v5, s[62:63]
    v_cndmask_b32 v147, v147, v5, s[68:69]
    v_cndmask_b32 v156, v156, v5, s[64:65]
    v_cndmask_b32 v148, v148, v5, s[68:69]
    v_cndmask_b32 v157, v157, v5, s[66:67]
    v_cndmask_b32 v149, v149, v5, s[68:69]
    v_max3_f32 v6, v146, v147, v148
    v_max3_f32 v6, v6, v149, v150
    v_max3_f32 v6, v6, v151, v152
    v_max3_f32 v6, v6, v153, v154
    v_max3_f32 v6, v6, v155, v156
    v_max_f32 v6, v6, v157
    v_mov_b32 v7, v6
    s_nop 1
    v_permlane32_swap_b32 v6, v7
    v_max_f32 v6, v6, v7
    v_mov_b32 v7, v6
    s_nop 1
    v_permlane16_swap_b32 v6, v7
    v_max_f32 v6, v6, v7
    v_mul_f32 v6, s38, v6
    v_fma_f32 v146, v146, s37, v6
    v_exp_f32 v146, v146
    v_fma_f32 v147, v147, s37, v6
    v_exp_f32 v147, v147
    v_fma_f32 v148, v148, s37, v6
    v_exp_f32 v148, v148
    v_fma_f32 v149, v149, s37, v6
    v_exp_f32 v149, v149
    v_fma_f32 v150, v150, s37, v6
    v_exp_f32 v150, v150
    v_fma_f32 v151, v151, s37, v6
    v_exp_f32 v151, v151
    v_fma_f32 v152, v152, s37, v6
    v_exp_f32 v152, v152
    v_fma_f32 v153, v153, s37, v6
    v_exp_f32 v153, v153
    v_fma_f32 v154, v154, s37, v6
    v_exp_f32 v154, v154
    v_fma_f32 v155, v155, s37, v6
    v_exp_f32 v155, v155
    v_fma_f32 v156, v156, s37, v6
    v_exp_f32 v156, v156
    v_fma_f32 v157, v157, s37, v6
    v_exp_f32 v157, v157
    v_cvt_pk_bf16_f32 v164, v150, v151
    v_cvt_pk_bf16_f32 v165, v152, v153
    v_cvt_pk_bf16_f32 v166, v154, v155
    v_cvt_pk_bf16_f32 v167, v156, v157
    v_cvt_pk_bf16_f32 v168, v146, v147
    v_cvt_pk_bf16_f32 v169, v148, v149
    s_waitcnt vmcnt(0)
    v_mfma_f32_16x16x32_bf16 v[174:177], v[170:173], v[158:161], 0
    v_mfma_f32_16x16x32_bf16 v[182:185], v[106:109], v[158:161], 0
    v_mfma_f32_16x16x32_bf16 v[186:189], v[110:113], v[158:161], 0
    v_mfma_f32_16x16x32_bf16 v[190:193], v[114:117], v[158:161], 0
    v_mfma_f32_16x16x32_bf16 v[194:197], v[118:121], v[158:161], 0
    v_mfma_f32_16x16x32_bf16 v[198:201], v[122:125], v[158:161], 0
    v_mfma_f32_16x16x32_bf16 v[202:205], v[126:129], v[158:161], 0
    v_mfma_f32_16x16x32_bf16 v[206:209], v[130:133], v[158:161], 0
    v_mfma_f32_16x16x32_bf16 v[210:213], v[134:137], v[158:161], 0
    v_mfma_f32_16x16x32_bf16 v[178:181], v[170:173], v[164:167], 0
    v_mfma_f32_16x16x32_bf16 v[214:217], v[106:109], v[164:167], 0
    v_mfma_f32_16x16x32_bf16 v[218:221], v[110:113], v[164:167], 0
    v_mfma_f32_16x16x32_bf16 v[222:225], v[114:117], v[164:167], 0
    v_mfma_f32_16x16x32_bf16 v[226:229], v[118:121], v[164:167], 0
    v_mfma_f32_16x16x32_bf16 v[230:233], v[122:125], v[164:167], 0
    v_mfma_f32_16x16x32_bf16 v[234:237], v[126:129], v[164:167], 0
    v_mfma_f32_16x16x32_bf16 v[238:241], v[130:133], v[164:167], 0
    v_mfma_f32_16x16x32_bf16 v[242:245], v[134:137], v[164:167], 0
    v_mfma_f32_16x16x16_bf16 v[174:177], v[170:171], v[162:163], v[174:177]
    v_mfma_f32_16x16x16_bf16 v[182:185], v[90:91], v[162:163], v[182:185]
    v_mfma_f32_16x16x16_bf16 v[186:189], v[92:93], v[162:163], v[186:189]
    v_mfma_f32_16x16x16_bf16 v[190:193], v[94:95], v[162:163], v[190:193]
    v_mfma_f32_16x16x16_bf16 v[194:197], v[96:97], v[162:163], v[194:197]
    v_mfma_f32_16x16x16_bf16 v[198:201], v[98:99], v[162:163], v[198:201]
    v_mfma_f32_16x16x16_bf16 v[202:205], v[100:101], v[162:163], v[202:205]
    v_mfma_f32_16x16x16_bf16 v[206:209], v[102:103], v[162:163], v[206:209]
    v_mfma_f32_16x16x16_bf16 v[210:213], v[104:105], v[162:163], v[210:213]
    v_mfma_f32_16x16x16_bf16 v[178:181], v[170:171], v[168:169], v[178:181]
    v_mfma_f32_16x16x16_bf16 v[214:217], v[90:91], v[168:169], v[214:217]
    v_mfma_f32_16x16x16_bf16 v[218:221], v[92:93], v[168:169], v[218:221]
    v_mfma_f32_16x16x16_bf16 v[222:225], v[94:95], v[168:169], v[222:225]
    v_mfma_f32_16x16x16_bf16 v[226:229], v[96:97], v[168:169], v[226:229]
    v_mfma_f32_16x16x16_bf16 v[230:233], v[98:99], v[168:169], v[230:233]
    v_mfma_f32_16x16x16_bf16 v[234:237], v[100:101], v[168:169], v[234:237]
    v_mfma_f32_16x16x16_bf16 v[238:241], v[102:103], v[168:169], v[238:241]
    v_mfma_f32_16x16x16_bf16 v[242:245], v[104:105], v[168:169], v[242:245]
    s_nop 7
    s_nop 3
    v_and_b32 v4, 1, v3
    v_lshlrev_b32 v4, 5, v4
    v_lshrrev_b32 v5, 1, v3
    v_lshl_add_u32 v4, v5, 4, v4
    v_lshl_add_u32 v4, v2, 13, v4
    s_add_u32 s31, s30, 67108864
    v_rcp_f32 v5, v174
    s_nop 0
    v_mul_f32 v182, v182, v5
    v_mul_f32 v183, v183, v5
    v_mul_f32 v184, v184, v5
    v_mul_f32 v185, v185, v5
    v_mul_f32 v186, v186, v5
    v_mul_f32 v187, v187, v5
    v_mul_f32 v188, v188, v5
    v_mul_f32 v189, v189, v5
    v_cvt_pk_bf16_f32 v182, v182, v183
    v_cvt_pk_bf16_f32 v183, v184, v185
    v_cvt_pk_bf16_f32 v184, v186, v187
    v_cvt_pk_bf16_f32 v185, v188, v189
    s_nop 0
    v_permlane16_swap_b32 v182, v184
    v_permlane16_swap_b32 v183, v185
    buffer_store_dwordx4 v[182:185], v4, s[4:7], s31 offen offset:0 sc1
    v_mul_f32 v190, v190, v5
    v_mul_f32 v191, v191, v5
    v_mul_f32 v192, v192, v5
    v_mul_f32 v193, v193, v5
    v_mul_f32 v194, v194, v5
    v_mul_f32 v195, v195, v5
    v_mul_f32 v196, v196, v5
    v_mul_f32 v197, v197, v5
    v_cvt_pk_bf16_f32 v190, v190, v191
    v_cvt_pk_bf16_f32 v191, v192, v193
    v_cvt_pk_bf16_f32 v192, v194, v195
    v_cvt_pk_bf16_f32 v193, v196, v197
    s_nop 0
    v_permlane16_swap_b32 v190, v192
    v_permlane16_swap_b32 v191, v193
    buffer_store_dwordx4 v[190:193], v4, s[4:7], s31 offen offset:64 sc1
    v_mul_f32 v198, v198, v5
    v_mul_f32 v199, v199, v5
    v_mul_f32 v200, v200, v5
    v_mul_f32 v201, v201, v5
    v_mul_f32 v202, v202, v5
    v_mul_f32 v203, v203, v5
    v_mul_f32 v204, v204, v5
    v_mul_f32 v205, v205, v5
    v_cvt_pk_bf16_f32 v198, v198, v199
    v_cvt_pk_bf16_f32 v199, v200, v201
    v_cvt_pk_bf16_f32 v200, v202, v203
    v_cvt_pk_bf16_f32 v201, v204, v205
    s_nop 0
    v_permlane16_swap_b32 v198, v200
    v_permlane16_swap_b32 v199, v201
    buffer_store_dwordx4 v[198:201], v4, s[4:7], s31 offen offset:128 sc1
    v_mul_f32 v206, v206, v5
    v_mul_f32 v207, v207, v5
    v_mul_f32 v208, v208, v5
    v_mul_f32 v209, v209, v5
    v_mul_f32 v210, v210, v5
    v_mul_f32 v211, v211, v5
    v_mul_f32 v212, v212, v5
    v_mul_f32 v213, v213, v5
    v_cvt_pk_bf16_f32 v206, v206, v207
    v_cvt_pk_bf16_f32 v207, v208, v209
    v_cvt_pk_bf16_f32 v208, v210, v211
    v_cvt_pk_bf16_f32 v209, v212, v213
    s_nop 0
    v_permlane16_swap_b32 v206, v208
    v_permlane16_swap_b32 v207, v209
    buffer_store_dwordx4 v[206:209], v4, s[4:7], s31 offen offset:192 sc1
    s_add_u32 s31, s31, 131072
    v_rcp_f32 v5, v178
    s_nop 0
    v_mul_f32 v214, v214, v5
    v_mul_f32 v215, v215, v5
    v_mul_f32 v216, v216, v5
    v_mul_f32 v217, v217, v5
    v_mul_f32 v218, v218, v5
    v_mul_f32 v219, v219, v5
    v_mul_f32 v220, v220, v5
    v_mul_f32 v221, v221, v5
    v_cvt_pk_bf16_f32 v214, v214, v215
    v_cvt_pk_bf16_f32 v215, v216, v217
    v_cvt_pk_bf16_f32 v216, v218, v219
    v_cvt_pk_bf16_f32 v217, v220, v221
    s_nop 0
    v_permlane16_swap_b32 v214, v216
    v_permlane16_swap_b32 v215, v217
    buffer_store_dwordx4 v[214:217], v4, s[4:7], s31 offen offset:0 sc1
    v_mul_f32 v222, v222, v5
    v_mul_f32 v223, v223, v5
    v_mul_f32 v224, v224, v5
    v_mul_f32 v225, v225, v5
    v_mul_f32 v226, v226, v5
    v_mul_f32 v227, v227, v5
    v_mul_f32 v228, v228, v5
    v_mul_f32 v229, v229, v5
    v_cvt_pk_bf16_f32 v222, v222, v223
    v_cvt_pk_bf16_f32 v223, v224, v225
    v_cvt_pk_bf16_f32 v224, v226, v227
    v_cvt_pk_bf16_f32 v225, v228, v229
    s_nop 0
    v_permlane16_swap_b32 v222, v224
    v_permlane16_swap_b32 v223, v225
    buffer_store_dwordx4 v[222:225], v4, s[4:7], s31 offen offset:64 sc1
    v_mul_f32 v230, v230, v5
    v_mul_f32 v231, v231, v5
    v_mul_f32 v232, v232, v5
    v_mul_f32 v233, v233, v5
    v_mul_f32 v234, v234, v5
    v_mul_f32 v235, v235, v5
    v_mul_f32 v236, v236, v5
    v_mul_f32 v237, v237, v5
    v_cvt_pk_bf16_f32 v230, v230, v231
    v_cvt_pk_bf16_f32 v231, v232, v233
    v_cvt_pk_bf16_f32 v232, v234, v235
    v_cvt_pk_bf16_f32 v233, v236, v237
    s_nop 0
    v_permlane16_swap_b32 v230, v232
    v_permlane16_swap_b32 v231, v233
    buffer_store_dwordx4 v[230:233], v4, s[4:7], s31 offen offset:128 sc1
    v_mul_f32 v238, v238, v5
    v_mul_f32 v239, v239, v5
    v_mul_f32 v240, v240, v5
    v_mul_f32 v241, v241, v5
    v_mul_f32 v242, v242, v5
    v_mul_f32 v243, v243, v5
    v_mul_f32 v244, v244, v5
    v_mul_f32 v245, v245, v5
    v_cvt_pk_bf16_f32 v238, v238, v239
    v_cvt_pk_bf16_f32 v239, v240, v241
    v_cvt_pk_bf16_f32 v240, v242, v243
    v_cvt_pk_bf16_f32 v241, v244, v245
    s_nop 0
    v_permlane16_swap_b32 v238, v240
    v_permlane16_swap_b32 v239, v241
    buffer_store_dwordx4 v[238:241], v4, s[4:7], s31 offen offset:192 sc1
    s_add_u32 s31, s31, 131072
    s_and_b32 s78, s76, 7
    s_lshl_b32 s77, s74, 3
    s_add_u32 s77, s77, s78
    s_lshl_b32 s77, s77, 7
    s_add_u32 s77, s77, 802816
    s_waitcnt vmcnt(0)
    s_barrier
    s_cmp_lg_u32 s26, 0
    s_cbranch_scc1 L_sig_118
    v_mov_b32 v1, 0
    v_mov_b32 v2, 1
    s_mov_b64 exec, 1
    buffer_atomic_add v2, v1, s[4:7], s77 offen
    s_mov_b64 exec, -1
L_sig_118:
    s_branch L_next_104
L_wo_102:
    s_load_dwordx2 s[8:9], s[0:1], 40
    s_sub_u32 s16, s76, 32
    s_mul_i32 s17, s16, 52
    s_lshr_b32 s17, s17, 8
    s_mul_i32 s18, s17, 5
    s_sub_u32 s16, s16, s18
    v_and_b32 v144, 63, v0
    v_and_b32 v145, 15, v144
    v_lshrrev_b32 v146, 4, v144
    v_lshrrev_b32 v147, 6, v0
    s_nop 0
    v_readfirstlane_b32 s40, v147
    s_nop 0
    s_and_b32 s41, s40, 1
    s_lshr_b32 s42, s40, 1
    s_waitcnt lgkmcnt(0)
    s_and_b32 s9, s9, 0xffff
    s_mov_b32 s10, 5242880
    s_mov_b32 s11, 0x20000
    s_mul_i32 s48, s40, 4
    s_add_u32 s48, s48, 0
    v_lshrrev_b32 v148, 3, v144
    s_lshl_b32 s49, s48, 3
    v_add_u32 v148, s49, v148
    v_and_b32 v149, 7, v144
    v_bfe_u32 v150, v148, 1, 3
    v_xor_b32 v149, v149, v150
    s_mov_b32 s49, 8192
    v_mul_lo_u32 v148, v148, s49
    v_lshl_add_u32 v130, v149, 4, v148
    s_mul_i32 s48, s40, 4
    s_add_u32 s48, s48, 1
    v_lshrrev_b32 v148, 3, v144
    s_lshl_b32 s49, s48, 3
    v_add_u32 v148, s49, v148
    v_and_b32 v149, 7, v144
    v_bfe_u32 v150, v148, 1, 3
    v_xor_b32 v149, v149, v150
    s_mov_b32 s49, 8192
    v_mul_lo_u32 v148, v148, s49
    v_lshl_add_u32 v131, v149, 4, v148
    s_mul_i32 s48, s40, 4
    s_add_u32 s48, s48, 2
    v_lshrrev_b32 v148, 3, v144
    s_lshl_b32 s49, s48, 3
    v_add_u32 v148, s49, v148
    v_and_b32 v149, 7, v144
    v_bfe_u32 v150, v148, 1, 3
    v_xor_b32 v149, v149, v150
    s_mov_b32 s49, 8192
    v_mul_lo_u32 v148, v148, s49
    v_lshl_add_u32 v132, v149, 4, v148
    s_mul_i32 s48, s40, 4
    s_add_u32 s48, s48, 3
    v_lshrrev_b32 v148, 3, v144
    s_lshl_b32 s49, s48, 3
    v_add_u32 v148, s49, v148
    v_and_b32 v149, 7, v144
    v_bfe_u32 v150, v148, 1, 3
    v_xor_b32 v149, v149, v150
    s_mov_b32 s49, 8192
    v_mul_lo_u32 v148, v148, s49
    v_lshl_add_u32 v133, v149, 4, v148
    s_mul_i32 s48, s40, 4
    s_add_u32 s48, s48, 0
    v_lshrrev_b32 v148, 4, v144
    s_mul_i32 s49, s48, 4
    v_add_u32 v148, s49, v148
    v_and_b32 v149, 15, v144
    v_and_b32 v150, 3, v148
    v_bfe_u32 v151, v148, 3, 1
    v_lshl_add_u32 v150, v151, 2, v150
    v_lshlrev_b32 v150, 1, v150
    v_xor_b32 v149, v149, v150
    s_mov_b32 s49, 1280
    v_mul_lo_u32 v148, v148, s49
    v_lshl_add_u32 v134, v149, 4, v148
    s_mul_i32 s48, s40, 4
    s_add_u32 s48, s48, 1
    v_lshrrev_b32 v148, 4, v144
    s_mul_i32 s49, s48, 4
    v_add_u32 v148, s49, v148
    v_and_b32 v149, 15, v144
    v_and_b32 v150, 3, v148
    v_bfe_u32 v151, v148, 3, 1
    v_lshl_add_u32 v150, v151, 2, v150
    v_lshlrev_b32 v150, 1, v150
    v_xor_b32 v149, v149, v150
    s_mov_b32 s49, 1280
    v_mul_lo_u32 v148, v148, s49
    v_lshl_add_u32 v135, v149, 4, v148
    s_mul_i32 s48, s40, 4
    s_add_u32 s48, s48, 2
    v_lshrrev_b32 v148, 4, v144
    s_mul_i32 s49, s48, 4
    v_add_u32 v148, s49, v148
    v_and_b32 v149, 15, v144
    v_and_b32 v150, 3, v148
    v_bfe_u32 v151, v148, 3, 1
    v_lshl_add_u32 v150, v151, 2, v150
    v_lshlrev_b32 v150, 1, v150
    v_xor_b32 v149, v149, v150
    s_mov_b32 s49, 1280
    v_mul_lo_u32 v148, v148, s49
    v_lshl_add_u32 v136, v149, 4, v148
    s_mul_i32 s48, s40, 4
    s_add_u32 s48, s48, 3
    v_lshrrev_b32 v148, 4, v144
    s_mul_i32 s49, s48, 4
    v_add_u32 v148, s49, v148
    v_and_b32 v149, 15, v144
    v_and_b32 v150, 3, v148
    v_bfe_u32 v151, v148, 3, 1
    v_lshl_add_u32 v150, v151, 2, v150
    v_lshlrev_b32 v150, 1, v150
    v_xor_b32 v149, v149, v150
    s_mov_b32 s49, 1280
    v_mul_lo_u32 v148, v148, s49
    v_lshl_add_u32 v137, v149, 4, v148
    v_bfe_u32 v148, v145, 1, 3
    v_xor_b32 v148, v148, v146
    v_lshlrev_b32 v148, 4, v148
    v_lshl_add_u32 v148, v145, 7, v148
    s_mul_i32 s48, s41, 8192
    s_add_u32 s48, s48, 0
    v_add_u32 v138, s48, v148
    v_xor_b32 v139, 64, v138
    v_lshrrev_b32 v148, 2, v145
    v_and_b32 v149, 3, v145
    v_and_b32 v151, 1, v146
    v_lshl_add_u32 v150, v151, 2, v148
    v_lshlrev_b32 v150, 1, v150
    v_lshrrev_b32 v151, 1, v149
    v_xor_b32 v150, v150, v151
    v_lshlrev_b32 v150, 4, v150
    v_and_b32 v151, 1, v149
    v_lshl_add_u32 v150, v151, 3, v150
    v_lshl_add_u32 v151, v146, 3, v148
    s_mov_b32 s48, 256
    v_mul_lo_u32 v151, v151, s48
    v_add_u32 v150, v150, v151
    s_mul_i32 s48, s42, 4
    s_add_u32 s48, s48, 0
    s_and_b32 s49, s48, 7
    s_lshl_b32 s49, s49, 5
    v_xor_b32 v140, s49, v150
    s_lshr_b32 s48, s48, 3
    s_lshl_b32 s48, s48, 8
    s_add_u32 s48, s48, 16384
    v_add_u32 v140, s48, v140
    s_mul_i32 s48, s42, 4
    s_add_u32 s48, s48, 1
    s_and_b32 s49, s48, 7
    s_lshl_b32 s49, s49, 5
    v_xor_b32 v141, s49, v150
    s_lshr_b32 s48, s48, 3
    s_lshl_b32 s48, s48, 8
    s_add_u32 s48, s48, 16384
    v_add_u32 v141, s48, v141
    s_mul_i32 s48, s42, 4
    s_add_u32 s48, s48, 2
    s_and_b32 s49, s48, 7
    s_lshl_b32 s49, s49, 5
    v_xor_b32 v142, s49, v150
    s_lshr_b32 s48, s48, 3
    s_lshl_b32 s48, s48, 8
    s_add_u32 s48, s48, 16384
    v_add_u32 v142, s48, v142
    s_mul_i32 s48, s42, 4
    s_add_u32 s48, s48, 3
    s_and_b32 s49, s48, 7
    s_lshl_b32 s49, s49, 5
    v_xor_b32 v143, s49, v150
    s_lshr_b32 s48, s48, 3
    s_lshl_b32 s48, s48, 8
    s_add_u32 s48, s48, 16384
    v_add_u32 v143, s48, v143
    s_mul_i32 s43, s74, 1048576
    s_lshl_b32 s18, s17, 10
    s_add_u32 s43, s43, s18
    s_add_u32 s43, s43, 67108864
    s_mul_i32 s44, s17, 655360
    s_lshl_b32 s18, s16, 8
    s_add_u32 s44, s44, s18
    s_mul_i32 s19, s17, 2621440
    s_mul_i32 s18, s74, 163840
    s_add_u32 s19, s19, s18
    s_lshl_b32 s18, s16, 8
    s_add_u32 s19, s19, s18
    s_add_u32 s19, s19, 109051904
    s_lshl_b32 s77, s74, 3
    s_add_u32 s77, s77, s17
    s_lshl_b32 s77, s77, 7
    s_add_u32 s77, s77, 802816
    s_mul_i32 s54, s40, 4096
    s_mul_i32 s55, s40, 4096
    s_mov_b32 s46, 0
    s_mov_b32 s51, 0
    s_mov_b32 s52, s54
    s_mov_b32 s53, s55
    s_add_u32 s50, s44, 0
    s_add_u32 s53, s55, 0
    s_add_u32 m0, s53, 16384
    s_nop 0
    buffer_load_dwordx4 v134, s[8:11], s50 offen lds
    s_add_u32 m0, s53, 17408
    s_nop 0
    buffer_load_dwordx4 v135, s[8:11], s50 offen lds
    s_add_u32 m0, s53, 18432
    s_nop 0
    buffer_load_dwordx4 v136, s[8:11], s50 offen lds
    s_add_u32 m0, s53, 19456
    s_nop 0
    buffer_load_dwordx4 v137, s[8:11], s50 offen lds
    s_add_u32 s50, s44, 81920
    s_add_u32 s53, s55, 32768
    s_add_u32 m0, s53, 16384
    s_nop 0
    buffer_load_dwordx4 v134, s[8:11], s50 offen lds
    s_add_u32 m0, s53, 17408
    s_nop 0
    buffer_load_dwordx4 v135, s[8:11], s50 offen lds
    s_add_u32 m0, s53, 18432
    s_nop 0
    buffer_load_dwordx4 v136, s[8:11], s50 offen lds
    s_add_u32 m0, s53, 19456
    s_nop 0
    buffer_load_dwordx4 v137, s[8:11], s50 offen lds
    s_add_u32 s50, s44, 163840
    s_add_u32 s53, s55, 65536
    s_add_u32 m0, s53, 16384
    s_nop 0
    buffer_load_dwordx4 v134, s[8:11], s50 offen lds
    s_add_u32 m0, s53, 17408
    s_nop 0
    buffer_load_dwordx4 v135, s[8:11], s50 offen lds
    s_add_u32 m0, s53, 18432
    s_nop 0
    buffer_load_dwordx4 v136, s[8:11], s50 offen lds
    s_add_u32 m0, s53, 19456
    s_nop 0
    buffer_load_dwordx4 v137, s[8:11], s50 offen lds
    s_add_u32 s50, s44, 245760
    s_add_u32 s53, s55, 98304
    s_add_u32 m0, s53, 16384
    s_nop 0
    buffer_load_dwordx4 v134, s[8:11], s50 offen lds
    s_add_u32 m0, s53, 17408
    s_nop 0
    buffer_load_dwordx4 v135, s[8:11], s50 offen lds
    s_add_u32 m0, s53, 18432
    s_nop 0
    buffer_load_dwordx4 v136, s[8:11], s50 offen lds
    s_add_u32 m0, s53, 19456
    s_nop 0
    buffer_load_dwordx4 v137, s[8:11], s50 offen lds
    s_add_u32 s50, s44, 327680
    s_add_u32 s53, s55, 131072
    s_add_u32 m0, s53, 16384
    s_nop 0
    buffer_load_dwordx4 v134, s[8:11], s50 offen lds
    s_add_u32 m0, s53, 17408
    s_nop 0
    buffer_load_dwordx4 v135, s[8:11], s50 offen lds
    s_add_u32 m0, s53, 18432
    s_nop 0
    buffer_load_dwordx4 v136, s[8:11], s50 offen lds
    s_add_u32 m0, s53, 19456
    s_nop 0
    buffer_load_dwordx4 v137, s[8:11], s50 offen lds
    s_cmp_lg_u32 s26, 0
    s_cbranch_scc1 L_wgw_119
    s_mov_b32 s79, 0x200000
    v_mov_b32 v152, 0
L_cw_120:
    buffer_load_dword v153, v152, s[4:7], s77 offen sc1
    s_waitcnt vmcnt(0)
    v_readfirstlane_b32 s78, v153
    s_nop 0
    s_cmp_ge_u32 s78, 4
    s_cbranch_scc1 L_cd_121
    s_sleep 2
    s_sub_u32 s79, s79, 1
    s_cbranch_scc0 L_cw_120
L_cd_121:
L_wgw_119:
    s_barrier
    s_add_u32 s50, s43, 0
    s_add_u32 s52, s54, 0
    s_add_u32 m0, s52, 0
    s_nop 0
    buffer_load_dwordx4 v130, s[4:7], s50 offen sc1 lds
    s_add_u32 m0, s52, 1024
    s_nop 0
    buffer_load_dwordx4 v131, s[4:7], s50 offen sc1 lds
    s_add_u32 m0, s52, 2048
    s_nop 0
    buffer_load_dwordx4 v132, s[4:7], s50 offen sc1 lds
    s_add_u32 m0, s52, 3072
    s_nop 0
    buffer_load_dwordx4 v133, s[4:7], s50 offen sc1 lds
    s_add_u32 s50, s43, 128
    s_add_u32 s52, s54, 32768
    s_add_u32 m0, s52, 0
    s_nop 0
    buffer_load_dwordx4 v130, s[4:7], s50 offen sc1 lds
    s_add_u32 m0, s52, 1024
    s_nop 0
    buffer_load_dwordx4 v131, s[4:7], s50 offen sc1 lds
    s_add_u32 m0, s52, 2048
    s_nop 0
    buffer_load_dwordx4 v132, s[4:7], s50 offen sc1 lds
    s_add_u32 m0, s52, 3072
    s_nop 0
    buffer_load_dwordx4 v133, s[4:7], s50 offen sc1 lds
    s_add_u32 s50, s43, 256
    s_add_u32 s52, s54, 65536
    s_add_u32 m0, s52, 0
    s_nop 0
    buffer_load_dwordx4 v130, s[4:7], s50 offen sc1 lds
    s_add_u32 m0, s52, 1024
    s_nop 0
    buffer_load_dwordx4 v131, s[4:7], s50 offen sc1 lds
    s_add_u32 m0, s52, 2048
    s_nop 0
    buffer_load_dwordx4 v132, s[4:7], s50 offen sc1 lds
    s_add_u32 m0, s52, 3072
    s_nop 0
    buffer_load_dwordx4 v133, s[4:7], s50 offen sc1 lds
    s_add_u32 s50, s43, 384
    s_add_u32 s52, s54, 98304
    s_add_u32 m0, s52, 0
    s_nop 0
    buffer_load_dwordx4 v130, s[4:7], s50 offen sc1 lds
    s_add_u32 m0, s52, 1024
    s_nop 0
    buffer_load_dwordx4 v131, s[4:7], s50 offen sc1 lds
    s_add_u32 m0, s52, 2048
    s_nop 0
    buffer_load_dwordx4 v132, s[4:7], s50 offen sc1 lds
    s_add_u32 m0, s52, 3072
    s_nop 0
    buffer_load_dwordx4 v133, s[4:7], s50 offen sc1 lds
    s_add_u32 s50, s43, 512
    s_add_u32 s52, s54, 131072
    s_add_u32 m0, s52, 0
    s_nop 0
    buffer_load_dwordx4 v130, s[4:7], s50 offen sc1 lds
    s_add_u32 m0, s52, 1024
    s_nop 0
    buffer_load_dwordx4 v131, s[4:7], s50 offen sc1 lds
    s_add_u32 m0, s52, 2048
    s_nop 0
    buffer_load_dwordx4 v132, s[4:7], s50 offen sc1 lds
    s_add_u32 m0, s52, 3072
    s_nop 0
    buffer_load_dwordx4 v133, s[4:7], s50 offen sc1 lds
    s_add_u32 s43, s43, 128
    s_add_u32 s44, s44, 81920
    s_add_u32 s51, s51, 1
    s_cmp_ge_u32 s51, 8
    s_cmov_b32 s43, 0x40000000
    s_cmov_b32 s44, 0x40000000
    s_add_u32 s46, s46, 32768
    s_cmp_eq_u32 s46, 163840
    s_cmov_b32 s46, 0
    s_add_u32 s52, s46, s54
    s_add_u32 s53, s46, s55
    s_add_u32 s43, s43, 128
    s_add_u32 s44, s44, 81920
    s_add_u32 s51, s51, 1
    s_cmp_ge_u32 s51, 8
    s_cmov_b32 s43, 0x40000000
    s_cmov_b32 s44, 0x40000000
    s_add_u32 s46, s46, 32768
    s_cmp_eq_u32 s46, 163840
    s_cmov_b32 s46, 0
    s_add_u32 s52, s46, s54
    s_add_u32 s53, s46, s55
    s_add_u32 s43, s43, 128
    s_add_u32 s44, s44, 81920
    s_add_u32 s51, s51, 1
    s_cmp_ge_u32 s51, 8
    s_cmov_b32 s43, 0x40000000
    s_cmov_b32 s44, 0x40000000
    s_add_u32 s46, s46, 32768
    s_cmp_eq_u32 s46, 163840
    s_cmov_b32 s46, 0
    s_add_u32 s52, s46, s54
    s_add_u32 s53, s46, s55
    s_add_u32 s43, s43, 128
    s_add_u32 s44, s44, 81920
    s_add_u32 s51, s51, 1
    s_cmp_ge_u32 s51, 8
    s_cmov_b32 s43, 0x40000000
    s_cmov_b32 s44, 0x40000000
    s_add_u32 s46, s46, 32768
    s_cmp_eq_u32 s46, 163840
    s_cmov_b32 s46, 0
    s_add_u32 s52, s46, s54
    s_add_u32 s53, s46, s55
    s_add_u32 s43, s43, 128
    s_add_u32 s44, s44, 81920
    s_add_u32 s51, s51, 1
    s_cmp_ge_u32 s51, 8
    s_cmov_b32 s43, 0x40000000
    s_cmov_b32 s44, 0x40000000
    s_add_u32 s46, s46, 32768
    s_cmp_eq_u32 s46, 163840
    s_cmov_b32 s46, 0
    s_add_u32 s52, s46, s54
    s_add_u32 s53, s46, s55
    v_mov_b32 v2, 0
    v_mov_b32 v3, 0
    v_mov_b32 v4, 0
    v_mov_b32 v5, 0
    v_mov_b32 v6, 0
    v_mov_b32 v7, 0
    v_mov_b32 v8, 0
    v_mov_b32 v9, 0
    v_mov_b32 v10, 0
    v_mov_b32 v11, 0
    v_mov_b32 v12, 0
    v_mov_b32 v13, 0
    v_mov_b32 v14, 0
    v_mov_b32 v15, 0
    v_mov_b32 v16, 0
    v_mov_b32 v17, 0
    v_mov_b32 v18, 0
    v_mov_b32 v19, 0
    v_mov_b32 v20, 0
    v_mov_b32 v21, 0
    v_mov_b32 v22, 0
    v_mov_b32 v23, 0
    v_mov_b32 v24, 0
    v_mov_b32 v25, 0
    v_mov_b32 v26, 0
    v_mov_b32 v27, 0
    v_mov_b32 v28, 0
    v_mov_b32 v29, 0
    v_mov_b32 v30, 0
    v_mov_b32 v31, 0
    v_mov_b32 v32, 0
    v_mov_b32 v33, 0
    v_mov_b32 v34, 0
    v_mov_b32 v35, 0
    v_mov_b32 v36, 0
    v_mov_b32 v37, 0
    v_mov_b32 v38, 0
    v_mov_b32 v39, 0
    v_mov_b32 v40, 0
    v_mov_b32 v41, 0
    v_mov_b32 v42, 0
    v_mov_b32 v43, 0
    v_mov_b32 v44, 0
    v_mov_b32 v45, 0
    v_mov_b32 v46, 0
    v_mov_b32 v47, 0
    v_mov_b32 v48, 0
    v_mov_b32 v49, 0
    v_mov_b32 v50, 0
    v_mov_b32 v51, 0
    v_mov_b32 v52, 0
    v_mov_b32 v53, 0
    v_mov_b32 v54, 0
    v_mov_b32 v55, 0
    v_mov_b32 v56, 0
    v_mov_b32 v57, 0
    v_mov_b32 v58, 0
    v_mov_b32 v59, 0
    v_mov_b32 v60, 0
    v_mov_b32 v61, 0
    v_mov_b32 v62, 0
    v_mov_b32 v63, 0
    v_mov_b32 v64, 0
    v_mov_b32 v65, 0
    s_mov_b32 s45, 0
    s_mov_b32 s47, 0
    s_waitcnt vmcnt(16)
    s_barrier
    ds_read_b64_tr_b16 v[98:99], v140 offset:0
    ds_read_b64_tr_b16 v[100:101], v140 offset:1024
    ds_read_b64_tr_b16 v[102:103], v141 offset:0
    ds_read_b64_tr_b16 v[104:105], v141 offset:1024
    ds_read_b64_tr_b16 v[106:107], v142 offset:0
    ds_read_b64_tr_b16 v[108:109], v142 offset:1024
    ds_read_b64_tr_b16 v[110:111], v143 offset:0
    ds_read_b64_tr_b16 v[112:113], v143 offset:1024
    ds_read_b128 v[66:69], v138 offset:0
    ds_read_b128 v[70:73], v138 offset:2048
    ds_read_b128 v[74:77], v138 offset:4096
    ds_read_b128 v[78:81], v138 offset:6144
    s_waitcnt lgkmcnt(0)
    v_mfma_f32_16x16x32_bf16 v[2:5], v[98:101], v[66:69], v[2:5]
    ds_read_b64_tr_b16 v[114:115], v140 offset:8192
    v_mfma_f32_16x16x32_bf16 v[6:9], v[98:101], v[70:73], v[6:9]
    ds_read_b64_tr_b16 v[116:117], v140 offset:9216
    v_mfma_f32_16x16x32_bf16 v[10:13], v[98:101], v[74:77], v[10:13]
    ds_read_b64_tr_b16 v[118:119], v141 offset:8192
    v_mfma_f32_16x16x32_bf16 v[14:17], v[98:101], v[78:81], v[14:17]
    ds_read_b64_tr_b16 v[120:121], v141 offset:9216
    v_mfma_f32_16x16x32_bf16 v[18:21], v[102:105], v[66:69], v[18:21]
    ds_read_b64_tr_b16 v[122:123], v142 offset:8192
    v_mfma_f32_16x16x32_bf16 v[22:25], v[102:105], v[70:73], v[22:25]
    ds_read_b64_tr_b16 v[124:125], v142 offset:9216
    v_mfma_f32_16x16x32_bf16 v[26:29], v[102:105], v[74:77], v[26:29]
    ds_read_b64_tr_b16 v[126:127], v143 offset:8192
    v_mfma_f32_16x16x32_bf16 v[30:33], v[102:105], v[78:81], v[30:33]
    ds_read_b64_tr_b16 v[128:129], v143 offset:9216
    v_mfma_f32_16x16x32_bf16 v[34:37], v[106:109], v[66:69], v[34:37]
    ds_read_b128 v[82:85], v139 offset:0
    v_mfma_f32_16x16x32_bf16 v[38:41], v[106:109], v[70:73], v[38:41]
    ds_read_b128 v[86:89], v139 offset:2048
    v_mfma_f32_16x16x32_bf16 v[42:45], v[106:109], v[74:77], v[42:45]
    ds_read_b128 v[90:93], v139 offset:4096
    v_mfma_f32_16x16x32_bf16 v[46:49], v[106:109], v[78:81], v[46:49]
    ds_read_b128 v[94:97], v139 offset:6144
    v_mfma_f32_16x16x32_bf16 v[50:53], v[110:113], v[66:69], v[50:53]
    v_mfma_f32_16x16x32_bf16 v[54:57], v[110:113], v[70:73], v[54:57]
    v_mfma_f32_16x16x32_bf16 v[58:61], v[110:113], v[74:77], v[58:61]
    v_mfma_f32_16x16x32_bf16 v[62:65], v[110:113], v[78:81], v[62:65]
    s_add_u32 s47, s47, 1
    s_cmp_eq_u32 s47, 5
    s_mov_b32 s49, 32768
    s_cmov_b32 s49, 0xfffe0000
    s_cmov_b32 s47, 0
    s_waitcnt lgkmcnt(0)
    v_add_u32 v138, s49, v138
    v_add_u32 v139, s49, v139
    v_add_u32 v140, s49, v140
    v_add_u32 v141, s49, v141
    v_add_u32 v142, s49, v142
    v_add_u32 v143, s49, v143
    s_waitcnt vmcnt(12)
    s_barrier
    v_mfma_f32_16x16x32_bf16 v[2:5], v[114:117], v[82:85], v[2:5]
    ds_read_b64_tr_b16 v[98:99], v140 offset:0
    v_mfma_f32_16x16x32_bf16 v[6:9], v[114:117], v[86:89], v[6:9]
    ds_read_b64_tr_b16 v[100:101], v140 offset:1024
    s_add_u32 m0, s52, 0
    s_nop 0
    buffer_load_dwordx4 v130, s[4:7], s43 offen sc1 lds
    v_mfma_f32_16x16x32_bf16 v[10:13], v[114:117], v[90:93], v[10:13]
    ds_read_b64_tr_b16 v[102:103], v141 offset:0
    v_mfma_f32_16x16x32_bf16 v[14:17], v[114:117], v[94:97], v[14:17]
    ds_read_b64_tr_b16 v[104:105], v141 offset:1024
    s_add_u32 m0, s52, 1024
    s_nop 0
    buffer_load_dwordx4 v131, s[4:7], s43 offen sc1 lds
    v_mfma_f32_16x16x32_bf16 v[18:21], v[118:121], v[82:85], v[18:21]
    ds_read_b64_tr_b16 v[106:107], v142 offset:0
    v_mfma_f32_16x16x32_bf16 v[22:25], v[118:121], v[86:89], v[22:25]
    ds_read_b64_tr_b16 v[108:109], v142 offset:1024
    s_add_u32 m0, s52, 2048
    s_nop 0
    buffer_load_dwordx4 v132, s[4:7], s43 offen sc1 lds
    v_mfma_f32_16x16x32_bf16 v[26:29], v[118:121], v[90:93], v[26:29]
    ds_read_b64_tr_b16 v[110:111], v143 offset:0
    v_mfma_f32_16x16x32_bf16 v[30:33], v[118:121], v[94:97], v[30:33]
    ds_read_b64_tr_b16 v[112:113], v143 offset:1024
    s_add_u32 m0, s52, 3072
    s_nop 0
    buffer_load_dwordx4 v133, s[4:7], s43 offen sc1 lds
    v_mfma_f32_16x16x32_bf16 v[34:37], v[122:125], v[82:85], v[34:37]
    ds_read_b128 v[66:69], v138 offset:0
    v_mfma_f32_16x16x32_bf16 v[38:41], v[122:125], v[86:89], v[38:41]
    ds_read_b128 v[70:73], v138 offset:2048
    s_add_u32 m0, s53, 16384
    s_nop 0
    buffer_load_dwordx4 v134, s[8:11], s44 offen lds
    v_mfma_f32_16x16x32_bf16 v[42:45], v[122:125], v[90:93], v[42:45]
    ds_read_b128 v[74:77], v138 offset:4096
    v_mfma_f32_16x16x32_bf16 v[46:49], v[122:125], v[94:97], v[46:49]
    ds_read_b128 v[78:81], v138 offset:6144
    s_add_u32 m0, s53, 17408
    s_nop 0
    buffer_load_dwordx4 v135, s[8:11], s44 offen lds
    v_mfma_f32_16x16x32_bf16 v[50:53], v[126:129], v[82:85], v[50:53]
    v_mfma_f32_16x16x32_bf16 v[54:57], v[126:129], v[86:89], v[54:57]
    s_add_u32 m0, s53, 18432
    s_nop 0
    buffer_load_dwordx4 v136, s[8:11], s44 offen lds
    v_mfma_f32_16x16x32_bf16 v[58:61], v[126:129], v[90:93], v[58:61]
    v_mfma_f32_16x16x32_bf16 v[62:65], v[126:129], v[94:97], v[62:65]
    s_add_u32 m0, s53, 19456
    s_nop 0
    buffer_load_dwordx4 v137, s[8:11], s44 offen lds
    s_add_u32 s43, s43, 128
    s_add_u32 s44, s44, 81920
    s_add_u32 s46, s46, 32768
    s_cmp_eq_u32 s46, 163840
    s_cmov_b32 s46, 0
    s_add_u32 s52, s46, s54
    s_add_u32 s53, s46, s55
    s_waitcnt lgkmcnt(0)
    v_mfma_f32_16x16x32_bf16 v[2:5], v[98:101], v[66:69], v[2:5]
    ds_read_b64_tr_b16 v[114:115], v140 offset:8192
    v_mfma_f32_16x16x32_bf16 v[6:9], v[98:101], v[70:73], v[6:9]
    ds_read_b64_tr_b16 v[116:117], v140 offset:9216
    v_mfma_f32_16x16x32_bf16 v[10:13], v[98:101], v[74:77], v[10:13]
    ds_read_b64_tr_b16 v[118:119], v141 offset:8192
    v_mfma_f32_16x16x32_bf16 v[14:17], v[98:101], v[78:81], v[14:17]
    ds_read_b64_tr_b16 v[120:121], v141 offset:9216
    v_mfma_f32_16x16x32_bf16 v[18:21], v[102:105], v[66:69], v[18:21]
    ds_read_b64_tr_b16 v[122:123], v142 offset:8192
    v_mfma_f32_16x16x32_bf16 v[22:25], v[102:105], v[70:73], v[22:25]
    ds_read_b64_tr_b16 v[124:125], v142 offset:9216
    v_mfma_f32_16x16x32_bf16 v[26:29], v[102:105], v[74:77], v[26:29]
    ds_read_b64_tr_b16 v[126:127], v143 offset:8192
    v_mfma_f32_16x16x32_bf16 v[30:33], v[102:105], v[78:81], v[30:33]
    ds_read_b64_tr_b16 v[128:129], v143 offset:9216
    v_mfma_f32_16x16x32_bf16 v[34:37], v[106:109], v[66:69], v[34:37]
    ds_read_b128 v[82:85], v139 offset:0
    v_mfma_f32_16x16x32_bf16 v[38:41], v[106:109], v[70:73], v[38:41]
    ds_read_b128 v[86:89], v139 offset:2048
    v_mfma_f32_16x16x32_bf16 v[42:45], v[106:109], v[74:77], v[42:45]
    ds_read_b128 v[90:93], v139 offset:4096
    v_mfma_f32_16x16x32_bf16 v[46:49], v[106:109], v[78:81], v[46:49]
    ds_read_b128 v[94:97], v139 offset:6144
    v_mfma_f32_16x16x32_bf16 v[50:53], v[110:113], v[66:69], v[50:53]
    v_mfma_f32_16x16x32_bf16 v[54:57], v[110:113], v[70:73], v[54:57]
    v_mfma_f32_16x16x32_bf16 v[58:61], v[110:113], v[74:77], v[58:61]
    v_mfma_f32_16x16x32_bf16 v[62:65], v[110:113], v[78:81], v[62:65]
    s_add_u32 s47, s47, 1
    s_cmp_eq_u32 s47, 5
    s_mov_b32 s49, 32768
    s_cmov_b32 s49, 0xfffe0000
    s_cmov_b32 s47, 0
    s_waitcnt lgkmcnt(0)
    v_add_u32 v138, s49, v138
    v_add_u32 v139, s49, v139
    v_add_u32 v140, s49, v140
    v_add_u32 v141, s49, v141
    v_add_u32 v142, s49, v142
    v_add_u32 v143, s49, v143
    s_waitcnt vmcnt(16)
    s_barrier
    v_mfma_f32_16x16x32_bf16 v[2:5], v[114:117], v[82:85], v[2:5]
    ds_read_b64_tr_b16 v[98:99], v140 offset:0
    v_mfma_f32_16x16x32_bf16 v[6:9], v[114:117], v[86:89], v[6:9]
    ds_read_b64_tr_b16 v[100:101], v140 offset:1024
    s_add_u32 m0, s52, 0
    s_nop 0
    buffer_load_dwordx4 v130, s[4:7], s43 offen sc1 lds
    v_mfma_f32_16x16x32_bf16 v[10:13], v[114:117], v[90:93], v[10:13]
    ds_read_b64_tr_b16 v[102:103], v141 offset:0
    v_mfma_f32_16x16x32_bf16 v[14:17], v[114:117], v[94:97], v[14:17]
    ds_read_b64_tr_b16 v[104:105], v141 offset:1024
    s_add_u32 m0, s52, 1024
    s_nop 0
    buffer_load_dwordx4 v131, s[4:7], s43 offen sc1 lds
    v_mfma_f32_16x16x32_bf16 v[18:21], v[118:121], v[82:85], v[18:21]
    ds_read_b64_tr_b16 v[106:107], v142 offset:0
    v_mfma_f32_16x16x32_bf16 v[22:25], v[118:121], v[86:89], v[22:25]
    ds_read_b64_tr_b16 v[108:109], v142 offset:1024
    s_add_u32 m0, s52, 2048
    s_nop 0
    buffer_load_dwordx4 v132, s[4:7], s43 offen sc1 lds
    v_mfma_f32_16x16x32_bf16 v[26:29], v[118:121], v[90:93], v[26:29]
    ds_read_b64_tr_b16 v[110:111], v143 offset:0
    v_mfma_f32_16x16x32_bf16 v[30:33], v[118:121], v[94:97], v[30:33]
    ds_read_b64_tr_b16 v[112:113], v143 offset:1024
    s_add_u32 m0, s52, 3072
    s_nop 0
    buffer_load_dwordx4 v133, s[4:7], s43 offen sc1 lds
    v_mfma_f32_16x16x32_bf16 v[34:37], v[122:125], v[82:85], v[34:37]
    ds_read_b128 v[66:69], v138 offset:0
    v_mfma_f32_16x16x32_bf16 v[38:41], v[122:125], v[86:89], v[38:41]
    ds_read_b128 v[70:73], v138 offset:2048
    s_add_u32 m0, s53, 16384
    s_nop 0
    buffer_load_dwordx4 v134, s[8:11], s44 offen lds
    v_mfma_f32_16x16x32_bf16 v[42:45], v[122:125], v[90:93], v[42:45]
    ds_read_b128 v[74:77], v138 offset:4096
    v_mfma_f32_16x16x32_bf16 v[46:49], v[122:125], v[94:97], v[46:49]
    ds_read_b128 v[78:81], v138 offset:6144
    s_add_u32 m0, s53, 17408
    s_nop 0
    buffer_load_dwordx4 v135, s[8:11], s44 offen lds
    v_mfma_f32_16x16x32_bf16 v[50:53], v[126:129], v[82:85], v[50:53]
    v_mfma_f32_16x16x32_bf16 v[54:57], v[126:129], v[86:89], v[54:57]
    s_add_u32 m0, s53, 18432
    s_nop 0
    buffer_load_dwordx4 v136, s[8:11], s44 offen lds
    v_mfma_f32_16x16x32_bf16 v[58:61], v[126:129], v[90:93], v[58:61]
    v_mfma_f32_16x16x32_bf16 v[62:65], v[126:129], v[94:97], v[62:65]
    s_add_u32 m0, s53, 19456
    s_nop 0
    buffer_load_dwordx4 v137, s[8:11], s44 offen lds
    s_add_u32 s43, s43, 128
    s_add_u32 s44, s44, 81920
    s_add_u32 s46, s46, 32768
    s_cmp_eq_u32 s46, 163840
    s_cmov_b32 s46, 0
    s_add_u32 s52, s46, s54
    s_add_u32 s53, s46, s55
    s_waitcnt lgkmcnt(0)
    v_mfma_f32_16x16x32_bf16 v[2:5], v[98:101], v[66:69], v[2:5]
    ds_read_b64_tr_b16 v[114:115], v140 offset:8192
    v_mfma_f32_16x16x32_bf16 v[6:9], v[98:101], v[70:73], v[6:9]
    ds_read_b64_tr_b16 v[116:117], v140 offset:9216
    v_mfma_f32_16x16x32_bf16 v[10:13], v[98:101], v[74:77], v[10:13]
    ds_read_b64_tr_b16 v[118:119], v141 offset:8192
    v_mfma_f32_16x16x32_bf16 v[14:17], v[98:101], v[78:81], v[14:17]
    ds_read_b64_tr_b16 v[120:121], v141 offset:9216
    v_mfma_f32_16x16x32_bf16 v[18:21], v[102:105], v[66:69], v[18:21]
    ds_read_b64_tr_b16 v[122:123], v142 offset:8192
    v_mfma_f32_16x16x32_bf16 v[22:25], v[102:105], v[70:73], v[22:25]
    ds_read_b64_tr_b16 v[124:125], v142 offset:9216
    v_mfma_f32_16x16x32_bf16 v[26:29], v[102:105], v[74:77], v[26:29]
    ds_read_b64_tr_b16 v[126:127], v143 offset:8192
    v_mfma_f32_16x16x32_bf16 v[30:33], v[102:105], v[78:81], v[30:33]
    ds_read_b64_tr_b16 v[128:129], v143 offset:9216
    v_mfma_f32_16x16x32_bf16 v[34:37], v[106:109], v[66:69], v[34:37]
    ds_read_b128 v[82:85], v139 offset:0
    v_mfma_f32_16x16x32_bf16 v[38:41], v[106:109], v[70:73], v[38:41]
    ds_read_b128 v[86:89], v139 offset:2048
    v_mfma_f32_16x16x32_bf16 v[42:45], v[106:109], v[74:77], v[42:45]
    ds_read_b128 v[90:93], v139 offset:4096
    v_mfma_f32_16x16x32_bf16 v[46:49], v[106:109], v[78:81], v[46:49]
    ds_read_b128 v[94:97], v139 offset:6144
    v_mfma_f32_16x16x32_bf16 v[50:53], v[110:113], v[66:69], v[50:53]
    v_mfma_f32_16x16x32_bf16 v[54:57], v[110:113], v[70:73], v[54:57]
    v_mfma_f32_16x16x32_bf16 v[58:61], v[110:113], v[74:77], v[58:61]
    v_mfma_f32_16x16x32_bf16 v[62:65], v[110:113], v[78:81], v[62:65]
    s_add_u32 s47, s47, 1
    s_cmp_eq_u32 s47, 5
    s_mov_b32 s49, 32768
    s_cmov_b32 s49, 0xfffe0000
    s_cmov_b32 s47, 0
    s_waitcnt lgkmcnt(0)
    v_add_u32 v138, s49, v138
    v_add_u32 v139, s49, v139
    v_add_u32 v140, s49, v140
    v_add_u32 v141, s49, v141
    v_add_u32 v142, s49, v142
    v_add_u32 v143, s49, v143
    s_waitcnt vmcnt(20)
    s_barrier
    v_mfma_f32_16x16x32_bf16 v[2:5], v[114:117], v[82:85], v[2:5]
    ds_read_b64_tr_b16 v[98:99], v140 offset:0
    v_mfma_f32_16x16x32_bf16 v[6:9], v[114:117], v[86:89], v[6:9]
    ds_read_b64_tr_b16 v[100:101], v140 offset:1024
    s_add_u32 m0, s52, 0
    s_nop 0
    buffer_load_dwordx4 v130, s[4:7], s43 offen sc1 lds
    v_mfma_f32_16x16x32_bf16 v[10:13], v[114:117], v[90:93], v[10:13]
    ds_read_b64_tr_b16 v[102:103], v141 offset:0
    v_mfma_f32_16x16x32_bf16 v[14:17], v[114:117], v[94:97], v[14:17]
    ds_read_b64_tr_b16 v[104:105], v141 offset:1024
    s_add_u32 m0, s52, 1024
    s_nop 0
    buffer_load_dwordx4 v131, s[4:7], s43 offen sc1 lds
    v_mfma_f32_16x16x32_bf16 v[18:21], v[118:121], v[82:85], v[18:21]
    ds_read_b64_tr_b16 v[106:107], v142 offset:0
    v_mfma_f32_16x16x32_bf16 v[22:25], v[118:121], v[86:89], v[22:25]
    ds_read_b64_tr_b16 v[108:109], v142 offset:1024
    s_add_u32 m0, s52, 2048
    s_nop 0
    buffer_load_dwordx4 v132, s[4:7], s43 offen sc1 lds
    v_mfma_f32_16x16x32_bf16 v[26:29], v[118:121], v[90:93], v[26:29]
    ds_read_b64_tr_b16 v[110:111], v143 offset:0
    v_mfma_f32_16x16x32_bf16 v[30:33], v[118:121], v[94:97], v[30:33]
    ds_read_b64_tr_b16 v[112:113], v143 offset:1024
    s_add_u32 m0, s52, 3072
    s_nop 0
    buffer_load_dwordx4 v133, s[4:7], s43 offen sc1 lds
    v_mfma_f32_16x16x32_bf16 v[34:37], v[122:125], v[82:85], v[34:37]
    ds_read_b128 v[66:69], v138 offset:0
    v_mfma_f32_16x16x32_bf16 v[38:41], v[122:125], v[86:89], v[38:41]
    ds_read_b128 v[70:73], v138 offset:2048
    s_add_u32 m0, s53, 16384
    s_nop 0
    buffer_load_dwordx4 v134, s[8:11], s44 offen lds
    v_mfma_f32_16x16x32_bf16 v[42:45], v[122:125], v[90:93], v[42:45]
    ds_read_b128 v[74:77], v138 offset:4096
    v_mfma_f32_16x16x32_bf16 v[46:49], v[122:125], v[94:97], v[46:49]
    ds_read_b128 v[78:81], v138 offset:6144
    s_add_u32 m0, s53, 17408
    s_nop 0
    buffer_load_dwordx4 v135, s[8:11], s44 offen lds
    v_mfma_f32_16x16x32_bf16 v[50:53], v[126:129], v[82:85], v[50:53]
    v_mfma_f32_16x16x32_bf16 v[54:57], v[126:129], v[86:89], v[54:57]
    s_add_u32 m0, s53, 18432
    s_nop 0
    buffer_load_dwordx4 v136, s[8:11], s44 offen lds
    v_mfma_f32_16x16x32_bf16 v[58:61], v[126:129], v[90:93], v[58:61]
    v_mfma_f32_16x16x32_bf16 v[62:65], v[126:129], v[94:97], v[62:65]
    s_add_u32 m0, s53, 19456
    s_nop 0
    buffer_load_dwordx4 v137, s[8:11], s44 offen lds
    s_add_u32 s43, s43, 128
    s_add_u32 s44, s44, 81920
    s_add_u32 s46, s46, 32768
    s_cmp_eq_u32 s46, 163840
    s_cmov_b32 s46, 0
    s_add_u32 s52, s46, s54
    s_add_u32 s53, s46, s55
    s_waitcnt lgkmcnt(0)
    v_mfma_f32_16x16x32_bf16 v[2:5], v[98:101], v[66:69], v[2:5]
    ds_read_b64_tr_b16 v[114:115], v140 offset:8192
    v_mfma_f32_16x16x32_bf16 v[6:9], v[98:101], v[70:73], v[6:9]
    ds_read_b64_tr_b16 v[116:117], v140 offset:9216
    v_mfma_f32_16x16x32_bf16 v[10:13], v[98:101], v[74:77], v[10:13]
    ds_read_b64_tr_b16 v[118:119], v141 offset:8192
    v_mfma_f32_16x16x32_bf16 v[14:17], v[98:101], v[78:81], v[14:17]
    ds_read_b64_tr_b16 v[120:121], v141 offset:9216
    v_mfma_f32_16x16x32_bf16 v[18:21], v[102:105], v[66:69], v[18:21]
    ds_read_b64_tr_b16 v[122:123], v142 offset:8192
    v_mfma_f32_16x16x32_bf16 v[22:25], v[102:105], v[70:73], v[22:25]
    ds_read_b64_tr_b16 v[124:125], v142 offset:9216
    v_mfma_f32_16x16x32_bf16 v[26:29], v[102:105], v[74:77], v[26:29]
    ds_read_b64_tr_b16 v[126:127], v143 offset:8192
    v_mfma_f32_16x16x32_bf16 v[30:33], v[102:105], v[78:81], v[30:33]
    ds_read_b64_tr_b16 v[128:129], v143 offset:9216
    v_mfma_f32_16x16x32_bf16 v[34:37], v[106:109], v[66:69], v[34:37]
    ds_read_b128 v[82:85], v139 offset:0
    v_mfma_f32_16x16x32_bf16 v[38:41], v[106:109], v[70:73], v[38:41]
    ds_read_b128 v[86:89], v139 offset:2048
    v_mfma_f32_16x16x32_bf16 v[42:45], v[106:109], v[74:77], v[42:45]
    ds_read_b128 v[90:93], v139 offset:4096
    v_mfma_f32_16x16x32_bf16 v[46:49], v[106:109], v[78:81], v[46:49]
    ds_read_b128 v[94:97], v139 offset:6144
    v_mfma_f32_16x16x32_bf16 v[50:53], v[110:113], v[66:69], v[50:53]
    v_mfma_f32_16x16x32_bf16 v[54:57], v[110:113], v[70:73], v[54:57]
    v_mfma_f32_16x16x32_bf16 v[58:61], v[110:113], v[74:77], v[58:61]
    v_mfma_f32_16x16x32_bf16 v[62:65], v[110:113], v[78:81], v[62:65]
    s_add_u32 s47, s47, 1
    s_cmp_eq_u32 s47, 5
    s_mov_b32 s49, 32768
    s_cmov_b32 s49, 0xfffe0000
    s_cmov_b32 s47, 0
    s_waitcnt lgkmcnt(0)
    v_add_u32 v138, s49, v138
    v_add_u32 v139, s49, v139
    v_add_u32 v140, s49, v140
    v_add_u32 v141, s49, v141
    v_add_u32 v142, s49, v142
    v_add_u32 v143, s49, v143
    s_waitcnt vmcnt(24)
    s_barrier
    v_mfma_f32_16x16x32_bf16 v[2:5], v[114:117], v[82:85], v[2:5]
    ds_read_b64_tr_b16 v[98:99], v140 offset:0
    v_mfma_f32_16x16x32_bf16 v[6:9], v[114:117], v[86:89], v[6:9]
    ds_read_b64_tr_b16 v[100:101], v140 offset:1024
    v_mfma_f32_16x16x32_bf16 v[10:13], v[114:117], v[90:93], v[10:13]
    ds_read_b64_tr_b16 v[102:103], v141 offset:0
    v_mfma_f32_16x16x32_bf16 v[14:17], v[114:117], v[94:97], v[14:17]
    ds_read_b64_tr_b16 v[104:105], v141 offset:1024
    v_mfma_f32_16x16x32_bf16 v[18:21], v[118:121], v[82:85], v[18:21]
    ds_read_b64_tr_b16 v[106:107], v142 offset:0
    v_mfma_f32_16x16x32_bf16 v[22:25], v[118:121], v[86:89], v[22:25]
    ds_read_b64_tr_b16 v[108:109], v142 offset:1024
    v_mfma_f32_16x16x32_bf16 v[26:29], v[118:121], v[90:93], v[26:29]
    ds_read_b64_tr_b16 v[110:111], v143 offset:0
    v_mfma_f32_16x16x32_bf16 v[30:33], v[118:121], v[94:97], v[30:33]
    ds_read_b64_tr_b16 v[112:113], v143 offset:1024
    v_mfma_f32_16x16x32_bf16 v[34:37], v[122:125], v[82:85], v[34:37]
    ds_read_b128 v[66:69], v138 offset:0
    v_mfma_f32_16x16x32_bf16 v[38:41], v[122:125], v[86:89], v[38:41]
    ds_read_b128 v[70:73], v138 offset:2048
    v_mfma_f32_16x16x32_bf16 v[42:45], v[122:125], v[90:93], v[42:45]
    ds_read_b128 v[74:77], v138 offset:4096
    v_mfma_f32_16x16x32_bf16 v[46:49], v[122:125], v[94:97], v[46:49]
    ds_read_b128 v[78:81], v138 offset:6144
    v_mfma_f32_16x16x32_bf16 v[50:53], v[126:129], v[82:85], v[50:53]
    v_mfma_f32_16x16x32_bf16 v[54:57], v[126:129], v[86:89], v[54:57]
    v_mfma_f32_16x16x32_bf16 v[58:61], v[126:129], v[90:93], v[58:61]
    v_mfma_f32_16x16x32_bf16 v[62:65], v[126:129], v[94:97], v[62:65]
    s_waitcnt lgkmcnt(0)
    v_mfma_f32_16x16x32_bf16 v[2:5], v[98:101], v[66:69], v[2:5]
    ds_read_b64_tr_b16 v[114:115], v140 offset:8192
    v_mfma_f32_16x16x32_bf16 v[6:9], v[98:101], v[70:73], v[6:9]
    ds_read_b64_tr_b16 v[116:117], v140 offset:9216
    v_mfma_f32_16x16x32_bf16 v[10:13], v[98:101], v[74:77], v[10:13]
    ds_read_b64_tr_b16 v[118:119], v141 offset:8192
    v_mfma_f32_16x16x32_bf16 v[14:17], v[98:101], v[78:81], v[14:17]
    ds_read_b64_tr_b16 v[120:121], v141 offset:9216
    v_mfma_f32_16x16x32_bf16 v[18:21], v[102:105], v[66:69], v[18:21]
    ds_read_b64_tr_b16 v[122:123], v142 offset:8192
    v_mfma_f32_16x16x32_bf16 v[22:25], v[102:105], v[70:73], v[22:25]
    ds_read_b64_tr_b16 v[124:125], v142 offset:9216
    v_mfma_f32_16x16x32_bf16 v[26:29], v[102:105], v[74:77], v[26:29]
    ds_read_b64_tr_b16 v[126:127], v143 offset:8192
    v_mfma_f32_16x16x32_bf16 v[30:33], v[102:105], v[78:81], v[30:33]
    ds_read_b64_tr_b16 v[128:129], v143 offset:9216
    v_mfma_f32_16x16x32_bf16 v[34:37], v[106:109], v[66:69], v[34:37]
    ds_read_b128 v[82:85], v139 offset:0
    v_mfma_f32_16x16x32_bf16 v[38:41], v[106:109], v[70:73], v[38:41]
    ds_read_b128 v[86:89], v139 offset:2048
    v_mfma_f32_16x16x32_bf16 v[42:45], v[106:109], v[74:77], v[42:45]
    ds_read_b128 v[90:93], v139 offset:4096
    v_mfma_f32_16x16x32_bf16 v[46:49], v[106:109], v[78:81], v[46:49]
    ds_read_b128 v[94:97], v139 offset:6144
    v_mfma_f32_16x16x32_bf16 v[50:53], v[110:113], v[66:69], v[50:53]
    v_mfma_f32_16x16x32_bf16 v[54:57], v[110:113], v[70:73], v[54:57]
    v_mfma_f32_16x16x32_bf16 v[58:61], v[110:113], v[74:77], v[58:61]
    v_mfma_f32_16x16x32_bf16 v[62:65], v[110:113], v[78:81], v[62:65]
    s_add_u32 s47, s47, 1
    s_cmp_eq_u32 s47, 5
    s_mov_b32 s49, 32768
    s_cmov_b32 s49, 0xfffe0000
    s_cmov_b32 s47, 0
    s_waitcnt lgkmcnt(0)
    v_add_u32 v138, s49, v138
    v_add_u32 v139, s49, v139
    v_add_u32 v140, s49, v140
    v_add_u32 v141, s49, v141
    v_add_u32 v142, s49, v142
    v_add_u32 v143, s49, v143
    s_waitcnt vmcnt(16)
    s_barrier
    v_mfma_f32_16x16x32_bf16 v[2:5], v[114:117], v[82:85], v[2:5]
    ds_read_b64_tr_b16 v[98:99], v140 offset:0
    v_mfma_f32_16x16x32_bf16 v[6:9], v[114:117], v[86:89], v[6:9]
    ds_read_b64_tr_b16 v[100:101], v140 offset:1024
    v_mfma_f32_16x16x32_bf16 v[10:13], v[114:117], v[90:93], v[10:13]
    ds_read_b64_tr_b16 v[102:103], v141 offset:0
    v_mfma_f32_16x16x32_bf16 v[14:17], v[114:117], v[94:97], v[14:17]
    ds_read_b64_tr_b16 v[104:105], v141 offset:1024
    v_mfma_f32_16x16x32_bf16 v[18:21], v[118:121], v[82:85], v[18:21]
    ds_read_b64_tr_b16 v[106:107], v142 offset:0
    v_mfma_f32_16x16x32_bf16 v[22:25], v[118:121], v[86:89], v[22:25]
    ds_read_b64_tr_b16 v[108:109], v142 offset:1024
    v_mfma_f32_16x16x32_bf16 v[26:29], v[118:121], v[90:93], v[26:29]
    ds_read_b64_tr_b16 v[110:111], v143 offset:0
    v_mfma_f32_16x16x32_bf16 v[30:33], v[118:121], v[94:97], v[30:33]
    ds_read_b64_tr_b16 v[112:113], v143 offset:1024
    v_mfma_f32_16x16x32_bf16 v[34:37], v[122:125], v[82:85], v[34:37]
    ds_read_b128 v[66:69], v138 offset:0
    v_mfma_f32_16x16x32_bf16 v[38:41], v[122:125], v[86:89], v[38:41]
    ds_read_b128 v[70:73], v138 offset:2048
    v_mfma_f32_16x16x32_bf16 v[42:45], v[122:125], v[90:93], v[42:45]
    ds_read_b128 v[74:77], v138 offset:4096
    v_mfma_f32_16x16x32_bf16 v[46:49], v[122:125], v[94:97], v[46:49]
    ds_read_b128 v[78:81], v138 offset:6144
    v_mfma_f32_16x16x32_bf16 v[50:53], v[126:129], v[82:85], v[50:53]
    v_mfma_f32_16x16x32_bf16 v[54:57], v[126:129], v[86:89], v[54:57]
    v_mfma_f32_16x16x32_bf16 v[58:61], v[126:129], v[90:93], v[58:61]
    v_mfma_f32_16x16x32_bf16 v[62:65], v[126:129], v[94:97], v[62:65]
    s_waitcnt lgkmcnt(0)
    v_mfma_f32_16x16x32_bf16 v[2:5], v[98:101], v[66:69], v[2:5]
    ds_read_b64_tr_b16 v[114:115], v140 offset:8192
    v_mfma_f32_16x16x32_bf16 v[6:9], v[98:101], v[70:73], v[6:9]
    ds_read_b64_tr_b16 v[116:117], v140 offset:9216
    v_mfma_f32_16x16x32_bf16 v[10:13], v[98:101], v[74:77], v[10:13]
    ds_read_b64_tr_b16 v[118:119], v141 offset:8192
    v_mfma_f32_16x16x32_bf16 v[14:17], v[98:101], v[78:81], v[14:17]
    ds_read_b64_tr_b16 v[120:121], v141 offset:9216
    v_mfma_f32_16x16x32_bf16 v[18:21], v[102:105], v[66:69], v[18:21]
    ds_read_b64_tr_b16 v[122:123], v142 offset:8192
    v_mfma_f32_16x16x32_bf16 v[22:25], v[102:105], v[70:73], v[22:25]
    ds_read_b64_tr_b16 v[124:125], v142 offset:9216
    v_mfma_f32_16x16x32_bf16 v[26:29], v[102:105], v[74:77], v[26:29]
    ds_read_b64_tr_b16 v[126:127], v143 offset:8192
    v_mfma_f32_16x16x32_bf16 v[30:33], v[102:105], v[78:81], v[30:33]
    ds_read_b64_tr_b16 v[128:129], v143 offset:9216
    v_mfma_f32_16x16x32_bf16 v[34:37], v[106:109], v[66:69], v[34:37]
    ds_read_b128 v[82:85], v139 offset:0
    v_mfma_f32_16x16x32_bf16 v[38:41], v[106:109], v[70:73], v[38:41]
    ds_read_b128 v[86:89], v139 offset:2048
    v_mfma_f32_16x16x32_bf16 v[42:45], v[106:109], v[74:77], v[42:45]
    ds_read_b128 v[90:93], v139 offset:4096
    v_mfma_f32_16x16x32_bf16 v[46:49], v[106:109], v[78:81], v[46:49]
    ds_read_b128 v[94:97], v139 offset:6144
    v_mfma_f32_16x16x32_bf16 v[50:53], v[110:113], v[66:69], v[50:53]
    v_mfma_f32_16x16x32_bf16 v[54:57], v[110:113], v[70:73], v[54:57]
    v_mfma_f32_16x16x32_bf16 v[58:61], v[110:113], v[74:77], v[58:61]
    v_mfma_f32_16x16x32_bf16 v[62:65], v[110:113], v[78:81], v[62:65]
    s_add_u32 s47, s47, 1
    s_cmp_eq_u32 s47, 5
    s_mov_b32 s49, 32768
    s_cmov_b32 s49, 0xfffe0000
    s_cmov_b32 s47, 0
    s_waitcnt lgkmcnt(0)
    v_add_u32 v138, s49, v138
    v_add_u32 v139, s49, v139
    v_add_u32 v140, s49, v140
    v_add_u32 v141, s49, v141
    v_add_u32 v142, s49, v142
    v_add_u32 v143, s49, v143
    s_waitcnt vmcnt(8)
    s_barrier
    v_mfma_f32_16x16x32_bf16 v[2:5], v[114:117], v[82:85], v[2:5]
    ds_read_b64_tr_b16 v[98:99], v140 offset:0
    v_mfma_f32_16x16x32_bf16 v[6:9], v[114:117], v[86:89], v[6:9]
    ds_read_b64_tr_b16 v[100:101], v140 offset:1024
    v_mfma_f32_16x16x32_bf16 v[10:13], v[114:117], v[90:93], v[10:13]
    ds_read_b64_tr_b16 v[102:103], v141 offset:0
    v_mfma_f32_16x16x32_bf16 v[14:17], v[114:117], v[94:97], v[14:17]
    ds_read_b64_tr_b16 v[104:105], v141 offset:1024
    v_mfma_f32_16x16x32_bf16 v[18:21], v[118:121], v[82:85], v[18:21]
    ds_read_b64_tr_b16 v[106:107], v142 offset:0
    v_mfma_f32_16x16x32_bf16 v[22:25], v[118:121], v[86:89], v[22:25]
    ds_read_b64_tr_b16 v[108:109], v142 offset:1024
    v_mfma_f32_16x16x32_bf16 v[26:29], v[118:121], v[90:93], v[26:29]
    ds_read_b64_tr_b16 v[110:111], v143 offset:0
    v_mfma_f32_16x16x32_bf16 v[30:33], v[118:121], v[94:97], v[30:33]
    ds_read_b64_tr_b16 v[112:113], v143 offset:1024
    v_mfma_f32_16x16x32_bf16 v[34:37], v[122:125], v[82:85], v[34:37]
    ds_read_b128 v[66:69], v138 offset:0
    v_mfma_f32_16x16x32_bf16 v[38:41], v[122:125], v[86:89], v[38:41]
    ds_read_b128 v[70:73], v138 offset:2048
    v_mfma_f32_16x16x32_bf16 v[42:45], v[122:125], v[90:93], v[42:45]
    ds_read_b128 v[74:77], v138 offset:4096
    v_mfma_f32_16x16x32_bf16 v[46:49], v[122:125], v[94:97], v[46:49]
    ds_read_b128 v[78:81], v138 offset:6144
    v_mfma_f32_16x16x32_bf16 v[50:53], v[126:129], v[82:85], v[50:53]
    v_mfma_f32_16x16x32_bf16 v[54:57], v[126:129], v[86:89], v[54:57]
    v_mfma_f32_16x16x32_bf16 v[58:61], v[126:129], v[90:93], v[58:61]
    v_mfma_f32_16x16x32_bf16 v[62:65], v[126:129], v[94:97], v[62:65]
    s_waitcnt lgkmcnt(0)
    v_mfma_f32_16x16x32_bf16 v[2:5], v[98:101], v[66:69], v[2:5]
    ds_read_b64_tr_b16 v[114:115], v140 offset:8192
    v_mfma_f32_16x16x32_bf16 v[6:9], v[98:101], v[70:73], v[6:9]
    ds_read_b64_tr_b16 v[116:117], v140 offset:9216
    v_mfma_f32_16x16x32_bf16 v[10:13], v[98:101], v[74:77], v[10:13]
    ds_read_b64_tr_b16 v[118:119], v141 offset:8192
    v_mfma_f32_16x16x32_bf16 v[14:17], v[98:101], v[78:81], v[14:17]
    ds_read_b64_tr_b16 v[120:121], v141 offset:9216
    v_mfma_f32_16x16x32_bf16 v[18:21], v[102:105], v[66:69], v[18:21]
    ds_read_b64_tr_b16 v[122:123], v142 offset:8192
    v_mfma_f32_16x16x32_bf16 v[22:25], v[102:105], v[70:73], v[22:25]
    ds_read_b64_tr_b16 v[124:125], v142 offset:9216
    v_mfma_f32_16x16x32_bf16 v[26:29], v[102:105], v[74:77], v[26:29]
    ds_read_b64_tr_b16 v[126:127], v143 offset:8192
    v_mfma_f32_16x16x32_bf16 v[30:33], v[102:105], v[78:81], v[30:33]
    ds_read_b64_tr_b16 v[128:129], v143 offset:9216
    v_mfma_f32_16x16x32_bf16 v[34:37], v[106:109], v[66:69], v[34:37]
    ds_read_b128 v[82:85], v139 offset:0
    v_mfma_f32_16x16x32_bf16 v[38:41], v[106:109], v[70:73], v[38:41]
    ds_read_b128 v[86:89], v139 offset:2048
    v_mfma_f32_16x16x32_bf16 v[42:45], v[106:109], v[74:77], v[42:45]
    ds_read_b128 v[90:93], v139 offset:4096
    v_mfma_f32_16x16x32_bf16 v[46:49], v[106:109], v[78:81], v[46:49]
    ds_read_b128 v[94:97], v139 offset:6144
    v_mfma_f32_16x16x32_bf16 v[50:53], v[110:113], v[66:69], v[50:53]
    v_mfma_f32_16x16x32_bf16 v[54:57], v[110:113], v[70:73], v[54:57]
    v_mfma_f32_16x16x32_bf16 v[58:61], v[110:113], v[74:77], v[58:61]
    v_mfma_f32_16x16x32_bf16 v[62:65], v[110:113], v[78:81], v[62:65]
    s_add_u32 s47, s47, 1
    s_cmp_eq_u32 s47, 5
    s_mov_b32 s49, 32768
    s_cmov_b32 s49, 0xfffe0000
    s_cmov_b32 s47, 0
    s_waitcnt lgkmcnt(0)
    v_add_u32 v138, s49, v138
    v_add_u32 v139, s49, v139
    v_add_u32 v140, s49, v140
    v_add_u32 v141, s49, v141
    v_add_u32 v142, s49, v142
    v_add_u32 v143, s49, v143
    s_waitcnt vmcnt(0)
    s_barrier
    v_mfma_f32_16x16x32_bf16 v[2:5], v[114:117], v[82:85], v[2:5]
    ds_read_b64_tr_b16 v[98:99], v140 offset:0
    v_mfma_f32_16x16x32_bf16 v[6:9], v[114:117], v[86:89], v[6:9]
    ds_read_b64_tr_b16 v[100:101], v140 offset:1024
    v_mfma_f32_16x16x32_bf16 v[10:13], v[114:117], v[90:93], v[10:13]
    ds_read_b64_tr_b16 v[102:103], v141 offset:0
    v_mfma_f32_16x16x32_bf16 v[14:17], v[114:117], v[94:97], v[14:17]
    ds_read_b64_tr_b16 v[104:105], v141 offset:1024
    v_mfma_f32_16x16x32_bf16 v[18:21], v[118:121], v[82:85], v[18:21]
    ds_read_b64_tr_b16 v[106:107], v142 offset:0
    v_mfma_f32_16x16x32_bf16 v[22:25], v[118:121], v[86:89], v[22:25]
    ds_read_b64_tr_b16 v[108:109], v142 offset:1024
    v_mfma_f32_16x16x32_bf16 v[26:29], v[118:121], v[90:93], v[26:29]
    ds_read_b64_tr_b16 v[110:111], v143 offset:0
    v_mfma_f32_16x16x32_bf16 v[30:33], v[118:121], v[94:97], v[30:33]
    ds_read_b64_tr_b16 v[112:113], v143 offset:1024
    v_mfma_f32_16x16x32_bf16 v[34:37], v[122:125], v[82:85], v[34:37]
    ds_read_b128 v[66:69], v138 offset:0
    v_mfma_f32_16x16x32_bf16 v[38:41], v[122:125], v[86:89], v[38:41]
    ds_read_b128 v[70:73], v138 offset:2048
    v_mfma_f32_16x16x32_bf16 v[42:45], v[122:125], v[90:93], v[42:45]
    ds_read_b128 v[74:77], v138 offset:4096
    v_mfma_f32_16x16x32_bf16 v[46:49], v[122:125], v[94:97], v[46:49]
    ds_read_b128 v[78:81], v138 offset:6144
    v_mfma_f32_16x16x32_bf16 v[50:53], v[126:129], v[82:85], v[50:53]
    v_mfma_f32_16x16x32_bf16 v[54:57], v[126:129], v[86:89], v[54:57]
    v_mfma_f32_16x16x32_bf16 v[58:61], v[126:129], v[90:93], v[58:61]
    v_mfma_f32_16x16x32_bf16 v[62:65], v[126:129], v[94:97], v[62:65]
    s_waitcnt lgkmcnt(0)
    v_mfma_f32_16x16x32_bf16 v[2:5], v[98:101], v[66:69], v[2:5]
    ds_read_b64_tr_b16 v[114:115], v140 offset:8192
    v_mfma_f32_16x16x32_bf16 v[6:9], v[98:101], v[70:73], v[6:9]
    ds_read_b64_tr_b16 v[116:117], v140 offset:9216
    v_mfma_f32_16x16x32_bf16 v[10:13], v[98:101], v[74:77], v[10:13]
    ds_read_b64_tr_b16 v[118:119], v141 offset:8192
    v_mfma_f32_16x16x32_bf16 v[14:17], v[98:101], v[78:81], v[14:17]
    ds_read_b64_tr_b16 v[120:121], v141 offset:9216
    v_mfma_f32_16x16x32_bf16 v[18:21], v[102:105], v[66:69], v[18:21]
    ds_read_b64_tr_b16 v[122:123], v142 offset:8192
    v_mfma_f32_16x16x32_bf16 v[22:25], v[102:105], v[70:73], v[22:25]
    ds_read_b64_tr_b16 v[124:125], v142 offset:9216
    v_mfma_f32_16x16x32_bf16 v[26:29], v[102:105], v[74:77], v[26:29]
    ds_read_b64_tr_b16 v[126:127], v143 offset:8192
    v_mfma_f32_16x16x32_bf16 v[30:33], v[102:105], v[78:81], v[30:33]
    ds_read_b64_tr_b16 v[128:129], v143 offset:9216
    v_mfma_f32_16x16x32_bf16 v[34:37], v[106:109], v[66:69], v[34:37]
    ds_read_b128 v[82:85], v139 offset:0
    v_mfma_f32_16x16x32_bf16 v[38:41], v[106:109], v[70:73], v[38:41]
    ds_read_b128 v[86:89], v139 offset:2048
    v_mfma_f32_16x16x32_bf16 v[42:45], v[106:109], v[74:77], v[42:45]
    ds_read_b128 v[90:93], v139 offset:4096
    v_mfma_f32_16x16x32_bf16 v[46:49], v[106:109], v[78:81], v[46:49]
    ds_read_b128 v[94:97], v139 offset:6144
    v_mfma_f32_16x16x32_bf16 v[50:53], v[110:113], v[66:69], v[50:53]
    v_mfma_f32_16x16x32_bf16 v[54:57], v[110:113], v[70:73], v[54:57]
    v_mfma_f32_16x16x32_bf16 v[58:61], v[110:113], v[74:77], v[58:61]
    v_mfma_f32_16x16x32_bf16 v[62:65], v[110:113], v[78:81], v[62:65]
    s_waitcnt lgkmcnt(0)
    v_mfma_f32_16x16x32_bf16 v[2:5], v[114:117], v[82:85], v[2:5]
    v_mfma_f32_16x16x32_bf16 v[6:9], v[114:117], v[86:89], v[6:9]
    v_mfma_f32_16x16x32_bf16 v[10:13], v[114:117], v[90:93], v[10:13]
    v_mfma_f32_16x16x32_bf16 v[14:17], v[114:117], v[94:97], v[14:17]
    v_mfma_f32_16x16x32_bf16 v[18:21], v[118:121], v[82:85], v[18:21]
    v_mfma_f32_16x16x32_bf16 v[22:25], v[118:121], v[86:89], v[22:25]
    v_mfma_f32_16x16x32_bf16 v[26:29], v[118:121], v[90:93], v[26:29]
    v_mfma_f32_16x16x32_bf16 v[30:33], v[118:121], v[94:97], v[30:33]
    v_mfma_f32_16x16x32_bf16 v[34:37], v[122:125], v[82:85], v[34:37]
    v_mfma_f32_16x16x32_bf16 v[38:41], v[122:125], v[86:89], v[38:41]
    v_mfma_f32_16x16x32_bf16 v[42:45], v[122:125], v[90:93], v[42:45]
    v_mfma_f32_16x16x32_bf16 v[46:49], v[122:125], v[94:97], v[46:49]
    v_mfma_f32_16x16x32_bf16 v[50:53], v[126:129], v[82:85], v[50:53]
    v_mfma_f32_16x16x32_bf16 v[54:57], v[126:129], v[86:89], v[54:57]
    v_mfma_f32_16x16x32_bf16 v[58:61], v[126:129], v[90:93], v[58:61]
    v_mfma_f32_16x16x32_bf16 v[62:65], v[126:129], v[94:97], v[62:65]
    s_waitcnt vmcnt(0)
    s_nop 7
    s_nop 3
    s_barrier
    s_mul_i32 s48, s40, 9216
    s_add_u32 s48, s48, 0
    v_mul_u32_u24 v148, 144, v145
    v_lshl_add_u32 v148, v146, 3, v148
    v_add_u32 v148, s48, v148
    v_cvt_pk_bf16_f32 v2, v2, v3
    v_cvt_pk_bf16_f32 v3, v4, v5
    ds_write_b64 v148, v[2:3] offset:0
    v_cvt_pk_bf16_f32 v6, v6, v7
    v_cvt_pk_bf16_f32 v7, v8, v9
    ds_write_b64 v148, v[6:7] offset:2304
    v_cvt_pk_bf16_f32 v10, v10, v11
    v_cvt_pk_bf16_f32 v11, v12, v13
    ds_write_b64 v148, v[10:11] offset:4608
    v_cvt_pk_bf16_f32 v14, v14, v15
    v_cvt_pk_bf16_f32 v15, v16, v17
    ds_write_b64 v148, v[14:15] offset:6912
    v_cvt_pk_bf16_f32 v18, v18, v19
    v_cvt_pk_bf16_f32 v19, v20, v21
    ds_write_b64 v148, v[18:19] offset:32
    v_cvt_pk_bf16_f32 v22, v22, v23
    v_cvt_pk_bf16_f32 v23, v24, v25
    ds_write_b64 v148, v[22:23] offset:2336
    v_cvt_pk_bf16_f32 v26, v26, v27
    v_cvt_pk_bf16_f32 v27, v28, v29
    ds_write_b64 v148, v[26:27] offset:4640
    v_cvt_pk_bf16_f32 v30, v30, v31
    v_cvt_pk_bf16_f32 v31, v32, v33
    ds_write_b64 v148, v[30:31] offset:6944
    v_cvt_pk_bf16_f32 v34, v34, v35
    v_cvt_pk_bf16_f32 v35, v36, v37
    ds_write_b64 v148, v[34:35] offset:64
    v_cvt_pk_bf16_f32 v38, v38, v39
    v_cvt_pk_bf16_f32 v39, v40, v41
    ds_write_b64 v148, v[38:39] offset:2368
    v_cvt_pk_bf16_f32 v42, v42, v43
    v_cvt_pk_bf16_f32 v43, v44, v45
    ds_write_b64 v148, v[42:43] offset:4672
    v_cvt_pk_bf16_f32 v46, v46, v47
    v_cvt_pk_bf16_f32 v47, v48, v49
    ds_write_b64 v148, v[46:47] offset:6976
    v_cvt_pk_bf16_f32 v50, v50, v51
    v_cvt_pk_bf16_f32 v51, v52, v53
    ds_write_b64 v148, v[50:51] offset:96
    v_cvt_pk_bf16_f32 v54, v54, v55
    v_cvt_pk_bf16_f32 v55, v56, v57
    ds_write_b64 v148, v[54:55] offset:2400
    v_cvt_pk_bf16_f32 v58, v58, v59
    v_cvt_pk_bf16_f32 v59, v60, v61
    ds_write_b64 v148, v[58:59] offset:4704
    v_cvt_pk_bf16_f32 v62, v62, v63
    v_cvt_pk_bf16_f32 v63, v64, v65
    ds_write_b64 v148, v[62:63] offset:7008
    v_lshrrev_b32 v149, 3, v144
    v_and_b32 v150, 7, v144
    s_mov_b32 s50, 1280
    v_mul_lo_u32 v151, v149, s50
    v_mul_u32_u24 v149, 144, v149
    v_lshl_add_u32 v149, v150, 4, v149
    v_add_u32 v149, s48, v149
    v_lshl_add_u32 v150, v150, 4, v151
    s_mul_i32 s48, s41, 81920
    s_mul_i32 s49, s42, 128
    s_add_u32 s48, s48, s49
    s_add_u32 s48, s48, s19
    s_waitcnt lgkmcnt(0)
    ds_read_b128 v[2:5], v149 offset:0
    ds_read_b128 v[6:9], v149 offset:1152
    ds_read_b128 v[10:13], v149 offset:2304
    ds_read_b128 v[14:17], v149 offset:3456
    ds_read_b128 v[18:21], v149 offset:4608
    ds_read_b128 v[22:25], v149 offset:5760
    ds_read_b128 v[26:29], v149 offset:6912
    ds_read_b128 v[30:33], v149 offset:8064
    s_waitcnt lgkmcnt(7)
    buffer_store_dwordx4 v[2:5], v150, s[4:7], s48 offen sc1
    s_add_u32 s48, s48, 10240
    s_waitcnt lgkmcnt(6)
    buffer_store_dwordx4 v[6:9], v150, s[4:7], s48 offen sc1
    s_add_u32 s48, s48, 10240
    s_waitcnt lgkmcnt(5)
    buffer_store_dwordx4 v[10:13], v150, s[4:7], s48 offen sc1
    s_add_u32 s48, s48, 10240
    s_waitcnt lgkmcnt(4)
    buffer_store_dwordx4 v[14:17], v150, s[4:7], s48 offen sc1
    s_add_u32 s48, s48, 10240
    s_waitcnt lgkmcnt(3)
    buffer_store_dwordx4 v[18:21], v150, s[4:7], s48 offen sc1
    s_add_u32 s48, s48, 10240
    s_waitcnt lgkmcnt(2)
    buffer_store_dwordx4 v[22:25], v150, s[4:7], s48 offen sc1
    s_add_u32 s48, s48, 10240
    s_waitcnt lgkmcnt(1)
    buffer_store_dwordx4 v[26:29], v150, s[4:7], s48 offen sc1
    s_add_u32 s48, s48, 10240
    s_waitcnt lgkmcnt(0)
    buffer_store_dwordx4 v[30:33], v150, s[4:7], s48 offen sc1
    s_add_u32 s48, s48, 10240
    s_lshl_b32 s77, s74, 7
    s_add_u32 s77, s77, 790528
    s_waitcnt vmcnt(0)
    s_barrier
    s_cmp_lg_u32 s26, 0
    s_cbranch_scc1 L_sig_122
    v_mov_b32 v1, 0
    v_mov_b32 v2, 1
    s_mov_b64 exec, 1
    buffer_atomic_add v2, v1, s[4:7], s77 offen
    s_mov_b64 exec, -1
L_sig_122:
    s_branch L_next_104
L_fin_103:
    s_load_dwordx2 s[12:13], s[0:1], 0
    s_sub_u32 s16, s76, 72
    s_lshl_b32 s16, s16, 2
    s_lshl_b32 s17, s74, 7
    s_add_u32 s16, s16, s17
    s_add_u32 s20, s16, s26
    v_and_b32 v1, 63, v0
    s_waitcnt lgkmcnt(0)
    s_and_b32 s13, s13, 0xffff
    s_mov_b32 s14, 2621440
    s_mov_b32 s15, 0x20000
    s_lshl_b32 s77, s74, 7
    s_add_u32 s77, s77, 790528
    v_lshlrev_b32 v2, 2, v1
    v_lshlrev_b32 v3, 3, v1
    s_mov_b32 s21, 7680
    s_mov_b32 s22, 10240
    s_mov_b32 s23, 5120
    buffer_load_dwordx2 v[40:41], v3, s[4:7], s21 offen offset:0 sc1
    buffer_load_dwordx2 v[50:51], v3, s[4:7], s22 offen offset:0 sc1
    buffer_load_dwordx2 v[60:61], v3, s[4:7], s23 offen offset:0 sc1
    buffer_load_dwordx2 v[42:43], v3, s[4:7], s21 offen offset:512 sc1
    buffer_load_dwordx2 v[52:53], v3, s[4:7], s22 offen offset:512 sc1
    buffer_load_dwordx2 v[62:63], v3, s[4:7], s23 offen offset:512 sc1
    buffer_load_dwordx2 v[44:45], v3, s[4:7], s21 offen offset:1024 sc1
    buffer_load_dwordx2 v[54:55], v3, s[4:7], s22 offen offset:1024 sc1
    buffer_load_dwordx2 v[64:65], v3, s[4:7], s23 offen offset:1024 sc1
    buffer_load_dwordx2 v[46:47], v3, s[4:7], s21 offen offset:1536 sc1
    buffer_load_dwordx2 v[56:57], v3, s[4:7], s22 offen offset:1536 sc1
    buffer_load_dwordx2 v[66:67], v3, s[4:7], s23 offen offset:1536 sc1
    buffer_load_dwordx2 v[48:49], v3, s[4:7], s21 offen offset:2048 sc1
    buffer_load_dwordx2 v[58:59], v3, s[4:7], s22 offen offset:2048 sc1
    buffer_load_dwordx2 v[68:69], v3, s[4:7], s23 offen offset:2048 sc1
    s_mul_i32 s25, s20, 1280
    buffer_load_dword v15, v2, s[12:15], s25 offen offset:0
    buffer_load_dword v16, v2, s[12:15], s25 offen offset:256
    buffer_load_dword v17, v2, s[12:15], s25 offen offset:512
    buffer_load_dword v18, v2, s[12:15], s25 offen offset:768
    buffer_load_dword v19, v2, s[12:15], s25 offen offset:1024
    s_cmp_lg_u32 s26, 0
    s_cbranch_scc1 L_wgw_123
    s_mov_b32 s79, 0x200000
    v_mov_b32 v10, 0
L_cw_124:
    buffer_load_dword v11, v10, s[4:7], s77 offen sc1
    s_waitcnt vmcnt(0)
    v_readfirstlane_b32 s78, v11
    s_nop 0
    s_cmp_ge_u32 s78, 40
    s_cbranch_scc1 L_cd_125
    s_sleep 2
    s_sub_u32 s79, s79, 1
    s_cbranch_scc0 L_cw_124
L_cd_125:
L_wgw_123:
    s_barrier
    s_mul_i32 s25, s20, 1280
    s_add_u32 s25, s25, 109051904
    buffer_load_dword v80, v2, s[4:7], s25 offen offset:0 sc1
    buffer_load_dword v81, v2, s[4:7], s25 offen offset:256 sc1
    buffer_load_dword v82, v2, s[4:7], s25 offen offset:512 sc1
    buffer_load_dword v83, v2, s[4:7], s25 offen offset:768 sc1
    buffer_load_dword v84, v2, s[4:7], s25 offen offset:1024 sc1
    s_add_u32 s25, s25, 2621440
    buffer_load_dword v85, v2, s[4:7], s25 offen offset:0 sc1
    buffer_load_dword v86, v2, s[4:7], s25 offen offset:256 sc1
    buffer_load_dword v87, v2, s[4:7], s25 offen offset:512 sc1
    buffer_load_dword v88, v2, s[4:7], s25 offen offset:768 sc1
    buffer_load_dword v89, v2, s[4:7], s25 offen offset:1024 sc1
    s_add_u32 s25, s25, 2621440
    buffer_load_dword v90, v2, s[4:7], s25 offen offset:0 sc1
    buffer_load_dword v91, v2, s[4:7], s25 offen offset:256 sc1
    buffer_load_dword v92, v2, s[4:7], s25 offen offset:512 sc1
    buffer_load_dword v93, v2, s[4:7], s25 offen offset:768 sc1
    buffer_load_dword v94, v2, s[4:7], s25 offen offset:1024 sc1
    s_add_u32 s25, s25, 2621440
    buffer_load_dword v95, v2, s[4:7], s25 offen offset:0 sc1
    buffer_load_dword v96, v2, s[4:7], s25 offen offset:256 sc1
    buffer_load_dword v97, v2, s[4:7], s25 offen offset:512 sc1
    buffer_load_dword v98, v2, s[4:7], s25 offen offset:768 sc1
    buffer_load_dword v99, v2, s[4:7], s25 offen offset:1024 sc1
    s_add_u32 s25, s25, 2621440
    buffer_load_dword v100, v2, s[4:7], s25 offen offset:0 sc1
    buffer_load_dword v101, v2, s[4:7], s25 offen offset:256 sc1
    buffer_load_dword v102, v2, s[4:7], s25 offen offset:512 sc1
    buffer_load_dword v103, v2, s[4:7], s25 offen offset:768 sc1
    buffer_load_dword v104, v2, s[4:7], s25 offen offset:1024 sc1
    s_add_u32 s25, s25, 2621440
    buffer_load_dword v105, v2, s[4:7], s25 offen offset:0 sc1
    buffer_load_dword v106, v2, s[4:7], s25 offen offset:256 sc1
    buffer_load_dword v107, v2, s[4:7], s25 offen offset:512 sc1
    buffer_load_dword v108, v2, s[4:7], s25 offen offset:768 sc1
    buffer_load_dword v109, v2, s[4:7], s25 offen offset:1024 sc1
    s_add_u32 s25, s25, 2621440
    buffer_load_dword v110, v2, s[4:7], s25 offen offset:0 sc1
    buffer_load_dword v111, v2, s[4:7], s25 offen offset:256 sc1
    buffer_load_dword v112, v2, s[4:7], s25 offen offset:512 sc1
    buffer_load_dword v113, v2, s[4:7], s25 offen offset:768 sc1
    buffer_load_dword v114, v2, s[4:7], s25 offen offset:1024 sc1
    s_add_u32 s25, s25, 2621440
    buffer_load_dword v115, v2, s[4:7], s25 offen offset:0 sc1
    buffer_load_dword v116, v2, s[4:7], s25 offen offset:256 sc1
    buffer_load_dword v117, v2, s[4:7], s25 offen offset:512 sc1
    buffer_load_dword v118, v2, s[4:7], s25 offen offset:768 sc1
    buffer_load_dword v119, v2, s[4:7], s25 offen offset:1024 sc1
    s_add_u32 s25, s25, 2621440
    s_waitcnt vmcnt(35)
    v_lshlrev_b32 v70, 16, v80
    v_and_b32 v71, 0xffff0000, v80
    v_lshlrev_b32 v72, 16, v81
    v_and_b32 v73, 0xffff0000, v81
    v_lshlrev_b32 v74, 16, v82
    v_and_b32 v75, 0xffff0000, v82
    v_lshlrev_b32 v76, 16, v83
    v_and_b32 v77, 0xffff0000, v83
    v_lshlrev_b32 v78, 16, v84
    v_and_b32 v79, 0xffff0000, v84
    s_waitcnt vmcnt(30)
    v_lshlrev_b32 v5, 16, v85
    v_and_b32 v8, 0xffff0000, v85
    v_add_f32 v70, v70, v5
    v_add_f32 v71, v71, v8
    v_lshlrev_b32 v5, 16, v86
    v_and_b32 v8, 0xffff0000, v86
    v_add_f32 v72, v72, v5
    v_add_f32 v73, v73, v8
    v_lshlrev_b32 v5, 16, v87
    v_and_b32 v8, 0xffff0000, v87
    v_add_f32 v74, v74, v5
    v_add_f32 v75, v75, v8
    v_lshlrev_b32 v5, 16, v88
    v_and_b32 v8, 0xffff0000, v88
    v_add_f32 v76, v76, v5
    v_add_f32 v77, v77, v8
    v_lshlrev_b32 v5, 16, v89
    v_and_b32 v8, 0xffff0000, v89
    v_add_f32 v78, v78, v5
    v_add_f32 v79, v79, v8
    s_waitcnt vmcnt(25)
    v_lshlrev_b32 v5, 16, v90
    v_and_b32 v8, 0xffff0000, v90
    v_add_f32 v70, v70, v5
    v_add_f32 v71, v71, v8
    v_lshlrev_b32 v5, 16, v91
    v_and_b32 v8, 0xffff0000, v91
    v_add_f32 v72, v72, v5
    v_add_f32 v73, v73, v8
    v_lshlrev_b32 v5, 16, v92
    v_and_b32 v8, 0xffff0000, v92
    v_add_f32 v74, v74, v5
    v_add_f32 v75, v75, v8
    v_lshlrev_b32 v5, 16, v93
    v_and_b32 v8, 0xffff0000, v93
    v_add_f32 v76, v76, v5
    v_add_f32 v77, v77, v8
    v_lshlrev_b32 v5, 16, v94
    v_and_b32 v8, 0xffff0000, v94
    v_add_f32 v78, v78, v5
    v_add_f32 v79, v79, v8
    s_waitcnt vmcnt(20)
    v_lshlrev_b32 v5, 16, v95
    v_and_b32 v8, 0xffff0000, v95
    v_add_f32 v70, v70, v5
    v_add_f32 v71, v71, v8
    v_lshlrev_b32 v5, 16, v96
    v_and_b32 v8, 0xffff0000, v96
    v_add_f32 v72, v72, v5
    v_add_f32 v73, v73, v8
    v_lshlrev_b32 v5, 16, v97
    v_and_b32 v8, 0xffff0000, v97
    v_add_f32 v74, v74, v5
    v_add_f32 v75, v75, v8
    v_lshlrev_b32 v5, 16, v98
    v_and_b32 v8, 0xffff0000, v98
    v_add_f32 v76, v76, v5
    v_add_f32 v77, v77, v8
    v_lshlrev_b32 v5, 16, v99
    v_and_b32 v8, 0xffff0000, v99
    v_add_f32 v78, v78, v5
    v_add_f32 v79, v79, v8
    s_waitcnt vmcnt(15)
    v_lshlrev_b32 v5, 16, v100
    v_and_b32 v8, 0xffff0000, v100
    v_add_f32 v70, v70, v5
    v_add_f32 v71, v71, v8
    v_lshlrev_b32 v5, 16, v101
    v_and_b32 v8, 0xffff0000, v101
    v_add_f32 v72, v72, v5
    v_add_f32 v73, v73, v8
    v_lshlrev_b32 v5, 16, v102
    v_and_b32 v8, 0xffff0000, v102
    v_add_f32 v74, v74, v5
    v_add_f32 v75, v75, v8
    v_lshlrev_b32 v5, 16, v103
    v_and_b32 v8, 0xffff0000, v103
    v_add_f32 v76, v76, v5
    v_add_f32 v77, v77, v8
    v_lshlrev_b32 v5, 16, v104
    v_and_b32 v8, 0xffff0000, v104
    v_add_f32 v78, v78, v5
    v_add_f32 v79, v79, v8
    s_waitcnt vmcnt(10)
    v_lshlrev_b32 v5, 16, v105
    v_and_b32 v8, 0xffff0000, v105
    v_add_f32 v70, v70, v5
    v_add_f32 v71, v71, v8
    v_lshlrev_b32 v5, 16, v106
    v_and_b32 v8, 0xffff0000, v106
    v_add_f32 v72, v72, v5
    v_add_f32 v73, v73, v8
    v_lshlrev_b32 v5, 16, v107
    v_and_b32 v8, 0xffff0000, v107
    v_add_f32 v74, v74, v5
    v_add_f32 v75, v75, v8
    v_lshlrev_b32 v5, 16, v108
    v_and_b32 v8, 0xffff0000, v108
    v_add_f32 v76, v76, v5
    v_add_f32 v77, v77, v8
    v_lshlrev_b32 v5, 16, v109
    v_and_b32 v8, 0xffff0000, v109
    v_add_f32 v78, v78, v5
    v_add_f32 v79, v79, v8
    s_waitcnt vmcnt(5)
    v_lshlrev_b32 v5, 16, v110
    v_and_b32 v8, 0xffff0000, v110
    v_add_f32 v70, v70, v5
    v_add_f32 v71, v71, v8
    v_lshlrev_b32 v5, 16, v111
    v_and_b32 v8, 0xffff0000, v111
    v_add_f32 v72, v72, v5
    v_add_f32 v73, v73, v8
    v_lshlrev_b32 v5, 16, v112
    v_and_b32 v8, 0xffff0000, v112
    v_add_f32 v74, v74, v5
    v_add_f32 v75, v75, v8
    v_lshlrev_b32 v5, 16, v113
    v_and_b32 v8, 0xffff0000, v113
    v_add_f32 v76, v76, v5
    v_add_f32 v77, v77, v8
    v_lshlrev_b32 v5, 16, v114
    v_and_b32 v8, 0xffff0000, v114
    v_add_f32 v78, v78, v5
    v_add_f32 v79, v79, v8
    s_waitcnt vmcnt(0)
    v_lshlrev_b32 v5, 16, v115
    v_and_b32 v8, 0xffff0000, v115
    v_add_f32 v70, v70, v5
    v_add_f32 v71, v71, v8
    v_lshlrev_b32 v5, 16, v116
    v_and_b32 v8, 0xffff0000, v116
    v_add_f32 v72, v72, v5
    v_add_f32 v73, v73, v8
    v_lshlrev_b32 v5, 16, v117
    v_and_b32 v8, 0xffff0000, v117
    v_add_f32 v74, v74, v5
    v_add_f32 v75, v75, v8
    v_lshlrev_b32 v5, 16, v118
    v_and_b32 v8, 0xffff0000, v118
    v_add_f32 v76, v76, v5
    v_add_f32 v77, v77, v8
    v_lshlrev_b32 v5, 16, v119
    v_and_b32 v8, 0xffff0000, v119
    v_add_f32 v78, v78, v5
    v_add_f32 v79, v79, v8
    v_cvt_pk_bf16_f32 v30, v70, v70
    v_and_b32 v30, 0xffff0000, v30
    v_mul_f32 v30, v30, v60
    v_cvt_pk_bf16_f32 v30, v30, v30
    v_and_b32 v30, 0xffff0000, v30
    v_lshlrev_b32 v5, 16, v15
    v_add_f32 v30, v30, v5
    v_cvt_pk_bf16_f32 v31, v71, v71
    v_and_b32 v31, 0xffff0000, v31
    v_mul_f32 v31, v31, v61
    v_cvt_pk_bf16_f32 v31, v31, v31
    v_and_b32 v31, 0xffff0000, v31
    v_and_b32 v5, 0xffff0000, v15
    v_add_f32 v31, v31, v5
    v_cvt_pk_bf16_f32 v32, v72, v72
    v_and_b32 v32, 0xffff0000, v32
    v_mul_f32 v32, v32, v62
    v_cvt_pk_bf16_f32 v32, v32, v32
    v_and_b32 v32, 0xffff0000, v32
    v_lshlrev_b32 v5, 16, v16
    v_add_f32 v32, v32, v5
    v_cvt_pk_bf16_f32 v33, v73, v73
    v_and_b32 v33, 0xffff0000, v33
    v_mul_f32 v33, v33, v63
    v_cvt_pk_bf16_f32 v33, v33, v33
    v_and_b32 v33, 0xffff0000, v33
    v_and_b32 v5, 0xffff0000, v16
    v_add_f32 v33, v33, v5
    v_cvt_pk_bf16_f32 v34, v74, v74
    v_and_b32 v34, 0xffff0000, v34
    v_mul_f32 v34, v34, v64
    v_cvt_pk_bf16_f32 v34, v34, v34
    v_and_b32 v34, 0xffff0000, v34
    v_lshlrev_b32 v5, 16, v17
    v_add_f32 v34, v34, v5
    v_cvt_pk_bf16_f32 v35, v75, v75
    v_and_b32 v35, 0xffff0000, v35
    v_mul_f32 v35, v35, v65
    v_cvt_pk_bf16_f32 v35, v35, v35
    v_and_b32 v35, 0xffff0000, v35
    v_and_b32 v5, 0xffff0000, v17
    v_add_f32 v35, v35, v5
    v_cvt_pk_bf16_f32 v36, v76, v76
    v_and_b32 v36, 0xffff0000, v36
    v_mul_f32 v36, v36, v66
    v_cvt_pk_bf16_f32 v36, v36, v36
    v_and_b32 v36, 0xffff0000, v36
    v_lshlrev_b32 v5, 16, v18
    v_add_f32 v36, v36, v5
    v_cvt_pk_bf16_f32 v37, v77, v77
    v_and_b32 v37, 0xffff0000, v37
    v_mul_f32 v37, v37, v67
    v_cvt_pk_bf16_f32 v37, v37, v37
    v_and_b32 v37, 0xffff0000, v37
    v_and_b32 v5, 0xffff0000, v18
    v_add_f32 v37, v37, v5
    v_cvt_pk_bf16_f32 v38, v78, v78
    v_and_b32 v38, 0xffff0000, v38
    v_mul_f32 v38, v38, v68
    v_cvt_pk_bf16_f32 v38, v38, v38
    v_and_b32 v38, 0xffff0000, v38
    v_lshlrev_b32 v5, 16, v19
    v_add_f32 v38, v38, v5
    v_cvt_pk_bf16_f32 v39, v79, v79
    v_and_b32 v39, 0xffff0000, v39
    v_mul_f32 v39, v39, v69
    v_cvt_pk_bf16_f32 v39, v39, v39
    v_and_b32 v39, 0xffff0000, v39
    v_and_b32 v5, 0xffff0000, v19
    v_add_f32 v39, v39, v5
    s_add_u32 s24, s20, 0
    s_mul_i32 s24, s24, 1280
    s_add_u32 s25, s24, 4194304
    v_cvt_pk_bf16_f32 v10, v30, v31
    buffer_store_dword v10, v2, s[4:7], s25 offen offset:0 sc1
    v_lshlrev_b32 v30, 16, v10
    v_and_b32 v31, 0xffff0000, v10
    v_cvt_pk_bf16_f32 v11, v32, v33
    buffer_store_dword v11, v2, s[4:7], s25 offen offset:256 sc1
    v_lshlrev_b32 v32, 16, v11
    v_and_b32 v33, 0xffff0000, v11
    v_cvt_pk_bf16_f32 v12, v34, v35
    buffer_store_dword v12, v2, s[4:7], s25 offen offset:512 sc1
    v_lshlrev_b32 v34, 16, v12
    v_and_b32 v35, 0xffff0000, v12
    v_cvt_pk_bf16_f32 v13, v36, v37
    buffer_store_dword v13, v2, s[4:7], s25 offen offset:768 sc1
    v_lshlrev_b32 v36, 16, v13
    v_and_b32 v37, 0xffff0000, v13
    v_cvt_pk_bf16_f32 v14, v38, v39
    buffer_store_dword v14, v2, s[4:7], s25 offen offset:1024 sc1
    v_lshlrev_b32 v38, 16, v14
    v_and_b32 v39, 0xffff0000, v14
    v_add_f32 v4, v30, v31
    v_add_f32 v4, v4, v32
    v_add_f32 v4, v4, v33
    v_add_f32 v4, v4, v34
    v_add_f32 v4, v4, v35
    v_add_f32 v4, v4, v36
    v_add_f32 v4, v4, v37
    v_add_f32 v4, v4, v38
    v_add_f32 v4, v4, v39
    s_nop 1
    v_add_f32_dpp v4, v4, v4 row_ror:1 row_mask:0xf bank_mask:0xf
    s_nop 1
    v_add_f32_dpp v4, v4, v4 row_ror:2 row_mask:0xf bank_mask:0xf
    s_nop 1
    v_add_f32_dpp v4, v4, v4 row_ror:4 row_mask:0xf bank_mask:0xf
    s_nop 1
    v_add_f32_dpp v4, v4, v4 row_ror:8 row_mask:0xf bank_mask:0xf
    v_mov_b32 v5, v4
    s_nop 1
    v_permlane16_swap_b32 v4, v5
    v_add_f32 v4, v4, v5
    v_mov_b32 v5, v4
    s_nop 1
    v_permlane32_swap_b32 v4, v5
    v_add_f32 v4, v4, v5
    v_mul_f32 v4, 0x3acccccd, v4
    v_mov_b32 v6, 0
    v_sub_f32 v5, v30, v4
    v_fmac_f32 v6, v5, v5
    v_sub_f32 v5, v31, v4
    v_fmac_f32 v6, v5, v5
    v_sub_f32 v5, v32, v4
    v_fmac_f32 v6, v5, v5
    v_sub_f32 v5, v33, v4
    v_fmac_f32 v6, v5, v5
    v_sub_f32 v5, v34, v4
    v_fmac_f32 v6, v5, v5
    v_sub_f32 v5, v35, v4
    v_fmac_f32 v6, v5, v5
    v_sub_f32 v5, v36, v4
    v_fmac_f32 v6, v5, v5
    v_sub_f32 v5, v37, v4
    v_fmac_f32 v6, v5, v5
    v_sub_f32 v5, v38, v4
    v_fmac_f32 v6, v5, v5
    v_sub_f32 v5, v39, v4
    v_fmac_f32 v6, v5, v5
    s_nop 1
    v_add_f32_dpp v6, v6, v6 row_ror:1 row_mask:0xf bank_mask:0xf
    s_nop 1
    v_add_f32_dpp v6, v6, v6 row_ror:2 row_mask:0xf bank_mask:0xf
    s_nop 1
    v_add_f32_dpp v6, v6, v6 row_ror:4 row_mask:0xf bank_mask:0xf
    s_nop 1
    v_add_f32_dpp v6, v6, v6 row_ror:8 row_mask:0xf bank_mask:0xf
    v_mov_b32 v5, v6
    s_nop 1
    v_permlane16_swap_b32 v6, v5
    v_add_f32 v6, v6, v5
    v_mov_b32 v5, v6
    s_nop 1
    v_permlane32_swap_b32 v6, v5
    v_add_f32 v6, v6, v5
    v_mul_f32 v6, 0x3acccccd, v6
    v_cvt_pk_bf16_f32 v6, v6, v6
    v_and_b32 v6, 0xffff0000, v6
    v_add_f32 v6, 0x3727c5ac, v6
    v_cvt_pk_bf16_f32 v6, v6, v6
    v_and_b32 v6, 0xffff0000, v6
    v_sqrt_f32 v6, v6
    s_nop 0
    v_cvt_pk_bf16_f32 v6, v6, v6
    v_and_b32 v6, 0xffff0000, v6
    v_rcp_f32 v7, v6
    v_cvt_pk_bf16_f32 v4, v4, v4
    v_and_b32 v4, 0xffff0000, v4
    v_sub_f32 v30, v30, v4
    v_cvt_pk_bf16_f32 v30, v30, v30
    v_and_b32 v30, 0xffff0000, v30
    v_mul_f32 v5, v30, v7
    v_fma_f32 v8, -v5, v6, v30
    v_fma_f32 v30, v8, v7, v5
    v_cvt_pk_bf16_f32 v30, v30, v30
    v_and_b32 v30, 0xffff0000, v30
    v_mul_f32 v30, v30, v50
    v_cvt_pk_bf16_f32 v30, v30, v30
    v_and_b32 v30, 0xffff0000, v30
    v_add_f32 v30, v30, v40
    v_sub_f32 v31, v31, v4
    v_cvt_pk_bf16_f32 v31, v31, v31
    v_and_b32 v31, 0xffff0000, v31
    v_mul_f32 v5, v31, v7
    v_fma_f32 v8, -v5, v6, v31
    v_fma_f32 v31, v8, v7, v5
    v_cvt_pk_bf16_f32 v31, v31, v31
    v_and_b32 v31, 0xffff0000, v31
    v_mul_f32 v31, v31, v51
    v_cvt_pk_bf16_f32 v31, v31, v31
    v_and_b32 v31, 0xffff0000, v31
    v_add_f32 v31, v31, v41
    v_sub_f32 v32, v32, v4
    v_cvt_pk_bf16_f32 v32, v32, v32
    v_and_b32 v32, 0xffff0000, v32
    v_mul_f32 v5, v32, v7
    v_fma_f32 v8, -v5, v6, v32
    v_fma_f32 v32, v8, v7, v5
    v_cvt_pk_bf16_f32 v32, v32, v32
    v_and_b32 v32, 0xffff0000, v32
    v_mul_f32 v32, v32, v52
    v_cvt_pk_bf16_f32 v32, v32, v32
    v_and_b32 v32, 0xffff0000, v32
    v_add_f32 v32, v32, v42
    v_sub_f32 v33, v33, v4
    v_cvt_pk_bf16_f32 v33, v33, v33
    v_and_b32 v33, 0xffff0000, v33
    v_mul_f32 v5, v33, v7
    v_fma_f32 v8, -v5, v6, v33
    v_fma_f32 v33, v8, v7, v5
    v_cvt_pk_bf16_f32 v33, v33, v33
    v_and_b32 v33, 0xffff0000, v33
    v_mul_f32 v33, v33, v53
    v_cvt_pk_bf16_f32 v33, v33, v33
    v_and_b32 v33, 0xffff0000, v33
    v_add_f32 v33, v33, v43
    v_sub_f32 v34, v34, v4
    v_cvt_pk_bf16_f32 v34, v34, v34
    v_and_b32 v34, 0xffff0000, v34
    v_mul_f32 v5, v34, v7
    v_fma_f32 v8, -v5, v6, v34
    v_fma_f32 v34, v8, v7, v5
    v_cvt_pk_bf16_f32 v34, v34, v34
    v_and_b32 v34, 0xffff0000, v34
    v_mul_f32 v34, v34, v54
    v_cvt_pk_bf16_f32 v34, v34, v34
    v_and_b32 v34, 0xffff0000, v34
    v_add_f32 v34, v34, v44
    v_sub_f32 v35, v35, v4
    v_cvt_pk_bf16_f32 v35, v35, v35
    v_and_b32 v35, 0xffff0000, v35
    v_mul_f32 v5, v35, v7
    v_fma_f32 v8, -v5, v6, v35
    v_fma_f32 v35, v8, v7, v5
    v_cvt_pk_bf16_f32 v35, v35, v35
    v_and_b32 v35, 0xffff0000, v35
    v_mul_f32 v35, v35, v55
    v_cvt_pk_bf16_f32 v35, v35, v35
    v_and_b32 v35, 0xffff0000, v35
    v_add_f32 v35, v35, v45
    v_sub_f32 v36, v36, v4
    v_cvt_pk_bf16_f32 v36, v36, v36
    v_and_b32 v36, 0xffff0000, v36
    v_mul_f32 v5, v36, v7
    v_fma_f32 v8, -v5, v6, v36
    v_fma_f32 v36, v8, v7, v5
    v_cvt_pk_bf16_f32 v36, v36, v36
    v_and_b32 v36, 0xffff0000, v36
    v_mul_f32 v36, v36, v56
    v_cvt_pk_bf16_f32 v36, v36, v36
    v_and_b32 v36, 0xffff0000, v36
    v_add_f32 v36, v36, v46
    v_sub_f32 v37, v37, v4
    v_cvt_pk_bf16_f32 v37, v37, v37
    v_and_b32 v37, 0xffff0000, v37
    v_mul_f32 v5, v37, v7
    v_fma_f32 v8, -v5, v6, v37
    v_fma_f32 v37, v8, v7, v5
    v_cvt_pk_bf16_f32 v37, v37, v37
    v_and_b32 v37, 0xffff0000, v37
    v_mul_f32 v37, v37, v57
    v_cvt_pk_bf16_f32 v37, v37, v37
    v_and_b32 v37, 0xffff0000, v37
    v_add_f32 v37, v37, v47
    v_sub_f32 v38, v38, v4
    v_cvt_pk_bf16_f32 v38, v38, v38
    v_and_b32 v38, 0xffff0000, v38
    v_mul_f32 v5, v38, v7
    v_fma_f32 v8, -v5, v6, v38
    v_fma_f32 v38, v8, v7, v5
    v_cvt_pk_bf16_f32 v38, v38, v38
    v_and_b32 v38, 0xffff0000, v38
    v_mul_f32 v38, v38, v58
    v_cvt_pk_bf16_f32 v38, v38, v38
    v_and_b32 v38, 0xffff0000, v38
    v_add_f32 v38, v38, v48
    v_sub_f32 v39, v39, v4
    v_cvt_pk_bf16_f32 v39, v39, v39
    v_and_b32 v39, 0xffff0000, v39
    v_mul_f32 v5, v39, v7
    v_fma_f32 v8, -v5, v6, v39
    v_fma_f32 v39, v8, v7, v5
    v_cvt_pk_bf16_f32 v39, v39, v39
    v_and_b32 v39, 0xffff0000, v39
    v_mul_f32 v39, v39, v59
    v_cvt_pk_bf16_f32 v39, v39, v39
    v_and_b32 v39, 0xffff0000, v39
    v_add_f32 v39, v39, v49
    s_add_u32 s25, s24, 7340032
    v_cvt_pk_bf16_f32 v25, v30, v31
    buffer_store_dword v25, v2, s[4:7], s25 offen offset:0 sc1
    v_cvt_pk_bf16_f32 v26, v32, v33
    buffer_store_dword v26, v2, s[4:7], s25 offen offset:256 sc1
    v_cvt_pk_bf16_f32 v27, v34, v35
    buffer_store_dword v27, v2, s[4:7], s25 offen offset:512 sc1
    v_cvt_pk_bf16_f32 v28, v36, v37
    buffer_store_dword v28, v2, s[4:7], s25 offen offset:768 sc1
    v_cvt_pk_bf16_f32 v29, v38, v39
    buffer_store_dword v29, v2, s[4:7], s25 offen offset:1024 sc1
    s_lshl_b32 s77, s74, 7
    s_add_u32 s77, s77, 792576
    s_waitcnt vmcnt(0)
    s_barrier
    s_cmp_lg_u32 s26, 0
    s_cbranch_scc1 L_sig_126
    v_mov_b32 v1, 0
    v_mov_b32 v2, 1
    s_mov_b64 exec, 1
    buffer_atomic_add v2, v1, s[4:7], s77 offen
    s_mov_b64 exec, -1
L_sig_126:
    s_branch L_next_104
L_m1_105:
    s_load_dwordx2 s[8:9], s[0:1], 64
    s_mul_hi_u32 s16, s76, 0x33333334
    s_mul_i32 s17, s16, 5
    s_sub_u32 s17, s76, s17
    v_and_b32 v94, 63, v0
    v_and_b32 v95, 15, v94
    v_lshrrev_b32 v96, 4, v94
    v_lshrrev_b32 v97, 6, v0
    s_nop 0
    v_readfirstlane_b32 s40, v97
    s_nop 0
    s_and_b32 s41, s40, 1
    s_lshr_b32 s42, s40, 1
    s_waitcnt lgkmcnt(0)
    s_and_b32 s9, s9, 0xffff
    s_mov_b32 s10, 7077888
    s_mov_b32 s11, 0x20000
    s_mul_i32 s48, s40, 4
    s_add_u32 s48, s48, 0
    v_lshrrev_b32 v98, 4, v94
    s_mul_i32 s49, s48, 4
    v_add_u32 v98, s49, v98
    v_and_b32 v99, 15, v94
    v_and_b32 v100, 3, v98
    v_bfe_u32 v101, v98, 3, 1
    v_lshl_add_u32 v100, v101, 2, v100
    v_lshlrev_b32 v100, 1, v100
    v_xor_b32 v99, v99, v100
    s_mov_b32 s49, 1280
    v_mul_lo_u32 v98, v98, s49
    v_lshl_add_u32 v82, v99, 4, v98
    s_mul_i32 s48, s40, 4
    s_add_u32 s48, s48, 1
    v_lshrrev_b32 v98, 4, v94
    s_mul_i32 s49, s48, 4
    v_add_u32 v98, s49, v98
    v_and_b32 v99, 15, v94
    v_and_b32 v100, 3, v98
    v_bfe_u32 v101, v98, 3, 1
    v_lshl_add_u32 v100, v101, 2, v100
    v_lshlrev_b32 v100, 1, v100
    v_xor_b32 v99, v99, v100
    s_mov_b32 s49, 1280
    v_mul_lo_u32 v98, v98, s49
    v_lshl_add_u32 v83, v99, 4, v98
    s_mul_i32 s48, s40, 4
    s_add_u32 s48, s48, 2
    v_lshrrev_b32 v98, 4, v94
    s_mul_i32 s49, s48, 4
    v_add_u32 v98, s49, v98
    v_and_b32 v99, 15, v94
    v_and_b32 v100, 3, v98
    v_bfe_u32 v101, v98, 3, 1
    v_lshl_add_u32 v100, v101, 2, v100
    v_lshlrev_b32 v100, 1, v100
    v_xor_b32 v99, v99, v100
    s_mov_b32 s49, 1280
    v_mul_lo_u32 v98, v98, s49
    v_lshl_add_u32 v84, v99, 4, v98
    s_mul_i32 s48, s40, 4
    s_add_u32 s48, s48, 3
    v_lshrrev_b32 v98, 4, v94
    s_mul_i32 s49, s48, 4
    v_add_u32 v98, s49, v98
    v_and_b32 v99, 15, v94
    v_and_b32 v100, 3, v98
    v_bfe_u32 v101, v98, 3, 1
    v_lshl_add_u32 v100, v101, 2, v100
    v_lshlrev_b32 v100, 1, v100
    v_xor_b32 v99, v99, v100
    s_mov_b32 s49, 1280
    v_mul_lo_u32 v98, v98, s49
    v_lshl_add_u32 v85, v99, 4, v98
    s_mul_i32 s48, s40, 2
    s_add_u32 s48, s48, 0
    v_lshrrev_b32 v98, 3, v94
    s_lshl_b32 s49, s48, 3
    v_add_u32 v98, s49, v98
    v_and_b32 v99, 7, v94
    v_bfe_u32 v100, v98, 1, 1
    v_bfe_u32 v101, v98, 3, 1
    v_lshl_add_u32 v100, v101, 1, v100
    v_lshlrev_b32 v100, 1, v100
    v_xor_b32 v99, v99, v100
    s_mov_b32 s49, 3456
    v_mul_lo_u32 v98, v98, s49
    v_lshl_add_u32 v86, v99, 4, v98
    s_mul_i32 s48, s40, 2
    s_add_u32 s48, s48, 1
    v_lshrrev_b32 v98, 3, v94
    s_lshl_b32 s49, s48, 3
    v_add_u32 v98, s49, v98
    v_and_b32 v99, 7, v94
    v_bfe_u32 v100, v98, 1, 1
    v_bfe_u32 v101, v98, 3, 1
    v_lshl_add_u32 v100, v101, 1, v100
    v_lshlrev_b32 v100, 1, v100
    v_xor_b32 v99, v99, v100
    s_mov_b32 s49, 3456
    v_mul_lo_u32 v98, v98, s49
    v_lshl_add_u32 v87, v99, 4, v98
    v_lshrrev_b32 v98, 2, v95
    v_and_b32 v99, 3, v95
    v_and_b32 v101, 1, v96
    v_lshl_add_u32 v100, v101, 2, v98
    v_lshlrev_b32 v100, 1, v100
    v_lshrrev_b32 v101, 1, v99
    v_xor_b32 v100, v100, v101
    v_lshlrev_b32 v100, 4, v100
    v_and_b32 v101, 1, v99
    v_lshl_add_u32 v100, v101, 3, v100
    v_lshl_add_u32 v101, v96, 3, v98
    s_mov_b32 s48, 256
    v_mul_lo_u32 v101, v101, s48
    v_add_u32 v100, v100, v101
    s_mul_i32 s48, s41, 4
    s_add_u32 s48, s48, 0
    s_and_b32 s49, s48, 7
    s_lshl_b32 s49, s49, 5
    v_xor_b32 v88, s49, v100
    s_lshr_b32 s48, s48, 3
    s_lshl_b32 s48, s48, 8
    s_add_u32 s48, s48, 0
    v_add_u32 v88, s48, v88
    s_mul_i32 s48, s41, 4
    s_add_u32 s48, s48, 1
    s_and_b32 s49, s48, 7
    s_lshl_b32 s49, s49, 5
    v_xor_b32 v89, s49, v100
    s_lshr_b32 s48, s48, 3
    s_lshl_b32 s48, s48, 8
    s_add_u32 s48, s48, 0
    v_add_u32 v89, s48, v89
    s_mul_i32 s48, s41, 4
    s_add_u32 s48, s48, 2
    s_and_b32 s49, s48, 7
    s_lshl_b32 s49, s49, 5
    v_xor_b32 v90, s49, v100
    s_lshr_b32 s48, s48, 3
    s_lshl_b32 s48, s48, 8
    s_add_u32 s48, s48, 0
    v_add_u32 v90, s48, v90
    s_mul_i32 s48, s41, 4
    s_add_u32 s48, s48, 3
    s_and_b32 s49, s48, 7
    s_lshl_b32 s49, s49, 5
    v_xor_b32 v91, s49, v100
    s_lshr_b32 s48, s48, 3
    s_lshl_b32 s48, s48, 8
    s_add_u32 s48, s48, 0
    v_add_u32 v91, s48, v91
    v_lshrrev_b32 v98, 2, v95
    v_and_b32 v99, 3, v95
    v_lshrrev_b32 v100, 1, v98
    v_and_b32 v101, 1, v96
    v_lshl_add_u32 v100, v101, 1, v100
    v_lshlrev_b32 v100, 1, v100
    v_lshrrev_b32 v101, 1, v99
    v_xor_b32 v100, v100, v101
    v_lshlrev_b32 v100, 4, v100
    v_and_b32 v101, 1, v99
    v_lshl_add_u32 v100, v101, 3, v100
    v_lshl_add_u32 v101, v96, 3, v98
    s_mov_b32 s48, 128
    v_mul_lo_u32 v101, v101, s48
    v_add_u32 v100, v100, v101
    s_mul_i32 s48, s42, 2
    s_add_u32 s48, s48, 0
    s_and_b32 s49, s48, 3
    s_lshl_b32 s49, s49, 5
    v_xor_b32 v92, s49, v100
    s_lshr_b32 s48, s48, 3
    s_lshl_b32 s48, s48, 8
    s_add_u32 s48, s48, 16384
    v_add_u32 v92, s48, v92
    s_mul_i32 s48, s42, 2
    s_add_u32 s48, s48, 1
    s_and_b32 s49, s48, 3
    s_lshl_b32 s49, s49, 5
    v_xor_b32 v93, s49, v100
    s_lshr_b32 s48, s48, 3
    s_lshl_b32 s48, s48, 8
    s_add_u32 s48, s48, 16384
    v_add_u32 v93, s48, v93
    s_lshl_b32 s43, s17, 8
    s_add_u32 s43, s43, 7340032
    s_lshl_b32 s44, s16, 7
    s_mul_i32 s20, s17, 884736
    s_lshl_b32 s21, s16, 8
    s_add_u32 s20, s20, s21
    s_add_u32 s20, s20, 153092096
    s_mul_i32 s54, s40, 4096
    s_mul_i32 s55, s40, 2048
    s_mov_b32 s46, 0
    s_mov_b32 s51, 0
    s_mov_b32 s52, s54
    s_mov_b32 s53, s55
    s_add_u32 s50, s44, 0
    s_add_u32 s53, s55, 0
    s_add_u32 m0, s53, 16384
    s_nop 0
    buffer_load_dwordx4 v86, s[8:11], s50 offen lds
    s_add_u32 m0, s53, 17408
    s_nop 0
    buffer_load_dwordx4 v87, s[8:11], s50 offen lds
    s_add_u32 s50, s44, 221184
    s_add_u32 s53, s55, 24576
    s_add_u32 m0, s53, 16384
    s_nop 0
    buffer_load_dwordx4 v86, s[8:11], s50 offen lds
    s_add_u32 m0, s53, 17408
    s_nop 0
    buffer_load_dwordx4 v87, s[8:11], s50 offen lds
    s_add_u32 s50, s44, 442368
    s_add_u32 s53, s55, 49152
    s_add_u32 m0, s53, 16384
    s_nop 0
    buffer_load_dwordx4 v86, s[8:11], s50 offen lds
    s_add_u32 m0, s53, 17408
    s_nop 0
    buffer_load_dwordx4 v87, s[8:11], s50 offen lds
    s_add_u32 s50, s44, 663552
    s_add_u32 s53, s55, 73728
    s_add_u32 m0, s53, 16384
    s_nop 0
    buffer_load_dwordx4 v86, s[8:11], s50 offen lds
    s_add_u32 m0, s53, 17408
    s_nop 0
    buffer_load_dwordx4 v87, s[8:11], s50 offen lds
    s_add_u32 s50, s44, 884736
    s_add_u32 s53, s55, 98304
    s_add_u32 m0, s53, 16384
    s_nop 0
    buffer_load_dwordx4 v86, s[8:11], s50 offen lds
    s_add_u32 m0, s53, 17408
    s_nop 0
    buffer_load_dwordx4 v87, s[8:11], s50 offen lds
    s_add_u32 s50, s44, 1105920
    s_add_u32 s53, s55, 122880
    s_add_u32 m0, s53, 16384
    s_nop 0
    buffer_load_dwordx4 v86, s[8:11], s50 offen lds
    s_add_u32 m0, s53, 17408
    s_nop 0
    buffer_load_dwordx4 v87, s[8:11], s50 offen lds
    s_mov_b32 s77, 792576
    s_cmp_lg_u32 s26, 0
    s_cbranch_scc1 L_wgw_127
    s_mov_b32 s79, 0x200000
    v_mov_b32 v102, 0
L_cw_128:
    buffer_load_dword v103, v102, s[4:7], s77 offen sc1
    s_waitcnt vmcnt(0)
    v_readfirstlane_b32 s78, v103
    s_nop 0
    s_cmp_ge_u32 s78, 32
    s_cbranch_scc1 L_cd_129
    s_sleep 2
    s_sub_u32 s79, s79, 1
    s_cbranch_scc0 L_cw_128
L_cd_129:
L_wgw_127:
    s_barrier
    s_mov_b32 s77, 792704
    s_cmp_lg_u32 s26, 0
    s_cbranch_scc1 L_wgw_130
    s_mov_b32 s79, 0x200000
    v_mov_b32 v102, 0
L_cw_131:
    buffer_load_dword v103, v102, s[4:7], s77 offen sc1
    s_waitcnt vmcnt(0)
    v_readfirstlane_b32 s78, v103
    s_nop 0
    s_cmp_ge_u32 s78, 32
    s_cbranch_scc1 L_cd_132
    s_sleep 2
    s_sub_u32 s79, s79, 1
    s_cbranch_scc0 L_cw_131
L_cd_132:
L_wgw_130:
    s_barrier
    s_mov_b32 s77, 792832
    s_cmp_lg_u32 s26, 0
    s_cbranch_scc1 L_wgw_133
    s_mov_b32 s79, 0x200000
    v_mov_b32 v102, 0
L_cw_134:
    buffer_load_dword v103, v102, s[4:7], s77 offen sc1
    s_waitcnt vmcnt(0)
    v_readfirstlane_b32 s78, v103
    s_nop 0
    s_cmp_ge_u32 s78, 32
    s_cbranch_scc1 L_cd_135
    s_sleep 2
    s_sub_u32 s79, s79, 1
    s_cbranch_scc0 L_cw_134
L_cd_135:
L_wgw_133:
    s_barrier
    s_mov_b32 s77, 792960
    s_cmp_lg_u32 s26, 0
    s_cbranch_scc1 L_wgw_136
    s_mov_b32 s79, 0x200000
    v_mov_b32 v102, 0
L_cw_137:
    buffer_load_dword v103, v102, s[4:7], s77 offen sc1
    s_waitcnt vmcnt(0)
    v_readfirstlane_b32 s78, v103
    s_nop 0
    s_cmp_ge_u32 s78, 32
    s_cbranch_scc1 L_cd_138
    s_sleep 2
    s_sub_u32 s79, s79, 1
    s_cbranch_scc0 L_cw_137
L_cd_138:
L_wgw_136:
    s_barrier
    s_mov_b32 s77, 793088
    s_cmp_lg_u32 s26, 0
    s_cbranch_scc1 L_wgw_139
    s_mov_b32 s79, 0x200000
    v_mov_b32 v102, 0
L_cw_140:
    buffer_load_dword v103, v102, s[4:7], s77 offen sc1
    s_waitcnt vmcnt(0)
    v_readfirstlane_b32 s78, v103
    s_nop 0
    s_cmp_ge_u32 s78, 32
    s_cbranch_scc1 L_cd_141
    s_sleep 2
    s_sub_u32 s79, s79, 1
    s_cbranch_scc0 L_cw_140
L_cd_141:
L_wgw_139:
    s_barrier
    s_mov_b32 s77, 793216
    s_cmp_lg_u32 s26, 0
    s_cbranch_scc1 L_wgw_142
    s_mov_b32 s79, 0x200000
    v_mov_b32 v102, 0
L_cw_143:
    buffer_load_dword v103, v102, s[4:7], s77 offen sc1
    s_waitcnt vmcnt(0)
    v_readfirstlane_b32 s78, v103
    s_nop 0
    s_cmp_ge_u32 s78, 32
    s_cbranch_scc1 L_cd_144
    s_sleep 2
    s_sub_u32 s79, s79, 1
    s_cbranch_scc0 L_cw_143
L_cd_144:
L_wgw_142:
    s_barrier
    s_mov_b32 s77, 793344
    s_cmp_lg_u32 s26, 0
    s_cbranch_scc1 L_wgw_145
    s_mov_b32 s79, 0x200000
    v_mov_b32 v102, 0
L_cw_146:
    buffer_load_dword v103, v102, s[4:7], s77 offen sc1
    s_waitcnt vmcnt(0)
    v_readfirstlane_b32 s78, v103
    s_nop 0
    s_cmp_ge_u32 s78, 32
    s_cbranch_scc1 L_cd_147
    s_sleep 2
    s_sub_u32 s79, s79, 1
    s_cbranch_scc0 L_cw_146
L_cd_147:
L_wgw_145:
    s_barrier
    s_mov_b32 s77, 793472
    s_cmp_lg_u32 s26, 0
    s_cbranch_scc1 L_wgw_148
    s_mov_b32 s79, 0x200000
    v_mov_b32 v102, 0
L_cw_149:
    buffer_load_dword v103, v102, s[4:7], s77 offen sc1
    s_waitcnt vmcnt(0)
    v_readfirstlane_b32 s78, v103
    s_nop 0
    s_cmp_ge_u32 s78, 32
    s_cbranch_scc1 L_cd_150
    s_sleep 2
    s_sub_u32 s79, s79, 1
    s_cbranch_scc0 L_cw_149
L_cd_150:
L_wgw_148:
    s_barrier
    s_mov_b32 s77, 793600
    s_cmp_lg_u32 s26, 0
    s_cbranch_scc1 L_wgw_151
    s_mov_b32 s79, 0x200000
    v_mov_b32 v102, 0
L_cw_152:
    buffer_load_dword v103, v102, s[4:7], s77 offen sc1
    s_waitcnt vmcnt(0)
    v_readfirstlane_b32 s78, v103
    s_nop 0
    s_cmp_ge_u32 s78, 32
    s_cbranch_scc1 L_cd_153
    s_sleep 2
    s_sub_u32 s79, s79, 1
    s_cbranch_scc0 L_cw_152
L_cd_153:
L_wgw_151:
    s_barrier
    s_mov_b32 s77, 793728
    s_cmp_lg_u32 s26, 0
    s_cbranch_scc1 L_wgw_154
    s_mov_b32 s79, 0x200000
    v_mov_b32 v102, 0
L_cw_155:
    buffer_load_dword v103, v102, s[4:7], s77 offen sc1
    s_waitcnt vmcnt(0)
    v_readfirstlane_b32 s78, v103
    s_nop 0
    s_cmp_ge_u32 s78, 32
    s_cbranch_scc1 L_cd_156
    s_sleep 2
    s_sub_u32 s79, s79, 1
    s_cbranch_scc0 L_cw_155
L_cd_156:
L_wgw_154:
    s_barrier
    s_add_u32 s50, s43, 0
    s_add_u32 s52, s54, 0
    s_add_u32 m0, s52, 0
    s_nop 0
    buffer_load_dwordx4 v82, s[4:7], s50 offen sc1 lds
    s_add_u32 m0, s52, 1024
    s_nop 0
    buffer_load_dwordx4 v83, s[4:7], s50 offen sc1 lds
    s_add_u32 m0, s52, 2048
    s_nop 0
    buffer_load_dwordx4 v84, s[4:7], s50 offen sc1 lds
    s_add_u32 m0, s52, 3072
    s_nop 0
    buffer_load_dwordx4 v85, s[4:7], s50 offen sc1 lds
    s_add_u32 s50, s43, 81920
    s_add_u32 s52, s54, 24576
    s_add_u32 m0, s52, 0
    s_nop 0
    buffer_load_dwordx4 v82, s[4:7], s50 offen sc1 lds
    s_add_u32 m0, s52, 1024
    s_nop 0
    buffer_load_dwordx4 v83, s[4:7], s50 offen sc1 lds
    s_add_u32 m0, s52, 2048
    s_nop 0
    buffer_load_dwordx4 v84, s[4:7], s50 offen sc1 lds
    s_add_u32 m0, s52, 3072
    s_nop 0
    buffer_load_dwordx4 v85, s[4:7], s50 offen sc1 lds
    s_add_u32 s50, s43, 163840
    s_add_u32 s52, s54, 49152
    s_add_u32 m0, s52, 0
    s_nop 0
    buffer_load_dwordx4 v82, s[4:7], s50 offen sc1 lds
    s_add_u32 m0, s52, 1024
    s_nop 0
    buffer_load_dwordx4 v83, s[4:7], s50 offen sc1 lds
    s_add_u32 m0, s52, 2048
    s_nop 0
    buffer_load_dwordx4 v84, s[4:7], s50 offen sc1 lds
    s_add_u32 m0, s52, 3072
    s_nop 0
    buffer_load_dwordx4 v85, s[4:7], s50 offen sc1 lds
    s_add_u32 s50, s43, 245760
    s_add_u32 s52, s54, 73728
    s_add_u32 m0, s52, 0
    s_nop 0
    buffer_load_dwordx4 v82, s[4:7], s50 offen sc1 lds
    s_add_u32 m0, s52, 1024
    s_nop 0
    buffer_load_dwordx4 v83, s[4:7], s50 offen sc1 lds
    s_add_u32 m0, s52, 2048
    s_nop 0
    buffer_load_dwordx4 v84, s[4:7], s50 offen sc1 lds
    s_add_u32 m0, s52, 3072
    s_nop 0
    buffer_load_dwordx4 v85, s[4:7], s50 offen sc1 lds
    s_add_u32 s50, s43, 327680
    s_add_u32 s52, s54, 98304
    s_add_u32 m0, s52, 0
    s_nop 0
    buffer_load_dwordx4 v82, s[4:7], s50 offen sc1 lds
    s_add_u32 m0, s52, 1024
    s_nop 0
    buffer_load_dwordx4 v83, s[4:7], s50 offen sc1 lds
    s_add_u32 m0, s52, 2048
    s_nop 0
    buffer_load_dwordx4 v84, s[4:7], s50 offen sc1 lds
    s_add_u32 m0, s52, 3072
    s_nop 0
    buffer_load_dwordx4 v85, s[4:7], s50 offen sc1 lds
    s_add_u32 s50, s43, 409600
    s_add_u32 s52, s54, 122880
    s_add_u32 m0, s52, 0
    s_nop 0
    buffer_load_dwordx4 v82, s[4:7], s50 offen sc1 lds
    s_add_u32 m0, s52, 1024
    s_nop 0
    buffer_load_dwordx4 v83, s[4:7], s50 offen sc1 lds
    s_add_u32 m0, s52, 2048
    s_nop 0
    buffer_load_dwordx4 v84, s[4:7], s50 offen sc1 lds
    s_add_u32 m0, s52, 3072
    s_nop 0
    buffer_load_dwordx4 v85, s[4:7], s50 offen sc1 lds
    s_add_u32 s43, s43, 81920
    s_add_u32 s44, s44, 221184
    s_add_u32 s51, s51, 1
    s_cmp_ge_u32 s51, 20
    s_cmov_b32 s43, 0x40000000
    s_cmov_b32 s44, 0x40000000
    s_add_u32 s46, s46, 24576
    s_cmp_eq_u32 s46, 147456
    s_cmov_b32 s46, 0
    s_add_u32 s52, s46, s54
    s_add_u32 s53, s46, s55
    s_add_u32 s43, s43, 81920
    s_add_u32 s44, s44, 221184
    s_add_u32 s51, s51, 1
    s_cmp_ge_u32 s51, 20
    s_cmov_b32 s43, 0x40000000
    s_cmov_b32 s44, 0x40000000
    s_add_u32 s46, s46, 24576
    s_cmp_eq_u32 s46, 147456
    s_cmov_b32 s46, 0
    s_add_u32 s52, s46, s54
    s_add_u32 s53, s46, s55
    s_add_u32 s43, s43, 81920
    s_add_u32 s44, s44, 221184
    s_add_u32 s51, s51, 1
    s_cmp_ge_u32 s51, 20
    s_cmov_b32 s43, 0x40000000
    s_cmov_b32 s44, 0x40000000
    s_add_u32 s46, s46, 24576
    s_cmp_eq_u32 s46, 147456
    s_cmov_b32 s46, 0
    s_add_u32 s52, s46, s54
    s_add_u32 s53, s46, s55
    s_add_u32 s43, s43, 81920
    s_add_u32 s44, s44, 221184
    s_add_u32 s51, s51, 1
    s_cmp_ge_u32 s51, 20
    s_cmov_b32 s43, 0x40000000
    s_cmov_b32 s44, 0x40000000
    s_add_u32 s46, s46, 24576
    s_cmp_eq_u32 s46, 147456
    s_cmov_b32 s46, 0
    s_add_u32 s52, s46, s54
    s_add_u32 s53, s46, s55
    s_add_u32 s43, s43, 81920
    s_add_u32 s44, s44, 221184
    s_add_u32 s51, s51, 1
    s_cmp_ge_u32 s51, 20
    s_cmov_b32 s43, 0x40000000
    s_cmov_b32 s44, 0x40000000
    s_add_u32 s46, s46, 24576
    s_cmp_eq_u32 s46, 147456
    s_cmov_b32 s46, 0
    s_add_u32 s52, s46, s54
    s_add_u32 s53, s46, s55
    s_add_u32 s43, s43, 81920
    s_add_u32 s44, s44, 221184
    s_add_u32 s51, s51, 1
    s_cmp_ge_u32 s51, 20
    s_cmov_b32 s43, 0x40000000
    s_cmov_b32 s44, 0x40000000
    s_add_u32 s46, s46, 24576
    s_cmp_eq_u32 s46, 147456
    s_cmov_b32 s46, 0
    s_add_u32 s52, s46, s54
    s_add_u32 s53, s46, s55
    v_mov_b32 v2, 0
    v_mov_b32 v3, 0
    v_mov_b32 v4, 0
    v_mov_b32 v5, 0
    v_mov_b32 v6, 0
    v_mov_b32 v7, 0
    v_mov_b32 v8, 0
    v_mov_b32 v9, 0
    v_mov_b32 v10, 0
    v_mov_b32 v11, 0
    v_mov_b32 v12, 0
    v_mov_b32 v13, 0
    v_mov_b32 v14, 0
    v_mov_b32 v15, 0
    v_mov_b32 v16, 0
    v_mov_b32 v17, 0
    v_mov_b32 v18, 0
    v_mov_b32 v19, 0
    v_mov_b32 v20, 0
    v_mov_b32 v21, 0
    v_mov_b32 v22, 0
    v_mov_b32 v23, 0
    v_mov_b32 v24, 0
    v_mov_b32 v25, 0
    v_mov_b32 v26, 0
    v_mov_b32 v27, 0
    v_mov_b32 v28, 0
    v_mov_b32 v29, 0
    v_mov_b32 v30, 0
    v_mov_b32 v31, 0
    v_mov_b32 v32, 0
    v_mov_b32 v33, 0
    s_mov_b32 s45, 0
    s_mov_b32 s47, 0
    s_waitcnt vmcnt(20)
    s_barrier
    ds_read_b64_tr_b16 v[66:67], v92 offset:0
    ds_read_b64_tr_b16 v[68:69], v92 offset:512
    ds_read_b64_tr_b16 v[70:71], v93 offset:0
    ds_read_b64_tr_b16 v[72:73], v93 offset:512
    ds_read_b64_tr_b16 v[34:35], v88 offset:0
    ds_read_b64_tr_b16 v[36:37], v88 offset:1024
    ds_read_b64_tr_b16 v[38:39], v89 offset:0
    ds_read_b64_tr_b16 v[40:41], v89 offset:1024
    ds_read_b64_tr_b16 v[42:43], v90 offset:0
    ds_read_b64_tr_b16 v[44:45], v90 offset:1024
    ds_read_b64_tr_b16 v[46:47], v91 offset:0
    ds_read_b64_tr_b16 v[48:49], v91 offset:1024
    s_waitcnt lgkmcnt(0)
    v_mfma_f32_16x16x32_bf16 v[2:5], v[66:69], v[34:37], v[2:5]
    ds_read_b64_tr_b16 v[74:75], v92 offset:4096
    ds_read_b64_tr_b16 v[76:77], v92 offset:4608
    v_mfma_f32_16x16x32_bf16 v[6:9], v[66:69], v[38:41], v[6:9]
    ds_read_b64_tr_b16 v[78:79], v93 offset:4096
    ds_read_b64_tr_b16 v[80:81], v93 offset:4608
    v_mfma_f32_16x16x32_bf16 v[10:13], v[66:69], v[42:45], v[10:13]
    ds_read_b64_tr_b16 v[50:51], v88 offset:8192
    ds_read_b64_tr_b16 v[52:53], v88 offset:9216
    v_mfma_f32_16x16x32_bf16 v[14:17], v[66:69], v[46:49], v[14:17]
    ds_read_b64_tr_b16 v[54:55], v89 offset:8192
    ds_read_b64_tr_b16 v[56:57], v89 offset:9216
    v_mfma_f32_16x16x32_bf16 v[18:21], v[70:73], v[34:37], v[18:21]
    ds_read_b64_tr_b16 v[58:59], v90 offset:8192
    ds_read_b64_tr_b16 v[60:61], v90 offset:9216
    v_mfma_f32_16x16x32_bf16 v[22:25], v[70:73], v[38:41], v[22:25]
    ds_read_b64_tr_b16 v[62:63], v91 offset:8192
    ds_read_b64_tr_b16 v[64:65], v91 offset:9216
    v_mfma_f32_16x16x32_bf16 v[26:29], v[70:73], v[42:45], v[26:29]
    v_mfma_f32_16x16x32_bf16 v[30:33], v[70:73], v[46:49], v[30:33]
    s_add_u32 s47, s47, 1
    s_cmp_eq_u32 s47, 6
    s_mov_b32 s49, 24576
    s_cmov_b32 s49, 0xfffe2000
    s_cmov_b32 s47, 0
    s_waitcnt lgkmcnt(0)
    v_add_u32 v88, s49, v88
    v_add_u32 v89, s49, v89
    v_add_u32 v90, s49, v90
    v_add_u32 v91, s49, v91
    v_add_u32 v92, s49, v92
    v_add_u32 v93, s49, v93
    s_waitcnt vmcnt(16)
    s_barrier
    v_mfma_f32_16x16x32_bf16 v[2:5], v[74:77], v[50:53], v[2:5]
    ds_read_b64_tr_b16 v[66:67], v92 offset:0
    ds_read_b64_tr_b16 v[68:69], v92 offset:512
    s_add_u32 m0, s52, 0
    s_nop 0
    buffer_load_dwordx4 v82, s[4:7], s43 offen sc1 lds
    v_mfma_f32_16x16x32_bf16 v[6:9], v[74:77], v[54:57], v[6:9]
    ds_read_b64_tr_b16 v[70:71], v93 offset:0
    ds_read_b64_tr_b16 v[72:73], v93 offset:512
    s_add_u32 m0, s52, 1024
    s_nop 0
    buffer_load_dwordx4 v83, s[4:7], s43 offen sc1 lds
    v_mfma_f32_16x16x32_bf16 v[10:13], v[74:77], v[58:61], v[10:13]
    ds_read_b64_tr_b16 v[34:35], v88 offset:0
    ds_read_b64_tr_b16 v[36:37], v88 offset:1024
    s_add_u32 m0, s52, 2048
    s_nop 0
    buffer_load_dwordx4 v84, s[4:7], s43 offen sc1 lds
    v_mfma_f32_16x16x32_bf16 v[14:17], v[74:77], v[62:65], v[14:17]
    ds_read_b64_tr_b16 v[38:39], v89 offset:0
    ds_read_b64_tr_b16 v[40:41], v89 offset:1024
    v_mfma_f32_16x16x32_bf16 v[18:21], v[78:81], v[50:53], v[18:21]
    ds_read_b64_tr_b16 v[42:43], v90 offset:0
    ds_read_b64_tr_b16 v[44:45], v90 offset:1024
    s_add_u32 m0, s52, 3072
    s_nop 0
    buffer_load_dwordx4 v85, s[4:7], s43 offen sc1 lds
    v_mfma_f32_16x16x32_bf16 v[22:25], v[78:81], v[54:57], v[22:25]
    ds_read_b64_tr_b16 v[46:47], v91 offset:0
    ds_read_b64_tr_b16 v[48:49], v91 offset:1024
    s_add_u32 m0, s53, 16384
    s_nop 0
    buffer_load_dwordx4 v86, s[8:11], s44 offen lds
    v_mfma_f32_16x16x32_bf16 v[26:29], v[78:81], v[58:61], v[26:29]
    s_add_u32 m0, s53, 17408
    s_nop 0
    buffer_load_dwordx4 v87, s[8:11], s44 offen lds
    v_mfma_f32_16x16x32_bf16 v[30:33], v[78:81], v[62:65], v[30:33]
    s_add_u32 s43, s43, 81920
    s_add_u32 s44, s44, 221184
    s_add_u32 s46, s46, 24576
    s_cmp_eq_u32 s46, 147456
    s_cmov_b32 s46, 0
    s_add_u32 s52, s46, s54
    s_add_u32 s53, s46, s55
    s_waitcnt lgkmcnt(0)
    v_mfma_f32_16x16x32_bf16 v[2:5], v[66:69], v[34:37], v[2:5]
    ds_read_b64_tr_b16 v[74:75], v92 offset:4096
    ds_read_b64_tr_b16 v[76:77], v92 offset:4608
    v_mfma_f32_16x16x32_bf16 v[6:9], v[66:69], v[38:41], v[6:9]
    ds_read_b64_tr_b16 v[78:79], v93 offset:4096
    ds_read_b64_tr_b16 v[80:81], v93 offset:4608
    v_mfma_f32_16x16x32_bf16 v[10:13], v[66:69], v[42:45], v[10:13]
    ds_read_b64_tr_b16 v[50:51], v88 offset:8192
    ds_read_b64_tr_b16 v[52:53], v88 offset:9216
    v_mfma_f32_16x16x32_bf16 v[14:17], v[66:69], v[46:49], v[14:17]
    ds_read_b64_tr_b16 v[54:55], v89 offset:8192
    ds_read_b64_tr_b16 v[56:57], v89 offset:9216
    v_mfma_f32_16x16x32_bf16 v[18:21], v[70:73], v[34:37], v[18:21]
    ds_read_b64_tr_b16 v[58:59], v90 offset:8192
    ds_read_b64_tr_b16 v[60:61], v90 offset:9216
    v_mfma_f32_16x16x32_bf16 v[22:25], v[70:73], v[38:41], v[22:25]
    ds_read_b64_tr_b16 v[62:63], v91 offset:8192
    ds_read_b64_tr_b16 v[64:65], v91 offset:9216
    v_mfma_f32_16x16x32_bf16 v[26:29], v[70:73], v[42:45], v[26:29]
    v_mfma_f32_16x16x32_bf16 v[30:33], v[70:73], v[46:49], v[30:33]
    s_add_u32 s47, s47, 1
    s_cmp_eq_u32 s47, 6
    s_mov_b32 s49, 24576
    s_cmov_b32 s49, 0xfffe2000
    s_cmov_b32 s47, 0
    s_waitcnt lgkmcnt(0)
    v_add_u32 v88, s49, v88
    v_add_u32 v89, s49, v89
    v_add_u32 v90, s49, v90
    v_add_u32 v91, s49, v91
    v_add_u32 v92, s49, v92
    v_add_u32 v93, s49, v93
    s_waitcnt vmcnt(18)
    s_barrier
    v_mfma_f32_16x16x32_bf16 v[2:5], v[74:77], v[50:53], v[2:5]
    ds_read_b64_tr_b16 v[66:67], v92 offset:0
    ds_read_b64_tr_b16 v[68:69], v92 offset:512
    s_add_u32 m0, s52, 0
    s_nop 0
    buffer_load_dwordx4 v82, s[4:7], s43 offen sc1 lds
    v_mfma_f32_16x16x32_bf16 v[6:9], v[74:77], v[54:57], v[6:9]
    ds_read_b64_tr_b16 v[70:71], v93 offset:0
    ds_read_b64_tr_b16 v[72:73], v93 offset:512
    s_add_u32 m0, s52, 1024
    s_nop 0
    buffer_load_dwordx4 v83, s[4:7], s43 offen sc1 lds
    v_mfma_f32_16x16x32_bf16 v[10:13], v[74:77], v[58:61], v[10:13]
    ds_read_b64_tr_b16 v[34:35], v88 offset:0
    ds_read_b64_tr_b16 v[36:37], v88 offset:1024
    s_add_u32 m0, s52, 2048
    s_nop 0
    buffer_load_dwordx4 v84, s[4:7], s43 offen sc1 lds
    v_mfma_f32_16x16x32_bf16 v[14:17], v[74:77], v[62:65], v[14:17]
    ds_read_b64_tr_b16 v[38:39], v89 offset:0
    ds_read_b64_tr_b16 v[40:41], v89 offset:1024
    v_mfma_f32_16x16x32_bf16 v[18:21], v[78:81], v[50:53], v[18:21]
    ds_read_b64_tr_b16 v[42:43], v90 offset:0
    ds_read_b64_tr_b16 v[44:45], v90 offset:1024
    s_add_u32 m0, s52, 3072
    s_nop 0
    buffer_load_dwordx4 v85, s[4:7], s43 offen sc1 lds
    v_mfma_f32_16x16x32_bf16 v[22:25], v[78:81], v[54:57], v[22:25]
    ds_read_b64_tr_b16 v[46:47], v91 offset:0
    ds_read_b64_tr_b16 v[48:49], v91 offset:1024
    s_add_u32 m0, s53, 16384
    s_nop 0
    buffer_load_dwordx4 v86, s[8:11], s44 offen lds
    v_mfma_f32_16x16x32_bf16 v[26:29], v[78:81], v[58:61], v[26:29]
    s_add_u32 m0, s53, 17408
    s_nop 0
    buffer_load_dwordx4 v87, s[8:11], s44 offen lds
    v_mfma_f32_16x16x32_bf16 v[30:33], v[78:81], v[62:65], v[30:33]
    s_add_u32 s43, s43, 81920
    s_add_u32 s44, s44, 221184
    s_add_u32 s46, s46, 24576
    s_cmp_eq_u32 s46, 147456
    s_cmov_b32 s46, 0
    s_add_u32 s52, s46, s54
    s_add_u32 s53, s46, s55
    s_waitcnt lgkmcnt(0)
    v_mfma_f32_16x16x32_bf16 v[2:5], v[66:69], v[34:37], v[2:5]
    ds_read_b64_tr_b16 v[74:75], v92 offset:4096
    ds_read_b64_tr_b16 v[76:77], v92 offset:4608
    v_mfma_f32_16x16x32_bf16 v[6:9], v[66:69], v[38:41], v[6:9]
    ds_read_b64_tr_b16 v[78:79], v93 offset:4096
    ds_read_b64_tr_b16 v[80:81], v93 offset:4608
    v_mfma_f32_16x16x32_bf16 v[10:13], v[66:69], v[42:45], v[10:13]
    ds_read_b64_tr_b16 v[50:51], v88 offset:8192
    ds_read_b64_tr_b16 v[52:53], v88 offset:9216
    v_mfma_f32_16x16x32_bf16 v[14:17], v[66:69], v[46:49], v[14:17]
    ds_read_b64_tr_b16 v[54:55], v89 offset:8192
    ds_read_b64_tr_b16 v[56:57], v89 offset:9216
    v_mfma_f32_16x16x32_bf16 v[18:21], v[70:73], v[34:37], v[18:21]
    ds_read_b64_tr_b16 v[58:59], v90 offset:8192
    ds_read_b64_tr_b16 v[60:61], v90 offset:9216
    v_mfma_f32_16x16x32_bf16 v[22:25], v[70:73], v[38:41], v[22:25]
    ds_read_b64_tr_b16 v[62:63], v91 offset:8192
    ds_read_b64_tr_b16 v[64:65], v91 offset:9216
    v_mfma_f32_16x16x32_bf16 v[26:29], v[70:73], v[42:45], v[26:29]
    v_mfma_f32_16x16x32_bf16 v[30:33], v[70:73], v[46:49], v[30:33]
    s_add_u32 s47, s47, 1
    s_cmp_eq_u32 s47, 6
    s_mov_b32 s49, 24576
    s_cmov_b32 s49, 0xfffe2000
    s_cmov_b32 s47, 0
    s_waitcnt lgkmcnt(0)
    v_add_u32 v88, s49, v88
    v_add_u32 v89, s49, v89
    v_add_u32 v90, s49, v90
    v_add_u32 v91, s49, v91
    v_add_u32 v92, s49, v92
    v_add_u32 v93, s49, v93
    s_waitcnt vmcnt(20)
    s_barrier
    v_mfma_f32_16x16x32_bf16 v[2:5], v[74:77], v[50:53], v[2:5]
    ds_read_b64_tr_b16 v[66:67], v92 offset:0
    ds_read_b64_tr_b16 v[68:69], v92 offset:512
    s_add_u32 m0, s52, 0
    s_nop 0
    buffer_load_dwordx4 v82, s[4:7], s43 offen sc1 lds
    v_mfma_f32_16x16x32_bf16 v[6:9], v[74:77], v[54:57], v[6:9]
    ds_read_b64_tr_b16 v[70:71], v93 offset:0
    ds_read_b64_tr_b16 v[72:73], v93 offset:512
    s_add_u32 m0, s52, 1024
    s_nop 0
    buffer_load_dwordx4 v83, s[4:7], s43 offen sc1 lds
    v_mfma_f32_16x16x32_bf16 v[10:13], v[74:77], v[58:61], v[10:13]
    ds_read_b64_tr_b16 v[34:35], v88 offset:0
    ds_read_b64_tr_b16 v[36:37], v88 offset:1024
    s_add_u32 m0, s52, 2048
    s_nop 0
    buffer_load_dwordx4 v84, s[4:7], s43 offen sc1 lds
    v_mfma_f32_16x16x32_bf16 v[14:17], v[74:77], v[62:65], v[14:17]
    ds_read_b64_tr_b16 v[38:39], v89 offset:0
    ds_read_b64_tr_b16 v[40:41], v89 offset:1024
    v_mfma_f32_16x16x32_bf16 v[18:21], v[78:81], v[50:53], v[18:21]
    ds_read_b64_tr_b16 v[42:43], v90 offset:0
    ds_read_b64_tr_b16 v[44:45], v90 offset:1024
    s_add_u32 m0, s52, 3072
    s_nop 0
    buffer_load_dwordx4 v85, s[4:7], s43 offen sc1 lds
    v_mfma_f32_16x16x32_bf16 v[22:25], v[78:81], v[54:57], v[22:25]
    ds_read_b64_tr_b16 v[46:47], v91 offset:0
    ds_read_b64_tr_b16 v[48:49], v91 offset:1024
    s_add_u32 m0, s53, 16384
    s_nop 0
    buffer_load_dwordx4 v86, s[8:11], s44 offen lds
    v_mfma_f32_16x16x32_bf16 v[26:29], v[78:81], v[58:61], v[26:29]
    s_add_u32 m0, s53, 17408
    s_nop 0
    buffer_load_dwordx4 v87, s[8:11], s44 offen lds
    v_mfma_f32_16x16x32_bf16 v[30:33], v[78:81], v[62:65], v[30:33]
    s_add_u32 s43, s43, 81920
    s_add_u32 s44, s44, 221184
    s_add_u32 s46, s46, 24576
    s_cmp_eq_u32 s46, 147456
    s_cmov_b32 s46, 0
    s_add_u32 s52, s46, s54
    s_add_u32 s53, s46, s55
    s_waitcnt lgkmcnt(0)
    v_mfma_f32_16x16x32_bf16 v[2:5], v[66:69], v[34:37], v[2:5]
    ds_read_b64_tr_b16 v[74:75], v92 offset:4096
    ds_read_b64_tr_b16 v[76:77], v92 offset:4608
    v_mfma_f32_16x16x32_bf16 v[6:9], v[66:69], v[38:41], v[6:9]
    ds_read_b64_tr_b16 v[78:79], v93 offset:4096
    ds_read_b64_tr_b16 v[80:81], v93 offset:4608
    v_mfma_f32_16x16x32_bf16 v[10:13], v[66:69], v[42:45], v[10:13]
    ds_read_b64_tr_b16 v[50:51], v88 offset:8192
    ds_read_b64_tr_b16 v[52:53], v88 offset:9216
    v_mfma_f32_16x16x32_bf16 v[14:17], v[66:69], v[46:49], v[14:17]
    ds_read_b64_tr_b16 v[54:55], v89 offset:8192
    ds_read_b64_tr_b16 v[56:57], v89 offset:9216
    v_mfma_f32_16x16x32_bf16 v[18:21], v[70:73], v[34:37], v[18:21]
    ds_read_b64_tr_b16 v[58:59], v90 offset:8192
    ds_read_b64_tr_b16 v[60:61], v90 offset:9216
    v_mfma_f32_16x16x32_bf16 v[22:25], v[70:73], v[38:41], v[22:25]
    ds_read_b64_tr_b16 v[62:63], v91 offset:8192
    ds_read_b64_tr_b16 v[64:65], v91 offset:9216
    v_mfma_f32_16x16x32_bf16 v[26:29], v[70:73], v[42:45], v[26:29]
    v_mfma_f32_16x16x32_bf16 v[30:33], v[70:73], v[46:49], v[30:33]
    s_add_u32 s47, s47, 1
    s_cmp_eq_u32 s47, 6
    s_mov_b32 s49, 24576
    s_cmov_b32 s49, 0xfffe2000
    s_cmov_b32 s47, 0
    s_waitcnt lgkmcnt(0)
    v_add_u32 v88, s49, v88
    v_add_u32 v89, s49, v89
    v_add_u32 v90, s49, v90
    v_add_u32 v91, s49, v91
    v_add_u32 v92, s49, v92
    v_add_u32 v93, s49, v93
    s_waitcnt vmcnt(22)
    s_barrier
    v_mfma_f32_16x16x32_bf16 v[2:5], v[74:77], v[50:53], v[2:5]
    ds_read_b64_tr_b16 v[66:67], v92 offset:0
    ds_read_b64_tr_b16 v[68:69], v92 offset:512
    s_add_u32 m0, s52, 0
    s_nop 0
    buffer_load_dwordx4 v82, s[4:7], s43 offen sc1 lds
    v_mfma_f32_16x16x32_bf16 v[6:9], v[74:77], v[54:57], v[6:9]
    ds_read_b64_tr_b16 v[70:71], v93 offset:0
    ds_read_b64_tr_b16 v[72:73], v93 offset:512
    s_add_u32 m0, s52, 1024
    s_nop 0
    buffer_load_dwordx4 v83, s[4:7], s43 offen sc1 lds
    v_mfma_f32_16x16x32_bf16 v[10:13], v[74:77], v[58:61], v[10:13]
    ds_read_b64_tr_b16 v[34:35], v88 offset:0
    ds_read_b64_tr_b16 v[36:37], v88 offset:1024
    s_add_u32 m0, s52, 2048
    s_nop 0
    buffer_load_dwordx4 v84, s[4:7], s43 offen sc1 lds
    v_mfma_f32_16x16x32_bf16 v[14:17], v[74:77], v[62:65], v[14:17]
    ds_read_b64_tr_b16 v[38:39], v89 offset:0
    ds_read_b64_tr_b16 v[40:41], v89 offset:1024
    v_mfma_f32_16x16x32_bf16 v[18:21], v[78:81], v[50:53], v[18:21]
    ds_read_b64_tr_b16 v[42:43], v90 offset:0
    ds_read_b64_tr_b16 v[44:45], v90 offset:1024
    s_add_u32 m0, s52, 3072
    s_nop 0
    buffer_load_dwordx4 v85, s[4:7], s43 offen sc1 lds
    v_mfma_f32_16x16x32_bf16 v[22:25], v[78:81], v[54:57], v[22:25]
    ds_read_b64_tr_b16 v[46:47], v91 offset:0
    ds_read_b64_tr_b16 v[48:49], v91 offset:1024
    s_add_u32 m0, s53, 16384
    s_nop 0
    buffer_load_dwordx4 v86, s[8:11], s44 offen lds
    v_mfma_f32_16x16x32_bf16 v[26:29], v[78:81], v[58:61], v[26:29]
    s_add_u32 m0, s53, 17408
    s_nop 0
    buffer_load_dwordx4 v87, s[8:11], s44 offen lds
    v_mfma_f32_16x16x32_bf16 v[30:33], v[78:81], v[62:65], v[30:33]
    s_add_u32 s43, s43, 81920
    s_add_u32 s44, s44, 221184
    s_add_u32 s46, s46, 24576
    s_cmp_eq_u32 s46, 147456
    s_cmov_b32 s46, 0
    s_add_u32 s52, s46, s54
    s_add_u32 s53, s46, s55
    s_waitcnt lgkmcnt(0)
    s_mov_b32 s45, 4
L_gk_157:
    v_mfma_f32_16x16x32_bf16 v[2:5], v[66:69], v[34:37], v[2:5]
    ds_read_b64_tr_b16 v[74:75], v92 offset:4096
    ds_read_b64_tr_b16 v[76:77], v92 offset:4608
    v_mfma_f32_16x16x32_bf16 v[6:9], v[66:69], v[38:41], v[6:9]
    ds_read_b64_tr_b16 v[78:79], v93 offset:4096
    ds_read_b64_tr_b16 v[80:81], v93 offset:4608
    v_mfma_f32_16x16x32_bf16 v[10:13], v[66:69], v[42:45], v[10:13]
    ds_read_b64_tr_b16 v[50:51], v88 offset:8192
    ds_read_b64_tr_b16 v[52:53], v88 offset:9216
    v_mfma_f32_16x16x32_bf16 v[14:17], v[66:69], v[46:49], v[14:17]
    ds_read_b64_tr_b16 v[54:55], v89 offset:8192
    ds_read_b64_tr_b16 v[56:57], v89 offset:9216
    v_mfma_f32_16x16x32_bf16 v[18:21], v[70:73], v[34:37], v[18:21]
    ds_read_b64_tr_b16 v[58:59], v90 offset:8192
    ds_read_b64_tr_b16 v[60:61], v90 offset:9216
    v_mfma_f32_16x16x32_bf16 v[22:25], v[70:73], v[38:41], v[22:25]
    ds_read_b64_tr_b16 v[62:63], v91 offset:8192
    ds_read_b64_tr_b16 v[64:65], v91 offset:9216
    v_mfma_f32_16x16x32_bf16 v[26:29], v[70:73], v[42:45], v[26:29]
    v_mfma_f32_16x16x32_bf16 v[30:33], v[70:73], v[46:49], v[30:33]
    s_add_u32 s47, s47, 1
    s_cmp_eq_u32 s47, 6
    s_mov_b32 s49, 24576
    s_cmov_b32 s49, 0xfffe2000
    s_cmov_b32 s47, 0
    s_waitcnt lgkmcnt(0)
    v_add_u32 v88, s49, v88
    v_add_u32 v89, s49, v89
    v_add_u32 v90, s49, v90
    v_add_u32 v91, s49, v91
    v_add_u32 v92, s49, v92
    v_add_u32 v93, s49, v93
    s_waitcnt vmcnt(24)
    s_barrier
    v_mfma_f32_16x16x32_bf16 v[2:5], v[74:77], v[50:53], v[2:5]
    ds_read_b64_tr_b16 v[66:67], v92 offset:0
    ds_read_b64_tr_b16 v[68:69], v92 offset:512
    s_add_u32 m0, s52, 0
    s_nop 0
    buffer_load_dwordx4 v82, s[4:7], s43 offen sc1 lds
    v_mfma_f32_16x16x32_bf16 v[6:9], v[74:77], v[54:57], v[6:9]
    ds_read_b64_tr_b16 v[70:71], v93 offset:0
    ds_read_b64_tr_b16 v[72:73], v93 offset:512
    s_add_u32 m0, s52, 1024
    s_nop 0
    buffer_load_dwordx4 v83, s[4:7], s43 offen sc1 lds
    v_mfma_f32_16x16x32_bf16 v[10:13], v[74:77], v[58:61], v[10:13]
    ds_read_b64_tr_b16 v[34:35], v88 offset:0
    ds_read_b64_tr_b16 v[36:37], v88 offset:1024
    s_add_u32 m0, s52, 2048
    s_nop 0
    buffer_load_dwordx4 v84, s[4:7], s43 offen sc1 lds
    v_mfma_f32_16x16x32_bf16 v[14:17], v[74:77], v[62:65], v[14:17]
    ds_read_b64_tr_b16 v[38:39], v89 offset:0
    ds_read_b64_tr_b16 v[40:41], v89 offset:1024
    v_mfma_f32_16x16x32_bf16 v[18:21], v[78:81], v[50:53], v[18:21]
    ds_read_b64_tr_b16 v[42:43], v90 offset:0
    ds_read_b64_tr_b16 v[44:45], v90 offset:1024
    s_add_u32 m0, s52, 3072
    s_nop 0
    buffer_load_dwordx4 v85, s[4:7], s43 offen sc1 lds
    v_mfma_f32_16x16x32_bf16 v[22:25], v[78:81], v[54:57], v[22:25]
    ds_read_b64_tr_b16 v[46:47], v91 offset:0
    ds_read_b64_tr_b16 v[48:49], v91 offset:1024
    s_add_u32 m0, s53, 16384
    s_nop 0
    buffer_load_dwordx4 v86, s[8:11], s44 offen lds
    v_mfma_f32_16x16x32_bf16 v[26:29], v[78:81], v[58:61], v[26:29]
    s_add_u32 m0, s53, 17408
    s_nop 0
    buffer_load_dwordx4 v87, s[8:11], s44 offen lds
    v_mfma_f32_16x16x32_bf16 v[30:33], v[78:81], v[62:65], v[30:33]
    s_add_u32 s43, s43, 81920
    s_add_u32 s44, s44, 221184
    s_add_u32 s46, s46, 24576
    s_cmp_eq_u32 s46, 147456
    s_cmov_b32 s46, 0
    s_add_u32 s52, s46, s54
    s_add_u32 s53, s46, s55
    s_add_u32 s45, s45, 1
    s_cmp_lt_u32 s45, 14
    s_waitcnt lgkmcnt(0)
    s_cbranch_scc1 L_gk_157
    v_mfma_f32_16x16x32_bf16 v[2:5], v[66:69], v[34:37], v[2:5]
    ds_read_b64_tr_b16 v[74:75], v92 offset:4096
    ds_read_b64_tr_b16 v[76:77], v92 offset:4608
    v_mfma_f32_16x16x32_bf16 v[6:9], v[66:69], v[38:41], v[6:9]
    ds_read_b64_tr_b16 v[78:79], v93 offset:4096
    ds_read_b64_tr_b16 v[80:81], v93 offset:4608
    v_mfma_f32_16x16x32_bf16 v[10:13], v[66:69], v[42:45], v[10:13]
    ds_read_b64_tr_b16 v[50:51], v88 offset:8192
    ds_read_b64_tr_b16 v[52:53], v88 offset:9216
    v_mfma_f32_16x16x32_bf16 v[14:17], v[66:69], v[46:49], v[14:17]
    ds_read_b64_tr_b16 v[54:55], v89 offset:8192
    ds_read_b64_tr_b16 v[56:57], v89 offset:9216
    v_mfma_f32_16x16x32_bf16 v[18:21], v[70:73], v[34:37], v[18:21]
    ds_read_b64_tr_b16 v[58:59], v90 offset:8192
    ds_read_b64_tr_b16 v[60:61], v90 offset:9216
    v_mfma_f32_16x16x32_bf16 v[22:25], v[70:73], v[38:41], v[22:25]
    ds_read_b64_tr_b16 v[62:63], v91 offset:8192
    ds_read_b64_tr_b16 v[64:65], v91 offset:9216
    v_mfma_f32_16x16x32_bf16 v[26:29], v[70:73], v[42:45], v[26:29]
    v_mfma_f32_16x16x32_bf16 v[30:33], v[70:73], v[46:49], v[30:33]
    s_add_u32 s47, s47, 1
    s_cmp_eq_u32 s47, 6
    s_mov_b32 s49, 24576
    s_cmov_b32 s49, 0xfffe2000
    s_cmov_b32 s47, 0
    s_waitcnt lgkmcnt(0)
    v_add_u32 v88, s49, v88
    v_add_u32 v89, s49, v89
    v_add_u32 v90, s49, v90
    v_add_u32 v91, s49, v91
    v_add_u32 v92, s49, v92
    v_add_u32 v93, s49, v93
    s_waitcnt vmcnt(24)
    s_barrier
    v_mfma_f32_16x16x32_bf16 v[2:5], v[74:77], v[50:53], v[2:5]
    ds_read_b64_tr_b16 v[66:67], v92 offset:0
    ds_read_b64_tr_b16 v[68:69], v92 offset:512
    v_mfma_f32_16x16x32_bf16 v[6:9], v[74:77], v[54:57], v[6:9]
    ds_read_b64_tr_b16 v[70:71], v93 offset:0
    ds_read_b64_tr_b16 v[72:73], v93 offset:512
    v_mfma_f32_16x16x32_bf16 v[10:13], v[74:77], v[58:61], v[10:13]
    ds_read_b64_tr_b16 v[34:35], v88 offset:0
    ds_read_b64_tr_b16 v[36:37], v88 offset:1024
    v_mfma_f32_16x16x32_bf16 v[14:17], v[74:77], v[62:65], v[14:17]
    ds_read_b64_tr_b16 v[38:39], v89 offset:0
    ds_read_b64_tr_b16 v[40:41], v89 offset:1024
    v_mfma_f32_16x16x32_bf16 v[18:21], v[78:81], v[50:53], v[18:21]
    ds_read_b64_tr_b16 v[42:43], v90 offset:0
    ds_read_b64_tr_b16 v[44:45], v90 offset:1024
    v_mfma_f32_16x16x32_bf16 v[22:25], v[78:81], v[54:57], v[22:25]
    ds_read_b64_tr_b16 v[46:47], v91 offset:0
    ds_read_b64_tr_b16 v[48:49], v91 offset:1024
    v_mfma_f32_16x16x32_bf16 v[26:29], v[78:81], v[58:61], v[26:29]
    v_mfma_f32_16x16x32_bf16 v[30:33], v[78:81], v[62:65], v[30:33]
    s_waitcnt lgkmcnt(0)
    v_mfma_f32_16x16x32_bf16 v[2:5], v[66:69], v[34:37], v[2:5]
    ds_read_b64_tr_b16 v[74:75], v92 offset:4096
    ds_read_b64_tr_b16 v[76:77], v92 offset:4608
    v_mfma_f32_16x16x32_bf16 v[6:9], v[66:69], v[38:41], v[6:9]
    ds_read_b64_tr_b16 v[78:79], v93 offset:4096
    ds_read_b64_tr_b16 v[80:81], v93 offset:4608
    v_mfma_f32_16x16x32_bf16 v[10:13], v[66:69], v[42:45], v[10:13]
    ds_read_b64_tr_b16 v[50:51], v88 offset:8192
    ds_read_b64_tr_b16 v[52:53], v88 offset:9216
    v_mfma_f32_16x16x32_bf16 v[14:17], v[66:69], v[46:49], v[14:17]
    ds_read_b64_tr_b16 v[54:55], v89 offset:8192
    ds_read_b64_tr_b16 v[56:57], v89 offset:9216
    v_mfma_f32_16x16x32_bf16 v[18:21], v[70:73], v[34:37], v[18:21]
    ds_read_b64_tr_b16 v[58:59], v90 offset:8192
    ds_read_b64_tr_b16 v[60:61], v90 offset:9216
    v_mfma_f32_16x16x32_bf16 v[22:25], v[70:73], v[38:41], v[22:25]
    ds_read_b64_tr_b16 v[62:63], v91 offset:8192
    ds_read_b64_tr_b16 v[64:65], v91 offset:9216
    v_mfma_f32_16x16x32_bf16 v[26:29], v[70:73], v[42:45], v[26:29]
    v_mfma_f32_16x16x32_bf16 v[30:33], v[70:73], v[46:49], v[30:33]
    s_add_u32 s47, s47, 1
    s_cmp_eq_u32 s47, 6
    s_mov_b32 s49, 24576
    s_cmov_b32 s49, 0xfffe2000
    s_cmov_b32 s47, 0
    s_waitcnt lgkmcnt(0)
    v_add_u32 v88, s49, v88
    v_add_u32 v89, s49, v89
    v_add_u32 v90, s49, v90
    v_add_u32 v91, s49, v91
    v_add_u32 v92, s49, v92
    v_add_u32 v93, s49, v93
    s_waitcnt vmcnt(18)
    s_barrier
    v_mfma_f32_16x16x32_bf16 v[2:5], v[74:77], v[50:53], v[2:5]
    ds_read_b64_tr_b16 v[66:67], v92 offset:0
    ds_read_b64_tr_b16 v[68:69], v92 offset:512
    v_mfma_f32_16x16x32_bf16 v[6:9], v[74:77], v[54:57], v[6:9]
    ds_read_b64_tr_b16 v[70:71], v93 offset:0
    ds_read_b64_tr_b16 v[72:73], v93 offset:512
    v_mfma_f32_16x16x32_bf16 v[10:13], v[74:77], v[58:61], v[10:13]
    ds_read_b64_tr_b16 v[34:35], v88 offset:0
    ds_read_b64_tr_b16 v[36:37], v88 offset:1024
    v_mfma_f32_16x16x32_bf16 v[14:17], v[74:77], v[62:65], v[14:17]
    ds_read_b64_tr_b16 v[38:39], v89 offset:0
    ds_read_b64_tr_b16 v[40:41], v89 offset:1024
    v_mfma_f32_16x16x32_bf16 v[18:21], v[78:81], v[50:53], v[18:21]
    ds_read_b64_tr_b16 v[42:43], v90 offset:0
    ds_read_b64_tr_b16 v[44:45], v90 offset:1024
    v_mfma_f32_16x16x32_bf16 v[22:25], v[78:81], v[54:57], v[22:25]
    ds_read_b64_tr_b16 v[46:47], v91 offset:0
    ds_read_b64_tr_b16 v[48:49], v91 offset:1024
    v_mfma_f32_16x16x32_bf16 v[26:29], v[78:81], v[58:61], v[26:29]
    v_mfma_f32_16x16x32_bf16 v[30:33], v[78:81], v[62:65], v[30:33]
    s_waitcnt lgkmcnt(0)
    v_mfma_f32_16x16x32_bf16 v[2:5], v[66:69], v[34:37], v[2:5]
    ds_read_b64_tr_b16 v[74:75], v92 offset:4096
    ds_read_b64_tr_b16 v[76:77], v92 offset:4608
    v_mfma_f32_16x16x32_bf16 v[6:9], v[66:69], v[38:41], v[6:9]
    ds_read_b64_tr_b16 v[78:79], v93 offset:4096
    ds_read_b64_tr_b16 v[80:81], v93 offset:4608
    v_mfma_f32_16x16x32_bf16 v[10:13], v[66:69], v[42:45], v[10:13]
    ds_read_b64_tr_b16 v[50:51], v88 offset:8192
    ds_read_b64_tr_b16 v[52:53], v88 offset:9216
    v_mfma_f32_16x16x32_bf16 v[14:17], v[66:69], v[46:49], v[14:17]
    ds_read_b64_tr_b16 v[54:55], v89 offset:8192
    ds_read_b64_tr_b16 v[56:57], v89 offset:9216
    v_mfma_f32_16x16x32_bf16 v[18:21], v[70:73], v[34:37], v[18:21]
    ds_read_b64_tr_b16 v[58:59], v90 offset:8192
    ds_read_b64_tr_b16 v[60:61], v90 offset:9216
    v_mfma_f32_16x16x32_bf16 v[22:25], v[70:73], v[38:41], v[22:25]
    ds_read_b64_tr_b16 v[62:63], v91 offset:8192
    ds_read_b64_tr_b16 v[64:65], v91 offset:9216
    v_mfma_f32_16x16x32_bf16 v[26:29], v[70:73], v[42:45], v[26:29]
    v_mfma_f32_16x16x32_bf16 v[30:33], v[70:73], v[46:49], v[30:33]
    s_add_u32 s47, s47, 1
    s_cmp_eq_u32 s47, 6
    s_mov_b32 s49, 24576
    s_cmov_b32 s49, 0xfffe2000
    s_cmov_b32 s47, 0
    s_waitcnt lgkmcnt(0)
    v_add_u32 v88, s49, v88
    v_add_u32 v89, s49, v89
    v_add_u32 v90, s49, v90
    v_add_u32 v91, s49, v91
    v_add_u32 v92, s49, v92
    v_add_u32 v93, s49, v93
    s_waitcnt vmcnt(12)
    s_barrier
    v_mfma_f32_16x16x32_bf16 v[2:5], v[74:77], v[50:53], v[2:5]
    ds_read_b64_tr_b16 v[66:67], v92 offset:0
    ds_read_b64_tr_b16 v[68:69], v92 offset:512
    v_mfma_f32_16x16x32_bf16 v[6:9], v[74:77], v[54:57], v[6:9]
    ds_read_b64_tr_b16 v[70:71], v93 offset:0
    ds_read_b64_tr_b16 v[72:73], v93 offset:512
    v_mfma_f32_16x16x32_bf16 v[10:13], v[74:77], v[58:61], v[10:13]
    ds_read_b64_tr_b16 v[34:35], v88 offset:0
    ds_read_b64_tr_b16 v[36:37], v88 offset:1024
    v_mfma_f32_16x16x32_bf16 v[14:17], v[74:77], v[62:65], v[14:17]
    ds_read_b64_tr_b16 v[38:39], v89 offset:0
    ds_read_b64_tr_b16 v[40:41], v89 offset:1024
    v_mfma_f32_16x16x32_bf16 v[18:21], v[78:81], v[50:53], v[18:21]
    ds_read_b64_tr_b16 v[42:43], v90 offset:0
    ds_read_b64_tr_b16 v[44:45], v90 offset:1024
    v_mfma_f32_16x16x32_bf16 v[22:25], v[78:81], v[54:57], v[22:25]
    ds_read_b64_tr_b16 v[46:47], v91 offset:0
    ds_read_b64_tr_b16 v[48:49], v91 offset:1024
    v_mfma_f32_16x16x32_bf16 v[26:29], v[78:81], v[58:61], v[26:29]
    v_mfma_f32_16x16x32_bf16 v[30:33], v[78:81], v[62:65], v[30:33]
    s_waitcnt lgkmcnt(0)
    v_mfma_f32_16x16x32_bf16 v[2:5], v[66:69], v[34:37], v[2:5]
    ds_read_b64_tr_b16 v[74:75], v92 offset:4096
    ds_read_b64_tr_b16 v[76:77], v92 offset:4608
    v_mfma_f32_16x16x32_bf16 v[6:9], v[66:69], v[38:41], v[6:9]
    ds_read_b64_tr_b16 v[78:79], v93 offset:4096
    ds_read_b64_tr_b16 v[80:81], v93 offset:4608
    v_mfma_f32_16x16x32_bf16 v[10:13], v[66:69], v[42:45], v[10:13]
    ds_read_b64_tr_b16 v[50:51], v88 offset:8192
    ds_read_b64_tr_b16 v[52:53], v88 offset:9216
    v_mfma_f32_16x16x32_bf16 v[14:17], v[66:69], v[46:49], v[14:17]
    ds_read_b64_tr_b16 v[54:55], v89 offset:8192
    ds_read_b64_tr_b16 v[56:57], v89 offset:9216
    v_mfma_f32_16x16x32_bf16 v[18:21], v[70:73], v[34:37], v[18:21]
    ds_read_b64_tr_b16 v[58:59], v90 offset:8192
    ds_read_b64_tr_b16 v[60:61], v90 offset:9216
    v_mfma_f32_16x16x32_bf16 v[22:25], v[70:73], v[38:41], v[22:25]
    ds_read_b64_tr_b16 v[62:63], v91 offset:8192
    ds_read_b64_tr_b16 v[64:65], v91 offset:9216
    v_mfma_f32_16x16x32_bf16 v[26:29], v[70:73], v[42:45], v[26:29]
    v_mfma_f32_16x16x32_bf16 v[30:33], v[70:73], v[46:49], v[30:33]
    s_add_u32 s47, s47, 1
    s_cmp_eq_u32 s47, 6
    s_mov_b32 s49, 24576
    s_cmov_b32 s49, 0xfffe2000
    s_cmov_b32 s47, 0
    s_waitcnt lgkmcnt(0)
    v_add_u32 v88, s49, v88
    v_add_u32 v89, s49, v89
    v_add_u32 v90, s49, v90
    v_add_u32 v91, s49, v91
    v_add_u32 v92, s49, v92
    v_add_u32 v93, s49, v93
    s_waitcnt vmcnt(6)
    s_barrier
    v_mfma_f32_16x16x32_bf16 v[2:5], v[74:77], v[50:53], v[2:5]
    ds_read_b64_tr_b16 v[66:67], v92 offset:0
    ds_read_b64_tr_b16 v[68:69], v92 offset:512
    v_mfma_f32_16x16x32_bf16 v[6:9], v[74:77], v[54:57], v[6:9]
    ds_read_b64_tr_b16 v[70:71], v93 offset:0
    ds_read_b64_tr_b16 v[72:73], v93 offset:512
    v_mfma_f32_16x16x32_bf16 v[10:13], v[74:77], v[58:61], v[10:13]
    ds_read_b64_tr_b16 v[34:35], v88 offset:0
    ds_read_b64_tr_b16 v[36:37], v88 offset:1024
    v_mfma_f32_16x16x32_bf16 v[14:17], v[74:77], v[62:65], v[14:17]
    ds_read_b64_tr_b16 v[38:39], v89 offset:0
    ds_read_b64_tr_b16 v[40:41], v89 offset:1024
    v_mfma_f32_16x16x32_bf16 v[18:21], v[78:81], v[50:53], v[18:21]
    ds_read_b64_tr_b16 v[42:43], v90 offset:0
    ds_read_b64_tr_b16 v[44:45], v90 offset:1024
    v_mfma_f32_16x16x32_bf16 v[22:25], v[78:81], v[54:57], v[22:25]
    ds_read_b64_tr_b16 v[46:47], v91 offset:0
    ds_read_b64_tr_b16 v[48:49], v91 offset:1024
    v_mfma_f32_16x16x32_bf16 v[26:29], v[78:81], v[58:61], v[26:29]
    v_mfma_f32_16x16x32_bf16 v[30:33], v[78:81], v[62:65], v[30:33]
    s_waitcnt lgkmcnt(0)
    v_mfma_f32_16x16x32_bf16 v[2:5], v[66:69], v[34:37], v[2:5]
    ds_read_b64_tr_b16 v[74:75], v92 offset:4096
    ds_read_b64_tr_b16 v[76:77], v92 offset:4608
    v_mfma_f32_16x16x32_bf16 v[6:9], v[66:69], v[38:41], v[6:9]
    ds_read_b64_tr_b16 v[78:79], v93 offset:4096
    ds_read_b64_tr_b16 v[80:81], v93 offset:4608
    v_mfma_f32_16x16x32_bf16 v[10:13], v[66:69], v[42:45], v[10:13]
    ds_read_b64_tr_b16 v[50:51], v88 offset:8192
    ds_read_b64_tr_b16 v[52:53], v88 offset:9216
    v_mfma_f32_16x16x32_bf16 v[14:17], v[66:69], v[46:49], v[14:17]
    ds_read_b64_tr_b16 v[54:55], v89 offset:8192
    ds_read_b64_tr_b16 v[56:57], v89 offset:9216
    v_mfma_f32_16x16x32_bf16 v[18:21], v[70:73], v[34:37], v[18:21]
    ds_read_b64_tr_b16 v[58:59], v90 offset:8192
    ds_read_b64_tr_b16 v[60:61], v90 offset:9216
    v_mfma_f32_16x16x32_bf16 v[22:25], v[70:73], v[38:41], v[22:25]
    ds_read_b64_tr_b16 v[62:63], v91 offset:8192
    ds_read_b64_tr_b16 v[64:65], v91 offset:9216
    v_mfma_f32_16x16x32_bf16 v[26:29], v[70:73], v[42:45], v[26:29]
    v_mfma_f32_16x16x32_bf16 v[30:33], v[70:73], v[46:49], v[30:33]
    s_add_u32 s47, s47, 1
    s_cmp_eq_u32 s47, 6
    s_mov_b32 s49, 24576
    s_cmov_b32 s49, 0xfffe2000
    s_cmov_b32 s47, 0
    s_waitcnt lgkmcnt(0)
    v_add_u32 v88, s49, v88
    v_add_u32 v89, s49, v89
    v_add_u32 v90, s49, v90
    v_add_u32 v91, s49, v91
    v_add_u32 v92, s49, v92
    v_add_u32 v93, s49, v93
    s_waitcnt vmcnt(0)
    s_barrier
    v_mfma_f32_16x16x32_bf16 v[2:5], v[74:77], v[50:53], v[2:5]
    ds_read_b64_tr_b16 v[66:67], v92 offset:0
    ds_read_b64_tr_b16 v[68:69], v92 offset:512
    v_mfma_f32_16x16x32_bf16 v[6:9], v[74:77], v[54:57], v[6:9]
    ds_read_b64_tr_b16 v[70:71], v93 offset:0
    ds_read_b64_tr_b16 v[72:73], v93 offset:512
    v_mfma_f32_16x16x32_bf16 v[10:13], v[74:77], v[58:61], v[10:13]
    ds_read_b64_tr_b16 v[34:35], v88 offset:0
    ds_read_b64_tr_b16 v[36:37], v88 offset:1024
    v_mfma_f32_16x16x32_bf16 v[14:17], v[74:77], v[62:65], v[14:17]
    ds_read_b64_tr_b16 v[38:39], v89 offset:0
    ds_read_b64_tr_b16 v[40:41], v89 offset:1024
    v_mfma_f32_16x16x32_bf16 v[18:21], v[78:81], v[50:53], v[18:21]
    ds_read_b64_tr_b16 v[42:43], v90 offset:0
    ds_read_b64_tr_b16 v[44:45], v90 offset:1024
    v_mfma_f32_16x16x32_bf16 v[22:25], v[78:81], v[54:57], v[22:25]
    ds_read_b64_tr_b16 v[46:47], v91 offset:0
    ds_read_b64_tr_b16 v[48:49], v91 offset:1024
    v_mfma_f32_16x16x32_bf16 v[26:29], v[78:81], v[58:61], v[26:29]
    v_mfma_f32_16x16x32_bf16 v[30:33], v[78:81], v[62:65], v[30:33]
    s_waitcnt lgkmcnt(0)
    v_mfma_f32_16x16x32_bf16 v[2:5], v[66:69], v[34:37], v[2:5]
    ds_read_b64_tr_b16 v[74:75], v92 offset:4096
    ds_read_b64_tr_b16 v[76:77], v92 offset:4608
    v_mfma_f32_16x16x32_bf16 v[6:9], v[66:69], v[38:41], v[6:9]
    ds_read_b64_tr_b16 v[78:79], v93 offset:4096
    ds_read_b64_tr_b16 v[80:81], v93 offset:4608
    v_mfma_f32_16x16x32_bf16 v[10:13], v[66:69], v[42:45], v[10:13]
    ds_read_b64_tr_b16 v[50:51], v88 offset:8192
    ds_read_b64_tr_b16 v[52:53], v88 offset:9216
    v_mfma_f32_16x16x32_bf16 v[14:17], v[66:69], v[46:49], v[14:17]
    ds_read_b64_tr_b16 v[54:55], v89 offset:8192
    ds_read_b64_tr_b16 v[56:57], v89 offset:9216
    v_mfma_f32_16x16x32_bf16 v[18:21], v[70:73], v[34:37], v[18:21]
    ds_read_b64_tr_b16 v[58:59], v90 offset:8192
    ds_read_b64_tr_b16 v[60:61], v90 offset:9216
    v_mfma_f32_16x16x32_bf16 v[22:25], v[70:73], v[38:41], v[22:25]
    ds_read_b64_tr_b16 v[62:63], v91 offset:8192
    ds_read_b64_tr_b16 v[64:65], v91 offset:9216
    v_mfma_f32_16x16x32_bf16 v[26:29], v[70:73], v[42:45], v[26:29]
    v_mfma_f32_16x16x32_bf16 v[30:33], v[70:73], v[46:49], v[30:33]
    s_waitcnt lgkmcnt(0)
    v_mfma_f32_16x16x32_bf16 v[2:5], v[74:77], v[50:53], v[2:5]
    v_mfma_f32_16x16x32_bf16 v[6:9], v[74:77], v[54:57], v[6:9]
    v_mfma_f32_16x16x32_bf16 v[10:13], v[74:77], v[58:61], v[10:13]
    v_mfma_f32_16x16x32_bf16 v[14:17], v[74:77], v[62:65], v[14:17]
    v_mfma_f32_16x16x32_bf16 v[18:21], v[78:81], v[50:53], v[18:21]
    v_mfma_f32_16x16x32_bf16 v[22:25], v[78:81], v[54:57], v[22:25]
    v_mfma_f32_16x16x32_bf16 v[26:29], v[78:81], v[58:61], v[26:29]
    v_mfma_f32_16x16x32_bf16 v[30:33], v[78:81], v[62:65], v[30:33]
    s_waitcnt vmcnt(0)
    s_nop 7
    s_nop 3
    s_mov_b32 s50, 6912
    v_mul_lo_u32 v98, v95, s50
    v_lshl_add_u32 v98, v96, 4, v98
    s_mul_i32 s48, s41, 442368
    s_mul_i32 s49, s42, 128
    s_add_u32 s48, s48, s49
    s_add_u32 s48, s48, s20
    buffer_store_dwordx4 v[2:5], v98, s[4:7], s48 offen offset:0 sc1
    buffer_store_dwordx4 v[18:21], v98, s[4:7], s48 offen offset:64 sc1
    s_add_u32 s48, s48, 110592
    buffer_store_dwordx4 v[6:9], v98, s[4:7], s48 offen offset:0 sc1
    buffer_store_dwordx4 v[22:25], v98, s[4:7], s48 offen offset:64 sc1
    s_add_u32 s48, s48, 110592
    buffer_store_dwordx4 v[10:13], v98, s[4:7], s48 offen offset:0 sc1
    buffer_store_dwordx4 v[26:29], v98, s[4:7], s48 offen offset:64 sc1
    s_add_u32 s48, s48, 110592
    buffer_store_dwordx4 v[14:17], v98, s[4:7], s48 offen offset:0 sc1
    buffer_store_dwordx4 v[30:33], v98, s[4:7], s48 offen offset:64 sc1
    s_add_u32 s48, s48, 110592
    s_mov_b32 s77, 821248
    s_waitcnt vmcnt(0)
    s_barrier
    s_cmp_lg_u32 s26, 0
    s_cbranch_scc1 L_sig_158
    v_mov_b32 v1, 0
    v_mov_b32 v2, 1
    s_mov_b64 exec, 1
    buffer_atomic_add v2, v1, s[4:7], s77 offen
    s_mov_b64 exec, -1
L_sig_158:
    s_branch L_next_104
L_m1b_108:
    s_load_dwordx2 s[8:9], s[0:1], 64
    s_load_dwordx2 s[12:13], s[0:1], 72
    s_mul_hi_u32 s16, s76, 0x33333334
    s_mul_i32 s17, s16, 5
    s_sub_u32 s17, s76, s17
    v_and_b32 v94, 63, v0
    v_and_b32 v95, 15, v94
    v_lshrrev_b32 v96, 4, v94
    v_lshrrev_b32 v97, 6, v0
    s_nop 0
    v_readfirstlane_b32 s40, v97
    s_nop 0
    s_and_b32 s41, s40, 1
    s_lshr_b32 s42, s40, 1
    s_waitcnt lgkmcnt(0)
    s_and_b32 s9, s9, 0xffff
    s_mov_b32 s10, 7077888
    s_mov_b32 s11, 0x20000
    s_and_b32 s13, s13, 0xffff
    s_mov_b32 s14, 3456
    s_mov_b32 s15, 0x20000
    s_mul_i32 s48, s40, 4
    s_add_u32 s48, s48, 0
    v_lshrrev_b32 v98, 4, v94
    s_mul_i32 s49, s48, 4
    v_add_u32 v98, s49, v98
    v_and_b32 v99, 15, v94
    v_and_b32 v100, 3, v98
    v_bfe_u32 v101, v98, 3, 1
    v_lshl_add_u32 v100, v101, 2, v100
    v_lshlrev_b32 v100, 1, v100
    v_xor_b32 v99, v99, v100
    s_mov_b32 s49, 1280
    v_mul_lo_u32 v98, v98, s49
    v_lshl_add_u32 v82, v99, 4, v98
    s_mul_i32 s48, s40, 4
    s_add_u32 s48, s48, 1
    v_lshrrev_b32 v98, 4, v94
    s_mul_i32 s49, s48, 4
    v_add_u32 v98, s49, v98
    v_and_b32 v99, 15, v94
    v_and_b32 v100, 3, v98
    v_bfe_u32 v101, v98, 3, 1
    v_lshl_add_u32 v100, v101, 2, v100
    v_lshlrev_b32 v100, 1, v100
    v_xor_b32 v99, v99, v100
    s_mov_b32 s49, 1280
    v_mul_lo_u32 v98, v98, s49
    v_lshl_add_u32 v83, v99, 4, v98
    s_mul_i32 s48, s40, 4
    s_add_u32 s48, s48, 2
    v_lshrrev_b32 v98, 4, v94
    s_mul_i32 s49, s48, 4
    v_add_u32 v98, s49, v98
    v_and_b32 v99, 15, v94
    v_and_b32 v100, 3, v98
    v_bfe_u32 v101, v98, 3, 1
    v_lshl_add_u32 v100, v101, 2, v100
    v_lshlrev_b32 v100, 1, v100
    v_xor_b32 v99, v99, v100
    s_mov_b32 s49, 1280
    v_mul_lo_u32 v98, v98, s49
    v_lshl_add_u32 v84, v99, 4, v98
    s_mul_i32 s48, s40, 4
    s_add_u32 s48, s48, 3
    v_lshrrev_b32 v98, 4, v94
    s_mul_i32 s49, s48, 4
    v_add_u32 v98, s49, v98
    v_and_b32 v99, 15, v94
    v_and_b32 v100, 3, v98
    v_bfe_u32 v101, v98, 3, 1
    v_lshl_add_u32 v100, v101, 2, v100
    v_lshlrev_b32 v100, 1, v100
    v_xor_b32 v99, v99, v100
    s_mov_b32 s49, 1280
    v_mul_lo_u32 v98, v98, s49
    v_lshl_add_u32 v85, v99, 4, v98
    s_mul_i32 s48, s40, 2
    s_add_u32 s48, s48, 0
    v_lshrrev_b32 v98, 3, v94
    s_lshl_b32 s49, s48, 3
    v_add_u32 v98, s49, v98
    v_and_b32 v99, 7, v94
    v_bfe_u32 v100, v98, 1, 1
    v_bfe_u32 v101, v98, 3, 1
    v_lshl_add_u32 v100, v101, 1, v100
    v_lshlrev_b32 v100, 1, v100
    v_xor_b32 v99, v99, v100
    s_mov_b32 s49, 3456
    v_mul_lo_u32 v98, v98, s49
    v_lshl_add_u32 v86, v99, 4, v98
    s_mul_i32 s48, s40, 2
    s_add_u32 s48, s48, 1
    v_lshrrev_b32 v98, 3, v94
    s_lshl_b32 s49, s48, 3
    v_add_u32 v98, s49, v98
    v_and_b32 v99, 7, v94
    v_bfe_u32 v100, v98, 1, 1
    v_bfe_u32 v101, v98, 3, 1
    v_lshl_add_u32 v100, v101, 1, v100
    v_lshlrev_b32 v100, 1, v100
    v_xor_b32 v99, v99, v100
    s_mov_b32 s49, 3456
    v_mul_lo_u32 v98, v98, s49
    v_lshl_add_u32 v87, v99, 4, v98
    v_lshrrev_b32 v98, 2, v95
    v_and_b32 v99, 3, v95
    v_and_b32 v101, 1, v96
    v_lshl_add_u32 v100, v101, 2, v98
    v_lshlrev_b32 v100, 1, v100
    v_lshrrev_b32 v101, 1, v99
    v_xor_b32 v100, v100, v101
    v_lshlrev_b32 v100, 4, v100
    v_and_b32 v101, 1, v99
    v_lshl_add_u32 v100, v101, 3, v100
    v_lshl_add_u32 v101, v96, 3, v98
    s_mov_b32 s48, 256
    v_mul_lo_u32 v101, v101, s48
    v_add_u32 v100, v100, v101
    s_mul_i32 s48, s41, 4
    s_add_u32 s48, s48, 0
    s_and_b32 s49, s48, 7
    s_lshl_b32 s49, s49, 5
    v_xor_b32 v88, s49, v100
    s_lshr_b32 s48, s48, 3
    s_lshl_b32 s48, s48, 8
    s_add_u32 s48, s48, 0
    v_add_u32 v88, s48, v88
    s_mul_i32 s48, s41, 4
    s_add_u32 s48, s48, 1
    s_and_b32 s49, s48, 7
    s_lshl_b32 s49, s49, 5
    v_xor_b32 v89, s49, v100
    s_lshr_b32 s48, s48, 3
    s_lshl_b32 s48, s48, 8
    s_add_u32 s48, s48, 0
    v_add_u32 v89, s48, v89
    s_mul_i32 s48, s41, 4
    s_add_u32 s48, s48, 2
    s_and_b32 s49, s48, 7
    s_lshl_b32 s49, s49, 5
    v_xor_b32 v90, s49, v100
    s_lshr_b32 s48, s48, 3
    s_lshl_b32 s48, s48, 8
    s_add_u32 s48, s48, 0
    v_add_u32 v90, s48, v90
    s_mul_i32 s48, s41, 4
    s_add_u32 s48, s48, 3
    s_and_b32 s49, s48, 7
    s_lshl_b32 s49, s49, 5
    v_xor_b32 v91, s49, v100
    s_lshr_b32 s48, s48, 3
    s_lshl_b32 s48, s48, 8
    s_add_u32 s48, s48, 0
    v_add_u32 v91, s48, v91
    v_lshrrev_b32 v98, 2, v95
    v_and_b32 v99, 3, v95
    v_lshrrev_b32 v100, 1, v98
    v_and_b32 v101, 1, v96
    v_lshl_add_u32 v100, v101, 1, v100
    v_lshlrev_b32 v100, 1, v100
    v_lshrrev_b32 v101, 1, v99
    v_xor_b32 v100, v100, v101
    v_lshlrev_b32 v100, 4, v100
    v_and_b32 v101, 1, v99
    v_lshl_add_u32 v100, v101, 3, v100
    v_lshl_add_u32 v101, v96, 3, v98
    s_mov_b32 s48, 128
    v_mul_lo_u32 v101, v101, s48
    v_add_u32 v100, v100, v101
    s_mul_i32 s48, s42, 2
    s_add_u32 s48, s48, 0
    s_and_b32 s49, s48, 3
    s_lshl_b32 s49, s49, 5
    v_xor_b32 v92, s49, v100
    s_lshr_b32 s48, s48, 3
    s_lshl_b32 s48, s48, 8
    s_add_u32 s48, s48, 16384
    v_add_u32 v92, s48, v92
    s_mul_i32 s48, s42, 2
    s_add_u32 s48, s48, 1
    s_and_b32 s49, s48, 3
    s_lshl_b32 s49, s49, 5
    v_xor_b32 v93, s49, v100
    s_lshr_b32 s48, s48, 3
    s_lshl_b32 s48, s48, 8
    s_add_u32 s48, s48, 16384
    v_add_u32 v93, s48, v93
    s_lshl_b32 s48, s16, 7
    s_mul_i32 s49, s42, 64
    s_add_u32 s48, s48, s49
    v_lshlrev_b32 v102, 3, v96
    buffer_load_dwordx2 v[106:107], v102, s[12:15], s48 offen offset:0
    buffer_load_dwordx2 v[110:111], v102, s[12:15], s48 offen offset:32
    s_mov_b32 s77, 821248
    s_cmp_lg_u32 s26, 0
    s_cbranch_scc1 L_wgw_159
    s_mov_b32 s79, 0x200000
    v_mov_b32 v102, 0
L_cw_160:
    buffer_load_dword v103, v102, s[4:7], s77 offen sc1
    s_waitcnt vmcnt(0)
    v_readfirstlane_b32 s78, v103
    s_nop 0
    s_cmp_ge_u32 s78, 135
    s_cbranch_scc1 L_cd_161
    s_sleep 2
    s_sub_u32 s79, s79, 1
    s_cbranch_scc0 L_cw_160
L_cd_161:
L_wgw_159:
    s_barrier
    s_mul_i32 s20, s17, 884736
    s_lshl_b32 s21, s16, 8
    s_add_u32 s20, s20, s21
    s_add_u32 s20, s20, 153092096
    s_mov_b32 s50, 6912
    v_mul_lo_u32 v98, v95, s50
    v_lshl_add_u32 v98, v96, 4, v98
    s_mul_i32 s48, s41, 442368
    s_mul_i32 s49, s42, 128
    s_add_u32 s48, s48, s49
    s_add_u32 s48, s48, s20
    buffer_load_dwordx4 v[2:5], v98, s[4:7], s48 offen offset:0 sc1
    buffer_load_dwordx4 v[18:21], v98, s[4:7], s48 offen offset:64 sc1
    s_add_u32 s48, s48, 110592
    buffer_load_dwordx4 v[6:9], v98, s[4:7], s48 offen offset:0 sc1
    buffer_load_dwordx4 v[22:25], v98, s[4:7], s48 offen offset:64 sc1
    s_add_u32 s48, s48, 110592
    buffer_load_dwordx4 v[10:13], v98, s[4:7], s48 offen offset:0 sc1
    buffer_load_dwordx4 v[26:29], v98, s[4:7], s48 offen offset:64 sc1
    s_add_u32 s48, s48, 110592
    buffer_load_dwordx4 v[14:17], v98, s[4:7], s48 offen offset:0 sc1
    buffer_load_dwordx4 v[30:33], v98, s[4:7], s48 offen offset:64 sc1
    s_add_u32 s48, s48, 110592
    s_lshl_b32 s43, s17, 8
    s_add_u32 s43, s43, 8978432
    s_lshl_b32 s44, s16, 7
    s_add_u32 s44, s44, 4423680
    s_mul_i32 s54, s40, 4096
    s_mul_i32 s55, s40, 2048
    s_mov_b32 s46, 0
    s_mov_b32 s51, 0
    s_mov_b32 s52, s54
    s_mov_b32 s53, s55
    s_add_u32 s50, s44, 0
    s_add_u32 s53, s55, 0
    s_add_u32 m0, s53, 16384
    s_nop 0
    buffer_load_dwordx4 v86, s[8:11], s50 offen lds
    s_add_u32 m0, s53, 17408
    s_nop 0
    buffer_load_dwordx4 v87, s[8:11], s50 offen lds
    s_add_u32 s50, s44, 221184
    s_add_u32 s53, s55, 24576
    s_add_u32 m0, s53, 16384
    s_nop 0
    buffer_load_dwordx4 v86, s[8:11], s50 offen lds
    s_add_u32 m0, s53, 17408
    s_nop 0
    buffer_load_dwordx4 v87, s[8:11], s50 offen lds
    s_add_u32 s50, s44, 442368
    s_add_u32 s53, s55, 49152
    s_add_u32 m0, s53, 16384
    s_nop 0
    buffer_load_dwordx4 v86, s[8:11], s50 offen lds
    s_add_u32 m0, s53, 17408
    s_nop 0
    buffer_load_dwordx4 v87, s[8:11], s50 offen lds
    s_add_u32 s50, s44, 663552
    s_add_u32 s53, s55, 73728
    s_add_u32 m0, s53, 16384
    s_nop 0
    buffer_load_dwordx4 v86, s[8:11], s50 offen lds
    s_add_u32 m0, s53, 17408
    s_nop 0
    buffer_load_dwordx4 v87, s[8:11], s50 offen lds
    s_add_u32 s50, s44, 884736
    s_add_u32 s53, s55, 98304
    s_add_u32 m0, s53, 16384
    s_nop 0
    buffer_load_dwordx4 v86, s[8:11], s50 offen lds
    s_add_u32 m0, s53, 17408
    s_nop 0
    buffer_load_dwordx4 v87, s[8:11], s50 offen lds
    s_add_u32 s50, s44, 1105920
    s_add_u32 s53, s55, 122880
    s_add_u32 m0, s53, 16384
    s_nop 0
    buffer_load_dwordx4 v86, s[8:11], s50 offen lds
    s_add_u32 m0, s53, 17408
    s_nop 0
    buffer_load_dwordx4 v87, s[8:11], s50 offen lds
    s_mov_b32 s77, 793856
    s_cmp_lg_u32 s26, 0
    s_cbranch_scc1 L_wgw_162
    s_mov_b32 s79, 0x200000
    v_mov_b32 v102, 0
L_cw_163:
    buffer_load_dword v103, v102, s[4:7], s77 offen sc1
    s_waitcnt vmcnt(0)
    v_readfirstlane_b32 s78, v103
    s_nop 0
    s_cmp_ge_u32 s78, 32
    s_cbranch_scc1 L_cd_164
    s_sleep 2
    s_sub_u32 s79, s79, 1
    s_cbranch_scc0 L_cw_163
L_cd_164:
L_wgw_162:
    s_barrier
    s_mov_b32 s77, 793984
    s_cmp_lg_u32 s26, 0
    s_cbranch_scc1 L_wgw_165
    s_mov_b32 s79, 0x200000
    v_mov_b32 v102, 0
L_cw_166:
    buffer_load_dword v103, v102, s[4:7], s77 offen sc1
    s_waitcnt vmcnt(0)
    v_readfirstlane_b32 s78, v103
    s_nop 0
    s_cmp_ge_u32 s78, 32
    s_cbranch_scc1 L_cd_167
    s_sleep 2
    s_sub_u32 s79, s79, 1
    s_cbranch_scc0 L_cw_166
L_cd_167:
L_wgw_165:
    s_barrier
    s_mov_b32 s77, 794112
    s_cmp_lg_u32 s26, 0
    s_cbranch_scc1 L_wgw_168
    s_mov_b32 s79, 0x200000
    v_mov_b32 v102, 0
L_cw_169:
    buffer_load_dword v103, v102, s[4:7], s77 offen sc1
    s_waitcnt vmcnt(0)
    v_readfirstlane_b32 s78, v103
    s_nop 0
    s_cmp_ge_u32 s78, 32
    s_cbranch_scc1 L_cd_170
    s_sleep 2
    s_sub_u32 s79, s79, 1
    s_cbranch_scc0 L_cw_169
L_cd_170:
L_wgw_168:
    s_barrier
    s_mov_b32 s77, 794240
    s_cmp_lg_u32 s26, 0
    s_cbranch_scc1 L_wgw_171
    s_mov_b32 s79, 0x200000
    v_mov_b32 v102, 0
L_cw_172:
    buffer_load_dword v103, v102, s[4:7], s77 offen sc1
    s_waitcnt vmcnt(0)
    v_readfirstlane_b32 s78, v103
    s_nop 0
    s_cmp_ge_u32 s78, 32
    s_cbranch_scc1 L_cd_173
    s_sleep 2
    s_sub_u32 s79, s79, 1
    s_cbranch_scc0 L_cw_172
L_cd_173:
L_wgw_171:
    s_barrier
    s_mov_b32 s77, 794368
    s_cmp_lg_u32 s26, 0
    s_cbranch_scc1 L_wgw_174
    s_mov_b32 s79, 0x200000
    v_mov_b32 v102, 0
L_cw_175:
    buffer_load_dword v103, v102, s[4:7], s77 offen sc1
    s_waitcnt vmcnt(0)
    v_readfirstlane_b32 s78, v103
    s_nop 0
    s_cmp_ge_u32 s78, 32
    s_cbranch_scc1 L_cd_176
    s_sleep 2
    s_sub_u32 s79, s79, 1
    s_cbranch_scc0 L_cw_175
L_cd_176:
L_wgw_174:
    s_barrier
    s_add_u32 s50, s43, 0
    s_add_u32 s52, s54, 0
    s_add_u32 m0, s52, 0
    s_nop 0
    buffer_load_dwordx4 v82, s[4:7], s50 offen sc1 lds
    s_add_u32 m0, s52, 1024
    s_nop 0
    buffer_load_dwordx4 v83, s[4:7], s50 offen sc1 lds
    s_add_u32 m0, s52, 2048
    s_nop 0
    buffer_load_dwordx4 v84, s[4:7], s50 offen sc1 lds
    s_add_u32 m0, s52, 3072
    s_nop 0
    buffer_load_dwordx4 v85, s[4:7], s50 offen sc1 lds
    s_add_u32 s50, s43, 81920
    s_add_u32 s52, s54, 24576
    s_add_u32 m0, s52, 0
    s_nop 0
    buffer_load_dwordx4 v82, s[4:7], s50 offen sc1 lds
    s_add_u32 m0, s52, 1024
    s_nop 0
    buffer_load_dwordx4 v83, s[4:7], s50 offen sc1 lds
    s_add_u32 m0, s52, 2048
    s_nop 0
    buffer_load_dwordx4 v84, s[4:7], s50 offen sc1 lds
    s_add_u32 m0, s52, 3072
    s_nop 0
    buffer_load_dwordx4 v85, s[4:7], s50 offen sc1 lds
    s_add_u32 s50, s43, 163840
    s_add_u32 s52, s54, 49152
    s_add_u32 m0, s52, 0
    s_nop 0
    buffer_load_dwordx4 v82, s[4:7], s50 offen sc1 lds
    s_add_u32 m0, s52, 1024
    s_nop 0
    buffer_load_dwordx4 v83, s[4:7], s50 offen sc1 lds
    s_add_u32 m0, s52, 2048
    s_nop 0
    buffer_load_dwordx4 v84, s[4:7], s50 offen sc1 lds
    s_add_u32 m0, s52, 3072
    s_nop 0
    buffer_load_dwordx4 v85, s[4:7], s50 offen sc1 lds
    s_add_u32 s50, s43, 245760
    s_add_u32 s52, s54, 73728
    s_add_u32 m0, s52, 0
    s_nop 0
    buffer_load_dwordx4 v82, s[4:7], s50 offen sc1 lds
    s_add_u32 m0, s52, 1024
    s_nop 0
    buffer_load_dwordx4 v83, s[4:7], s50 offen sc1 lds
    s_add_u32 m0, s52, 2048
    s_nop 0
    buffer_load_dwordx4 v84, s[4:7], s50 offen sc1 lds
    s_add_u32 m0, s52, 3072
    s_nop 0
    buffer_load_dwordx4 v85, s[4:7], s50 offen sc1 lds
    s_add_u32 s50, s43, 327680
    s_add_u32 s52, s54, 98304
    s_add_u32 m0, s52, 0
    s_nop 0
    buffer_load_dwordx4 v82, s[4:7], s50 offen sc1 lds
    s_add_u32 m0, s52, 1024
    s_nop 0
    buffer_load_dwordx4 v83, s[4:7], s50 offen sc1 lds
    s_add_u32 m0, s52, 2048
    s_nop 0
    buffer_load_dwordx4 v84, s[4:7], s50 offen sc1 lds
    s_add_u32 m0, s52, 3072
    s_nop 0
    buffer_load_dwordx4 v85, s[4:7], s50 offen sc1 lds
    s_add_u32 s50, s43, 409600
    s_add_u32 s52, s54, 122880
    s_add_u32 m0, s52, 0
    s_nop 0
    buffer_load_dwordx4 v82, s[4:7], s50 offen sc1 lds
    s_add_u32 m0, s52, 1024
    s_nop 0
    buffer_load_dwordx4 v83, s[4:7], s50 offen sc1 lds
    s_add_u32 m0, s52, 2048
    s_nop 0
    buffer_load_dwordx4 v84, s[4:7], s50 offen sc1 lds
    s_add_u32 m0, s52, 3072
    s_nop 0
    buffer_load_dwordx4 v85, s[4:7], s50 offen sc1 lds
    s_add_u32 s43, s43, 81920
    s_add_u32 s44, s44, 221184
    s_add_u32 s51, s51, 1
    s_cmp_ge_u32 s51, 10
    s_cmov_b32 s43, 0x40000000
    s_cmov_b32 s44, 0x40000000
    s_add_u32 s46, s46, 24576
    s_cmp_eq_u32 s46, 147456
    s_cmov_b32 s46, 0
    s_add_u32 s52, s46, s54
    s_add_u32 s53, s46, s55
    s_add_u32 s43, s43, 81920
    s_add_u32 s44, s44, 221184
    s_add_u32 s51, s51, 1
    s_cmp_ge_u32 s51, 10
    s_cmov_b32 s43, 0x40000000
    s_cmov_b32 s44, 0x40000000
    s_add_u32 s46, s46, 24576
    s_cmp_eq_u32 s46, 147456
    s_cmov_b32 s46, 0
    s_add_u32 s52, s46, s54
    s_add_u32 s53, s46, s55
    s_add_u32 s43, s43, 81920
    s_add_u32 s44, s44, 221184
    s_add_u32 s51, s51, 1
    s_cmp_ge_u32 s51, 10
    s_cmov_b32 s43, 0x40000000
    s_cmov_b32 s44, 0x40000000
    s_add_u32 s46, s46, 24576
    s_cmp_eq_u32 s46, 147456
    s_cmov_b32 s46, 0
    s_add_u32 s52, s46, s54
    s_add_u32 s53, s46, s55
    s_add_u32 s43, s43, 81920
    s_add_u32 s44, s44, 221184
    s_add_u32 s51, s51, 1
    s_cmp_ge_u32 s51, 10
    s_cmov_b32 s43, 0x40000000
    s_cmov_b32 s44, 0x40000000
    s_add_u32 s46, s46, 24576
    s_cmp_eq_u32 s46, 147456
    s_cmov_b32 s46, 0
    s_add_u32 s52, s46, s54
    s_add_u32 s53, s46, s55
    s_add_u32 s43, s43, 81920
    s_add_u32 s44, s44, 221184
    s_add_u32 s51, s51, 1
    s_cmp_ge_u32 s51, 10
    s_cmov_b32 s43, 0x40000000
    s_cmov_b32 s44, 0x40000000
    s_add_u32 s46, s46, 24576
    s_cmp_eq_u32 s46, 147456
    s_cmov_b32 s46, 0
    s_add_u32 s52, s46, s54
    s_add_u32 s53, s46, s55
    s_add_u32 s43, s43, 81920
    s_add_u32 s44, s44, 221184
    s_add_u32 s51, s51, 1
    s_cmp_ge_u32 s51, 10
    s_cmov_b32 s43, 0x40000000
    s_cmov_b32 s44, 0x40000000
    s_add_u32 s46, s46, 24576
    s_cmp_eq_u32 s46, 147456
    s_cmov_b32 s46, 0
    s_add_u32 s52, s46, s54
    s_add_u32 s53, s46, s55
    s_mov_b32 s45, 0
    s_mov_b32 s47, 0
    s_waitcnt vmcnt(20)
    s_barrier
    ds_read_b64_tr_b16 v[66:67], v92 offset:0
    ds_read_b64_tr_b16 v[68:69], v92 offset:512
    ds_read_b64_tr_b16 v[70:71], v93 offset:0
    ds_read_b64_tr_b16 v[72:73], v93 offset:512
    ds_read_b64_tr_b16 v[34:35], v88 offset:0
    ds_read_b64_tr_b16 v[36:37], v88 offset:1024
    ds_read_b64_tr_b16 v[38:39], v89 offset:0
    ds_read_b64_tr_b16 v[40:41], v89 offset:1024
    ds_read_b64_tr_b16 v[42:43], v90 offset:0
    ds_read_b64_tr_b16 v[44:45], v90 offset:1024
    ds_read_b64_tr_b16 v[46:47], v91 offset:0
    ds_read_b64_tr_b16 v[48:49], v91 offset:1024
    s_waitcnt lgkmcnt(0)
    v_mfma_f32_16x16x32_bf16 v[2:5], v[66:69], v[34:37], v[2:5]
    ds_read_b64_tr_b16 v[74:75], v92 offset:4096
    ds_read_b64_tr_b16 v[76:77], v92 offset:4608
    v_mfma_f32_16x16x32_bf16 v[6:9], v[66:69], v[38:41], v[6:9]
    ds_read_b64_tr_b16 v[78:79], v93 offset:4096
    ds_read_b64_tr_b16 v[80:81], v93 offset:4608
    v_mfma_f32_16x16x32_bf16 v[10:13], v[66:69], v[42:45], v[10:13]
    ds_read_b64_tr_b16 v[50:51], v88 offset:8192
    ds_read_b64_tr_b16 v[52:53], v88 offset:9216
    v_mfma_f32_16x16x32_bf16 v[14:17], v[66:69], v[46:49], v[14:17]
    ds_read_b64_tr_b16 v[54:55], v89 offset:8192
    ds_read_b64_tr_b16 v[56:57], v89 offset:9216
    v_mfma_f32_16x16x32_bf16 v[18:21], v[70:73], v[34:37], v[18:21]
    ds_read_b64_tr_b16 v[58:59], v90 offset:8192
    ds_read_b64_tr_b16 v[60:61], v90 offset:9216
    v_mfma_f32_16x16x32_bf16 v[22:25], v[70:73], v[38:41], v[22:25]
    ds_read_b64_tr_b16 v[62:63], v91 offset:8192
    ds_read_b64_tr_b16 v[64:65], v91 offset:9216
    v_mfma_f32_16x16x32_bf16 v[26:29], v[70:73], v[42:45], v[26:29]
    v_mfma_f32_16x16x32_bf16 v[30:33], v[70:73], v[46:49], v[30:33]
    s_add_u32 s47, s47, 1
    s_cmp_eq_u32 s47, 6
    s_mov_b32 s49, 24576
    s_cmov_b32 s49, 0xfffe2000
    s_cmov_b32 s47, 0
    s_waitcnt lgkmcnt(0)
    v_add_u32 v88, s49, v88
    v_add_u32 v89, s49, v89
    v_add_u32 v90, s49, v90
    v_add_u32 v91, s49, v91
    v_add_u32 v92, s49, v92
    v_add_u32 v93, s49, v93
    s_waitcnt vmcnt(16)
    s_barrier
    v_mfma_f32_16x16x32_bf16 v[2:5], v[74:77], v[50:53], v[2:5]
    ds_read_b64_tr_b16 v[66:67], v92 offset:0
    ds_read_b64_tr_b16 v[68:69], v92 offset:512
    s_add_u32 m0, s52, 0
    s_nop 0
    buffer_load_dwordx4 v82, s[4:7], s43 offen sc1 lds
    v_mfma_f32_16x16x32_bf16 v[6:9], v[74:77], v[54:57], v[6:9]
    ds_read_b64_tr_b16 v[70:71], v93 offset:0
    ds_read_b64_tr_b16 v[72:73], v93 offset:512
    s_add_u32 m0, s52, 1024
    s_nop 0
    buffer_load_dwordx4 v83, s[4:7], s43 offen sc1 lds
    v_mfma_f32_16x16x32_bf16 v[10:13], v[74:77], v[58:61], v[10:13]
    ds_read_b64_tr_b16 v[34:35], v88 offset:0
    ds_read_b64_tr_b16 v[36:37], v88 offset:1024
    s_add_u32 m0, s52, 2048
    s_nop 0
    buffer_load_dwordx4 v84, s[4:7], s43 offen sc1 lds
    v_mfma_f32_16x16x32_bf16 v[14:17], v[74:77], v[62:65], v[14:17]
    ds_read_b64_tr_b16 v[38:39], v89 offset:0
    ds_read_b64_tr_b16 v[40:41], v89 offset:1024
    v_mfma_f32_16x16x32_bf16 v[18:21], v[78:81], v[50:53], v[18:21]
    ds_read_b64_tr_b16 v[42:43], v90 offset:0
    ds_read_b64_tr_b16 v[44:45], v90 offset:1024
    s_add_u32 m0, s52, 3072
    s_nop 0
    buffer_load_dwordx4 v85, s[4:7], s43 offen sc1 lds
    v_mfma_f32_16x16x32_bf16 v[22:25], v[78:81], v[54:57], v[22:25]
    ds_read_b64_tr_b16 v[46:47], v91 offset:0
    ds_read_b64_tr_b16 v[48:49], v91 offset:1024
    s_add_u32 m0, s53, 16384
    s_nop 0
    buffer_load_dwordx4 v86, s[8:11], s44 offen lds
    v_mfma_f32_16x16x32_bf16 v[26:29], v[78:81], v[58:61], v[26:29]
    s_add_u32 m0, s53, 17408
    s_nop 0
    buffer_load_dwordx4 v87, s[8:11], s44 offen lds
    v_mfma_f32_16x16x32_bf16 v[30:33], v[78:81], v[62:65], v[30:33]
    s_add_u32 s43, s43, 81920
    s_add_u32 s44, s44, 221184
    s_add_u32 s46, s46, 24576
    s_cmp_eq_u32 s46, 147456
    s_cmov_b32 s46, 0
    s_add_u32 s52, s46, s54
    s_add_u32 s53, s46, s55
    s_waitcnt lgkmcnt(0)
    v_mfma_f32_16x16x32_bf16 v[2:5], v[66:69], v[34:37], v[2:5]
    ds_read_b64_tr_b16 v[74:75], v92 offset:4096
    ds_read_b64_tr_b16 v[76:77], v92 offset:4608
    v_mfma_f32_16x16x32_bf16 v[6:9], v[66:69], v[38:41], v[6:9]
    ds_read_b64_tr_b16 v[78:79], v93 offset:4096
    ds_read_b64_tr_b16 v[80:81], v93 offset:4608
    v_mfma_f32_16x16x32_bf16 v[10:13], v[66:69], v[42:45], v[10:13]
    ds_read_b64_tr_b16 v[50:51], v88 offset:8192
    ds_read_b64_tr_b16 v[52:53], v88 offset:9216
    v_mfma_f32_16x16x32_bf16 v[14:17], v[66:69], v[46:49], v[14:17]
    ds_read_b64_tr_b16 v[54:55], v89 offset:8192
    ds_read_b64_tr_b16 v[56:57], v89 offset:9216
    v_mfma_f32_16x16x32_bf16 v[18:21], v[70:73], v[34:37], v[18:21]
    ds_read_b64_tr_b16 v[58:59], v90 offset:8192
    ds_read_b64_tr_b16 v[60:61], v90 offset:9216
    v_mfma_f32_16x16x32_bf16 v[22:25], v[70:73], v[38:41], v[22:25]
    ds_read_b64_tr_b16 v[62:63], v91 offset:8192
    ds_read_b64_tr_b16 v[64:65], v91 offset:9216
    v_mfma_f32_16x16x32_bf16 v[26:29], v[70:73], v[42:45], v[26:29]
    v_mfma_f32_16x16x32_bf16 v[30:33], v[70:73], v[46:49], v[30:33]
    s_add_u32 s47, s47, 1
    s_cmp_eq_u32 s47, 6
    s_mov_b32 s49, 24576
    s_cmov_b32 s49, 0xfffe2000
    s_cmov_b32 s47, 0
    s_waitcnt lgkmcnt(0)
    v_add_u32 v88, s49, v88
    v_add_u32 v89, s49, v89
    v_add_u32 v90, s49, v90
    v_add_u32 v91, s49, v91
    v_add_u32 v92, s49, v92
    v_add_u32 v93, s49, v93
    s_waitcnt vmcnt(18)
    s_barrier
    v_mfma_f32_16x16x32_bf16 v[2:5], v[74:77], v[50:53], v[2:5]
    ds_read_b64_tr_b16 v[66:67], v92 offset:0
    ds_read_b64_tr_b16 v[68:69], v92 offset:512
    s_add_u32 m0, s52, 0
    s_nop 0
    buffer_load_dwordx4 v82, s[4:7], s43 offen sc1 lds
    v_mfma_f32_16x16x32_bf16 v[6:9], v[74:77], v[54:57], v[6:9]
    ds_read_b64_tr_b16 v[70:71], v93 offset:0
    ds_read_b64_tr_b16 v[72:73], v93 offset:512
    s_add_u32 m0, s52, 1024
    s_nop 0
    buffer_load_dwordx4 v83, s[4:7], s43 offen sc1 lds
    v_mfma_f32_16x16x32_bf16 v[10:13], v[74:77], v[58:61], v[10:13]
    ds_read_b64_tr_b16 v[34:35], v88 offset:0
    ds_read_b64_tr_b16 v[36:37], v88 offset:1024
    s_add_u32 m0, s52, 2048
    s_nop 0
    buffer_load_dwordx4 v84, s[4:7], s43 offen sc1 lds
    v_mfma_f32_16x16x32_bf16 v[14:17], v[74:77], v[62:65], v[14:17]
    ds_read_b64_tr_b16 v[38:39], v89 offset:0
    ds_read_b64_tr_b16 v[40:41], v89 offset:1024
    v_mfma_f32_16x16x32_bf16 v[18:21], v[78:81], v[50:53], v[18:21]
    ds_read_b64_tr_b16 v[42:43], v90 offset:0
    ds_read_b64_tr_b16 v[44:45], v90 offset:1024
    s_add_u32 m0, s52, 3072
    s_nop 0
    buffer_load_dwordx4 v85, s[4:7], s43 offen sc1 lds
    v_mfma_f32_16x16x32_bf16 v[22:25], v[78:81], v[54:57], v[22:25]
    ds_read_b64_tr_b16 v[46:47], v91 offset:0
    ds_read_b64_tr_b16 v[48:49], v91 offset:1024
    s_add_u32 m0, s53, 16384
    s_nop 0
    buffer_load_dwordx4 v86, s[8:11], s44 offen lds
    v_mfma_f32_16x16x32_bf16 v[26:29], v[78:81], v[58:61], v[26:29]
    s_add_u32 m0, s53, 17408
    s_nop 0
    buffer_load_dwordx4 v87, s[8:11], s44 offen lds
    v_mfma_f32_16x16x32_bf16 v[30:33], v[78:81], v[62:65], v[30:33]
    s_add_u32 s43, s43, 81920
    s_add_u32 s44, s44, 221184
    s_add_u32 s46, s46, 24576
    s_cmp_eq_u32 s46, 147456
    s_cmov_b32 s46, 0
    s_add_u32 s52, s46, s54
    s_add_u32 s53, s46, s55
    s_waitcnt lgkmcnt(0)
    v_mfma_f32_16x16x32_bf16 v[2:5], v[66:69], v[34:37], v[2:5]
    ds_read_b64_tr_b16 v[74:75], v92 offset:4096
    ds_read_b64_tr_b16 v[76:77], v92 offset:4608
    v_mfma_f32_16x16x32_bf16 v[6:9], v[66:69], v[38:41], v[6:9]
    ds_read_b64_tr_b16 v[78:79], v93 offset:4096
    ds_read_b64_tr_b16 v[80:81], v93 offset:4608
    v_mfma_f32_16x16x32_bf16 v[10:13], v[66:69], v[42:45], v[10:13]
    ds_read_b64_tr_b16 v[50:51], v88 offset:8192
    ds_read_b64_tr_b16 v[52:53], v88 offset:9216
    v_mfma_f32_16x16x32_bf16 v[14:17], v[66:69], v[46:49], v[14:17]
    ds_read_b64_tr_b16 v[54:55], v89 offset:8192
    ds_read_b64_tr_b16 v[56:57], v89 offset:9216
    v_mfma_f32_16x16x32_bf16 v[18:21], v[70:73], v[34:37], v[18:21]
    ds_read_b64_tr_b16 v[58:59], v90 offset:8192
    ds_read_b64_tr_b16 v[60:61], v90 offset:9216
    v_mfma_f32_16x16x32_bf16 v[22:25], v[70:73], v[38:41], v[22:25]
    ds_read_b64_tr_b16 v[62:63], v91 offset:8192
    ds_read_b64_tr_b16 v[64:65], v91 offset:9216
    v_mfma_f32_16x16x32_bf16 v[26:29], v[70:73], v[42:45], v[26:29]
    v_mfma_f32_16x16x32_bf16 v[30:33], v[70:73], v[46:49], v[30:33]
    s_add_u32 s47, s47, 1
    s_cmp_eq_u32 s47, 6
    s_mov_b32 s49, 24576
    s_cmov_b32 s49, 0xfffe2000
    s_cmov_b32 s47, 0
    s_waitcnt lgkmcnt(0)
    v_add_u32 v88, s49, v88
    v_add_u32 v89, s49, v89
    v_add_u32 v90, s49, v90
    v_add_u32 v91, s49, v91
    v_add_u32 v92, s49, v92
    v_add_u32 v93, s49, v93
    s_waitcnt vmcnt(20)
    s_barrier
    v_mfma_f32_16x16x32_bf16 v[2:5], v[74:77], v[50:53], v[2:5]
    ds_read_b64_tr_b16 v[66:67], v92 offset:0
    ds_read_b64_tr_b16 v[68:69], v92 offset:512
    s_add_u32 m0, s52, 0
    s_nop 0
    buffer_load_dwordx4 v82, s[4:7], s43 offen sc1 lds
    v_mfma_f32_16x16x32_bf16 v[6:9], v[74:77], v[54:57], v[6:9]
    ds_read_b64_tr_b16 v[70:71], v93 offset:0
    ds_read_b64_tr_b16 v[72:73], v93 offset:512
    s_add_u32 m0, s52, 1024
    s_nop 0
    buffer_load_dwordx4 v83, s[4:7], s43 offen sc1 lds
    v_mfma_f32_16x16x32_bf16 v[10:13], v[74:77], v[58:61], v[10:13]
    ds_read_b64_tr_b16 v[34:35], v88 offset:0
    ds_read_b64_tr_b16 v[36:37], v88 offset:1024
    s_add_u32 m0, s52, 2048
    s_nop 0
    buffer_load_dwordx4 v84, s[4:7], s43 offen sc1 lds
    v_mfma_f32_16x16x32_bf16 v[14:17], v[74:77], v[62:65], v[14:17]
    ds_read_b64_tr_b16 v[38:39], v89 offset:0
    ds_read_b64_tr_b16 v[40:41], v89 offset:1024
    v_mfma_f32_16x16x32_bf16 v[18:21], v[78:81], v[50:53], v[18:21]
    ds_read_b64_tr_b16 v[42:43], v90 offset:0
    ds_read_b64_tr_b16 v[44:45], v90 offset:1024
    s_add_u32 m0, s52, 3072
    s_nop 0
    buffer_load_dwordx4 v85, s[4:7], s43 offen sc1 lds
    v_mfma_f32_16x16x32_bf16 v[22:25], v[78:81], v[54:57], v[22:25]
    ds_read_b64_tr_b16 v[46:47], v91 offset:0
    ds_read_b64_tr_b16 v[48:49], v91 offset:1024
    s_add_u32 m0, s53, 16384
    s_nop 0
    buffer_load_dwordx4 v86, s[8:11], s44 offen lds
    v_mfma_f32_16x16x32_bf16 v[26:29], v[78:81], v[58:61], v[26:29]
    s_add_u32 m0, s53, 17408
    s_nop 0
    buffer_load_dwordx4 v87, s[8:11], s44 offen lds
    v_mfma_f32_16x16x32_bf16 v[30:33], v[78:81], v[62:65], v[30:33]
    s_add_u32 s43, s43, 81920
    s_add_u32 s44, s44, 221184
    s_add_u32 s46, s46, 24576
    s_cmp_eq_u32 s46, 147456
    s_cmov_b32 s46, 0
    s_add_u32 s52, s46, s54
    s_add_u32 s53, s46, s55
    s_waitcnt lgkmcnt(0)
    v_mfma_f32_16x16x32_bf16 v[2:5], v[66:69], v[34:37], v[2:5]
    ds_read_b64_tr_b16 v[74:75], v92 offset:4096
    ds_read_b64_tr_b16 v[76:77], v92 offset:4608
    v_mfma_f32_16x16x32_bf16 v[6:9], v[66:69], v[38:41], v[6:9]
    ds_read_b64_tr_b16 v[78:79], v93 offset:4096
    ds_read_b64_tr_b16 v[80:81], v93 offset:4608
    v_mfma_f32_16x16x32_bf16 v[10:13], v[66:69], v[42:45], v[10:13]
    ds_read_b64_tr_b16 v[50:51], v88 offset:8192
    ds_read_b64_tr_b16 v[52:53], v88 offset:9216
    v_mfma_f32_16x16x32_bf16 v[14:17], v[66:69], v[46:49], v[14:17]
    ds_read_b64_tr_b16 v[54:55], v89 offset:8192
    ds_read_b64_tr_b16 v[56:57], v89 offset:9216
    v_mfma_f32_16x16x32_bf16 v[18:21], v[70:73], v[34:37], v[18:21]
    ds_read_b64_tr_b16 v[58:59], v90 offset:8192
    ds_read_b64_tr_b16 v[60:61], v90 offset:9216
    v_mfma_f32_16x16x32_bf16 v[22:25], v[70:73], v[38:41], v[22:25]
    ds_read_b64_tr_b16 v[62:63], v91 offset:8192
    ds_read_b64_tr_b16 v[64:65], v91 offset:9216
    v_mfma_f32_16x16x32_bf16 v[26:29], v[70:73], v[42:45], v[26:29]
    v_mfma_f32_16x16x32_bf16 v[30:33], v[70:73], v[46:49], v[30:33]
    s_add_u32 s47, s47, 1
    s_cmp_eq_u32 s47, 6
    s_mov_b32 s49, 24576
    s_cmov_b32 s49, 0xfffe2000
    s_cmov_b32 s47, 0
    s_waitcnt lgkmcnt(0)
    v_add_u32 v88, s49, v88
    v_add_u32 v89, s49, v89
    v_add_u32 v90, s49, v90
    v_add_u32 v91, s49, v91
    v_add_u32 v92, s49, v92
    v_add_u32 v93, s49, v93
    s_waitcnt vmcnt(22)
    s_barrier
    v_mfma_f32_16x16x32_bf16 v[2:5], v[74:77], v[50:53], v[2:5]
    ds_read_b64_tr_b16 v[66:67], v92 offset:0
    ds_read_b64_tr_b16 v[68:69], v92 offset:512
    s_add_u32 m0, s52, 0
    s_nop 0
    buffer_load_dwordx4 v82, s[4:7], s43 offen sc1 lds
    v_mfma_f32_16x16x32_bf16 v[6:9], v[74:77], v[54:57], v[6:9]
    ds_read_b64_tr_b16 v[70:71], v93 offset:0
    ds_read_b64_tr_b16 v[72:73], v93 offset:512
    s_add_u32 m0, s52, 1024
    s_nop 0
    buffer_load_dwordx4 v83, s[4:7], s43 offen sc1 lds
    v_mfma_f32_16x16x32_bf16 v[10:13], v[74:77], v[58:61], v[10:13]
    ds_read_b64_tr_b16 v[34:35], v88 offset:0
    ds_read_b64_tr_b16 v[36:37], v88 offset:1024
    s_add_u32 m0, s52, 2048
    s_nop 0
    buffer_load_dwordx4 v84, s[4:7], s43 offen sc1 lds
    v_mfma_f32_16x16x32_bf16 v[14:17], v[74:77], v[62:65], v[14:17]
    ds_read_b64_tr_b16 v[38:39], v89 offset:0
    ds_read_b64_tr_b16 v[40:41], v89 offset:1024
    v_mfma_f32_16x16x32_bf16 v[18:21], v[78:81], v[50:53], v[18:21]
    ds_read_b64_tr_b16 v[42:43], v90 offset:0
    ds_read_b64_tr_b16 v[44:45], v90 offset:1024
    s_add_u32 m0, s52, 3072
    s_nop 0
    buffer_load_dwordx4 v85, s[4:7], s43 offen sc1 lds
    v_mfma_f32_16x16x32_bf16 v[22:25], v[78:81], v[54:57], v[22:25]
    ds_read_b64_tr_b16 v[46:47], v91 offset:0
    ds_read_b64_tr_b16 v[48:49], v91 offset:1024
    s_add_u32 m0, s53, 16384
    s_nop 0
    buffer_load_dwordx4 v86, s[8:11], s44 offen lds
    v_mfma_f32_16x16x32_bf16 v[26:29], v[78:81], v[58:61], v[26:29]
    s_add_u32 m0, s53, 17408
    s_nop 0
    buffer_load_dwordx4 v87, s[8:11], s44 offen lds
    v_mfma_f32_16x16x32_bf16 v[30:33], v[78:81], v[62:65], v[30:33]
    s_add_u32 s43, s43, 81920
    s_add_u32 s44, s44, 221184
    s_add_u32 s46, s46, 24576
    s_cmp_eq_u32 s46, 147456
    s_cmov_b32 s46, 0
    s_add_u32 s52, s46, s54
    s_add_u32 s53, s46, s55
    s_waitcnt lgkmcnt(0)
    v_mfma_f32_16x16x32_bf16 v[2:5], v[66:69], v[34:37], v[2:5]
    ds_read_b64_tr_b16 v[74:75], v92 offset:4096
    ds_read_b64_tr_b16 v[76:77], v92 offset:4608
    v_mfma_f32_16x16x32_bf16 v[6:9], v[66:69], v[38:41], v[6:9]
    ds_read_b64_tr_b16 v[78:79], v93 offset:4096
    ds_read_b64_tr_b16 v[80:81], v93 offset:4608
    v_mfma_f32_16x16x32_bf16 v[10:13], v[66:69], v[42:45], v[10:13]
    ds_read_b64_tr_b16 v[50:51], v88 offset:8192
    ds_read_b64_tr_b16 v[52:53], v88 offset:9216
    v_mfma_f32_16x16x32_bf16 v[14:17], v[66:69], v[46:49], v[14:17]
    ds_read_b64_tr_b16 v[54:55], v89 offset:8192
    ds_read_b64_tr_b16 v[56:57], v89 offset:9216
    v_mfma_f32_16x16x32_bf16 v[18:21], v[70:73], v[34:37], v[18:21]
    ds_read_b64_tr_b16 v[58:59], v90 offset:8192
    ds_read_b64_tr_b16 v[60:61], v90 offset:9216
    v_mfma_f32_16x16x32_bf16 v[22:25], v[70:73], v[38:41], v[22:25]
    ds_read_b64_tr_b16 v[62:63], v91 offset:8192
    ds_read_b64_tr_b16 v[64:65], v91 offset:9216
    v_mfma_f32_16x16x32_bf16 v[26:29], v[70:73], v[42:45], v[26:29]
    v_mfma_f32_16x16x32_bf16 v[30:33], v[70:73], v[46:49], v[30:33]
    s_add_u32 s47, s47, 1
    s_cmp_eq_u32 s47, 6
    s_mov_b32 s49, 24576
    s_cmov_b32 s49, 0xfffe2000
    s_cmov_b32 s47, 0
    s_waitcnt lgkmcnt(0)
    v_add_u32 v88, s49, v88
    v_add_u32 v89, s49, v89
    v_add_u32 v90, s49, v90
    v_add_u32 v91, s49, v91
    v_add_u32 v92, s49, v92
    v_add_u32 v93, s49, v93
    s_waitcnt vmcnt(24)
    s_barrier
    v_mfma_f32_16x16x32_bf16 v[2:5], v[74:77], v[50:53], v[2:5]
    ds_read_b64_tr_b16 v[66:67], v92 offset:0
    ds_read_b64_tr_b16 v[68:69], v92 offset:512
    v_mfma_f32_16x16x32_bf16 v[6:9], v[74:77], v[54:57], v[6:9]
    ds_read_b64_tr_b16 v[70:71], v93 offset:0
    ds_read_b64_tr_b16 v[72:73], v93 offset:512
    v_mfma_f32_16x16x32_bf16 v[10:13], v[74:77], v[58:61], v[10:13]
    ds_read_b64_tr_b16 v[34:35], v88 offset:0
    ds_read_b64_tr_b16 v[36:37], v88 offset:1024
    v_mfma_f32_16x16x32_bf16 v[14:17], v[74:77], v[62:65], v[14:17]
    ds_read_b64_tr_b16 v[38:39], v89 offset:0
    ds_read_b64_tr_b16 v[40:41], v89 offset:1024
    v_mfma_f32_16x16x32_bf16 v[18:21], v[78:81], v[50:53], v[18:21]
    ds_read_b64_tr_b16 v[42:43], v90 offset:0
    ds_read_b64_tr_b16 v[44:45], v90 offset:1024
    v_mfma_f32_16x16x32_bf16 v[22:25], v[78:81], v[54:57], v[22:25]
    ds_read_b64_tr_b16 v[46:47], v91 offset:0
    ds_read_b64_tr_b16 v[48:49], v91 offset:1024
    v_mfma_f32_16x16x32_bf16 v[26:29], v[78:81], v[58:61], v[26:29]
    v_mfma_f32_16x16x32_bf16 v[30:33], v[78:81], v[62:65], v[30:33]
    s_waitcnt lgkmcnt(0)
    v_mfma_f32_16x16x32_bf16 v[2:5], v[66:69], v[34:37], v[2:5]
    ds_read_b64_tr_b16 v[74:75], v92 offset:4096
    ds_read_b64_tr_b16 v[76:77], v92 offset:4608
    v_mfma_f32_16x16x32_bf16 v[6:9], v[66:69], v[38:41], v[6:9]
    ds_read_b64_tr_b16 v[78:79], v93 offset:4096
    ds_read_b64_tr_b16 v[80:81], v93 offset:4608
    v_mfma_f32_16x16x32_bf16 v[10:13], v[66:69], v[42:45], v[10:13]
    ds_read_b64_tr_b16 v[50:51], v88 offset:8192
    ds_read_b64_tr_b16 v[52:53], v88 offset:9216
    v_mfma_f32_16x16x32_bf16 v[14:17], v[66:69], v[46:49], v[14:17]
    ds_read_b64_tr_b16 v[54:55], v89 offset:8192
    ds_read_b64_tr_b16 v[56:57], v89 offset:9216
    v_mfma_f32_16x16x32_bf16 v[18:21], v[70:73], v[34:37], v[18:21]
    ds_read_b64_tr_b16 v[58:59], v90 offset:8192
    ds_read_b64_tr_b16 v[60:61], v90 offset:9216
    v_mfma_f32_16x16x32_bf16 v[22:25], v[70:73], v[38:41], v[22:25]
    ds_read_b64_tr_b16 v[62:63], v91 offset:8192
    ds_read_b64_tr_b16 v[64:65], v91 offset:9216
    v_mfma_f32_16x16x32_bf16 v[26:29], v[70:73], v[42:45], v[26:29]
    v_mfma_f32_16x16x32_bf16 v[30:33], v[70:73], v[46:49], v[30:33]
    s_add_u32 s47, s47, 1
    s_cmp_eq_u32 s47, 6
    s_mov_b32 s49, 24576
    s_cmov_b32 s49, 0xfffe2000
    s_cmov_b32 s47, 0
    s_waitcnt lgkmcnt(0)
    v_add_u32 v88, s49, v88
    v_add_u32 v89, s49, v89
    v_add_u32 v90, s49, v90
    v_add_u32 v91, s49, v91
    v_add_u32 v92, s49, v92
    v_add_u32 v93, s49, v93
    s_waitcnt vmcnt(18)
    s_barrier
    v_mfma_f32_16x16x32_bf16 v[2:5], v[74:77], v[50:53], v[2:5]
    ds_read_b64_tr_b16 v[66:67], v92 offset:0
    ds_read_b64_tr_b16 v[68:69], v92 offset:512
    v_mfma_f32_16x16x32_bf16 v[6:9], v[74:77], v[54:57], v[6:9]
    ds_read_b64_tr_b16 v[70:71], v93 offset:0
    ds_read_b64_tr_b16 v[72:73], v93 offset:512
    v_mfma_f32_16x16x32_bf16 v[10:13], v[74:77], v[58:61], v[10:13]
    ds_read_b64_tr_b16 v[34:35], v88 offset:0
    ds_read_b64_tr_b16 v[36:37], v88 offset:1024
    v_mfma_f32_16x16x32_bf16 v[14:17], v[74:77], v[62:65], v[14:17]
    ds_read_b64_tr_b16 v[38:39], v89 offset:0
    ds_read_b64_tr_b16 v[40:41], v89 offset:1024
    v_mfma_f32_16x16x32_bf16 v[18:21], v[78:81], v[50:53], v[18:21]
    ds_read_b64_tr_b16 v[42:43], v90 offset:0
    ds_read_b64_tr_b16 v[44:45], v90 offset:1024
    v_mfma_f32_16x16x32_bf16 v[22:25], v[78:81], v[54:57], v[22:25]
    ds_read_b64_tr_b16 v[46:47], v91 offset:0
    ds_read_b64_tr_b16 v[48:49], v91 offset:1024
    v_mfma_f32_16x16x32_bf16 v[26:29], v[78:81], v[58:61], v[26:29]
    v_mfma_f32_16x16x32_bf16 v[30:33], v[78:81], v[62:65], v[30:33]
    s_waitcnt lgkmcnt(0)
    v_mfma_f32_16x16x32_bf16 v[2:5], v[66:69], v[34:37], v[2:5]
    ds_read_b64_tr_b16 v[74:75], v92 offset:4096
    ds_read_b64_tr_b16 v[76:77], v92 offset:4608
    v_mfma_f32_16x16x32_bf16 v[6:9], v[66:69], v[38:41], v[6:9]
    ds_read_b64_tr_b16 v[78:79], v93 offset:4096
    ds_read_b64_tr_b16 v[80:81], v93 offset:4608
    v_mfma_f32_16x16x32_bf16 v[10:13], v[66:69], v[42:45], v[10:13]
    ds_read_b64_tr_b16 v[50:51], v88 offset:8192
    ds_read_b64_tr_b16 v[52:53], v88 offset:9216
    v_mfma_f32_16x16x32_bf16 v[14:17], v[66:69], v[46:49], v[14:17]
    ds_read_b64_tr_b16 v[54:55], v89 offset:8192
    ds_read_b64_tr_b16 v[56:57], v89 offset:9216
    v_mfma_f32_16x16x32_bf16 v[18:21], v[70:73], v[34:37], v[18:21]
    ds_read_b64_tr_b16 v[58:59], v90 offset:8192
    ds_read_b64_tr_b16 v[60:61], v90 offset:9216
    v_mfma_f32_16x16x32_bf16 v[22:25], v[70:73], v[38:41], v[22:25]
    ds_read_b64_tr_b16 v[62:63], v91 offset:8192
    ds_read_b64_tr_b16 v[64:65], v91 offset:9216
    v_mfma_f32_16x16x32_bf16 v[26:29], v[70:73], v[42:45], v[26:29]
    v_mfma_f32_16x16x32_bf16 v[30:33], v[70:73], v[46:49], v[30:33]
    s_add_u32 s47, s47, 1
    s_cmp_eq_u32 s47, 6
    s_mov_b32 s49, 24576
    s_cmov_b32 s49, 0xfffe2000
    s_cmov_b32 s47, 0
    s_waitcnt lgkmcnt(0)
    v_add_u32 v88, s49, v88
    v_add_u32 v89, s49, v89
    v_add_u32 v90, s49, v90
    v_add_u32 v91, s49, v91
    v_add_u32 v92, s49, v92
    v_add_u32 v93, s49, v93
    s_waitcnt vmcnt(12)
    s_barrier
    v_mfma_f32_16x16x32_bf16 v[2:5], v[74:77], v[50:53], v[2:5]
    ds_read_b64_tr_b16 v[66:67], v92 offset:0
    ds_read_b64_tr_b16 v[68:69], v92 offset:512
    v_mfma_f32_16x16x32_bf16 v[6:9], v[74:77], v[54:57], v[6:9]
    ds_read_b64_tr_b16 v[70:71], v93 offset:0
    ds_read_b64_tr_b16 v[72:73], v93 offset:512
    v_mfma_f32_16x16x32_bf16 v[10:13], v[74:77], v[58:61], v[10:13]
    ds_read_b64_tr_b16 v[34:35], v88 offset:0
    ds_read_b64_tr_b16 v[36:37], v88 offset:1024
    v_mfma_f32_16x16x32_bf16 v[14:17], v[74:77], v[62:65], v[14:17]
    ds_read_b64_tr_b16 v[38:39], v89 offset:0
    ds_read_b64_tr_b16 v[40:41], v89 offset:1024
    v_mfma_f32_16x16x32_bf16 v[18:21], v[78:81], v[50:53], v[18:21]
    ds_read_b64_tr_b16 v[42:43], v90 offset:0
    ds_read_b64_tr_b16 v[44:45], v90 offset:1024
    v_mfma_f32_16x16x32_bf16 v[22:25], v[78:81], v[54:57], v[22:25]
    ds_read_b64_tr_b16 v[46:47], v91 offset:0
    ds_read_b64_tr_b16 v[48:49], v91 offset:1024
    v_mfma_f32_16x16x32_bf16 v[26:29], v[78:81], v[58:61], v[26:29]
    v_mfma_f32_16x16x32_bf16 v[30:33], v[78:81], v[62:65], v[30:33]
    s_waitcnt lgkmcnt(0)
    v_mfma_f32_16x16x32_bf16 v[2:5], v[66:69], v[34:37], v[2:5]
    ds_read_b64_tr_b16 v[74:75], v92 offset:4096
    ds_read_b64_tr_b16 v[76:77], v92 offset:4608
    v_mfma_f32_16x16x32_bf16 v[6:9], v[66:69], v[38:41], v[6:9]
    ds_read_b64_tr_b16 v[78:79], v93 offset:4096
    ds_read_b64_tr_b16 v[80:81], v93 offset:4608
    v_mfma_f32_16x16x32_bf16 v[10:13], v[66:69], v[42:45], v[10:13]
    ds_read_b64_tr_b16 v[50:51], v88 offset:8192
    ds_read_b64_tr_b16 v[52:53], v88 offset:9216
    v_mfma_f32_16x16x32_bf16 v[14:17], v[66:69], v[46:49], v[14:17]
    ds_read_b64_tr_b16 v[54:55], v89 offset:8192
    ds_read_b64_tr_b16 v[56:57], v89 offset:9216
    v_mfma_f32_16x16x32_bf16 v[18:21], v[70:73], v[34:37], v[18:21]
    ds_read_b64_tr_b16 v[58:59], v90 offset:8192
    ds_read_b64_tr_b16 v[60:61], v90 offset:9216
    v_mfma_f32_16x16x32_bf16 v[22:25], v[70:73], v[38:41], v[22:25]
    ds_read_b64_tr_b16 v[62:63], v91 offset:8192
    ds_read_b64_tr_b16 v[64:65], v91 offset:9216
    v_mfma_f32_16x16x32_bf16 v[26:29], v[70:73], v[42:45], v[26:29]
    v_mfma_f32_16x16x32_bf16 v[30:33], v[70:73], v[46:49], v[30:33]
    s_add_u32 s47, s47, 1
    s_cmp_eq_u32 s47, 6
    s_mov_b32 s49, 24576
    s_cmov_b32 s49, 0xfffe2000
    s_cmov_b32 s47, 0
    s_waitcnt lgkmcnt(0)
    v_add_u32 v88, s49, v88
    v_add_u32 v89, s49, v89
    v_add_u32 v90, s49, v90
    v_add_u32 v91, s49, v91
    v_add_u32 v92, s49, v92
    v_add_u32 v93, s49, v93
    s_waitcnt vmcnt(6)
    s_barrier
    v_mfma_f32_16x16x32_bf16 v[2:5], v[74:77], v[50:53], v[2:5]
    ds_read_b64_tr_b16 v[66:67], v92 offset:0
    ds_read_b64_tr_b16 v[68:69], v92 offset:512
    v_mfma_f32_16x16x32_bf16 v[6:9], v[74:77], v[54:57], v[6:9]
    ds_read_b64_tr_b16 v[70:71], v93 offset:0
    ds_read_b64_tr_b16 v[72:73], v93 offset:512
    v_mfma_f32_16x16x32_bf16 v[10:13], v[74:77], v[58:61], v[10:13]
    ds_read_b64_tr_b16 v[34:35], v88 offset:0
    ds_read_b64_tr_b16 v[36:37], v88 offset:1024
    v_mfma_f32_16x16x32_bf16 v[14:17], v[74:77], v[62:65], v[14:17]
    ds_read_b64_tr_b16 v[38:39], v89 offset:0
    ds_read_b64_tr_b16 v[40:41], v89 offset:1024
    v_mfma_f32_16x16x32_bf16 v[18:21], v[78:81], v[50:53], v[18:21]
    ds_read_b64_tr_b16 v[42:43], v90 offset:0
    ds_read_b64_tr_b16 v[44:45], v90 offset:1024
    v_mfma_f32_16x16x32_bf16 v[22:25], v[78:81], v[54:57], v[22:25]
    ds_read_b64_tr_b16 v[46:47], v91 offset:0
    ds_read_b64_tr_b16 v[48:49], v91 offset:1024
    v_mfma_f32_16x16x32_bf16 v[26:29], v[78:81], v[58:61], v[26:29]
    v_mfma_f32_16x16x32_bf16 v[30:33], v[78:81], v[62:65], v[30:33]
    s_waitcnt lgkmcnt(0)
    v_mfma_f32_16x16x32_bf16 v[2:5], v[66:69], v[34:37], v[2:5]
    ds_read_b64_tr_b16 v[74:75], v92 offset:4096
    ds_read_b64_tr_b16 v[76:77], v92 offset:4608
    v_mfma_f32_16x16x32_bf16 v[6:9], v[66:69], v[38:41], v[6:9]
    ds_read_b64_tr_b16 v[78:79], v93 offset:4096
    ds_read_b64_tr_b16 v[80:81], v93 offset:4608
    v_mfma_f32_16x16x32_bf16 v[10:13], v[66:69], v[42:45], v[10:13]
    ds_read_b64_tr_b16 v[50:51], v88 offset:8192
    ds_read_b64_tr_b16 v[52:53], v88 offset:9216
    v_mfma_f32_16x16x32_bf16 v[14:17], v[66:69], v[46:49], v[14:17]
    ds_read_b64_tr_b16 v[54:55], v89 offset:8192
    ds_read_b64_tr_b16 v[56:57], v89 offset:9216
    v_mfma_f32_16x16x32_bf16 v[18:21], v[70:73], v[34:37], v[18:21]
    ds_read_b64_tr_b16 v[58:59], v90 offset:8192
    ds_read_b64_tr_b16 v[60:61], v90 offset:9216
    v_mfma_f32_16x16x32_bf16 v[22:25], v[70:73], v[38:41], v[22:25]
    ds_read_b64_tr_b16 v[62:63], v91 offset:8192
    ds_read_b64_tr_b16 v[64:65], v91 offset:9216
    v_mfma_f32_16x16x32_bf16 v[26:29], v[70:73], v[42:45], v[26:29]
    v_mfma_f32_16x16x32_bf16 v[30:33], v[70:73], v[46:49], v[30:33]
    s_add_u32 s47, s47, 1
    s_cmp_eq_u32 s47, 6
    s_mov_b32 s49, 24576
    s_cmov_b32 s49, 0xfffe2000
    s_cmov_b32 s47, 0
    s_waitcnt lgkmcnt(0)
    v_add_u32 v88, s49, v88
    v_add_u32 v89, s49, v89
    v_add_u32 v90, s49, v90
    v_add_u32 v91, s49, v91
    v_add_u32 v92, s49, v92
    v_add_u32 v93, s49, v93
    s_waitcnt vmcnt(0)
    s_barrier
    v_mfma_f32_16x16x32_bf16 v[2:5], v[74:77], v[50:53], v[2:5]
    ds_read_b64_tr_b16 v[66:67], v92 offset:0
    ds_read_b64_tr_b16 v[68:69], v92 offset:512
    v_mfma_f32_16x16x32_bf16 v[6:9], v[74:77], v[54:57], v[6:9]
    ds_read_b64_tr_b16 v[70:71], v93 offset:0
    ds_read_b64_tr_b16 v[72:73], v93 offset:512
    v_mfma_f32_16x16x32_bf16 v[10:13], v[74:77], v[58:61], v[10:13]
    ds_read_b64_tr_b16 v[34:35], v88 offset:0
    ds_read_b64_tr_b16 v[36:37], v88 offset:1024
    v_mfma_f32_16x16x32_bf16 v[14:17], v[74:77], v[62:65], v[14:17]
    ds_read_b64_tr_b16 v[38:39], v89 offset:0
    ds_read_b64_tr_b16 v[40:41], v89 offset:1024
    v_mfma_f32_16x16x32_bf16 v[18:21], v[78:81], v[50:53], v[18:21]
    ds_read_b64_tr_b16 v[42:43], v90 offset:0
    ds_read_b64_tr_b16 v[44:45], v90 offset:1024
    v_mfma_f32_16x16x32_bf16 v[22:25], v[78:81], v[54:57], v[22:25]
    ds_read_b64_tr_b16 v[46:47], v91 offset:0
    ds_read_b64_tr_b16 v[48:49], v91 offset:1024
    v_mfma_f32_16x16x32_bf16 v[26:29], v[78:81], v[58:61], v[26:29]
    v_mfma_f32_16x16x32_bf16 v[30:33], v[78:81], v[62:65], v[30:33]
    s_waitcnt lgkmcnt(0)
    v_mfma_f32_16x16x32_bf16 v[2:5], v[66:69], v[34:37], v[2:5]
    ds_read_b64_tr_b16 v[74:75], v92 offset:4096
    ds_read_b64_tr_b16 v[76:77], v92 offset:4608
    v_mfma_f32_16x16x32_bf16 v[6:9], v[66:69], v[38:41], v[6:9]
    ds_read_b64_tr_b16 v[78:79], v93 offset:4096
    ds_read_b64_tr_b16 v[80:81], v93 offset:4608
    v_mfma_f32_16x16x32_bf16 v[10:13], v[66:69], v[42:45], v[10:13]
    ds_read_b64_tr_b16 v[50:51], v88 offset:8192
    ds_read_b64_tr_b16 v[52:53], v88 offset:9216
    v_mfma_f32_16x16x32_bf16 v[14:17], v[66:69], v[46:49], v[14:17]
    ds_read_b64_tr_b16 v[54:55], v89 offset:8192
    ds_read_b64_tr_b16 v[56:57], v89 offset:9216
    v_mfma_f32_16x16x32_bf16 v[18:21], v[70:73], v[34:37], v[18:21]
    ds_read_b64_tr_b16 v[58:59], v90 offset:8192
    ds_read_b64_tr_b16 v[60:61], v90 offset:9216
    v_mfma_f32_16x16x32_bf16 v[22:25], v[70:73], v[38:41], v[22:25]
    ds_read_b64_tr_b16 v[62:63], v91 offset:8192
    ds_read_b64_tr_b16 v[64:65], v91 offset:9216
    v_mfma_f32_16x16x32_bf16 v[26:29], v[70:73], v[42:45], v[26:29]
    v_mfma_f32_16x16x32_bf16 v[30:33], v[70:73], v[46:49], v[30:33]
    s_waitcnt lgkmcnt(0)
    v_mfma_f32_16x16x32_bf16 v[2:5], v[74:77], v[50:53], v[2:5]
    v_mfma_f32_16x16x32_bf16 v[6:9], v[74:77], v[54:57], v[6:9]
    v_mfma_f32_16x16x32_bf16 v[10:13], v[74:77], v[58:61], v[10:13]
    v_mfma_f32_16x16x32_bf16 v[14:17], v[74:77], v[62:65], v[14:17]
    v_mfma_f32_16x16x32_bf16 v[18:21], v[78:81], v[50:53], v[18:21]
    v_mfma_f32_16x16x32_bf16 v[22:25], v[78:81], v[54:57], v[22:25]
    v_mfma_f32_16x16x32_bf16 v[26:29], v[78:81], v[58:61], v[26:29]
    v_mfma_f32_16x16x32_bf16 v[30:33], v[78:81], v[62:65], v[30:33]
    s_waitcnt vmcnt(0)
    s_nop 7
    s_nop 3
    v_subrev_u32 v88, 73728, v88
    v_subrev_u32 v89, 73728, v89
    v_subrev_u32 v90, 73728, v90
    v_subrev_u32 v91, 73728, v91
    v_subrev_u32 v92, 73728, v92
    v_subrev_u32 v93, 73728, v93
    s_barrier
    s_lshl_b32 s43, s17, 8
    s_add_u32 s43, s43, 9797632
    s_lshl_b32 s44, s16, 7
    s_add_u32 s44, s44, 6635520
    s_mul_i32 s54, s40, 4096
    s_mul_i32 s55, s40, 2048
    s_mov_b32 s46, 0
    s_mov_b32 s51, 0
    s_mov_b32 s52, s54
    s_mov_b32 s53, s55
    s_add_u32 s50, s44, 0
    s_add_u32 s53, s55, 0
    s_add_u32 m0, s53, 16384
    s_nop 0
    buffer_load_dwordx4 v86, s[8:11], s50 offen lds
    s_add_u32 m0, s53, 17408
    s_nop 0
    buffer_load_dwordx4 v87, s[8:11], s50 offen lds
    s_add_u32 s50, s44, 221184
    s_add_u32 s53, s55, 24576
    s_add_u32 m0, s53, 16384
    s_nop 0
    buffer_load_dwordx4 v86, s[8:11], s50 offen lds
    s_add_u32 m0, s53, 17408
    s_nop 0
    buffer_load_dwordx4 v87, s[8:11], s50 offen lds
    s_mov_b32 s50, 0x40000000
    s_add_u32 s53, s55, 49152
    s_add_u32 m0, s53, 16384
    s_nop 0
    buffer_load_dwordx4 v86, s[8:11], s50 offen lds
    s_add_u32 m0, s53, 17408
    s_nop 0
    buffer_load_dwordx4 v87, s[8:11], s50 offen lds
    s_mov_b32 s50, 0x40000000
    s_add_u32 s53, s55, 73728
    s_add_u32 m0, s53, 16384
    s_nop 0
    buffer_load_dwordx4 v86, s[8:11], s50 offen lds
    s_add_u32 m0, s53, 17408
    s_nop 0
    buffer_load_dwordx4 v87, s[8:11], s50 offen lds
    s_mov_b32 s50, 0x40000000
    s_add_u32 s53, s55, 98304
    s_add_u32 m0, s53, 16384
    s_nop 0
    buffer_load_dwordx4 v86, s[8:11], s50 offen lds
    s_add_u32 m0, s53, 17408
    s_nop 0
    buffer_load_dwordx4 v87, s[8:11], s50 offen lds
    s_mov_b32 s50, 0x40000000
    s_add_u32 s53, s55, 122880
    s_add_u32 m0, s53, 16384
    s_nop 0
    buffer_load_dwordx4 v86, s[8:11], s50 offen lds
    s_add_u32 m0, s53, 17408
    s_nop 0
    buffer_load_dwordx4 v87, s[8:11], s50 offen lds
    s_mov_b32 s77, 794496
    s_cmp_lg_u32 s26, 0
    s_cbranch_scc1 L_wgw_177
    s_mov_b32 s79, 0x200000
    v_mov_b32 v102, 0
L_cw_178:
    buffer_load_dword v103, v102, s[4:7], s77 offen sc1
    s_waitcnt vmcnt(0)
    v_readfirstlane_b32 s78, v103
    s_nop 0
    s_cmp_ge_u32 s78, 32
    s_cbranch_scc1 L_cd_179
    s_sleep 2
    s_sub_u32 s79, s79, 1
    s_cbranch_scc0 L_cw_178
L_cd_179:
L_wgw_177:
    s_barrier
    s_add_u32 s50, s43, 0
    s_add_u32 s52, s54, 0
    s_add_u32 m0, s52, 0
    s_nop 0
    buffer_load_dwordx4 v82, s[4:7], s50 offen sc1 lds
    s_add_u32 m0, s52, 1024
    s_nop 0
    buffer_load_dwordx4 v83, s[4:7], s50 offen sc1 lds
    s_add_u32 m0, s52, 2048
    s_nop 0
    buffer_load_dwordx4 v84, s[4:7], s50 offen sc1 lds
    s_add_u32 m0, s52, 3072
    s_nop 0
    buffer_load_dwordx4 v85, s[4:7], s50 offen sc1 lds
    s_add_u32 s50, s43, 81920
    s_add_u32 s52, s54, 24576
    s_add_u32 m0, s52, 0
    s_nop 0
    buffer_load_dwordx4 v82, s[4:7], s50 offen sc1 lds
    s_add_u32 m0, s52, 1024
    s_nop 0
    buffer_load_dwordx4 v83, s[4:7], s50 offen sc1 lds
    s_add_u32 m0, s52, 2048
    s_nop 0
    buffer_load_dwordx4 v84, s[4:7], s50 offen sc1 lds
    s_add_u32 m0, s52, 3072
    s_nop 0
    buffer_load_dwordx4 v85, s[4:7], s50 offen sc1 lds
    s_mov_b32 s50, 0x40000000
    s_add_u32 s52, s54, 49152
    s_add_u32 m0, s52, 0
    s_nop 0
    buffer_load_dwordx4 v82, s[4:7], s50 offen sc1 lds
    s_add_u32 m0, s52, 1024
    s_nop 0
    buffer_load_dwordx4 v83, s[4:7], s50 offen sc1 lds
    s_add_u32 m0, s52, 2048
    s_nop 0
    buffer_load_dwordx4 v84, s[4:7], s50 offen sc1 lds
    s_add_u32 m0, s52, 3072
    s_nop 0
    buffer_load_dwordx4 v85, s[4:7], s50 offen sc1 lds
    s_mov_b32 s50, 0x40000000
    s_add_u32 s52, s54, 73728
    s_add_u32 m0, s52, 0
    s_nop 0
    buffer_load_dwordx4 v82, s[4:7], s50 offen sc1 lds
    s_add_u32 m0, s52, 1024
    s_nop 0
    buffer_load_dwordx4 v83, s[4:7], s50 offen sc1 lds
    s_add_u32 m0, s52, 2048
    s_nop 0
    buffer_load_dwordx4 v84, s[4:7], s50 offen sc1 lds
    s_add_u32 m0, s52, 3072
    s_nop 0
    buffer_load_dwordx4 v85, s[4:7], s50 offen sc1 lds
    s_mov_b32 s50, 0x40000000
    s_add_u32 s52, s54, 98304
    s_add_u32 m0, s52, 0
    s_nop 0
    buffer_load_dwordx4 v82, s[4:7], s50 offen sc1 lds
    s_add_u32 m0, s52, 1024
    s_nop 0
    buffer_load_dwordx4 v83, s[4:7], s50 offen sc1 lds
    s_add_u32 m0, s52, 2048
    s_nop 0
    buffer_load_dwordx4 v84, s[4:7], s50 offen sc1 lds
    s_add_u32 m0, s52, 3072
    s_nop 0
    buffer_load_dwordx4 v85, s[4:7], s50 offen sc1 lds
    s_mov_b32 s50, 0x40000000
    s_add_u32 s52, s54, 122880
    s_add_u32 m0, s52, 0
    s_nop 0
    buffer_load_dwordx4 v82, s[4:7], s50 offen sc1 lds
    s_add_u32 m0, s52, 1024
    s_nop 0
    buffer_load_dwordx4 v83, s[4:7], s50 offen sc1 lds
    s_add_u32 m0, s52, 2048
    s_nop 0
    buffer_load_dwordx4 v84, s[4:7], s50 offen sc1 lds
    s_add_u32 m0, s52, 3072
    s_nop 0
    buffer_load_dwordx4 v85, s[4:7], s50 offen sc1 lds
    s_add_u32 s43, s43, 81920
    s_add_u32 s44, s44, 221184
    s_add_u32 s51, s51, 1
    s_cmp_ge_u32 s51, 2
    s_cmov_b32 s43, 0x40000000
    s_cmov_b32 s44, 0x40000000
    s_add_u32 s46, s46, 24576
    s_cmp_eq_u32 s46, 147456
    s_cmov_b32 s46, 0
    s_add_u32 s52, s46, s54
    s_add_u32 s53, s46, s55
    s_add_u32 s43, s43, 81920
    s_add_u32 s44, s44, 221184
    s_add_u32 s51, s51, 1
    s_cmp_ge_u32 s51, 2
    s_cmov_b32 s43, 0x40000000
    s_cmov_b32 s44, 0x40000000
    s_add_u32 s46, s46, 24576
    s_cmp_eq_u32 s46, 147456
    s_cmov_b32 s46, 0
    s_add_u32 s52, s46, s54
    s_add_u32 s53, s46, s55
    s_add_u32 s43, s43, 81920
    s_add_u32 s44, s44, 221184
    s_add_u32 s51, s51, 1
    s_cmp_ge_u32 s51, 2
    s_cmov_b32 s43, 0x40000000
    s_cmov_b32 s44, 0x40000000
    s_add_u32 s46, s46, 24576
    s_cmp_eq_u32 s46, 147456
    s_cmov_b32 s46, 0
    s_add_u32 s52, s46, s54
    s_add_u32 s53, s46, s55
    s_add_u32 s43, s43, 81920
    s_add_u32 s44, s44, 221184
    s_add_u32 s51, s51, 1
    s_cmp_ge_u32 s51, 2
    s_cmov_b32 s43, 0x40000000
    s_cmov_b32 s44, 0x40000000
    s_add_u32 s46, s46, 24576
    s_cmp_eq_u32 s46, 147456
    s_cmov_b32 s46, 0
    s_add_u32 s52, s46, s54
    s_add_u32 s53, s46, s55
    s_add_u32 s43, s43, 81920
    s_add_u32 s44, s44, 221184
    s_add_u32 s51, s51, 1
    s_cmp_ge_u32 s51, 2
    s_cmov_b32 s43, 0x40000000
    s_cmov_b32 s44, 0x40000000
    s_add_u32 s46, s46, 24576
    s_cmp_eq_u32 s46, 147456
    s_cmov_b32 s46, 0
    s_add_u32 s52, s46, s54
    s_add_u32 s53, s46, s55
    s_add_u32 s43, s43, 81920
    s_add_u32 s44, s44, 221184
    s_add_u32 s51, s51, 1
    s_cmp_ge_u32 s51, 2
    s_cmov_b32 s43, 0x40000000
    s_cmov_b32 s44, 0x40000000
    s_add_u32 s46, s46, 24576
    s_cmp_eq_u32 s46, 147456
    s_cmov_b32 s46, 0
    s_add_u32 s52, s46, s54
    s_add_u32 s53, s46, s55
    s_mov_b32 s45, 0
    s_mov_b32 s47, 0
    s_waitcnt vmcnt(20)
    s_barrier
    ds_read_b64_tr_b16 v[66:67], v92 offset:0
    ds_read_b64_tr_b16 v[68:69], v92 offset:512
    ds_read_b64_tr_b16 v[70:71], v93 offset:0
    ds_read_b64_tr_b16 v[72:73], v93 offset:512
    ds_read_b64_tr_b16 v[34:35], v88 offset:0
    ds_read_b64_tr_b16 v[36:37], v88 offset:1024
    ds_read_b64_tr_b16 v[38:39], v89 offset:0
    ds_read_b64_tr_b16 v[40:41], v89 offset:1024
    ds_read_b64_tr_b16 v[42:43], v90 offset:0
    ds_read_b64_tr_b16 v[44:45], v90 offset:1024
    ds_read_b64_tr_b16 v[46:47], v91 offset:0
    ds_read_b64_tr_b16 v[48:49], v91 offset:1024
    s_waitcnt lgkmcnt(0)
    v_mfma_f32_16x16x32_bf16 v[2:5], v[66:69], v[34:37], v[2:5]
    ds_read_b64_tr_b16 v[74:75], v92 offset:4096
    ds_read_b64_tr_b16 v[76:77], v92 offset:4608
    v_mfma_f32_16x16x32_bf16 v[6:9], v[66:69], v[38:41], v[6:9]
    ds_read_b64_tr_b16 v[78:79], v93 offset:4096
    ds_read_b64_tr_b16 v[80:81], v93 offset:4608
    v_mfma_f32_16x16x32_bf16 v[10:13], v[66:69], v[42:45], v[10:13]
    ds_read_b64_tr_b16 v[50:51], v88 offset:8192
    ds_read_b64_tr_b16 v[52:53], v88 offset:9216
    v_mfma_f32_16x16x32_bf16 v[14:17], v[66:69], v[46:49], v[14:17]
    ds_read_b64_tr_b16 v[54:55], v89 offset:8192
    ds_read_b64_tr_b16 v[56:57], v89 offset:9216
    v_mfma_f32_16x16x32_bf16 v[18:21], v[70:73], v[34:37], v[18:21]
    ds_read_b64_tr_b16 v[58:59], v90 offset:8192
    ds_read_b64_tr_b16 v[60:61], v90 offset:9216
    v_mfma_f32_16x16x32_bf16 v[22:25], v[70:73], v[38:41], v[22:25]
    ds_read_b64_tr_b16 v[62:63], v91 offset:8192
    ds_read_b64_tr_b16 v[64:65], v91 offset:9216
    v_mfma_f32_16x16x32_bf16 v[26:29], v[70:73], v[42:45], v[26:29]
    v_mfma_f32_16x16x32_bf16 v[30:33], v[70:73], v[46:49], v[30:33]
    s_add_u32 s47, s47, 1
    s_cmp_eq_u32 s47, 6
    s_mov_b32 s49, 24576
    s_cmov_b32 s49, 0xfffe2000
    s_cmov_b32 s47, 0
    s_waitcnt lgkmcnt(0)
    v_add_u32 v88, s49, v88
    v_add_u32 v89, s49, v89
    v_add_u32 v90, s49, v90
    v_add_u32 v91, s49, v91
    v_add_u32 v92, s49, v92
    v_add_u32 v93, s49, v93
    s_waitcnt vmcnt(16)
    s_barrier
    v_mfma_f32_16x16x32_bf16 v[2:5], v[74:77], v[50:53], v[2:5]
    ds_read_b64_tr_b16 v[66:67], v92 offset:0
    ds_read_b64_tr_b16 v[68:69], v92 offset:512
    v_mfma_f32_16x16x32_bf16 v[6:9], v[74:77], v[54:57], v[6:9]
    ds_read_b64_tr_b16 v[70:71], v93 offset:0
    ds_read_b64_tr_b16 v[72:73], v93 offset:512
    v_mfma_f32_16x16x32_bf16 v[10:13], v[74:77], v[58:61], v[10:13]
    ds_read_b64_tr_b16 v[34:35], v88 offset:0
    ds_read_b64_tr_b16 v[36:37], v88 offset:1024
    v_mfma_f32_16x16x32_bf16 v[14:17], v[74:77], v[62:65], v[14:17]
    ds_read_b64_tr_b16 v[38:39], v89 offset:0
    ds_read_b64_tr_b16 v[40:41], v89 offset:1024
    v_mfma_f32_16x16x32_bf16 v[18:21], v[78:81], v[50:53], v[18:21]
    ds_read_b64_tr_b16 v[42:43], v90 offset:0
    ds_read_b64_tr_b16 v[44:45], v90 offset:1024
    v_mfma_f32_16x16x32_bf16 v[22:25], v[78:81], v[54:57], v[22:25]
    ds_read_b64_tr_b16 v[46:47], v91 offset:0
    ds_read_b64_tr_b16 v[48:49], v91 offset:1024
    v_mfma_f32_16x16x32_bf16 v[26:29], v[78:81], v[58:61], v[26:29]
    v_mfma_f32_16x16x32_bf16 v[30:33], v[78:81], v[62:65], v[30:33]
    s_waitcnt lgkmcnt(0)
    v_mfma_f32_16x16x32_bf16 v[2:5], v[66:69], v[34:37], v[2:5]
    ds_read_b64_tr_b16 v[74:75], v92 offset:4096
    ds_read_b64_tr_b16 v[76:77], v92 offset:4608
    v_mfma_f32_16x16x32_bf16 v[6:9], v[66:69], v[38:41], v[6:9]
    ds_read_b64_tr_b16 v[78:79], v93 offset:4096
    ds_read_b64_tr_b16 v[80:81], v93 offset:4608
    v_mfma_f32_16x16x32_bf16 v[10:13], v[66:69], v[42:45], v[10:13]
    ds_read_b64_tr_b16 v[50:51], v88 offset:8192
    ds_read_b64_tr_b16 v[52:53], v88 offset:9216
    v_mfma_f32_16x16x32_bf16 v[14:17], v[66:69], v[46:49], v[14:17]
    ds_read_b64_tr_b16 v[54:55], v89 offset:8192
    ds_read_b64_tr_b16 v[56:57], v89 offset:9216
    v_mfma_f32_16x16x32_bf16 v[18:21], v[70:73], v[34:37], v[18:21]
    ds_read_b64_tr_b16 v[58:59], v90 offset:8192
    ds_read_b64_tr_b16 v[60:61], v90 offset:9216
    v_mfma_f32_16x16x32_bf16 v[22:25], v[70:73], v[38:41], v[22:25]
    ds_read_b64_tr_b16 v[62:63], v91 offset:8192
    ds_read_b64_tr_b16 v[64:65], v91 offset:9216
    v_mfma_f32_16x16x32_bf16 v[26:29], v[70:73], v[42:45], v[26:29]
    v_mfma_f32_16x16x32_bf16 v[30:33], v[70:73], v[46:49], v[30:33]
    s_waitcnt lgkmcnt(0)
    v_mfma_f32_16x16x32_bf16 v[2:5], v[74:77], v[50:53], v[2:5]
    v_mfma_f32_16x16x32_bf16 v[6:9], v[74:77], v[54:57], v[6:9]
    v_mfma_f32_16x16x32_bf16 v[10:13], v[74:77], v[58:61], v[10:13]
    v_mfma_f32_16x16x32_bf16 v[14:17], v[74:77], v[62:65], v[14:17]
    v_mfma_f32_16x16x32_bf16 v[18:21], v[78:81], v[50:53], v[18:21]
    v_mfma_f32_16x16x32_bf16 v[22:25], v[78:81], v[54:57], v[22:25]
    v_mfma_f32_16x16x32_bf16 v[26:29], v[78:81], v[58:61], v[26:29]
    v_mfma_f32_16x16x32_bf16 v[30:33], v[78:81], v[62:65], v[30:33]
    s_waitcnt vmcnt(0)
    s_nop 7
    s_nop 3
    s_mul_i32 s18, s17, 442368
    s_lshl_b32 s19, s16, 7
    s_add_u32 s18, s18, s19
    s_add_u32 s18, s18, 10485760
    v_and_b32 v109, 0xffff0000, v107
    v_lshlrev_b32 v108, 16, v107
    v_and_b32 v107, 0xffff0000, v106
    v_lshlrev_b32 v106, 16, v106
    v_and_b32 v113, 0xffff0000, v111
    v_lshlrev_b32 v112, 16, v111
    v_and_b32 v111, 0xffff0000, v110
    v_lshlrev_b32 v110, 16, v110
    s_mov_b32 s49, 0x3d372713
    s_mov_b32 s50, 0xc0135761
    s_barrier
    s_mul_i32 s48, s40, 5120
    s_add_u32 s48, s48, 0
    v_mul_u32_u24 v98, 80, v95
    v_lshl_add_u32 v98, v96, 3, v98
    v_add_u32 v98, s48, v98
    v_add_f32 v2, v2, v106
    v_add_f32 v3, v3, v107
    v_add_f32 v4, v4, v108
    v_add_f32 v5, v5, v109
    v_mul_f32 v102, v2, v2
    v_mul_f32 v103, v3, v3
    v_mul_f32 v97, v4, v4
    v_mul_f32 v101, v5, v5
    v_fma_f32 v102, v102, s49, 1.0
    v_fma_f32 v103, v103, s49, 1.0
    v_fma_f32 v97, v97, s49, 1.0
    v_fma_f32 v101, v101, s49, 1.0
    v_mul_f32 v102, v102, v2
    v_mul_f32 v103, v103, v3
    v_mul_f32 v97, v97, v4
    v_mul_f32 v101, v101, v5
    v_mul_f32 v102, s50, v102
    v_mul_f32 v103, s50, v103
    v_mul_f32 v97, s50, v97
    v_mul_f32 v101, s50, v101
    v_exp_f32 v102, v102
    v_exp_f32 v103, v103
    v_exp_f32 v97, v97
    v_exp_f32 v101, v101
    v_add_f32 v102, 1.0, v102
    v_add_f32 v103, 1.0, v103
    v_add_f32 v97, 1.0, v97
    v_add_f32 v101, 1.0, v101
    v_rcp_f32 v102, v102
    v_rcp_f32 v103, v103
    v_rcp_f32 v97, v97
    v_rcp_f32 v101, v101
    v_mul_f32 v2, v2, v102
    v_mul_f32 v3, v3, v103
    v_mul_f32 v4, v4, v97
    v_mul_f32 v5, v5, v101
    v_cvt_pk_bf16_f32 v2, v2, v3
    v_cvt_pk_bf16_f32 v3, v4, v5
    ds_write_b64 v98, v[2:3] offset:0
    v_add_f32 v6, v6, v106
    v_add_f32 v7, v7, v107
    v_add_f32 v8, v8, v108
    v_add_f32 v9, v9, v109
    v_mul_f32 v102, v6, v6
    v_mul_f32 v103, v7, v7
    v_mul_f32 v97, v8, v8
    v_mul_f32 v101, v9, v9
    v_fma_f32 v102, v102, s49, 1.0
    v_fma_f32 v103, v103, s49, 1.0
    v_fma_f32 v97, v97, s49, 1.0
    v_fma_f32 v101, v101, s49, 1.0
    v_mul_f32 v102, v102, v6
    v_mul_f32 v103, v103, v7
    v_mul_f32 v97, v97, v8
    v_mul_f32 v101, v101, v9
    v_mul_f32 v102, s50, v102
    v_mul_f32 v103, s50, v103
    v_mul_f32 v97, s50, v97
    v_mul_f32 v101, s50, v101
    v_exp_f32 v102, v102
    v_exp_f32 v103, v103
    v_exp_f32 v97, v97
    v_exp_f32 v101, v101
    v_add_f32 v102, 1.0, v102
    v_add_f32 v103, 1.0, v103
    v_add_f32 v97, 1.0, v97
    v_add_f32 v101, 1.0, v101
    v_rcp_f32 v102, v102
    v_rcp_f32 v103, v103
    v_rcp_f32 v97, v97
    v_rcp_f32 v101, v101
    v_mul_f32 v6, v6, v102
    v_mul_f32 v7, v7, v103
    v_mul_f32 v8, v8, v97
    v_mul_f32 v9, v9, v101
    v_cvt_pk_bf16_f32 v6, v6, v7
    v_cvt_pk_bf16_f32 v7, v8, v9
    ds_write_b64 v98, v[6:7] offset:1280
    v_add_f32 v10, v10, v106
    v_add_f32 v11, v11, v107
    v_add_f32 v12, v12, v108
    v_add_f32 v13, v13, v109
    v_mul_f32 v102, v10, v10
    v_mul_f32 v103, v11, v11
    v_mul_f32 v97, v12, v12
    v_mul_f32 v101, v13, v13
    v_fma_f32 v102, v102, s49, 1.0
    v_fma_f32 v103, v103, s49, 1.0
    v_fma_f32 v97, v97, s49, 1.0
    v_fma_f32 v101, v101, s49, 1.0
    v_mul_f32 v102, v102, v10
    v_mul_f32 v103, v103, v11
    v_mul_f32 v97, v97, v12
    v_mul_f32 v101, v101, v13
    v_mul_f32 v102, s50, v102
    v_mul_f32 v103, s50, v103
    v_mul_f32 v97, s50, v97
    v_mul_f32 v101, s50, v101
    v_exp_f32 v102, v102
    v_exp_f32 v103, v103
    v_exp_f32 v97, v97
    v_exp_f32 v101, v101
    v_add_f32 v102, 1.0, v102
    v_add_f32 v103, 1.0, v103
    v_add_f32 v97, 1.0, v97
    v_add_f32 v101, 1.0, v101
    v_rcp_f32 v102, v102
    v_rcp_f32 v103, v103
    v_rcp_f32 v97, v97
    v_rcp_f32 v101, v101
    v_mul_f32 v10, v10, v102
    v_mul_f32 v11, v11, v103
    v_mul_f32 v12, v12, v97
    v_mul_f32 v13, v13, v101
    v_cvt_pk_bf16_f32 v10, v10, v11
    v_cvt_pk_bf16_f32 v11, v12, v13
    ds_write_b64 v98, v[10:11] offset:2560
    v_add_f32 v14, v14, v106
    v_add_f32 v15, v15, v107
    v_add_f32 v16, v16, v108
    v_add_f32 v17, v17, v109
    v_mul_f32 v102, v14, v14
    v_mul_f32 v103, v15, v15
    v_mul_f32 v97, v16, v16
    v_mul_f32 v101, v17, v17
    v_fma_f32 v102, v102, s49, 1.0
    v_fma_f32 v103, v103, s49, 1.0
    v_fma_f32 v97, v97, s49, 1.0
    v_fma_f32 v101, v101, s49, 1.0
    v_mul_f32 v102, v102, v14
    v_mul_f32 v103, v103, v15
    v_mul_f32 v97, v97, v16
    v_mul_f32 v101, v101, v17
    v_mul_f32 v102, s50, v102
    v_mul_f32 v103, s50, v103
    v_mul_f32 v97, s50, v97
    v_mul_f32 v101, s50, v101
    v_exp_f32 v102, v102
    v_exp_f32 v103, v103
    v_exp_f32 v97, v97
    v_exp_f32 v101, v101
    v_add_f32 v102, 1.0, v102
    v_add_f32 v103, 1.0, v103
    v_add_f32 v97, 1.0, v97
    v_add_f32 v101, 1.0, v101
    v_rcp_f32 v102, v102
    v_rcp_f32 v103, v103
    v_rcp_f32 v97, v97
    v_rcp_f32 v101, v101
    v_mul_f32 v14, v14, v102
    v_mul_f32 v15, v15, v103
    v_mul_f32 v16, v16, v97
    v_mul_f32 v17, v17, v101
    v_cvt_pk_bf16_f32 v14, v14, v15
    v_cvt_pk_bf16_f32 v15, v16, v17
    ds_write_b64 v98, v[14:15] offset:3840
    v_add_f32 v18, v18, v110
    v_add_f32 v19, v19, v111
    v_add_f32 v20, v20, v112
    v_add_f32 v21, v21, v113
    v_mul_f32 v102, v18, v18
    v_mul_f32 v103, v19, v19
    v_mul_f32 v97, v20, v20
    v_mul_f32 v101, v21, v21
    v_fma_f32 v102, v102, s49, 1.0
    v_fma_f32 v103, v103, s49, 1.0
    v_fma_f32 v97, v97, s49, 1.0
    v_fma_f32 v101, v101, s49, 1.0
    v_mul_f32 v102, v102, v18
    v_mul_f32 v103, v103, v19
    v_mul_f32 v97, v97, v20
    v_mul_f32 v101, v101, v21
    v_mul_f32 v102, s50, v102
    v_mul_f32 v103, s50, v103
    v_mul_f32 v97, s50, v97
    v_mul_f32 v101, s50, v101
    v_exp_f32 v102, v102
    v_exp_f32 v103, v103
    v_exp_f32 v97, v97
    v_exp_f32 v101, v101
    v_add_f32 v102, 1.0, v102
    v_add_f32 v103, 1.0, v103
    v_add_f32 v97, 1.0, v97
    v_add_f32 v101, 1.0, v101
    v_rcp_f32 v102, v102
    v_rcp_f32 v103, v103
    v_rcp_f32 v97, v97
    v_rcp_f32 v101, v101
    v_mul_f32 v18, v18, v102
    v_mul_f32 v19, v19, v103
    v_mul_f32 v20, v20, v97
    v_mul_f32 v21, v21, v101
    v_cvt_pk_bf16_f32 v18, v18, v19
    v_cvt_pk_bf16_f32 v19, v20, v21
    ds_write_b64 v98, v[18:19] offset:32
    v_add_f32 v22, v22, v110
    v_add_f32 v23, v23, v111
    v_add_f32 v24, v24, v112
    v_add_f32 v25, v25, v113
    v_mul_f32 v102, v22, v22
    v_mul_f32 v103, v23, v23
    v_mul_f32 v97, v24, v24
    v_mul_f32 v101, v25, v25
    v_fma_f32 v102, v102, s49, 1.0
    v_fma_f32 v103, v103, s49, 1.0
    v_fma_f32 v97, v97, s49, 1.0
    v_fma_f32 v101, v101, s49, 1.0
    v_mul_f32 v102, v102, v22
    v_mul_f32 v103, v103, v23
    v_mul_f32 v97, v97, v24
    v_mul_f32 v101, v101, v25
    v_mul_f32 v102, s50, v102
    v_mul_f32 v103, s50, v103
    v_mul_f32 v97, s50, v97
    v_mul_f32 v101, s50, v101
    v_exp_f32 v102, v102
    v_exp_f32 v103, v103
    v_exp_f32 v97, v97
    v_exp_f32 v101, v101
    v_add_f32 v102, 1.0, v102
    v_add_f32 v103, 1.0, v103
    v_add_f32 v97, 1.0, v97
    v_add_f32 v101, 1.0, v101
    v_rcp_f32 v102, v102
    v_rcp_f32 v103, v103
    v_rcp_f32 v97, v97
    v_rcp_f32 v101, v101
    v_mul_f32 v22, v22, v102
    v_mul_f32 v23, v23, v103
    v_mul_f32 v24, v24, v97
    v_mul_f32 v25, v25, v101
    v_cvt_pk_bf16_f32 v22, v22, v23
    v_cvt_pk_bf16_f32 v23, v24, v25
    ds_write_b64 v98, v[22:23] offset:1312
    v_add_f32 v26, v26, v110
    v_add_f32 v27, v27, v111
    v_add_f32 v28, v28, v112
    v_add_f32 v29, v29, v113
    v_mul_f32 v102, v26, v26
    v_mul_f32 v103, v27, v27
    v_mul_f32 v97, v28, v28
    v_mul_f32 v101, v29, v29
    v_fma_f32 v102, v102, s49, 1.0
    v_fma_f32 v103, v103, s49, 1.0
    v_fma_f32 v97, v97, s49, 1.0
    v_fma_f32 v101, v101, s49, 1.0
    v_mul_f32 v102, v102, v26
    v_mul_f32 v103, v103, v27
    v_mul_f32 v97, v97, v28
    v_mul_f32 v101, v101, v29
    v_mul_f32 v102, s50, v102
    v_mul_f32 v103, s50, v103
    v_mul_f32 v97, s50, v97
    v_mul_f32 v101, s50, v101
    v_exp_f32 v102, v102
    v_exp_f32 v103, v103
    v_exp_f32 v97, v97
    v_exp_f32 v101, v101
    v_add_f32 v102, 1.0, v102
    v_add_f32 v103, 1.0, v103
    v_add_f32 v97, 1.0, v97
    v_add_f32 v101, 1.0, v101
    v_rcp_f32 v102, v102
    v_rcp_f32 v103, v103
    v_rcp_f32 v97, v97
    v_rcp_f32 v101, v101
    v_mul_f32 v26, v26, v102
    v_mul_f32 v27, v27, v103
    v_mul_f32 v28, v28, v97
    v_mul_f32 v29, v29, v101
    v_cvt_pk_bf16_f32 v26, v26, v27
    v_cvt_pk_bf16_f32 v27, v28, v29
    ds_write_b64 v98, v[26:27] offset:2592
    v_add_f32 v30, v30, v110
    v_add_f32 v31, v31, v111
    v_add_f32 v32, v32, v112
    v_add_f32 v33, v33, v113
    v_mul_f32 v102, v30, v30
    v_mul_f32 v103, v31, v31
    v_mul_f32 v97, v32, v32
    v_mul_f32 v101, v33, v33
    v_fma_f32 v102, v102, s49, 1.0
    v_fma_f32 v103, v103, s49, 1.0
    v_fma_f32 v97, v97, s49, 1.0
    v_fma_f32 v101, v101, s49, 1.0
    v_mul_f32 v102, v102, v30
    v_mul_f32 v103, v103, v31
    v_mul_f32 v97, v97, v32
    v_mul_f32 v101, v101, v33
    v_mul_f32 v102, s50, v102
    v_mul_f32 v103, s50, v103
    v_mul_f32 v97, s50, v97
    v_mul_f32 v101, s50, v101
    v_exp_f32 v102, v102
    v_exp_f32 v103, v103
    v_exp_f32 v97, v97
    v_exp_f32 v101, v101
    v_add_f32 v102, 1.0, v102
    v_add_f32 v103, 1.0, v103
    v_add_f32 v97, 1.0, v97
    v_add_f32 v101, 1.0, v101
    v_rcp_f32 v102, v102
    v_rcp_f32 v103, v103
    v_rcp_f32 v97, v97
    v_rcp_f32 v101, v101
    v_mul_f32 v30, v30, v102
    v_mul_f32 v31, v31, v103
    v_mul_f32 v32, v32, v97
    v_mul_f32 v33, v33, v101
    v_cvt_pk_bf16_f32 v30, v30, v31
    v_cvt_pk_bf16_f32 v31, v32, v33
    ds_write_b64 v98, v[30:31] offset:3872
    v_lshrrev_b32 v99, 2, v94
    v_and_b32 v100, 3, v94
    s_mov_b32 s50, 3456
    v_mul_lo_u32 v101, v99, s50
    v_mul_u32_u24 v99, 80, v99
    v_lshl_add_u32 v99, v100, 4, v99
    v_add_u32 v99, s48, v99
    v_lshl_add_u32 v100, v100, 4, v101
    s_mul_i32 s48, s41, 221184
    s_mul_i32 s49, s42, 64
    s_add_u32 s48, s48, s49
    s_add_u32 s48, s48, s18
    s_waitcnt lgkmcnt(0)
    ds_read_b128 v[2:5], v99 offset:0
    ds_read_b128 v[6:9], v99 offset:1280
    ds_read_b128 v[10:13], v99 offset:2560
    ds_read_b128 v[14:17], v99 offset:3840
    s_waitcnt lgkmcnt(3)
    buffer_store_dwordx4 v[2:5], v100, s[4:7], s48 offen sc1
    s_add_u32 s48, s48, 55296
    s_waitcnt lgkmcnt(2)
    buffer_store_dwordx4 v[6:9], v100, s[4:7], s48 offen sc1
    s_add_u32 s48, s48, 55296
    s_waitcnt lgkmcnt(1)
    buffer_store_dwordx4 v[10:13], v100, s[4:7], s48 offen sc1
    s_add_u32 s48, s48, 55296
    s_waitcnt lgkmcnt(0)
    buffer_store_dwordx4 v[14:17], v100, s[4:7], s48 offen sc1
    s_add_u32 s48, s48, 55296
    s_lshl_b32 s77, s17, 7
    s_add_u32 s77, s77, 821376
    s_waitcnt vmcnt(0)
    s_barrier
    s_cmp_lg_u32 s26, 0
    s_cbranch_scc1 L_sig_180
    v_mov_b32 v1, 0
    v_mov_b32 v2, 1
    s_mov_b64 exec, 1
    buffer_atomic_add v2, v1, s[4:7], s77 offen
    s_mov_b64 exec, -1
L_sig_180:
    s_branch L_next_104
L_m2t_109:
    s_load_dwordx2 s[8:9], s[0:1], 80
    s_load_dwordx2 s[12:13], s[0:1], 88
    s_load_dwordx2 s[16:17], s[0:1], 112
    s_lshr_b32 s29, s76, 3
    s_and_b32 s28, s76, 7
    v_and_b32 v78, 63, v0
    v_and_b32 v79, 15, v78
    v_lshrrev_b32 v80, 4, v78
    v_lshrrev_b32 v81, 6, v0
    s_nop 0
    v_readfirstlane_b32 s40, v81
    s_nop 0
    s_and_b32 s41, s40, 3
    s_lshr_b32 s42, s40, 2
    s_waitcnt lgkmcnt(0)
    s_and_b32 s9, s9, 0xffff
    s_mov_b32 s10, 7077888
    s_mov_b32 s11, 0x20000
    s_and_b32 s13, s13, 0xffff
    s_mov_b32 s14, 4096
    s_mov_b32 s15, 0x20000
    s_and_b32 s17, s17, 0xffff
    s_mov_b32 s18, 2621440
    s_mov_b32 s19, 0x20000
    s_mul_i32 s48, s40, 2
    s_add_u32 s48, s48, 0
    v_lshrrev_b32 v82, 3, v78
    s_lshl_b32 s49, s48, 3
    v_add_u32 v82, s49, v82
    v_and_b32 v83, 7, v78
    v_bfe_u32 v84, v82, 1, 1
    v_bfe_u32 v85, v82, 3, 1
    v_lshl_add_u32 v84, v85, 1, v84
    v_lshlrev_b32 v84, 1, v84
    v_xor_b32 v83, v83, v84
    s_mov_b32 s49, 4096
    v_mul_lo_u32 v82, v82, s49
    v_lshl_add_u32 v70, v83, 4, v82
    s_mul_i32 s48, s40, 2
    s_add_u32 s48, s48, 1
    v_lshrrev_b32 v82, 3, v78
    s_lshl_b32 s49, s48, 3
    v_add_u32 v82, s49, v82
    v_and_b32 v83, 7, v78
    v_bfe_u32 v84, v82, 1, 1
    v_bfe_u32 v85, v82, 3, 1
    v_lshl_add_u32 v84, v85, 1, v84
    v_lshlrev_b32 v84, 1, v84
    v_xor_b32 v83, v83, v84
    s_mov_b32 s49, 4096
    v_mul_lo_u32 v82, v82, s49
    v_lshl_add_u32 v71, v83, 4, v82
    s_mul_i32 s48, s40, 3
    s_add_u32 s48, s48, 0
    v_lshrrev_b32 v82, 3, v78
    s_lshl_b32 s49, s48, 3
    v_add_u32 v82, s49, v82
    v_and_b32 v83, 7, v78
    v_bfe_u32 v84, v82, 1, 3
    v_xor_b32 v83, v83, v84
    v_cmp_gt_u32 vcc, 80, v82
    s_mov_b32 s49, 3456
    v_mul_lo_u32 v82, v82, s49
    v_lshl_add_u32 v72, v83, 4, v82
    v_mov_b32 v82, 0x40000000
    v_cndmask_b32 v72, v82, v72, vcc
    s_mul_i32 s48, s40, 3
    s_add_u32 s48, s48, 1
    v_lshrrev_b32 v82, 3, v78
    s_lshl_b32 s49, s48, 3
    v_add_u32 v82, s49, v82
    v_and_b32 v83, 7, v78
    v_bfe_u32 v84, v82, 1, 3
    v_xor_b32 v83, v83, v84
    v_cmp_gt_u32 vcc, 80, v82
    s_mov_b32 s49, 3456
    v_mul_lo_u32 v82, v82, s49
    v_lshl_add_u32 v73, v83, 4, v82
    v_mov_b32 v82, 0x40000000
    v_cndmask_b32 v73, v82, v73, vcc
    s_mul_i32 s48, s40, 3
    s_add_u32 s48, s48, 2
    v_lshrrev_b32 v82, 3, v78
    s_lshl_b32 s49, s48, 3
    v_add_u32 v82, s49, v82
    v_and_b32 v83, 7, v78
    v_bfe_u32 v84, v82, 1, 3
    v_xor_b32 v83, v83, v84
    v_cmp_gt_u32 vcc, 80, v82
    s_mov_b32 s49, 3456
    v_mul_lo_u32 v82, v82, s49
    v_lshl_add_u32 v74, v83, 4, v82
    v_mov_b32 v82, 0x40000000
    v_cndmask_b32 v74, v82, v74, vcc
    v_lshrrev_b32 v82, 2, v79
    v_and_b32 v83, 3, v79
    v_lshrrev_b32 v84, 1, v82
    v_and_b32 v85, 1, v80
    v_lshl_add_u32 v84, v85, 1, v84
    v_lshlrev_b32 v84, 1, v84
    v_lshrrev_b32 v85, 1, v83
    v_xor_b32 v84, v84, v85
    v_lshlrev_b32 v84, 4, v84
    v_and_b32 v85, 1, v83
    v_lshl_add_u32 v84, v85, 3, v84
    v_lshl_add_u32 v85, v80, 3, v82
    s_mov_b32 s48, 128
    v_mul_lo_u32 v85, v85, s48
    v_add_u32 v84, v84, v85
    s_mul_i32 s48, s41, 1
    s_add_u32 s48, s48, 0
    s_and_b32 s49, s48, 3
    s_lshl_b32 s49, s49, 5
    v_xor_b32 v75, s49, v84
    s_lshr_b32 s48, s48, 3
    s_lshl_b32 s48, s48, 8
    s_add_u32 s48, s48, 0
    v_add_u32 v75, s48, v75
    v_bfe_u32 v82, v79, 1, 3
    v_xor_b32 v82, v82, v80
    v_lshlrev_b32 v82, 4, v82
    v_lshl_add_u32 v82, v79, 7, v82
    s_mul_i32 s48, s42, 10240
    s_add_u32 s48, s48, 8192
    v_add_u32 v76, s48, v82
    v_xor_b32 v77, 64, v76
    s_lshl_b32 s43, s29, 7
    s_mul_i32 s44, s28, 276480
    s_add_u32 s44, s44, 10485760
    s_mul_i32 s31, s29, 81920
    s_mul_i32 s30, s28, 160
    s_add_u32 s31, s31, s30
    s_add_u32 s30, s31, 4194304
    v_mul_u32_u24 v82, 6554, v78
    v_lshrrev_b32 v82, 16, v82
    v_mul_u32_u24 v83, 10, v82
    v_sub_u32 v83, v78, v83
    v_add_u32 v82, 0, v82
    s_mov_b32 s50, 1280
    v_mul_lo_u32 v88, v82, s50
    v_lshl_add_u32 v88, v83, 4, v88
    v_mov_b32 v84, 0x40000000
    v_cmp_gt_u32 vcc, 60, v78
    s_nop 1
    v_cndmask_b32 v88, v84, v88, vcc
    v_mul_u32_u24 v82, 6554, v78
    v_lshrrev_b32 v82, 16, v82
    v_mul_u32_u24 v83, 10, v82
    v_sub_u32 v83, v78, v83
    v_add_u32 v82, 6, v82
    s_mov_b32 s50, 1280
    v_mul_lo_u32 v89, v82, s50
    v_lshl_add_u32 v89, v83, 4, v89
    v_mov_b32 v84, 0x40000000
    v_cmp_gt_u32 vcc, 60, v78
    s_nop 1
    v_cndmask_b32 v89, v84, v89, vcc
    v_mul_u32_u24 v82, 6554, v78
    v_lshrrev_b32 v82, 16, v82
    v_mul_u32_u24 v83, 10, v82
    v_sub_u32 v83, v78, v83
    v_add_u32 v82, 12, v82
    s_mov_b32 s50, 1280
    v_mul_lo_u32 v90, v82, s50
    v_lshl_add_u32 v90, v83, 4, v90
    v_mov_b32 v84, 0x40000000
    v_cmp_gt_u32 vcc, 40, v78
    s_nop 1
    v_cndmask_b32 v90, v84, v90, vcc
    s_mul_i32 s54, s40, 2048
    s_mul_i32 s55, s40, 3072
    s_mov_b32 s46, 0
    s_mov_b32 s51, 0
    s_mov_b32 s52, s54
    s_mov_b32 s53, s55
    s_add_u32 s50, s43, 0
    s_add_u32 s52, s54, 0
    s_add_u32 m0, s52, 0
    s_nop 0
    buffer_load_dwordx4 v70, s[8:11], s50 offen lds
    s_add_u32 m0, s52, 1024
    s_nop 0
    buffer_load_dwordx4 v71, s[8:11], s50 offen lds
    s_add_u32 s50, s43, 262144
    s_add_u32 s52, s54, 20480
    s_add_u32 m0, s52, 0
    s_nop 0
    buffer_load_dwordx4 v70, s[8:11], s50 offen lds
    s_add_u32 m0, s52, 1024
    s_nop 0
    buffer_load_dwordx4 v71, s[8:11], s50 offen lds
    s_add_u32 s50, s43, 524288
    s_add_u32 s52, s54, 40960
    s_add_u32 m0, s52, 0
    s_nop 0
    buffer_load_dwordx4 v70, s[8:11], s50 offen lds
    s_add_u32 m0, s52, 1024
    s_nop 0
    buffer_load_dwordx4 v71, s[8:11], s50 offen lds
    s_add_u32 s50, s43, 786432
    s_add_u32 s52, s54, 61440
    s_add_u32 m0, s52, 0
    s_nop 0
    buffer_load_dwordx4 v70, s[8:11], s50 offen lds
    s_add_u32 m0, s52, 1024
    s_nop 0
    buffer_load_dwordx4 v71, s[8:11], s50 offen lds
    s_add_u32 s50, s43, 1048576
    s_add_u32 s52, s54, 81920
    s_add_u32 m0, s52, 0
    s_nop 0
    buffer_load_dwordx4 v70, s[8:11], s50 offen lds
    s_add_u32 m0, s52, 1024
    s_nop 0
    buffer_load_dwordx4 v71, s[8:11], s50 offen lds
    s_add_u32 s50, s43, 1310720
    s_add_u32 s52, s54, 102400
    s_add_u32 m0, s52, 0
    s_nop 0
    buffer_load_dwordx4 v70, s[8:11], s50 offen lds
    s_add_u32 m0, s52, 1024
    s_nop 0
    buffer_load_dwordx4 v71, s[8:11], s50 offen lds
    s_mul_i32 s77, s28, 80
    s_add_u32 s77, s77, 0
    s_lshr_b32 s77, s77, 7
    s_lshl_b32 s77, s77, 7
    s_add_u32 s77, s77, 821376
    s_cmp_lg_u32 s26, 0
    s_cbranch_scc1 L_wgw_181
    s_mov_b32 s79, 0x200000
    v_mov_b32 v86, 0
L_cw_182:
    buffer_load_dword v87, v86, s[4:7], s77 offen sc1
    s_waitcnt vmcnt(0)
    v_readfirstlane_b32 s78, v87
    s_nop 0
    s_cmp_ge_u32 s78, 27
    s_cbranch_scc1 L_cd_183
    s_sleep 2
    s_sub_u32 s79, s79, 1
    s_cbranch_scc0 L_cw_182
L_cd_183:
L_wgw_181:
    s_barrier
    s_mul_i32 s77, s28, 80
    s_add_u32 s77, s77, 79
    s_lshr_b32 s77, s77, 7
    s_lshl_b32 s77, s77, 7
    s_add_u32 s77, s77, 821376
    s_cmp_lg_u32 s26, 0
    s_cbranch_scc1 L_wgw_184
    s_mov_b32 s79, 0x200000
    v_mov_b32 v86, 0
L_cw_185:
    buffer_load_dword v87, v86, s[4:7], s77 offen sc1
    s_waitcnt vmcnt(0)
    v_readfirstlane_b32 s78, v87
    s_nop 0
    s_cmp_ge_u32 s78, 27
    s_cbranch_scc1 L_cd_186
    s_sleep 2
    s_sub_u32 s79, s79, 1
    s_cbranch_scc0 L_cw_185
L_cd_186:
L_wgw_184:
    s_barrier
    s_mul_i32 s48, s28, 320
    s_add_u32 s48, s48, 12800
    v_lshlrev_b32 v86, 4, v80
    buffer_load_dwordx4 v[92:95], v86, s[4:7], s48 offen offset:0 sc1
    buffer_load_dwordx4 v[96:99], v86, s[4:7], s48 offen offset:64 sc1
    buffer_load_dwordx4 v[100:103], v86, s[4:7], s48 offen offset:128 sc1
    buffer_load_dwordx4 v[104:107], v86, s[4:7], s48 offen offset:192 sc1
    buffer_load_dwordx4 v[108:111], v86, s[4:7], s48 offen offset:256 sc1
    s_lshl_b32 s48, s29, 6
    s_lshl_b32 s49, s41, 4
    s_add_u32 s48, s48, s49
    s_lshl_b32 s48, s48, 1
    v_lshlrev_b32 v87, 1, v79
    buffer_load_ushort v112, v87, s[12:15], s48 offen
    s_mul_i32 s48, s41, 20480
    s_add_u32 s48, s48, s30
    buffer_load_dwordx4 v[114:117], v88, s[4:7], s48 offen sc1
    buffer_load_dwordx4 v[118:121], v89, s[4:7], s48 offen sc1
    buffer_load_dwordx4 v[122:125], v90, s[4:7], s48 offen sc1
    s_add_u32 s50, s44, 0
    s_add_u32 s53, s55, 0
    s_add_u32 m0, s53, 8192
    s_nop 0
    buffer_load_dwordx4 v72, s[4:7], s50 offen sc1 lds
    s_add_u32 m0, s53, 9216
    s_nop 0
    buffer_load_dwordx4 v73, s[4:7], s50 offen sc1 lds
    s_add_u32 m0, s53, 10240
    s_nop 0
    buffer_load_dwordx4 v74, s[4:7], s50 offen sc1 lds
    s_add_u32 s50, s44, 128
    s_add_u32 s53, s55, 20480
    s_add_u32 m0, s53, 8192
    s_nop 0
    buffer_load_dwordx4 v72, s[4:7], s50 offen sc1 lds
    s_add_u32 m0, s53, 9216
    s_nop 0
    buffer_load_dwordx4 v73, s[4:7], s50 offen sc1 lds
    s_add_u32 m0, s53, 10240
    s_nop 0
    buffer_load_dwordx4 v74, s[4:7], s50 offen sc1 lds
    s_add_u32 s50, s44, 256
    s_add_u32 s53, s55, 40960
    s_add_u32 m0, s53, 8192
    s_nop 0
    buffer_load_dwordx4 v72, s[4:7], s50 offen sc1 lds
    s_add_u32 m0, s53, 9216
    s_nop 0
    buffer_load_dwordx4 v73, s[4:7], s50 offen sc1 lds
    s_add_u32 m0, s53, 10240
    s_nop 0
    buffer_load_dwordx4 v74, s[4:7], s50 offen sc1 lds
    s_add_u32 s50, s44, 384
    s_add_u32 s53, s55, 61440
    s_add_u32 m0, s53, 8192
    s_nop 0
    buffer_load_dwordx4 v72, s[4:7], s50 offen sc1 lds
    s_add_u32 m0, s53, 9216
    s_nop 0
    buffer_load_dwordx4 v73, s[4:7], s50 offen sc1 lds
    s_add_u32 m0, s53, 10240
    s_nop 0
    buffer_load_dwordx4 v74, s[4:7], s50 offen sc1 lds
    s_add_u32 s50, s44, 512
    s_add_u32 s53, s55, 81920
    s_add_u32 m0, s53, 8192
    s_nop 0
    buffer_load_dwordx4 v72, s[4:7], s50 offen sc1 lds
    s_add_u32 m0, s53, 9216
    s_nop 0
    buffer_load_dwordx4 v73, s[4:7], s50 offen sc1 lds
    s_add_u32 m0, s53, 10240
    s_nop 0
    buffer_load_dwordx4 v74, s[4:7], s50 offen sc1 lds
    s_add_u32 s50, s44, 640
    s_add_u32 s53, s55, 102400
    s_add_u32 m0, s53, 8192
    s_nop 0
    buffer_load_dwordx4 v72, s[4:7], s50 offen sc1 lds
    s_add_u32 m0, s53, 9216
    s_nop 0
    buffer_load_dwordx4 v73, s[4:7], s50 offen sc1 lds
    s_add_u32 m0, s53, 10240
    s_nop 0
    buffer_load_dwordx4 v74, s[4:7], s50 offen sc1 lds
    s_add_u32 s43, s43, 262144
    s_add_u32 s44, s44, 128
    s_add_u32 s51, s51, 1
    s_cmp_ge_u32 s51, 27
    s_cmov_b32 s43, 0x40000000
    s_cmov_b32 s44, 0x40000000
    s_add_u32 s46, s46, 20480
    s_cmp_eq_u32 s46, 122880
    s_cmov_b32 s46, 0
    s_add_u32 s52, s46, s54
    s_add_u32 s53, s46, s55
    s_add_u32 s43, s43, 262144
    s_add_u32 s44, s44, 128
    s_add_u32 s51, s51, 1
    s_cmp_ge_u32 s51, 27
    s_cmov_b32 s43, 0x40000000
    s_cmov_b32 s44, 0x40000000
    s_add_u32 s46, s46, 20480
    s_cmp_eq_u32 s46, 122880
    s_cmov_b32 s46, 0
    s_add_u32 s52, s46, s54
    s_add_u32 s53, s46, s55
    s_add_u32 s43, s43, 262144
    s_add_u32 s44, s44, 128
    s_add_u32 s51, s51, 1
    s_cmp_ge_u32 s51, 27
    s_cmov_b32 s43, 0x40000000
    s_cmov_b32 s44, 0x40000000
    s_add_u32 s46, s46, 20480
    s_cmp_eq_u32 s46, 122880
    s_cmov_b32 s46, 0
    s_add_u32 s52, s46, s54
    s_add_u32 s53, s46, s55
    s_add_u32 s43, s43, 262144
    s_add_u32 s44, s44, 128
    s_add_u32 s51, s51, 1
    s_cmp_ge_u32 s51, 27
    s_cmov_b32 s43, 0x40000000
    s_cmov_b32 s44, 0x40000000
    s_add_u32 s46, s46, 20480
    s_cmp_eq_u32 s46, 122880
    s_cmov_b32 s46, 0
    s_add_u32 s52, s46, s54
    s_add_u32 s53, s46, s55
    s_add_u32 s43, s43, 262144
    s_add_u32 s44, s44, 128
    s_add_u32 s51, s51, 1
    s_cmp_ge_u32 s51, 27
    s_cmov_b32 s43, 0x40000000
    s_cmov_b32 s44, 0x40000000
    s_add_u32 s46, s46, 20480
    s_cmp_eq_u32 s46, 122880
    s_cmov_b32 s46, 0
    s_add_u32 s52, s46, s54
    s_add_u32 s53, s46, s55
    s_add_u32 s43, s43, 262144
    s_add_u32 s44, s44, 128
    s_add_u32 s51, s51, 1
    s_cmp_ge_u32 s51, 27
    s_cmov_b32 s43, 0x40000000
    s_cmov_b32 s44, 0x40000000
    s_add_u32 s46, s46, 20480
    s_cmp_eq_u32 s46, 122880
    s_cmov_b32 s46, 0
    s_add_u32 s52, s46, s54
    s_add_u32 s53, s46, s55
    v_mov_b32 v2, 0
    v_mov_b32 v3, 0
    v_mov_b32 v4, 0
    v_mov_b32 v5, 0
    v_mov_b32 v6, 0
    v_mov_b32 v7, 0
    v_mov_b32 v8, 0
    v_mov_b32 v9, 0
    v_mov_b32 v10, 0
    v_mov_b32 v11, 0
    v_mov_b32 v12, 0
    v_mov_b32 v13, 0
    v_mov_b32 v14, 0
    v_mov_b32 v15, 0
    v_mov_b32 v16, 0
    v_mov_b32 v17, 0
    v_mov_b32 v18, 0
    v_mov_b32 v19, 0
    v_mov_b32 v20, 0
    v_mov_b32 v21, 0
    s_mov_b32 s45, 0
    s_mov_b32 s47, 0
    s_waitcnt vmcnt(15)
    s_barrier
    ds_read_b128 v[30:33], v76 offset:0
    ds_read_b128 v[34:37], v76 offset:2048
    ds_read_b128 v[38:41], v76 offset:4096
    ds_read_b128 v[42:45], v76 offset:6144
    ds_read_b128 v[46:49], v76 offset:8192
    ds_read_b64_tr_b16 v[22:23], v75 offset:0
    ds_read_b64_tr_b16 v[24:25], v75 offset:512
    s_waitcnt lgkmcnt(0)
    v_mfma_f32_16x16x32_bf16 v[2:5], v[30:33], v[22:25], v[2:5]
    ds_read_b128 v[50:53], v77 offset:0
    ds_read_b128 v[54:57], v77 offset:2048
    ds_read_b128 v[58:61], v77 offset:4096
    v_mfma_f32_16x16x32_bf16 v[6:9], v[34:37], v[22:25], v[6:9]
    ds_read_b128 v[62:65], v77 offset:6144
    ds_read_b128 v[66:69], v77 offset:8192
    v_mfma_f32_16x16x32_bf16 v[10:13], v[38:41], v[22:25], v[10:13]
    ds_read_b64_tr_b16 v[26:27], v75 offset:4096
    ds_read_b64_tr_b16 v[28:29], v75 offset:4608
    v_mfma_f32_16x16x32_bf16 v[14:17], v[42:45], v[22:25], v[14:17]
    v_mfma_f32_16x16x32_bf16 v[18:21], v[46:49], v[22:25], v[18:21]
    s_add_u32 s47, s47, 1
    s_cmp_eq_u32 s47, 6
    s_mov_b32 s49, 20480
    s_cmov_b32 s49, 0xfffe7000
    s_cmov_b32 s47, 0
    s_waitcnt lgkmcnt(0)
    v_add_u32 v75, s49, v75
    v_add_u32 v76, s49, v76
    v_add_u32 v77, s49, v77
    s_waitcnt vmcnt(12)
    s_barrier
    v_mfma_f32_16x16x32_bf16 v[2:5], v[50:53], v[26:29], v[2:5]
    ds_read_b128 v[30:33], v76 offset:0
    ds_read_b128 v[34:37], v76 offset:2048
    ds_read_b128 v[38:41], v76 offset:4096
    s_add_u32 m0, s52, 0
    s_nop 0
    buffer_load_dwordx4 v70, s[8:11], s43 offen lds
    v_mfma_f32_16x16x32_bf16 v[6:9], v[54:57], v[26:29], v[6:9]
    ds_read_b128 v[42:45], v76 offset:6144
    ds_read_b128 v[46:49], v76 offset:8192
    s_add_u32 m0, s52, 1024
    s_nop 0
    buffer_load_dwordx4 v71, s[8:11], s43 offen lds
    v_mfma_f32_16x16x32_bf16 v[10:13], v[58:61], v[26:29], v[10:13]
    ds_read_b64_tr_b16 v[22:23], v75 offset:0
    ds_read_b64_tr_b16 v[24:25], v75 offset:512
    s_add_u32 m0, s53, 8192
    s_nop 0
    buffer_load_dwordx4 v72, s[4:7], s44 offen sc1 lds
    v_mfma_f32_16x16x32_bf16 v[14:17], v[62:65], v[26:29], v[14:17]
    s_add_u32 m0, s53, 9216
    s_nop 0
    buffer_load_dwordx4 v73, s[4:7], s44 offen sc1 lds
    v_mfma_f32_16x16x32_bf16 v[18:21], v[66:69], v[26:29], v[18:21]
    s_add_u32 m0, s53, 10240
    s_nop 0
    buffer_load_dwordx4 v74, s[4:7], s44 offen sc1 lds
    s_add_u32 s43, s43, 262144
    s_add_u32 s44, s44, 128
    s_add_u32 s46, s46, 20480
    s_cmp_eq_u32 s46, 122880
    s_cmov_b32 s46, 0
    s_add_u32 s52, s46, s54
    s_add_u32 s53, s46, s55
    s_waitcnt lgkmcnt(0)
    v_mfma_f32_16x16x32_bf16 v[2:5], v[30:33], v[22:25], v[2:5]
    ds_read_b128 v[50:53], v77 offset:0
    ds_read_b128 v[54:57], v77 offset:2048
    ds_read_b128 v[58:61], v77 offset:4096
    v_mfma_f32_16x16x32_bf16 v[6:9], v[34:37], v[22:25], v[6:9]
    ds_read_b128 v[62:65], v77 offset:6144
    ds_read_b128 v[66:69], v77 offset:8192
    v_mfma_f32_16x16x32_bf16 v[10:13], v[38:41], v[22:25], v[10:13]
    ds_read_b64_tr_b16 v[26:27], v75 offset:4096
    ds_read_b64_tr_b16 v[28:29], v75 offset:4608
    v_mfma_f32_16x16x32_bf16 v[14:17], v[42:45], v[22:25], v[14:17]
    v_mfma_f32_16x16x32_bf16 v[18:21], v[46:49], v[22:25], v[18:21]
    s_add_u32 s47, s47, 1
    s_cmp_eq_u32 s47, 6
    s_mov_b32 s49, 20480
    s_cmov_b32 s49, 0xfffe7000
    s_cmov_b32 s47, 0
    s_waitcnt lgkmcnt(0)
    v_add_u32 v75, s49, v75
    v_add_u32 v76, s49, v76
    v_add_u32 v77, s49, v77
    s_waitcnt vmcnt(14)
    s_barrier
    v_mfma_f32_16x16x32_bf16 v[2:5], v[50:53], v[26:29], v[2:5]
    ds_read_b128 v[30:33], v76 offset:0
    ds_read_b128 v[34:37], v76 offset:2048
    ds_read_b128 v[38:41], v76 offset:4096
    s_add_u32 m0, s52, 0
    s_nop 0
    buffer_load_dwordx4 v70, s[8:11], s43 offen lds
    v_mfma_f32_16x16x32_bf16 v[6:9], v[54:57], v[26:29], v[6:9]
    ds_read_b128 v[42:45], v76 offset:6144
    ds_read_b128 v[46:49], v76 offset:8192
    s_add_u32 m0, s52, 1024
    s_nop 0
    buffer_load_dwordx4 v71, s[8:11], s43 offen lds
    v_mfma_f32_16x16x32_bf16 v[10:13], v[58:61], v[26:29], v[10:13]
    ds_read_b64_tr_b16 v[22:23], v75 offset:0
    ds_read_b64_tr_b16 v[24:25], v75 offset:512
    s_add_u32 m0, s53, 8192
    s_nop 0
    buffer_load_dwordx4 v72, s[4:7], s44 offen sc1 lds
    v_mfma_f32_16x16x32_bf16 v[14:17], v[62:65], v[26:29], v[14:17]
    s_add_u32 m0, s53, 9216
    s_nop 0
    buffer_load_dwordx4 v73, s[4:7], s44 offen sc1 lds
    v_mfma_f32_16x16x32_bf16 v[18:21], v[66:69], v[26:29], v[18:21]
    s_add_u32 m0, s53, 10240
    s_nop 0
    buffer_load_dwordx4 v74, s[4:7], s44 offen sc1 lds
    s_add_u32 s43, s43, 262144
    s_add_u32 s44, s44, 128
    s_add_u32 s46, s46, 20480
    s_cmp_eq_u32 s46, 122880
    s_cmov_b32 s46, 0
    s_add_u32 s52, s46, s54
    s_add_u32 s53, s46, s55
    s_waitcnt lgkmcnt(0)
    v_mfma_f32_16x16x32_bf16 v[2:5], v[30:33], v[22:25], v[2:5]
    ds_read_b128 v[50:53], v77 offset:0
    ds_read_b128 v[54:57], v77 offset:2048
    ds_read_b128 v[58:61], v77 offset:4096
    v_mfma_f32_16x16x32_bf16 v[6:9], v[34:37], v[22:25], v[6:9]
    ds_read_b128 v[62:65], v77 offset:6144
    ds_read_b128 v[66:69], v77 offset:8192
    v_mfma_f32_16x16x32_bf16 v[10:13], v[38:41], v[22:25], v[10:13]
    ds_read_b64_tr_b16 v[26:27], v75 offset:4096
    ds_read_b64_tr_b16 v[28:29], v75 offset:4608
    v_mfma_f32_16x16x32_bf16 v[14:17], v[42:45], v[22:25], v[14:17]
    v_mfma_f32_16x16x32_bf16 v[18:21], v[46:49], v[22:25], v[18:21]
    s_add_u32 s47, s47, 1
    s_cmp_eq_u32 s47, 6
    s_mov_b32 s49, 20480
    s_cmov_b32 s49, 0xfffe7000
    s_cmov_b32 s47, 0
    s_waitcnt lgkmcnt(0)
    v_add_u32 v75, s49, v75
    v_add_u32 v76, s49, v76
    v_add_u32 v77, s49, v77
    s_waitcnt vmcnt(16)
    s_barrier
    v_mfma_f32_16x16x32_bf16 v[2:5], v[50:53], v[26:29], v[2:5]
    ds_read_b128 v[30:33], v76 offset:0
    ds_read_b128 v[34:37], v76 offset:2048
    ds_read_b128 v[38:41], v76 offset:4096
    s_add_u32 m0, s52, 0
    s_nop 0
    buffer_load_dwordx4 v70, s[8:11], s43 offen lds
    v_mfma_f32_16x16x32_bf16 v[6:9], v[54:57], v[26:29], v[6:9]
    ds_read_b128 v[42:45], v76 offset:6144
    ds_read_b128 v[46:49], v76 offset:8192
    s_add_u32 m0, s52, 1024
    s_nop 0
    buffer_load_dwordx4 v71, s[8:11], s43 offen lds
    v_mfma_f32_16x16x32_bf16 v[10:13], v[58:61], v[26:29], v[10:13]
    ds_read_b64_tr_b16 v[22:23], v75 offset:0
    ds_read_b64_tr_b16 v[24:25], v75 offset:512
    s_add_u32 m0, s53, 8192
    s_nop 0
    buffer_load_dwordx4 v72, s[4:7], s44 offen sc1 lds
    v_mfma_f32_16x16x32_bf16 v[14:17], v[62:65], v[26:29], v[14:17]
    s_add_u32 m0, s53, 9216
    s_nop 0
    buffer_load_dwordx4 v73, s[4:7], s44 offen sc1 lds
    v_mfma_f32_16x16x32_bf16 v[18:21], v[66:69], v[26:29], v[18:21]
    s_add_u32 m0, s53, 10240
    s_nop 0
    buffer_load_dwordx4 v74, s[4:7], s44 offen sc1 lds
    s_add_u32 s43, s43, 262144
    s_add_u32 s44, s44, 128
    s_add_u32 s46, s46, 20480
    s_cmp_eq_u32 s46, 122880
    s_cmov_b32 s46, 0
    s_add_u32 s52, s46, s54
    s_add_u32 s53, s46, s55
    s_waitcnt lgkmcnt(0)
    v_mfma_f32_16x16x32_bf16 v[2:5], v[30:33], v[22:25], v[2:5]
    ds_read_b128 v[50:53], v77 offset:0
    ds_read_b128 v[54:57], v77 offset:2048
    ds_read_b128 v[58:61], v77 offset:4096
    v_mfma_f32_16x16x32_bf16 v[6:9], v[34:37], v[22:25], v[6:9]
    ds_read_b128 v[62:65], v77 offset:6144
    ds_read_b128 v[66:69], v77 offset:8192
    v_mfma_f32_16x16x32_bf16 v[10:13], v[38:41], v[22:25], v[10:13]
    ds_read_b64_tr_b16 v[26:27], v75 offset:4096
    ds_read_b64_tr_b16 v[28:29], v75 offset:4608
    v_mfma_f32_16x16x32_bf16 v[14:17], v[42:45], v[22:25], v[14:17]
    v_mfma_f32_16x16x32_bf16 v[18:21], v[46:49], v[22:25], v[18:21]
    s_add_u32 s47, s47, 1
    s_cmp_eq_u32 s47, 6
    s_mov_b32 s49, 20480
    s_cmov_b32 s49, 0xfffe7000
    s_cmov_b32 s47, 0
    s_waitcnt lgkmcnt(0)
    v_add_u32 v75, s49, v75
    v_add_u32 v76, s49, v76
    v_add_u32 v77, s49, v77
    s_waitcnt vmcnt(18)
    s_barrier
    v_mfma_f32_16x16x32_bf16 v[2:5], v[50:53], v[26:29], v[2:5]
    ds_read_b128 v[30:33], v76 offset:0
    ds_read_b128 v[34:37], v76 offset:2048
    ds_read_b128 v[38:41], v76 offset:4096
    s_add_u32 m0, s52, 0
    s_nop 0
    buffer_load_dwordx4 v70, s[8:11], s43 offen lds
    v_mfma_f32_16x16x32_bf16 v[6:9], v[54:57], v[26:29], v[6:9]
    ds_read_b128 v[42:45], v76 offset:6144
    ds_read_b128 v[46:49], v76 offset:8192
    s_add_u32 m0, s52, 1024
    s_nop 0
    buffer_load_dwordx4 v71, s[8:11], s43 offen lds
    v_mfma_f32_16x16x32_bf16 v[10:13], v[58:61], v[26:29], v[10:13]
    ds_read_b64_tr_b16 v[22:23], v75 offset:0
    ds_read_b64_tr_b16 v[24:25], v75 offset:512
    s_add_u32 m0, s53, 8192
    s_nop 0
    buffer_load_dwordx4 v72, s[4:7], s44 offen sc1 lds
    v_mfma_f32_16x16x32_bf16 v[14:17], v[62:65], v[26:29], v[14:17]
    s_add_u32 m0, s53, 9216
    s_nop 0
    buffer_load_dwordx4 v73, s[4:7], s44 offen sc1 lds
    v_mfma_f32_16x16x32_bf16 v[18:21], v[66:69], v[26:29], v[18:21]
    s_add_u32 m0, s53, 10240
    s_nop 0
    buffer_load_dwordx4 v74, s[4:7], s44 offen sc1 lds
    s_add_u32 s43, s43, 262144
    s_add_u32 s44, s44, 128
    s_add_u32 s46, s46, 20480
    s_cmp_eq_u32 s46, 122880
    s_cmov_b32 s46, 0
    s_add_u32 s52, s46, s54
    s_add_u32 s53, s46, s55
    s_waitcnt lgkmcnt(0)
    s_mov_b32 s45, 4
L_gk_187:
    v_mfma_f32_16x16x32_bf16 v[2:5], v[30:33], v[22:25], v[2:5]
    ds_read_b128 v[50:53], v77 offset:0
    ds_read_b128 v[54:57], v77 offset:2048
    ds_read_b128 v[58:61], v77 offset:4096
    v_mfma_f32_16x16x32_bf16 v[6:9], v[34:37], v[22:25], v[6:9]
    ds_read_b128 v[62:65], v77 offset:6144
    ds_read_b128 v[66:69], v77 offset:8192
    v_mfma_f32_16x16x32_bf16 v[10:13], v[38:41], v[22:25], v[10:13]
    ds_read_b64_tr_b16 v[26:27], v75 offset:4096
    ds_read_b64_tr_b16 v[28:29], v75 offset:4608
    v_mfma_f32_16x16x32_bf16 v[14:17], v[42:45], v[22:25], v[14:17]
    v_mfma_f32_16x16x32_bf16 v[18:21], v[46:49], v[22:25], v[18:21]
    s_add_u32 s47, s47, 1
    s_cmp_eq_u32 s47, 6
    s_mov_b32 s49, 20480
    s_cmov_b32 s49, 0xfffe7000
    s_cmov_b32 s47, 0
    s_waitcnt lgkmcnt(0)
    v_add_u32 v75, s49, v75
    v_add_u32 v76, s49, v76
    v_add_u32 v77, s49, v77
    s_waitcnt vmcnt(20)
    s_barrier
    v_mfma_f32_16x16x32_bf16 v[2:5], v[50:53], v[26:29], v[2:5]
    ds_read_b128 v[30:33], v76 offset:0
    ds_read_b128 v[34:37], v76 offset:2048
    ds_read_b128 v[38:41], v76 offset:4096
    s_add_u32 m0, s52, 0
    s_nop 0
    buffer_load_dwordx4 v70, s[8:11], s43 offen lds
    v_mfma_f32_16x16x32_bf16 v[6:9], v[54:57], v[26:29], v[6:9]
    ds_read_b128 v[42:45], v76 offset:6144
    ds_read_b128 v[46:49], v76 offset:8192
    s_add_u32 m0, s52, 1024
    s_nop 0
    buffer_load_dwordx4 v71, s[8:11], s43 offen lds
    v_mfma_f32_16x16x32_bf16 v[10:13], v[58:61], v[26:29], v[10:13]
    ds_read_b64_tr_b16 v[22:23], v75 offset:0
    ds_read_b64_tr_b16 v[24:25], v75 offset:512
    s_add_u32 m0, s53, 8192
    s_nop 0
    buffer_load_dwordx4 v72, s[4:7], s44 offen sc1 lds
    v_mfma_f32_16x16x32_bf16 v[14:17], v[62:65], v[26:29], v[14:17]
    s_add_u32 m0, s53, 9216
    s_nop 0
    buffer_load_dwordx4 v73, s[4:7], s44 offen sc1 lds
    v_mfma_f32_16x16x32_bf16 v[18:21], v[66:69], v[26:29], v[18:21]
    s_add_u32 m0, s53, 10240
    s_nop 0
    buffer_load_dwordx4 v74, s[4:7], s44 offen sc1 lds
    s_add_u32 s43, s43, 262144
    s_add_u32 s44, s44, 128
    s_add_u32 s46, s46, 20480
    s_cmp_eq_u32 s46, 122880
    s_cmov_b32 s46, 0
    s_add_u32 s52, s46, s54
    s_add_u32 s53, s46, s55
    s_add_u32 s45, s45, 1
    s_cmp_lt_u32 s45, 21
    s_waitcnt lgkmcnt(0)
    s_cbranch_scc1 L_gk_187
    v_mfma_f32_16x16x32_bf16 v[2:5], v[30:33], v[22:25], v[2:5]
    ds_read_b128 v[50:53], v77 offset:0
    ds_read_b128 v[54:57], v77 offset:2048
    ds_read_b128 v[58:61], v77 offset:4096
    v_mfma_f32_16x16x32_bf16 v[6:9], v[34:37], v[22:25], v[6:9]
    ds_read_b128 v[62:65], v77 offset:6144
    ds_read_b128 v[66:69], v77 offset:8192
    v_mfma_f32_16x16x32_bf16 v[10:13], v[38:41], v[22:25], v[10:13]
    ds_read_b64_tr_b16 v[26:27], v75 offset:4096
    ds_read_b64_tr_b16 v[28:29], v75 offset:4608
    v_mfma_f32_16x16x32_bf16 v[14:17], v[42:45], v[22:25], v[14:17]
    v_mfma_f32_16x16x32_bf16 v[18:21], v[46:49], v[22:25], v[18:21]
    s_add_u32 s47, s47, 1
    s_cmp_eq_u32 s47, 6
    s_mov_b32 s49, 20480
    s_cmov_b32 s49, 0xfffe7000
    s_cmov_b32 s47, 0
    s_waitcnt lgkmcnt(0)
    v_add_u32 v75, s49, v75
    v_add_u32 v76, s49, v76
    v_add_u32 v77, s49, v77
    s_waitcnt vmcnt(20)
    s_barrier
    v_mfma_f32_16x16x32_bf16 v[2:5], v[50:53], v[26:29], v[2:5]
    ds_read_b128 v[30:33], v76 offset:0
    ds_read_b128 v[34:37], v76 offset:2048
    ds_read_b128 v[38:41], v76 offset:4096
    v_mfma_f32_16x16x32_bf16 v[6:9], v[54:57], v[26:29], v[6:9]
    ds_read_b128 v[42:45], v76 offset:6144
    ds_read_b128 v[46:49], v76 offset:8192
    v_mfma_f32_16x16x32_bf16 v[10:13], v[58:61], v[26:29], v[10:13]
    ds_read_b64_tr_b16 v[22:23], v75 offset:0
    ds_read_b64_tr_b16 v[24:25], v75 offset:512
    v_mfma_f32_16x16x32_bf16 v[14:17], v[62:65], v[26:29], v[14:17]
    v_mfma_f32_16x16x32_bf16 v[18:21], v[66:69], v[26:29], v[18:21]
    s_waitcnt lgkmcnt(0)
    v_mfma_f32_16x16x32_bf16 v[2:5], v[30:33], v[22:25], v[2:5]
    ds_read_b128 v[50:53], v77 offset:0
    ds_read_b128 v[54:57], v77 offset:2048
    ds_read_b128 v[58:61], v77 offset:4096
    v_mfma_f32_16x16x32_bf16 v[6:9], v[34:37], v[22:25], v[6:9]
    ds_read_b128 v[62:65], v77 offset:6144
    ds_read_b128 v[66:69], v77 offset:8192
    v_mfma_f32_16x16x32_bf16 v[10:13], v[38:41], v[22:25], v[10:13]
    ds_read_b64_tr_b16 v[26:27], v75 offset:4096
    ds_read_b64_tr_b16 v[28:29], v75 offset:4608
    v_mfma_f32_16x16x32_bf16 v[14:17], v[42:45], v[22:25], v[14:17]
    v_mfma_f32_16x16x32_bf16 v[18:21], v[46:49], v[22:25], v[18:21]
    s_add_u32 s47, s47, 1
    s_cmp_eq_u32 s47, 6
    s_mov_b32 s49, 20480
    s_cmov_b32 s49, 0xfffe7000
    s_cmov_b32 s47, 0
    s_waitcnt lgkmcnt(0)
    v_add_u32 v75, s49, v75
    v_add_u32 v76, s49, v76
    v_add_u32 v77, s49, v77
    s_waitcnt vmcnt(15)
    s_barrier
    v_mfma_f32_16x16x32_bf16 v[2:5], v[50:53], v[26:29], v[2:5]
    ds_read_b128 v[30:33], v76 offset:0
    ds_read_b128 v[34:37], v76 offset:2048
    ds_read_b128 v[38:41], v76 offset:4096
    v_mfma_f32_16x16x32_bf16 v[6:9], v[54:57], v[26:29], v[6:9]
    ds_read_b128 v[42:45], v76 offset:6144
    ds_read_b128 v[46:49], v76 offset:8192
    v_mfma_f32_16x16x32_bf16 v[10:13], v[58:61], v[26:29], v[10:13]
    ds_read_b64_tr_b16 v[22:23], v75 offset:0
    ds_read_b64_tr_b16 v[24:25], v75 offset:512
    v_mfma_f32_16x16x32_bf16 v[14:17], v[62:65], v[26:29], v[14:17]
    v_mfma_f32_16x16x32_bf16 v[18:21], v[66:69], v[26:29], v[18:21]
    s_waitcnt lgkmcnt(0)
    v_mfma_f32_16x16x32_bf16 v[2:5], v[30:33], v[22:25], v[2:5]
    ds_read_b128 v[50:53], v77 offset:0
    ds_read_b128 v[54:57], v77 offset:2048
    ds_read_b128 v[58:61], v77 offset:4096
    v_mfma_f32_16x16x32_bf16 v[6:9], v[34:37], v[22:25], v[6:9]
    ds_read_b128 v[62:65], v77 offset:6144
    ds_read_b128 v[66:69], v77 offset:8192
    v_mfma_f32_16x16x32_bf16 v[10:13], v[38:41], v[22:25], v[10:13]
    ds_read_b64_tr_b16 v[26:27], v75 offset:4096
    ds_read_b64_tr_b16 v[28:29], v75 offset:4608
    v_mfma_f32_16x16x32_bf16 v[14:17], v[42:45], v[22:25], v[14:17]
    v_mfma_f32_16x16x32_bf16 v[18:21], v[46:49], v[22:25], v[18:21]
    s_add_u32 s47, s47, 1
    s_cmp_eq_u32 s47, 6
    s_mov_b32 s49, 20480
    s_cmov_b32 s49, 0xfffe7000
    s_cmov_b32 s47, 0
    s_waitcnt lgkmcnt(0)
    v_add_u32 v75, s49, v75
    v_add_u32 v76, s49, v76
    v_add_u32 v77, s49, v77
    s_waitcnt vmcnt(10)
    s_barrier
    v_mfma_f32_16x16x32_bf16 v[2:5], v[50:53], v[26:29], v[2:5]
    ds_read_b128 v[30:33], v76 offset:0
    ds_read_b128 v[34:37], v76 offset:2048
    ds_read_b128 v[38:41], v76 offset:4096
    v_mfma_f32_16x16x32_bf16 v[6:9], v[54:57], v[26:29], v[6:9]
    ds_read_b128 v[42:45], v76 offset:6144
    ds_read_b128 v[46:49], v76 offset:8192
    v_mfma_f32_16x16x32_bf16 v[10:13], v[58:61], v[26:29], v[10:13]
    ds_read_b64_tr_b16 v[22:23], v75 offset:0
    ds_read_b64_tr_b16 v[24:25], v75 offset:512
    v_mfma_f32_16x16x32_bf16 v[14:17], v[62:65], v[26:29], v[14:17]
    v_mfma_f32_16x16x32_bf16 v[18:21], v[66:69], v[26:29], v[18:21]
    s_waitcnt lgkmcnt(0)
    v_mfma_f32_16x16x32_bf16 v[2:5], v[30:33], v[22:25], v[2:5]
    ds_read_b128 v[50:53], v77 offset:0
    ds_read_b128 v[54:57], v77 offset:2048
    ds_read_b128 v[58:61], v77 offset:4096
    v_mfma_f32_16x16x32_bf16 v[6:9], v[34:37], v[22:25], v[6:9]
    ds_read_b128 v[62:65], v77 offset:6144
    ds_read_b128 v[66:69], v77 offset:8192
    v_mfma_f32_16x16x32_bf16 v[10:13], v[38:41], v[22:25], v[10:13]
    ds_read_b64_tr_b16 v[26:27], v75 offset:4096
    ds_read_b64_tr_b16 v[28:29], v75 offset:4608
    v_mfma_f32_16x16x32_bf16 v[14:17], v[42:45], v[22:25], v[14:17]
    v_mfma_f32_16x16x32_bf16 v[18:21], v[46:49], v[22:25], v[18:21]
    s_add_u32 s47, s47, 1
    s_cmp_eq_u32 s47, 6
    s_mov_b32 s49, 20480
    s_cmov_b32 s49, 0xfffe7000
    s_cmov_b32 s47, 0
    s_waitcnt lgkmcnt(0)
    v_add_u32 v75, s49, v75
    v_add_u32 v76, s49, v76
    v_add_u32 v77, s49, v77
    s_waitcnt vmcnt(5)
    s_barrier
    v_mfma_f32_16x16x32_bf16 v[2:5], v[50:53], v[26:29], v[2:5]
    ds_read_b128 v[30:33], v76 offset:0
    ds_read_b128 v[34:37], v76 offset:2048
    ds_read_b128 v[38:41], v76 offset:4096
    v_mfma_f32_16x16x32_bf16 v[6:9], v[54:57], v[26:29], v[6:9]
    ds_read_b128 v[42:45], v76 offset:6144
    ds_read_b128 v[46:49], v76 offset:8192
    v_mfma_f32_16x16x32_bf16 v[10:13], v[58:61], v[26:29], v[10:13]
    ds_read_b64_tr_b16 v[22:23], v75 offset:0
    ds_read_b64_tr_b16 v[24:25], v75 offset:512
    v_mfma_f32_16x16x32_bf16 v[14:17], v[62:65], v[26:29], v[14:17]
    v_mfma_f32_16x16x32_bf16 v[18:21], v[66:69], v[26:29], v[18:21]
    s_waitcnt lgkmcnt(0)
    v_mfma_f32_16x16x32_bf16 v[2:5], v[30:33], v[22:25], v[2:5]
    ds_read_b128 v[50:53], v77 offset:0
    ds_read_b128 v[54:57], v77 offset:2048
    ds_read_b128 v[58:61], v77 offset:4096
    v_mfma_f32_16x16x32_bf16 v[6:9], v[34:37], v[22:25], v[6:9]
    ds_read_b128 v[62:65], v77 offset:6144
    ds_read_b128 v[66:69], v77 offset:8192
    v_mfma_f32_16x16x32_bf16 v[10:13], v[38:41], v[22:25], v[10:13]
    ds_read_b64_tr_b16 v[26:27], v75 offset:4096
    ds_read_b64_tr_b16 v[28:29], v75 offset:4608
    v_mfma_f32_16x16x32_bf16 v[14:17], v[42:45], v[22:25], v[14:17]
    v_mfma_f32_16x16x32_bf16 v[18:21], v[46:49], v[22:25], v[18:21]
    s_add_u32 s47, s47, 1
    s_cmp_eq_u32 s47, 6
    s_mov_b32 s49, 20480
    s_cmov_b32 s49, 0xfffe7000
    s_cmov_b32 s47, 0
    s_waitcnt lgkmcnt(0)
    v_add_u32 v75, s49, v75
    v_add_u32 v76, s49, v76
    v_add_u32 v77, s49, v77
    s_waitcnt vmcnt(0)
    s_barrier
    v_mfma_f32_16x16x32_bf16 v[2:5], v[50:53], v[26:29], v[2:5]
    ds_read_b128 v[30:33], v76 offset:0
    ds_read_b128 v[34:37], v76 offset:2048
    ds_read_b128 v[38:41], v76 offset:4096
    v_mfma_f32_16x16x32_bf16 v[6:9], v[54:57], v[26:29], v[6:9]
    ds_read_b128 v[42:45], v76 offset:6144
    ds_read_b128 v[46:49], v76 offset:8192
    v_mfma_f32_16x16x32_bf16 v[10:13], v[58:61], v[26:29], v[10:13]
    ds_read_b64_tr_b16 v[22:23], v75 offset:0
    ds_read_b64_tr_b16 v[24:25], v75 offset:512
    v_mfma_f32_16x16x32_bf16 v[14:17], v[62:65], v[26:29], v[14:17]
    v_mfma_f32_16x16x32_bf16 v[18:21], v[66:69], v[26:29], v[18:21]
    s_waitcnt lgkmcnt(0)
    v_mfma_f32_16x16x32_bf16 v[2:5], v[30:33], v[22:25], v[2:5]
    ds_read_b128 v[50:53], v77 offset:0
    ds_read_b128 v[54:57], v77 offset:2048
    ds_read_b128 v[58:61], v77 offset:4096
    v_mfma_f32_16x16x32_bf16 v[6:9], v[34:37], v[22:25], v[6:9]
    ds_read_b128 v[62:65], v77 offset:6144
    ds_read_b128 v[66:69], v77 offset:8192
    v_mfma_f32_16x16x32_bf16 v[10:13], v[38:41], v[22:25], v[10:13]
    ds_read_b64_tr_b16 v[26:27], v75 offset:4096
    ds_read_b64_tr_b16 v[28:29], v75 offset:4608
    v_mfma_f32_16x16x32_bf16 v[14:17], v[42:45], v[22:25], v[14:17]
    v_mfma_f32_16x16x32_bf16 v[18:21], v[46:49], v[22:25], v[18:21]
    s_waitcnt lgkmcnt(0)
    v_mfma_f32_16x16x32_bf16 v[2:5], v[50:53], v[26:29], v[2:5]
    v_mfma_f32_16x16x32_bf16 v[6:9], v[54:57], v[26:29], v[6:9]
    v_mfma_f32_16x16x32_bf16 v[10:13], v[58:61], v[26:29], v[10:13]
    v_mfma_f32_16x16x32_bf16 v[14:17], v[62:65], v[26:29], v[14:17]
    v_mfma_f32_16x16x32_bf16 v[18:21], v[66:69], v[26:29], v[18:21]
    s_waitcnt vmcnt(0)
    s_nop 7
    s_nop 3
    v_lshlrev_b32 v112, 16, v112
    s_barrier
    s_mul_i32 s48, s40, 2816
    s_add_u32 s48, s48, 0
    v_mul_u32_u24 v85, 176, v79
    v_lshl_add_u32 v85, v80, 3, v85
    v_add_u32 v85, s48, v85
    v_add_f32 v2, v2, v112
    v_mul_f32 v2, v2, v92
    v_add_f32 v3, v3, v112
    v_mul_f32 v3, v3, v93
    v_add_f32 v4, v4, v112
    v_mul_f32 v4, v4, v94
    v_add_f32 v5, v5, v112
    v_mul_f32 v5, v5, v95
    v_cvt_pk_bf16_f32 v2, v2, v3
    v_cvt_pk_bf16_f32 v3, v4, v5
    ds_write_b64 v85, v[2:3] offset:0
    v_add_f32 v6, v6, v112
    v_mul_f32 v6, v6, v96
    v_add_f32 v7, v7, v112
    v_mul_f32 v7, v7, v97
    v_add_f32 v8, v8, v112
    v_mul_f32 v8, v8, v98
    v_add_f32 v9, v9, v112
    v_mul_f32 v9, v9, v99
    v_cvt_pk_bf16_f32 v6, v6, v7
    v_cvt_pk_bf16_f32 v7, v8, v9
    ds_write_b64 v85, v[6:7] offset:32
    v_add_f32 v10, v10, v112
    v_mul_f32 v10, v10, v100
    v_add_f32 v11, v11, v112
    v_mul_f32 v11, v11, v101
    v_add_f32 v12, v12, v112
    v_mul_f32 v12, v12, v102
    v_add_f32 v13, v13, v112
    v_mul_f32 v13, v13, v103
    v_cvt_pk_bf16_f32 v10, v10, v11
    v_cvt_pk_bf16_f32 v11, v12, v13
    ds_write_b64 v85, v[10:11] offset:64
    v_add_f32 v14, v14, v112
    v_mul_f32 v14, v14, v104
    v_add_f32 v15, v15, v112
    v_mul_f32 v15, v15, v105
    v_add_f32 v16, v16, v112
    v_mul_f32 v16, v16, v106
    v_add_f32 v17, v17, v112
    v_mul_f32 v17, v17, v107
    v_cvt_pk_bf16_f32 v14, v14, v15
    v_cvt_pk_bf16_f32 v15, v16, v17
    ds_write_b64 v85, v[14:15] offset:96
    v_add_f32 v18, v18, v112
    v_mul_f32 v18, v18, v108
    v_add_f32 v19, v19, v112
    v_mul_f32 v19, v19, v109
    v_add_f32 v20, v20, v112
    v_mul_f32 v20, v20, v110
    v_add_f32 v21, v21, v112
    v_mul_f32 v21, v21, v111
    v_cvt_pk_bf16_f32 v18, v18, v19
    v_cvt_pk_bf16_f32 v19, v20, v21
    ds_write_b64 v85, v[18:19] offset:128
    v_mul_u32_u24 v82, 6554, v78
    v_lshrrev_b32 v82, 16, v82
    v_mul_u32_u24 v83, 10, v82
    v_sub_u32 v83, v78, v83
    v_mul_u32_u24 v86, 176, v82
    v_lshl_add_u32 v86, v83, 4, v86
    v_add_u32 v86, s48, v86
    s_mul_i32 s48, s41, 20480
    s_add_u32 s48, s48, s31
    s_waitcnt lgkmcnt(0)
    ds_read_b128 v[2:5], v86 offset:0
    ds_read_b128 v[6:9], v86 offset:1056
    ds_read_b128 v[10:13], v86 offset:2112
    s_waitcnt lgkmcnt(2)
    v_lshlrev_b32 v126, 16, v2
    v_lshlrev_b32 v127, 16, v114
    v_and_b32 v128, 0xffff0000, v2
    v_and_b32 v129, 0xffff0000, v114
    v_add_f32 v126, v126, v127
    v_add_f32 v128, v128, v129
    v_cvt_pk_bf16_f32 v2, v126, v128
    v_lshlrev_b32 v126, 16, v3
    v_lshlrev_b32 v127, 16, v115
    v_and_b32 v128, 0xffff0000, v3
    v_and_b32 v129, 0xffff0000, v115
    v_add_f32 v126, v126, v127
    v_add_f32 v128, v128, v129
    v_cvt_pk_bf16_f32 v3, v126, v128
    v_lshlrev_b32 v126, 16, v4
    v_lshlrev_b32 v127, 16, v116
    v_and_b32 v128, 0xffff0000, v4
    v_and_b32 v129, 0xffff0000, v116
    v_add_f32 v126, v126, v127
    v_add_f32 v128, v128, v129
    v_cvt_pk_bf16_f32 v4, v126, v128
    v_lshlrev_b32 v126, 16, v5
    v_lshlrev_b32 v127, 16, v117
    v_and_b32 v128, 0xffff0000, v5
    v_and_b32 v129, 0xffff0000, v117
    v_add_f32 v126, v126, v127
    v_add_f32 v128, v128, v129
    v_cvt_pk_bf16_f32 v5, v126, v128
    buffer_store_dwordx4 v[2:5], v88, s[16:19], s48 offen
    s_waitcnt lgkmcnt(1)
    v_lshlrev_b32 v126, 16, v6
    v_lshlrev_b32 v127, 16, v118
    v_and_b32 v128, 0xffff0000, v6
    v_and_b32 v129, 0xffff0000, v118
    v_add_f32 v126, v126, v127
    v_add_f32 v128, v128, v129
    v_cvt_pk_bf16_f32 v6, v126, v128
    v_lshlrev_b32 v126, 16, v7
    v_lshlrev_b32 v127, 16, v119
    v_and_b32 v128, 0xffff0000, v7
    v_and_b32 v129, 0xffff0000, v119
    v_add_f32 v126, v126, v127
    v_add_f32 v128, v128, v129
    v_cvt_pk_bf16_f32 v7, v126, v128
    v_lshlrev_b32 v126, 16, v8
    v_lshlrev_b32 v127, 16, v120
    v_and_b32 v128, 0xffff0000, v8
    v_and_b32 v129, 0xffff0000, v120
    v_add_f32 v126, v126, v127
    v_add_f32 v128, v128, v129
    v_cvt_pk_bf16_f32 v8, v126, v128
    v_lshlrev_b32 v126, 16, v9
    v_lshlrev_b32 v127, 16, v121
    v_and_b32 v128, 0xffff0000, v9
    v_and_b32 v129, 0xffff0000, v121
    v_add_f32 v126, v126, v127
    v_add_f32 v128, v128, v129
    v_cvt_pk_bf16_f32 v9, v126, v128
    buffer_store_dwordx4 v[6:9], v89, s[16:19], s48 offen
    s_waitcnt lgkmcnt(0)
    v_lshlrev_b32 v126, 16, v10
    v_lshlrev_b32 v127, 16, v122
    v_and_b32 v128, 0xffff0000, v10
    v_and_b32 v129, 0xffff0000, v122
    v_add_f32 v126, v126, v127
    v_add_f32 v128, v128, v129
    v_cvt_pk_bf16_f32 v10, v126, v128
    v_lshlrev_b32 v126, 16, v11
    v_lshlrev_b32 v127, 16, v123
    v_and_b32 v128, 0xffff0000, v11
    v_and_b32 v129, 0xffff0000, v123
    v_add_f32 v126, v126, v127
    v_add_f32 v128, v128, v129
    v_cvt_pk_bf16_f32 v11, v126, v128
    v_lshlrev_b32 v126, 16, v12
    v_lshlrev_b32 v127, 16, v124
    v_and_b32 v128, 0xffff0000, v12
    v_and_b32 v129, 0xffff0000, v124
    v_add_f32 v126, v126, v127
    v_add_f32 v128, v128, v129
    v_cvt_pk_bf16_f32 v12, v126, v128
    v_lshlrev_b32 v126, 16, v13
    v_lshlrev_b32 v127, 16, v125
    v_and_b32 v128, 0xffff0000, v13
    v_and_b32 v129, 0xffff0000, v125
    v_add_f32 v126, v126, v127
    v_add_f32 v128, v128, v129
    v_cvt_pk_bf16_f32 v13, v126, v128
    buffer_store_dwordx4 v[10:13], v90, s[16:19], s48 offen
    s_waitcnt vmcnt(0)
    s_barrier
L_next_104:
    s_cmp_eq_u32 s90, 0
    s_cbranch_scc1 L_notcw_188
    s_cmp_eq_u32 s90, 2
    s_cbranch_scc1 main_kernel_exit
    s_mov_b32 s90, 2
    s_add_u32 s76, s91, 192
    s_branch L_m2t_109
L_notcw_188:
    s_add_u32 s73, s73, 1
    s_add_u32 s75, s75, 192
    s_add_u32 s77, s75, 192
    s_cmp_lt_u32 s77, 1799
    s_cbranch_scc1 L_nopf_189
    s_cmp_ge_u32 s75, 1799
    s_cbranch_scc1 L_nopf_189
    s_load_dwordx2 s[8:9], s[0:1], 80
    s_load_dwordx2 s[12:13], s[0:1], 64
    v_and_b32 v1, 255, v0
    v_lshlrev_b32 v1, 7, v1
    s_waitcnt lgkmcnt(0)
    s_and_b32 s9, s9, 0xffff
    s_mov_b32 s10, 7077888
    s_mov_b32 s11, 0x20000
    s_and_b32 s13, s13, 0xffff
    s_mov_b32 s14, 7077888
    s_mov_b32 s15, 0x20000
    s_mul_i32 s77, s70, 65536
    buffer_load_dword v2, v1, s[8:11], s77 offen
    s_add_u32 s77, s77, 32768
    buffer_load_dword v3, v1, s[8:11], s77 offen
    s_add_u32 s77, s77, 32768
    s_mul_i32 s77, s70, 32768
    s_add_u32 s77, s77, 4423680
    buffer_load_dword v4, v1, s[12:15], s77 offen
    s_waitcnt vmcnt(0)
L_nopf_189:
    s_branch L_task_101
main_kernel_chain_done:
    s_waitcnt vmcnt(0) lgkmcnt(0)
    s_barrier
    v_mbcnt_lo_u32_b32 v0, -1, 0
    v_mbcnt_hi_u32_b32 v0, -1, v0
    s_lshl_b32 s77, s26, 6
    v_add_u32 v0, s77, v0
    s_lshl_b32 s76, s27, 5
    s_add_u32 s76, s76, s28
    s_mov_b32 s90, 1
    s_mov_b32 s91, s76
    s_mov_b32 s70, 191
    s_branch L_m1b_108
L_wend_107:
main_kernel_exit:
main_kernel_xtra:
    s_endpgm
.section .rodata,"a"
.p2align 6
.amdhsa_kernel main_kernel
  .amdhsa_next_free_vgpr 512
  .amdhsa_next_free_sgpr 102
  .amdhsa_accum_offset 256
  .amdhsa_group_segment_fixed_size 0
  .amdhsa_kernarg_size 136
  .amdhsa_user_sgpr_count 2
  .amdhsa_user_sgpr_kernarg_segment_ptr 1
  .amdhsa_system_sgpr_workgroup_id_x 1
  .amdhsa_float_denorm_mode_32 3
.end_amdhsa_kernel
```
